```python
import torch

def _softmax(x, axis=-1):
    return torch.softmax(x, dim=axis)

def _gelu(x):
    return torch.nn.functional.gelu(x, approximate='tanh')

def _silu(x):
    return torch.nn.functional.silu(x)

def _sigmoid(x):
    return torch.sigmoid(x)

def _layernorm(x, axis=-1, eps=1e-05):
    m = x.mean(dim=axis, keepdim=True)
    v = x.var(dim=axis, keepdim=True, unbiased=False)
    return (x - m) / torch.sqrt(v + eps)

def _scatter_add(tgt, idx, src, axis=0):
    return tgt.clone().index_add_(axis, idx, src)

def _segment_sum(src, seg, n):
    out = torch.zeros((n,) + src.shape[1:], dtype=src.dtype)
    return out.index_add_(0, seg, src)

def _pad(x, pw):
    flat = tuple((v for pair in reversed(pw) for v in pair))
    return torch.nn.functional.pad(x, flat)
kernel_name = 'recurrent_scan__memory_aug_recurrent_mem_tr__dense_activation_squared_relu__prompt'

def setup_inputs():

    _w = lambda a: (lambda t: t.to(torch.bfloat16) if t.is_floating_point() else t)(torch.as_tensor(a))

    def _A_setup():
        B, S, Dm = (1, 2048, 512)
        H, Dh = (32, 128)
        M, seg = (8, 32)
        seg = min(seg, S)
        S = S // seg * seg
        return {'x': _w((lambda *s: torch.randn(*s, dtype=torch.bfloat16) * 0.05)(B, S, Dm)), 'mem0': _w((lambda *s: torch.randn(*s, dtype=torch.bfloat16) * 0.2)(B, M, Dm)), 'Wq': _w((lambda *s: torch.randn(*s, dtype=torch.bfloat16) * 1.6)(Dm, H, Dh) * Dm ** (-0.5)), 'Wk': _w((lambda *s: torch.randn(*s, dtype=torch.bfloat16) * 1.6)(Dm, H, Dh) * Dm ** (-0.5)), 'Wv': _w((lambda *s: torch.randn(*s, dtype=torch.bfloat16) * 0.2)(Dm, H, Dh) * Dm ** (-0.5)), 'Wo': _w((lambda *s: torch.randn(*s, dtype=torch.bfloat16) * 0.2)(H, Dh, Dm) * (H * Dh) ** (-0.5)), 'seg_len': seg}
    _A_in = _A_setup()

    def _B_setup():
        B, S, D, F = (1, 2048, 512, 1376)
        return {'x': _w((lambda *s: torch.randn(*s, dtype=torch.bfloat16) * 0.05)(B, S, D)), 'w1': _w((lambda *s: torch.randn(*s, dtype=torch.bfloat16) * 0.1)(D, F)), 'b1': _w((lambda *s: torch.randn(*s, dtype=torch.bfloat16) * 0.8)(F)), 'w2': _w((lambda *s: torch.randn(*s, dtype=torch.bfloat16) * 0.1)(F, D)), 'b2': _w((lambda *s: torch.randn(*s, dtype=torch.bfloat16) * 12.8)(D))}
    _B_in = _B_setup()
    return {'A_x': _A_in['x'], 'A_mem0': _A_in['mem0'], 'A_Wq': _A_in['Wq'], 'A_Wk': _A_in['Wk'], 'A_Wv': _A_in['Wv'], 'A_Wo': _A_in['Wo'], 'A_seg_len': _A_in['seg_len'], 'B_x': _B_in['x'], 'B_w1': _B_in['w1'], 'B_b1': _B_in['b1'], 'B_w2': _B_in['w2'], 'B_b2': _B_in['b2']}

def reference(A_x, A_mem0, A_Wq, A_Wk, A_Wv, A_Wo, A_seg_len, B_x, B_w1, B_b1, B_w2, B_b2):

    def _A_ref(x, mem0, Wq, Wk, Wv, Wo, seg_len):
        B, S, Dm = x.shape
        H, Dh = (Wq.shape[1], Wq.shape[2])
        M = mem0.shape[1]
        scale = Dh ** (-0.5)
        n_seg = S // seg_len
        L = M + seg_len
        idx = torch.arange(L)
        mask = (idx[:, None] < M) | (idx[:, None] >= idx[None, :])
        mem = mem0
        outs = []
        for s in range(n_seg):
            xs = x[:, s * seg_len:(s + 1) * seg_len, :].clone()
            h = torch.concatenate([mem, xs], axis=1)
            q = torch.einsum('btd,dhe->bhte', h, Wq)
            k = torch.einsum('btd,dhe->bhte', h, Wk)
            v = torch.einsum('btd,dhe->bhte', h, Wv)
            scores = torch.einsum('bhqe,bhke->bhqk', q, k) * scale
            scores = torch.where(mask[None, None], scores, -1000000000.0)
            p = _softmax(scores, axis=-1)
            o = torch.einsum('bhqk,bhke->bhqe', p, v)
            o = torch.einsum('bhte,hed->btd', o, Wo)
            mem = o[:, :M, :].clone()
            outs.append(o[:, M:, :])
        return torch.concatenate(outs, axis=1)

    def _B_ref(x, w1, b1, w2, b2):
        h = torch.einsum('bsd,df->bsf', x, w1) + b1
        zero = torch.zeros_like(h)
        r = torch.where(h > zero, h, zero)
        h = r * r
        out = torch.einsum('bsf,fd->bsd', h, w2) + b2
        return out
    x = A_x
    xn = _layernorm(x, axis=-1)
    s = _A_ref(xn, A_mem0, A_Wq, A_Wk, A_Wv, A_Wo, A_seg_len)
    g = _silu(_B_ref(xn, B_w1, B_b1, B_w2, B_b2))
    return x + s * g
```

```asm
; @launch kernel=fused_kernel grid=(256,1,1) block=(256,1,1) lds=163840
.amdgcn_target "amdgcn-amd-amdhsa--gfx950"
.text
.globl fused_kernel
.p2align 8
.type fused_kernel,@function
fused_kernel:
    s_cmp_ge_u32 s2, 256
    s_cbranch_scc1 F_exit
    s_load_dwordx2 s[4:5], s[0:1], 104
    s_load_dwordx2 s[6:7], s[0:1], 112
    s_load_dwordx2 s[20:21], s[0:1], 0
    s_getreg_b32 s3, hwreg(HW_REG_XCC_ID)
    s_and_b32 s3, s3, 7
    v_and_b32 v1, 63, v0
    v_lshrrev_b32 v2, 6, v0
    s_nop 0
    v_readfirstlane_b32 s17, v2
    v_lshlrev_b32 v4, 4, v1
    s_waitcnt lgkmcnt(0)
    s_lshl_b32 s19, s3, 2
    s_lshr_b32 s3, 0x43216507, s19
    s_and_b32 s3, s3, 7
    s_mov_b32 s8, s6
    s_and_b32 s9, s7, 0xffff
    s_mov_b32 s10, 0x10000000
    s_mov_b32 s11, 0x00020000
    s_mov_b32 s12, s4
    s_and_b32 s13, s5, 0xffff
    s_mov_b32 s14, 0x100
    s_mov_b32 s15, 0x00020000
    s_cmp_lg_u32 s2, 255
    s_cbranch_scc1 F_nozero
    v_lshlrev_b32 v5, 4, v0
    v_mov_b32 v8, 0
    v_mov_b32 v9, 0
    v_mov_b32 v10, 0
    v_mov_b32 v11, 0
    s_mov_b32 s19, 0x90000
    buffer_store_dwordx4 v[8:11], v5, s[8:11], s19 offen sc1
    s_mov_b32 s19, 0x91000
    buffer_store_dwordx4 v[8:11], v5, s[8:11], s19 offen sc1
    s_mov_b32 s19, 0x92000
    buffer_store_dwordx4 v[8:11], v5, s[8:11], s19 offen sc1
    s_mov_b32 s19, 0x93000
    buffer_store_dwordx4 v[8:11], v5, s[8:11], s19 offen sc1
    s_mov_b32 s19, 0x94000
    buffer_store_dwordx4 v[8:11], v5, s[8:11], s19 offen sc1
    s_mov_b32 s19, 0x95000
    buffer_store_dwordx4 v[8:11], v5, s[8:11], s19 offen sc1
    s_mov_b32 s19, 0x96000
    buffer_store_dwordx4 v[8:11], v5, s[8:11], s19 offen sc1
    F_nozero:
    s_bfe_u32 s16, s2, 0x50003
    s_cmp_lg_u32 s17, 0
    s_cbranch_scc1 F_noclaim
    s_lshl_b32 s19, s3, 2
    v_mov_b32 v5, s19
    s_lshl_b32 s19, 1, s16
    v_mov_b32 v124, s19
    s_mov_b64 exec, 1
    buffer_atomic_or v124, v5, s[12:15], 0 offen offset:64 sc0 sc1
    s_mov_b64 exec, -1
    F_noclaim:
    s_lshl_b32 s19, s3, 5
    s_add_u32 s16, s16, s19
    s_mov_b32 s18, 0
    F_dispatch:
    s_cmp_ge_u32 s16, 32
    s_cbranch_scc1 F_worker
    s_lshl_b32 s29, s16, 7
    s_add_u32 s29, s29, 0x90000
    s_lshl_b32 s28, s17, 2
    s_add_u32 s28, s28, s29
    s_add_u32 s28, s28, 8288
    v_and_b32 v120, 63, v0
    v_and_b32 v116, 15, v120
    v_lshrrev_b32 v117, 4, v120
    v_lshrrev_b32 v118, 2, v116
    v_and_b32 v119, 3, v116
    v_lshlrev_b32 v1, 4, v120
    s_mul_i32 s36, s17, 36864
    v_add_u32 v8, s36, v1
    s_load_dwordx8 s[84:91], s[0:1], 16
    s_load_dwordx2 s[92:93], s[0:1], 8
    v_and_b32 v26, 1, v117
    v_bfe_u32 v28, v120, 3, 1
    v_lshrrev_b32 v29, 5, v120
    v_and_b32 v27, 7, v120
    v_lshlrev_b32 v27, 4, v27
    v_lshl_add_u32 v24, v29, 3, v26
    v_lshl_add_u32 v24, v28, 4, v24
    v_lshl_add_u32 v24, v24, 13, v27
    s_lshl_b32 s19, s16, 8
    s_lshr_b32 s20, s17, 1
    s_lshl_b32 s20, s20, 7
    s_add_u32 s19, s19, s20
    v_add_u32 v24, s19, v24
    v_lshl_add_u32 v25, v29, 2, v28
    v_lshl_add_u32 v25, v26, 4, v25
    v_lshl_add_u32 v25, v25, 10, v27
    s_lshl_b32 s19, s17, 8
    v_add_u32 v25, s19, v25
    s_waitcnt lgkmcnt(0)
    s_mov_b32 s44, s84
    s_and_b32 s45, s85, 0xffff
    s_mov_b32 s46, 0x400000
    s_mov_b32 s47, 0x00020000
    s_mov_b32 s48, s86
    s_and_b32 s49, s87, 0xffff
    s_mov_b32 s50, 0x400000
    s_mov_b32 s51, 0x00020000
    s_mov_b32 s52, s88
    s_and_b32 s53, s89, 0xffff
    s_mov_b32 s54, 0x400000
    s_mov_b32 s55, 0x00020000
    s_mov_b32 s56, s90
    s_and_b32 s57, s91, 0xffff
    s_mov_b32 s58, 0x400000
    s_mov_b32 s59, 0x00020000
    s_mov_b32 s60, s92
    s_and_b32 s61, s93, 0xffff
    s_mov_b32 s62, 0x2000
    s_mov_b32 s63, 0x00020000
    s_xor_b32 s19, s17, 0
    s_and_b32 s20, s19, 1
    s_lshl_b32 s20, s20, 21
    s_lshr_b32 s19, s19, 1
    s_xor_b32 s19, s19, 1
    s_lshl_b32 s19, s19, 18
    s_add_u32 s40, s19, s20
    s_xor_b32 s19, s17, 1
    s_and_b32 s20, s19, 1
    s_lshl_b32 s20, s20, 21
    s_lshr_b32 s19, s19, 1
    s_xor_b32 s19, s19, 1
    s_lshl_b32 s19, s19, 18
    s_add_u32 s41, s19, s20
    s_xor_b32 s19, s17, 2
    s_and_b32 s20, s19, 1
    s_lshl_b32 s20, s20, 21
    s_lshr_b32 s19, s19, 1
    s_xor_b32 s19, s19, 1
    s_lshl_b32 s19, s19, 18
    s_add_u32 s42, s19, s20
    s_xor_b32 s19, s17, 3
    s_and_b32 s20, s19, 1
    s_lshl_b32 s20, s20, 21
    s_lshr_b32 s19, s19, 1
    s_xor_b32 s19, s19, 1
    s_lshl_b32 s19, s19, 18
    s_add_u32 s43, s19, s20
    s_lshr_b32 s19, s17, 1
    s_lshl_b32 s19, s19, 16
    s_lshl_b32 s38, s16, 17
    s_add_u32 s38, s38, s19
    s_and_b32 s19, s17, 1
    s_lshl_b32 s19, s19, 15
    s_add_u32 s38, s38, s19
    s_add_u32 s19, s40, 524288
    buffer_load_dwordx4 a[96:99], v24, s[48:51], s19 offen
    s_add_u32 s19, s40, 540672
    buffer_load_dwordx4 a[100:103], v24, s[48:51], s19 offen
    s_add_u32 s19, s40, 557056
    buffer_load_dwordx4 a[104:107], v24, s[48:51], s19 offen
    s_add_u32 s19, s40, 573440
    buffer_load_dwordx4 a[108:111], v24, s[48:51], s19 offen
    s_add_u32 s19, s40, 1572864
    buffer_load_dwordx4 a[128:131], v24, s[48:51], s19 offen
    s_add_u32 s19, s40, 1589248
    buffer_load_dwordx4 a[132:135], v24, s[48:51], s19 offen
    s_add_u32 s19, s40, 1605632
    buffer_load_dwordx4 a[136:139], v24, s[48:51], s19 offen
    s_add_u32 s19, s40, 1622016
    buffer_load_dwordx4 a[140:143], v24, s[48:51], s19 offen
    s_xor_b32 s19, s38, 0x0
    s_add_u32 s19, s19, 0
    buffer_load_dwordx4 v[160:163], v25, s[56:59], s19 offen
    s_xor_b32 s19, s38, 0x8000
    s_add_u32 s19, s19, 0
    buffer_load_dwordx4 v[164:167], v25, s[56:59], s19 offen
    s_xor_b32 s19, s38, 0x0
    s_add_u32 s19, s19, 2048
    buffer_load_dwordx4 v[168:171], v25, s[56:59], s19 offen
    s_xor_b32 s19, s38, 0x8000
    s_add_u32 s19, s19, 2048
    buffer_load_dwordx4 v[172:175], v25, s[56:59], s19 offen
    s_xor_b32 s19, s38, 0x0
    s_add_u32 s19, s19, 8192
    buffer_load_dwordx4 v[192:195], v25, s[56:59], s19 offen
    s_xor_b32 s19, s38, 0x8000
    s_add_u32 s19, s19, 8192
    buffer_load_dwordx4 v[196:199], v25, s[56:59], s19 offen
    s_xor_b32 s19, s38, 0x0
    s_add_u32 s19, s19, 10240
    buffer_load_dwordx4 v[200:203], v25, s[56:59], s19 offen
    s_xor_b32 s19, s38, 0x8000
    s_add_u32 s19, s19, 10240
    buffer_load_dwordx4 v[204:207], v25, s[56:59], s19 offen
    v_lshl_add_u32 v27, v117, 2, v118
    v_lshlrev_b32 v27, 6, v27
    v_lshl_add_u32 v27, v26, 5, v27
    v_lshl_add_u32 v27, v119, 3, v27
    v_add_u32 v27, s36, v27
    v_xor_b32 v28, 32, v27
    s_lshl_b32 s39, s17, 12
    s_add_u32 s39, s39, 0x24000
    s_sub_u32 s19, s39, s36
    v_add_u32 v44, s19, v27
    v_add_u32 v45, s19, v28
    v_xor_b32 v38, 0x1000, v44
    v_xor_b32 v39, 0x1000, v45
    v_lshrrev_b32 v30, 3, v120
    v_lshlrev_b32 v40, 1, v29
    v_xor_b32 v40, v40, v119
    v_lshlrev_b32 v40, 4, v40
    v_lshl_add_u32 v40, v30, 6, v40
    v_bfe_u32 v31, v120, 2, 1
    s_and_b32 s19, s17, 1
    v_cmp_eq_u32 s[94:95], s19, v31
    v_and_b32 v30, 1, v30
    v_lshl_add_u32 v41, v117, 2, v30
    v_and_b32 v30, 2, v120
    v_add_u32 v41, v41, v30
    v_lshlrev_b32 v41, 6, v41
    v_lshl_add_u32 v41, v26, 5, v41
    v_and_b32 v30, 1, v120
    v_lshl_add_u32 v41, v30, 4, v41
    s_barrier
    v_bfe_u32 v30, v120, 1, 1
    v_mov_b32 v3, 0x44444444
    v_mov_b32 v31, 0xeeeeeeee
    v_cmp_ne_u32 vcc, 0, v30
    s_nop 1
    v_cndmask_b32 v3, v3, v31, vcc
    v_and_b32 v32, 1, v116
    v_lshl_add_u32 v31, v118, 1, v32
    v_lshrrev_b32 v35, 1, v117
    v_add_u32 v2, 0x24000, v1
    v_lshlrev_b32 v33, 4, v116
    v_lshl_add_u32 v33, v35, 8, v33
    v_lshl_add_u32 v33, v26, 2, v33
    s_and_b32 s19, s17, 1
    s_lshl_b32 s19, s19, 9
    s_lshr_b32 s20, s17, 1
    s_lshl_b32 s20, s20, 3
    s_add_u32 s19, s19, s20
    s_add_u32 s19, s19, 0x24000
    v_add_u32 v11, s19, v33
    v_lshlrev_b32 v9, 10, v30
    v_lshl_add_u32 v9, v117, 8, v9
    v_lshl_add_u32 v9, v31, 4, v9
    v_lshrrev_b32 v30, 3, v116
    v_lshlrev_b32 v4, 12, v117
    v_lshl_add_u32 v4, v116, 2, v4
    v_and_b32 v33, 7, v116
    s_lshl_b32 s19, s17, 10
    s_add_u32 s19, s19, 0x27000
    v_lshlrev_b32 v33, 3, v33
    v_lshl_add_u32 v33, v30, 8, v33
    v_add_u32 v33, s19, v33
    v_xor_b32 v36, v117, v30
    v_lshl_add_u32 v6, v36, 6, v33
    v_lshlrev_b32 v33, 8, v35
    v_xor_b32 v36, v119, v35
    v_lshl_add_u32 v33, v36, 6, v33
    v_lshl_add_u32 v33, v26, 5, v33
    v_lshl_add_u32 v33, v118, 3, v33
    v_add_u32 v10, 0x27000, v33
    v_mov_b32 v0, 0x3e0293ee
    v_mov_b32 v7, 0
    v_and_b32 v33, 0xc, v120
    v_cmp_ne_u32 vcc, 0, v33
    s_lshr_b32 s22, s16, 3
    s_lshl_b32 s19, s17, 11
    s_xor_b32 s19, s19, 0x800
    v_lshlrev_b32 v5, 4, v117
    v_lshl_add_u32 v5, v119, 2, v5
    s_lshl_b32 s20, s16, 6
    s_add_u32 s19, s19, s20
    v_and_b32 v33, 2, v120
    v_lshlrev_b32 v125, 3, v33
    v_lshl_add_u32 v125, v26, 5, v125
    v_lshl_add_u32 v125, v31, 6, v125
    v_lshl_add_u32 v125, v35, 9, v125
    v_add_u32 v5, s19, v5
    v_mov_b32 v33, 0x7fffff00
    v_cndmask_b32 v5, v5, v33, vcc
    v_lshlrev_b32 v33, 1, v117
    v_lshl_add_u32 v33, v119, 3, v33
    s_lshl_b32 s19, s22, 8
    s_lshl_b32 s20, s17, 6
    s_add_u32 s19, s19, s20
    s_and_b32 s20, s16, 7
    s_lshl_b32 s20, s20, 10
    s_add_u32 s19, s19, s20
    buffer_load_ushort v34, v33, s[60:63], s19 offen
    buffer_load_ushort v35, v33, s[60:63], s19 offen offset:32
    v_mov_b64 v[48:49], 0
    v_mov_b64 v[50:51], 0
    s_lshl_b32 s19, s16, 13
    s_lshl_b32 s20, s17, 11
    s_add_u32 s19, s19, s20
    s_add_u32 s32, s19, 0x1400000
    s_lshl_b32 s19, s17, 16
    s_lshl_b32 s20, s16, 11
    s_add_u32 s19, s19, s20
    s_add_u32 s25, s19, 0x0
    s_add_u32 s26, s25, 0x40000
    s_lshl_b32 s19, s17, 14
    s_mul_i32 s20, s16, 64
    s_add_u32 s19, s19, s20
    s_add_u32 s27, s19, 0x0
    s_lshl_b32 s19, s16, 13
    s_lshr_b32 s20, s17, 1
    s_lshl_b32 s20, s20, 12
    s_add_u32 s19, s19, s20
    s_and_b32 s20, s17, 1
    s_lshl_b32 s20, s20, 7
    s_add_u32 s19, s19, s20
    s_add_u32 s31, s19, 0x400000
    s_lshl_b32 s19, s16, 12
    s_lshl_b32 s20, s17, 10
    s_add_u32 s19, s19, s20
    s_add_u32 s34, s19, 0x3400000
    s_mov_b32 s33, 0x7ff00000
    v_bfe_u32 v31, v120, 2, 1
    v_cmp_ne_u32 vcc, 0, v31
    s_add_u32 s19, s36, 16384
    v_mov_b32 v42, s19
    v_mov_b32 v43, s39
    v_cndmask_b32 v42, v43, v42, s[94:95]
    v_add_u32 v42, v42, v40
    s_waitcnt vmcnt(10)
    ds_write_b128 v42, a[96:99] offset:0
    ds_write_b128 v42, a[100:103] offset:512
    ds_write_b128 v42, a[104:107] offset:1024
    ds_write_b128 v42, a[108:111] offset:1536
    ds_write_b128 v42, a[128:131] offset:2048
    ds_write_b128 v42, a[132:135] offset:2560
    ds_write_b128 v42, a[136:139] offset:3072
    ds_write_b128 v42, a[140:143] offset:3584
    s_waitcnt lgkmcnt(0)
    s_barrier
    ds_read_b64_tr_b16 a[128:129], v38 offset:0
    ds_read_b64_tr_b16 a[130:131], v38 offset:1024
    ds_read_b64_tr_b16 a[132:133], v38 offset:2048
    ds_read_b64_tr_b16 a[134:135], v38 offset:3072
    ds_read_b64_tr_b16 a[136:137], v39 offset:0
    ds_read_b64_tr_b16 a[138:139], v39 offset:1024
    ds_read_b64_tr_b16 a[140:141], v39 offset:2048
    ds_read_b64_tr_b16 a[142:143], v39 offset:3072
    ds_read_b64_tr_b16 a[96:97], v27 offset:16384
    ds_read_b64_tr_b16 a[98:99], v27 offset:17408
    ds_read_b64_tr_b16 a[100:101], v27 offset:18432
    ds_read_b64_tr_b16 a[102:103], v27 offset:19456
    ds_read_b64_tr_b16 a[104:105], v28 offset:16384
    ds_read_b64_tr_b16 a[106:107], v28 offset:17408
    ds_read_b64_tr_b16 a[108:109], v28 offset:18432
    ds_read_b64_tr_b16 a[110:111], v28 offset:19456
    s_waitcnt lgkmcnt(8)
    s_barrier
    s_waitcnt lgkmcnt(0)
    s_cmp_lg_u32 s18, 0
    s_cbranch_scc1 CN_1_ok
    v_mov_b32 v30, 0x2000
    s_cmp_lg_u32 s17, 0
    s_cbranch_scc1 CN_1_a
    s_mov_b64 exec, 1
    ds_write_b32 v30, v124
    s_mov_b64 exec, -1
    CN_1_a:
    s_waitcnt lgkmcnt(0)
    s_barrier
    ds_read_b32 v31, v30
    s_cmp_lg_u32 s2, 255
    s_cbranch_scc1 CN_1_b
    s_cmp_lg_u32 s17, 0
    s_cbranch_scc1 CN_1_b
    v_mov_b32 v30, 192
    v_mov_b32 v124, 1
    s_mov_b64 exec, 1
    buffer_store_dword v124, v30, s[12:15], 0 offen sc1
    s_mov_b64 exec, -1
    CN_1_b:
    s_waitcnt lgkmcnt(0)
    v_readfirstlane_b32 s19, v31
    s_nop 0
    s_bitcmp1_b32 s19, s16
    s_cbranch_scc1 F_loser
    CN_1_ok:
    v_mov_b32 v20, -1
    v_mov_b32 v21, -1
    v_mov_b32 v22, -1
    v_mov_b32 v23, -1
    buffer_store_dwordx4 v[20:23], v1, s[8:11], s25 offen offset:0 sc1
    buffer_store_dwordx4 v[20:23], v1, s[8:11], s25 offen offset:1024 sc1
    buffer_store_dwordx4 v[20:23], v1, s[8:11], s26 offen offset:0 sc1
    buffer_store_dwordx4 v[20:23], v1, s[8:11], s26 offen offset:1024 sc1
    s_mov_b32 s19, 0x82000
    buffer_store_dword v20, v5, s[8:11], s19 offen sc1
    s_mov_b32 s19, 0x84000
    buffer_store_dword v20, v5, s[8:11], s19 offen sc1
    s_mov_b32 s19, 0x86000
    buffer_store_dword v20, v5, s[8:11], s19 offen sc1
    s_add_u32 s19, s40, 0
    buffer_load_dwordx4 v[52:55], v24, s[48:51], s19 offen
    s_add_u32 s19, s40, 16384
    buffer_load_dwordx4 v[56:59], v24, s[48:51], s19 offen
    s_add_u32 s19, s40, 32768
    buffer_load_dwordx4 v[60:63], v24, s[48:51], s19 offen
    s_add_u32 s19, s40, 49152
    buffer_load_dwordx4 v[64:67], v24, s[48:51], s19 offen
    s_add_u32 s19, s40, 1048576
    buffer_load_dwordx4 a[112:115], v24, s[48:51], s19 offen
    s_add_u32 s19, s40, 1064960
    buffer_load_dwordx4 a[116:119], v24, s[48:51], s19 offen
    s_add_u32 s19, s40, 1081344
    buffer_load_dwordx4 a[120:123], v24, s[48:51], s19 offen
    s_add_u32 s19, s40, 1097728
    buffer_load_dwordx4 a[124:127], v24, s[48:51], s19 offen
    v_mov_b32 v42, s39
    s_add_u32 s19, s36, 16384
    v_mov_b32 v43, s19
    v_cndmask_b32 v42, v42, v43, vcc
    v_add_u32 v42, v42, v41
    v_xor_b32 v43, 32, v42
    s_waitcnt vmcnt(17)
    ds_write_b128 v42, v[160:163] offset:0
    ds_write_b128 v43, v[164:167] offset:0
    ds_write_b128 v42, v[168:171] offset:1024
    ds_write_b128 v43, v[172:175] offset:1024
    ds_write_b128 v42, v[192:195] offset:2048
    ds_write_b128 v43, v[196:199] offset:2048
    ds_write_b128 v42, v[200:203] offset:3072
    ds_write_b128 v43, v[204:207] offset:3072
    s_waitcnt lgkmcnt(0)
    ds_read_b64_tr_b16 v[192:193], v27 offset:16384
    ds_read_b64_tr_b16 v[194:195], v27 offset:17408
    ds_read_b64_tr_b16 v[196:197], v27 offset:18432
    ds_read_b64_tr_b16 v[198:199], v27 offset:19456
    ds_read_b64_tr_b16 v[200:201], v28 offset:16384
    ds_read_b64_tr_b16 v[202:203], v28 offset:17408
    ds_read_b64_tr_b16 v[204:205], v28 offset:18432
    ds_read_b64_tr_b16 v[206:207], v28 offset:19456
    ds_read_b64_tr_b16 v[160:161], v44 offset:0
    ds_read_b64_tr_b16 v[162:163], v44 offset:1024
    ds_read_b64_tr_b16 v[164:165], v44 offset:2048
    ds_read_b64_tr_b16 v[166:167], v44 offset:3072
    ds_read_b64_tr_b16 v[168:169], v45 offset:0
    ds_read_b64_tr_b16 v[170:171], v45 offset:1024
    ds_read_b64_tr_b16 v[172:173], v45 offset:2048
    ds_read_b64_tr_b16 v[174:175], v45 offset:3072
    s_waitcnt lgkmcnt(0)
    s_xor_b32 s19, s38, 0x10000
    s_add_u32 s19, s19, 0
    buffer_load_dwordx4 v[176:179], v25, s[56:59], s19 offen
    s_xor_b32 s19, s38, 0x18000
    s_add_u32 s19, s19, 0
    buffer_load_dwordx4 v[180:183], v25, s[56:59], s19 offen
    s_xor_b32 s19, s38, 0x10000
    s_add_u32 s19, s19, 2048
    buffer_load_dwordx4 v[184:187], v25, s[56:59], s19 offen
    s_xor_b32 s19, s38, 0x18000
    s_add_u32 s19, s19, 2048
    buffer_load_dwordx4 v[188:191], v25, s[56:59], s19 offen
    s_xor_b32 s19, s38, 0x10000
    s_add_u32 s19, s19, 8192
    buffer_load_dwordx4 v[208:211], v25, s[56:59], s19 offen
    s_xor_b32 s19, s38, 0x18000
    s_add_u32 s19, s19, 8192
    buffer_load_dwordx4 v[212:215], v25, s[56:59], s19 offen
    s_xor_b32 s19, s38, 0x10000
    s_add_u32 s19, s19, 10240
    buffer_load_dwordx4 v[216:219], v25, s[56:59], s19 offen
    s_xor_b32 s19, s38, 0x18000
    s_add_u32 s19, s19, 10240
    buffer_load_dwordx4 v[220:223], v25, s[56:59], s19 offen
    s_add_u32 s19, s36, 28672
    v_mov_b32 v42, s19
    v_mov_b32 v43, s39
    v_cndmask_b32 v42, v43, v42, s[94:95]
    v_add_u32 v42, v42, v40
    s_waitcnt vmcnt(8)
    ds_write_b128 v42, v[52:55] offset:0
    ds_write_b128 v42, v[56:59] offset:512
    ds_write_b128 v42, v[60:63] offset:1024
    ds_write_b128 v42, v[64:67] offset:1536
    ds_write_b128 v42, a[112:115] offset:2048
    ds_write_b128 v42, a[116:119] offset:2560
    ds_write_b128 v42, a[120:123] offset:3072
    ds_write_b128 v42, a[124:127] offset:3584
    s_waitcnt lgkmcnt(0)
    s_barrier
    ds_read_b64_tr_b16 a[112:113], v38 offset:0
    ds_read_b64_tr_b16 a[114:115], v38 offset:1024
    ds_read_b64_tr_b16 a[116:117], v38 offset:2048
    ds_read_b64_tr_b16 a[118:119], v38 offset:3072
    ds_read_b64_tr_b16 a[120:121], v39 offset:0
    ds_read_b64_tr_b16 a[122:123], v39 offset:1024
    ds_read_b64_tr_b16 a[124:125], v39 offset:2048
    ds_read_b64_tr_b16 a[126:127], v39 offset:3072
    ds_read_b64_tr_b16 v[52:53], v27 offset:28672
    ds_read_b64_tr_b16 v[54:55], v27 offset:29696
    ds_read_b64_tr_b16 v[56:57], v27 offset:30720
    ds_read_b64_tr_b16 v[58:59], v27 offset:31744
    ds_read_b64_tr_b16 v[60:61], v28 offset:28672
    ds_read_b64_tr_b16 v[62:63], v28 offset:29696
    ds_read_b64_tr_b16 v[64:65], v28 offset:30720
    ds_read_b64_tr_b16 v[66:67], v28 offset:31744
    s_waitcnt lgkmcnt(8)
    s_barrier
    s_waitcnt lgkmcnt(0)
    ds_write_b128 v8, v[52:55] offset:28672
    ds_write_b128 v8, v[56:59] offset:29696
    ds_write_b128 v8, v[60:63] offset:30720
    ds_write_b128 v8, v[64:67] offset:31744
    v_lshl_or_b32 v34, v35, 16, v34
    s_mov_b32 s19, 0x80000
    buffer_store_dword v34, v5, s[8:11], s19 offen sc1
    s_add_u32 s19, s40, 524288
    buffer_load_dwordx4 a[176:179], v24, s[52:55], s19 offen
    s_add_u32 s19, s40, 540672
    buffer_load_dwordx4 a[180:183], v24, s[52:55], s19 offen
    s_add_u32 s19, s40, 557056
    buffer_load_dwordx4 a[184:187], v24, s[52:55], s19 offen
    s_add_u32 s19, s40, 573440
    buffer_load_dwordx4 a[188:191], v24, s[52:55], s19 offen
    s_add_u32 s19, s40, 1572864
    buffer_load_dwordx4 a[208:211], v24, s[52:55], s19 offen
    s_add_u32 s19, s40, 1589248
    buffer_load_dwordx4 a[212:215], v24, s[52:55], s19 offen
    s_add_u32 s19, s40, 1605632
    buffer_load_dwordx4 a[216:219], v24, s[52:55], s19 offen
    s_add_u32 s19, s40, 1622016
    buffer_load_dwordx4 a[220:223], v24, s[52:55], s19 offen
    v_mov_b32 v42, s39
    s_add_u32 s19, s36, 16384
    v_mov_b32 v43, s19
    v_cndmask_b32 v42, v42, v43, vcc
    v_add_u32 v42, v42, v41
    v_xor_b32 v43, 32, v42
    s_waitcnt vmcnt(9)
    ds_write_b128 v42, v[176:179] offset:0
    ds_write_b128 v43, v[180:183] offset:0
    ds_write_b128 v42, v[184:187] offset:1024
    ds_write_b128 v43, v[188:191] offset:1024
    ds_write_b128 v42, v[208:211] offset:2048
    ds_write_b128 v43, v[212:215] offset:2048
    ds_write_b128 v42, v[216:219] offset:3072
    ds_write_b128 v43, v[220:223] offset:3072
    s_waitcnt lgkmcnt(0)
    ds_read_b64_tr_b16 v[208:209], v27 offset:16384
    ds_read_b64_tr_b16 v[210:211], v27 offset:17408
    ds_read_b64_tr_b16 v[212:213], v27 offset:18432
    ds_read_b64_tr_b16 v[214:215], v27 offset:19456
    ds_read_b64_tr_b16 v[216:217], v28 offset:16384
    ds_read_b64_tr_b16 v[218:219], v28 offset:17408
    ds_read_b64_tr_b16 v[220:221], v28 offset:18432
    ds_read_b64_tr_b16 v[222:223], v28 offset:19456
    ds_read_b64_tr_b16 v[176:177], v44 offset:0
    ds_read_b64_tr_b16 v[178:179], v44 offset:1024
    ds_read_b64_tr_b16 v[180:181], v44 offset:2048
    ds_read_b64_tr_b16 v[182:183], v44 offset:3072
    ds_read_b64_tr_b16 v[184:185], v45 offset:0
    ds_read_b64_tr_b16 v[186:187], v45 offset:1024
    ds_read_b64_tr_b16 v[188:189], v45 offset:2048
    ds_read_b64_tr_b16 v[190:191], v45 offset:3072
    s_waitcnt lgkmcnt(0)
    s_xor_b32 s19, s38, 0x0
    s_add_u32 s19, s19, 128
    buffer_load_dwordx4 v[224:227], v25, s[56:59], s19 offen
    s_xor_b32 s19, s38, 0x8000
    s_add_u32 s19, s19, 128
    buffer_load_dwordx4 v[228:231], v25, s[56:59], s19 offen
    s_xor_b32 s19, s38, 0x0
    s_add_u32 s19, s19, 2176
    buffer_load_dwordx4 v[232:235], v25, s[56:59], s19 offen
    s_xor_b32 s19, s38, 0x8000
    s_add_u32 s19, s19, 2176
    buffer_load_dwordx4 v[236:239], v25, s[56:59], s19 offen
    s_xor_b32 s19, s38, 0x0
    s_add_u32 s19, s19, 8320
    buffer_load_dwordx4 v[240:243], v25, s[56:59], s19 offen
    s_xor_b32 s19, s38, 0x8000
    s_add_u32 s19, s19, 8320
    buffer_load_dwordx4 v[244:247], v25, s[56:59], s19 offen
    s_xor_b32 s19, s38, 0x0
    s_add_u32 s19, s19, 10368
    buffer_load_dwordx4 v[248:251], v25, s[56:59], s19 offen
    s_xor_b32 s19, s38, 0x8000
    s_add_u32 s19, s19, 10368
    buffer_load_dwordx4 v[252:255], v25, s[56:59], s19 offen
    s_add_u32 s19, s36, 16384
    v_mov_b32 v42, s19
    v_mov_b32 v43, s39
    v_cndmask_b32 v42, v43, v42, s[94:95]
    v_add_u32 v42, v42, v40
    s_waitcnt vmcnt(8)
    ds_write_b128 v42, a[176:179] offset:0
    ds_write_b128 v42, a[180:183] offset:512
    ds_write_b128 v42, a[184:187] offset:1024
    ds_write_b128 v42, a[188:191] offset:1536
    ds_write_b128 v42, a[208:211] offset:2048
    ds_write_b128 v42, a[212:215] offset:2560
    ds_write_b128 v42, a[216:219] offset:3072
    ds_write_b128 v42, a[220:223] offset:3584
    s_waitcnt lgkmcnt(0)
    s_barrier
    ds_read_b64_tr_b16 a[208:209], v38 offset:0
    ds_read_b64_tr_b16 a[210:211], v38 offset:1024
    ds_read_b64_tr_b16 a[212:213], v38 offset:2048
    ds_read_b64_tr_b16 a[214:215], v38 offset:3072
    ds_read_b64_tr_b16 a[216:217], v39 offset:0
    ds_read_b64_tr_b16 a[218:219], v39 offset:1024
    ds_read_b64_tr_b16 a[220:221], v39 offset:2048
    ds_read_b64_tr_b16 a[222:223], v39 offset:3072
    ds_read_b64_tr_b16 a[176:177], v27 offset:16384
    ds_read_b64_tr_b16 a[178:179], v27 offset:17408
    ds_read_b64_tr_b16 a[180:181], v27 offset:18432
    ds_read_b64_tr_b16 a[182:183], v27 offset:19456
    ds_read_b64_tr_b16 a[184:185], v28 offset:16384
    ds_read_b64_tr_b16 a[186:187], v28 offset:17408
    ds_read_b64_tr_b16 a[188:189], v28 offset:18432
    ds_read_b64_tr_b16 a[190:191], v28 offset:19456
    s_waitcnt lgkmcnt(8)
    s_barrier
    s_waitcnt lgkmcnt(0)
    s_cmp_lg_u32 s17, 0
    s_cbranch_scc1 C_noarr
    v_mov_b32 v32, 128
    v_mov_b32 v33, 1
    s_mov_b64 exec, 1
    buffer_atomic_add v33, v32, s[12:15], 0 offen sc1
    s_mov_b64 exec, -1
    C_noarr:
    s_add_u32 s19, s40, 0
    buffer_load_dwordx4 v[68:71], v24, s[52:55], s19 offen
    s_add_u32 s19, s40, 16384
    buffer_load_dwordx4 v[72:75], v24, s[52:55], s19 offen
    s_add_u32 s19, s40, 32768
    buffer_load_dwordx4 v[76:79], v24, s[52:55], s19 offen
    s_add_u32 s19, s40, 49152
    buffer_load_dwordx4 v[80:83], v24, s[52:55], s19 offen
    s_add_u32 s19, s40, 1048576
    buffer_load_dwordx4 a[192:195], v24, s[52:55], s19 offen
    s_add_u32 s19, s40, 1064960
    buffer_load_dwordx4 a[196:199], v24, s[52:55], s19 offen
    s_add_u32 s19, s40, 1081344
    buffer_load_dwordx4 a[200:203], v24, s[52:55], s19 offen
    s_add_u32 s19, s40, 1097728
    buffer_load_dwordx4 a[204:207], v24, s[52:55], s19 offen
    v_mov_b32 v42, s39
    s_add_u32 s19, s36, 16384
    v_mov_b32 v43, s19
    v_cndmask_b32 v42, v42, v43, vcc
    v_add_u32 v42, v42, v41
    v_xor_b32 v43, 32, v42
    s_waitcnt vmcnt(8)
    ds_write_b128 v42, v[224:227] offset:0
    ds_write_b128 v43, v[228:231] offset:0
    ds_write_b128 v42, v[232:235] offset:1024
    ds_write_b128 v43, v[236:239] offset:1024
    ds_write_b128 v42, v[240:243] offset:2048
    ds_write_b128 v43, v[244:247] offset:2048
    ds_write_b128 v42, v[248:251] offset:3072
    ds_write_b128 v43, v[252:255] offset:3072
    s_waitcnt lgkmcnt(0)
    ds_read_b64_tr_b16 v[240:241], v27 offset:16384
    ds_read_b64_tr_b16 v[242:243], v27 offset:17408
    ds_read_b64_tr_b16 v[244:245], v27 offset:18432
    ds_read_b64_tr_b16 v[246:247], v27 offset:19456
    ds_read_b64_tr_b16 v[248:249], v28 offset:16384
    ds_read_b64_tr_b16 v[250:251], v28 offset:17408
    ds_read_b64_tr_b16 v[252:253], v28 offset:18432
    ds_read_b64_tr_b16 v[254:255], v28 offset:19456
    ds_read_b64_tr_b16 v[224:225], v44 offset:0
    ds_read_b64_tr_b16 v[226:227], v44 offset:1024
    ds_read_b64_tr_b16 v[228:229], v44 offset:2048
    ds_read_b64_tr_b16 v[230:231], v44 offset:3072
    ds_read_b64_tr_b16 v[232:233], v45 offset:0
    ds_read_b64_tr_b16 v[234:235], v45 offset:1024
    ds_read_b64_tr_b16 v[236:237], v45 offset:2048
    ds_read_b64_tr_b16 v[238:239], v45 offset:3072
    s_waitcnt lgkmcnt(0)
    s_add_u32 s19, s42, 0
    buffer_load_dwordx4 v[84:87], v24, s[48:51], s19 offen
    s_add_u32 s19, s42, 16384
    buffer_load_dwordx4 v[88:91], v24, s[48:51], s19 offen
    s_add_u32 s19, s42, 32768
    buffer_load_dwordx4 v[92:95], v24, s[48:51], s19 offen
    s_add_u32 s19, s42, 49152
    buffer_load_dwordx4 v[96:99], v24, s[48:51], s19 offen
    s_add_u32 s19, s42, 1048576
    buffer_load_dwordx4 a[144:147], v24, s[48:51], s19 offen
    s_add_u32 s19, s42, 1064960
    buffer_load_dwordx4 a[148:151], v24, s[48:51], s19 offen
    s_add_u32 s19, s42, 1081344
    buffer_load_dwordx4 a[152:155], v24, s[48:51], s19 offen
    s_add_u32 s19, s42, 1097728
    buffer_load_dwordx4 a[156:159], v24, s[48:51], s19 offen
    s_add_u32 s19, s36, 32768
    v_mov_b32 v42, s19
    v_mov_b32 v43, s39
    v_cndmask_b32 v42, v43, v42, s[94:95]
    v_add_u32 v42, v42, v40
    s_waitcnt vmcnt(8)
    ds_write_b128 v42, v[68:71] offset:0
    ds_write_b128 v42, v[72:75] offset:512
    ds_write_b128 v42, v[76:79] offset:1024
    ds_write_b128 v42, v[80:83] offset:1536
    ds_write_b128 v42, a[192:195] offset:2048
    ds_write_b128 v42, a[196:199] offset:2560
    ds_write_b128 v42, a[200:203] offset:3072
    ds_write_b128 v42, a[204:207] offset:3584
    s_waitcnt lgkmcnt(0)
    s_barrier
    ds_read_b64_tr_b16 a[192:193], v38 offset:0
    ds_read_b64_tr_b16 a[194:195], v38 offset:1024
    ds_read_b64_tr_b16 a[196:197], v38 offset:2048
    ds_read_b64_tr_b16 a[198:199], v38 offset:3072
    ds_read_b64_tr_b16 a[200:201], v39 offset:0
    ds_read_b64_tr_b16 a[202:203], v39 offset:1024
    ds_read_b64_tr_b16 a[204:205], v39 offset:2048
    ds_read_b64_tr_b16 a[206:207], v39 offset:3072
    ds_read_b64_tr_b16 v[68:69], v27 offset:32768
    ds_read_b64_tr_b16 v[70:71], v27 offset:33792
    ds_read_b64_tr_b16 v[72:73], v27 offset:34816
    ds_read_b64_tr_b16 v[74:75], v27 offset:35840
    ds_read_b64_tr_b16 v[76:77], v28 offset:32768
    ds_read_b64_tr_b16 v[78:79], v28 offset:33792
    ds_read_b64_tr_b16 v[80:81], v28 offset:34816
    ds_read_b64_tr_b16 v[82:83], v28 offset:35840
    s_waitcnt lgkmcnt(8)
    s_barrier
    s_waitcnt lgkmcnt(0)
    ds_write_b128 v8, v[68:71] offset:32768
    ds_write_b128 v8, v[72:75] offset:33792
    ds_write_b128 v8, v[76:79] offset:34816
    ds_write_b128 v8, v[80:83] offset:35840
    s_add_u32 s19, s42, 0
    buffer_load_dwordx4 a[224:227], v24, s[52:55], s19 offen
    s_add_u32 s19, s42, 16384
    buffer_load_dwordx4 a[228:231], v24, s[52:55], s19 offen
    s_add_u32 s19, s42, 32768
    buffer_load_dwordx4 a[232:235], v24, s[52:55], s19 offen
    s_add_u32 s19, s42, 49152
    buffer_load_dwordx4 a[236:239], v24, s[52:55], s19 offen
    s_add_u32 s19, s42, 1048576
    buffer_load_dwordx4 a[240:243], v24, s[52:55], s19 offen
    s_add_u32 s19, s42, 1064960
    buffer_load_dwordx4 a[244:247], v24, s[52:55], s19 offen
    s_add_u32 s19, s42, 1081344
    buffer_load_dwordx4 a[248:251], v24, s[52:55], s19 offen
    s_add_u32 s19, s42, 1097728
    buffer_load_dwordx4 a[252:255], v24, s[52:55], s19 offen
    s_add_u32 s19, s36, 0
    v_mov_b32 v42, s19
    v_mov_b32 v43, s39
    v_cndmask_b32 v42, v43, v42, s[94:95]
    v_add_u32 v42, v42, v40
    s_waitcnt vmcnt(8)
    ds_write_b128 v42, v[84:87] offset:0
    ds_write_b128 v42, v[88:91] offset:512
    ds_write_b128 v42, v[92:95] offset:1024
    ds_write_b128 v42, v[96:99] offset:1536
    ds_write_b128 v42, a[144:147] offset:2048
    ds_write_b128 v42, a[148:151] offset:2560
    ds_write_b128 v42, a[152:155] offset:3072
    ds_write_b128 v42, a[156:159] offset:3584
    s_waitcnt lgkmcnt(0)
    s_barrier
    ds_read_b64_tr_b16 a[144:145], v38 offset:0
    ds_read_b64_tr_b16 a[146:147], v38 offset:1024
    ds_read_b64_tr_b16 a[148:149], v38 offset:2048
    ds_read_b64_tr_b16 a[150:151], v38 offset:3072
    ds_read_b64_tr_b16 a[152:153], v39 offset:0
    ds_read_b64_tr_b16 a[154:155], v39 offset:1024
    ds_read_b64_tr_b16 a[156:157], v39 offset:2048
    ds_read_b64_tr_b16 a[158:159], v39 offset:3072
    ds_read_b64_tr_b16 v[84:85], v27 offset:0
    ds_read_b64_tr_b16 v[86:87], v27 offset:1024
    ds_read_b64_tr_b16 v[88:89], v27 offset:2048
    ds_read_b64_tr_b16 v[90:91], v27 offset:3072
    ds_read_b64_tr_b16 v[92:93], v28 offset:0
    ds_read_b64_tr_b16 v[94:95], v28 offset:1024
    ds_read_b64_tr_b16 v[96:97], v28 offset:2048
    ds_read_b64_tr_b16 v[98:99], v28 offset:3072
    s_waitcnt lgkmcnt(8)
    s_barrier
    s_waitcnt lgkmcnt(0)
    ds_write_b128 v8, v[84:87] offset:0
    ds_write_b128 v8, v[88:91] offset:1024
    ds_write_b128 v8, v[92:95] offset:2048
    ds_write_b128 v8, v[96:99] offset:3072
    s_add_u32 s19, s42, 524288
    buffer_load_dwordx4 v[128:131], v24, s[48:51], s19 offen
    s_add_u32 s19, s42, 540672
    buffer_load_dwordx4 v[132:135], v24, s[48:51], s19 offen
    s_add_u32 s19, s42, 557056
    buffer_load_dwordx4 v[136:139], v24, s[48:51], s19 offen
    s_add_u32 s19, s42, 573440
    buffer_load_dwordx4 v[140:143], v24, s[48:51], s19 offen
    s_add_u32 s19, s42, 1572864
    buffer_load_dwordx4 a[160:163], v24, s[48:51], s19 offen
    s_add_u32 s19, s42, 1589248
    buffer_load_dwordx4 a[164:167], v24, s[48:51], s19 offen
    s_add_u32 s19, s42, 1605632
    buffer_load_dwordx4 a[168:171], v24, s[48:51], s19 offen
    s_add_u32 s19, s42, 1622016
    buffer_load_dwordx4 a[172:175], v24, s[48:51], s19 offen
    s_add_u32 s19, s36, 16384
    v_mov_b32 v42, s19
    v_mov_b32 v43, s39
    v_cndmask_b32 v42, v43, v42, s[94:95]
    v_add_u32 v42, v42, v40
    s_waitcnt vmcnt(8)
    ds_write_b128 v42, a[224:227] offset:0
    ds_write_b128 v42, a[228:231] offset:512
    ds_write_b128 v42, a[232:235] offset:1024
    ds_write_b128 v42, a[236:239] offset:1536
    ds_write_b128 v42, a[240:243] offset:2048
    ds_write_b128 v42, a[244:247] offset:2560
    ds_write_b128 v42, a[248:251] offset:3072
    ds_write_b128 v42, a[252:255] offset:3584
    s_waitcnt lgkmcnt(0)
    s_barrier
    ds_read_b64_tr_b16 a[240:241], v38 offset:0
    ds_read_b64_tr_b16 a[242:243], v38 offset:1024
    ds_read_b64_tr_b16 a[244:245], v38 offset:2048
    ds_read_b64_tr_b16 a[246:247], v38 offset:3072
    ds_read_b64_tr_b16 a[248:249], v39 offset:0
    ds_read_b64_tr_b16 a[250:251], v39 offset:1024
    ds_read_b64_tr_b16 a[252:253], v39 offset:2048
    ds_read_b64_tr_b16 a[254:255], v39 offset:3072
    ds_read_b64_tr_b16 a[224:225], v27 offset:16384
    ds_read_b64_tr_b16 a[226:227], v27 offset:17408
    ds_read_b64_tr_b16 a[228:229], v27 offset:18432
    ds_read_b64_tr_b16 a[230:231], v27 offset:19456
    ds_read_b64_tr_b16 a[232:233], v28 offset:16384
    ds_read_b64_tr_b16 a[234:235], v28 offset:17408
    ds_read_b64_tr_b16 a[236:237], v28 offset:18432
    ds_read_b64_tr_b16 a[238:239], v28 offset:19456
    s_waitcnt lgkmcnt(8)
    s_barrier
    s_waitcnt lgkmcnt(0)
    v_mov_b32 v31, 192
    buffer_load_dword v30, v31, s[12:15], 0 offen sc1
    s_add_u32 s19, s42, 524288
    buffer_load_dwordx4 v[52:55], v24, s[52:55], s19 offen
    s_add_u32 s19, s42, 540672
    buffer_load_dwordx4 v[56:59], v24, s[52:55], s19 offen
    s_add_u32 s19, s42, 557056
    buffer_load_dwordx4 v[60:63], v24, s[52:55], s19 offen
    s_add_u32 s19, s42, 573440
    buffer_load_dwordx4 v[64:67], v24, s[52:55], s19 offen
    s_add_u32 s19, s42, 1572864
    buffer_load_dwordx4 v[144:147], v24, s[52:55], s19 offen
    s_add_u32 s19, s42, 1589248
    buffer_load_dwordx4 v[148:151], v24, s[52:55], s19 offen
    s_add_u32 s19, s42, 1605632
    buffer_load_dwordx4 v[152:155], v24, s[52:55], s19 offen
    s_add_u32 s19, s42, 1622016
    buffer_load_dwordx4 v[156:159], v24, s[52:55], s19 offen
    s_add_u32 s19, s36, 4096
    v_mov_b32 v42, s19
    v_mov_b32 v43, s39
    v_cndmask_b32 v42, v43, v42, s[94:95]
    v_add_u32 v42, v42, v40
    s_waitcnt vmcnt(9)
    ds_write_b128 v42, v[128:131] offset:0
    ds_write_b128 v42, v[132:135] offset:512
    ds_write_b128 v42, v[136:139] offset:1024
    ds_write_b128 v42, v[140:143] offset:1536
    ds_write_b128 v42, a[160:163] offset:2048
    ds_write_b128 v42, a[164:167] offset:2560
    ds_write_b128 v42, a[168:171] offset:3072
    ds_write_b128 v42, a[172:175] offset:3584
    s_waitcnt lgkmcnt(0)
    s_barrier
    ds_read_b64_tr_b16 a[160:161], v38 offset:0
    ds_read_b64_tr_b16 a[162:163], v38 offset:1024
    ds_read_b64_tr_b16 a[164:165], v38 offset:2048
    ds_read_b64_tr_b16 a[166:167], v38 offset:3072
    ds_read_b64_tr_b16 a[168:169], v39 offset:0
    ds_read_b64_tr_b16 a[170:171], v39 offset:1024
    ds_read_b64_tr_b16 a[172:173], v39 offset:2048
    ds_read_b64_tr_b16 a[174:175], v39 offset:3072
    ds_read_b64_tr_b16 v[128:129], v27 offset:4096
    ds_read_b64_tr_b16 v[130:131], v27 offset:5120
    ds_read_b64_tr_b16 v[132:133], v27 offset:6144
    ds_read_b64_tr_b16 v[134:135], v27 offset:7168
    ds_read_b64_tr_b16 v[12:13], v28 offset:4096
    ds_read_b64_tr_b16 v[14:15], v28 offset:5120
    ds_read_b64_tr_b16 v[16:17], v28 offset:6144
    ds_read_b64_tr_b16 v[18:19], v28 offset:7168
    s_waitcnt lgkmcnt(8)
    s_barrier
    s_waitcnt lgkmcnt(0)
    ds_write_b128 v8, v[128:131] offset:4096
    ds_write_b128 v8, v[132:135] offset:5120
    ds_write_b128 v8, v[48:51] offset:6144
    s_add_u32 s19, s40, 0
    buffer_load_dwordx4 v[68:71], v24, s[44:47], s19 offen
    s_add_u32 s19, s40, 16384
    buffer_load_dwordx4 v[72:75], v24, s[44:47], s19 offen
    s_add_u32 s19, s40, 32768
    buffer_load_dwordx4 v[76:79], v24, s[44:47], s19 offen
    s_add_u32 s19, s40, 49152
    buffer_load_dwordx4 v[80:83], v24, s[44:47], s19 offen
    s_add_u32 s19, s40, 1048576
    buffer_load_dwordx4 a[0:3], v24, s[44:47], s19 offen
    s_add_u32 s19, s40, 1064960
    buffer_load_dwordx4 a[4:7], v24, s[44:47], s19 offen
    s_add_u32 s19, s40, 1081344
    buffer_load_dwordx4 a[8:11], v24, s[44:47], s19 offen
    s_add_u32 s19, s40, 1097728
    buffer_load_dwordx4 a[12:15], v24, s[44:47], s19 offen
    s_add_u32 s19, s36, 8192
    v_mov_b32 v42, s19
    v_mov_b32 v43, s39
    v_cndmask_b32 v42, v43, v42, s[94:95]
    v_add_u32 v42, v42, v40
    s_waitcnt vmcnt(8)
    ds_write_b128 v42, v[52:55] offset:0
    ds_write_b128 v42, v[56:59] offset:512
    ds_write_b128 v42, v[60:63] offset:1024
    ds_write_b128 v42, v[64:67] offset:1536
    ds_write_b128 v42, v[144:147] offset:2048
    ds_write_b128 v42, v[148:151] offset:2560
    ds_write_b128 v42, v[152:155] offset:3072
    ds_write_b128 v42, v[156:159] offset:3584
    s_waitcnt lgkmcnt(0)
    s_barrier
    ds_read_b64_tr_b16 v[144:145], v38 offset:0
    ds_read_b64_tr_b16 v[146:147], v38 offset:1024
    ds_read_b64_tr_b16 v[148:149], v38 offset:2048
    ds_read_b64_tr_b16 v[150:151], v38 offset:3072
    ds_read_b64_tr_b16 v[152:153], v39 offset:0
    ds_read_b64_tr_b16 v[154:155], v39 offset:1024
    ds_read_b64_tr_b16 v[156:157], v39 offset:2048
    ds_read_b64_tr_b16 v[158:159], v39 offset:3072
    ds_read_b64_tr_b16 v[52:53], v27 offset:8192
    ds_read_b64_tr_b16 v[54:55], v27 offset:9216
    ds_read_b64_tr_b16 v[56:57], v27 offset:10240
    ds_read_b64_tr_b16 v[58:59], v27 offset:11264
    ds_read_b64_tr_b16 v[60:61], v28 offset:8192
    ds_read_b64_tr_b16 v[62:63], v28 offset:9216
    ds_read_b64_tr_b16 v[64:65], v28 offset:10240
    ds_read_b64_tr_b16 v[66:67], v28 offset:11264
    s_waitcnt lgkmcnt(8)
    s_barrier
    s_waitcnt lgkmcnt(0)
    ds_write_b128 v8, v[52:55] offset:8192
    ds_write_b128 v8, v[56:59] offset:9216
    ds_write_b128 v8, v[60:63] offset:10240
    ds_write_b128 v8, v[64:67] offset:11264
    s_add_u32 s19, s42, 0
    buffer_load_dwordx4 a[32:35], v24, s[44:47], s19 offen
    s_add_u32 s19, s42, 16384
    buffer_load_dwordx4 a[36:39], v24, s[44:47], s19 offen
    s_add_u32 s19, s42, 32768
    buffer_load_dwordx4 a[40:43], v24, s[44:47], s19 offen
    s_add_u32 s19, s42, 49152
    buffer_load_dwordx4 a[44:47], v24, s[44:47], s19 offen
    s_add_u32 s19, s42, 1048576
    buffer_load_dwordx4 a[64:67], v24, s[44:47], s19 offen
    s_add_u32 s19, s42, 1064960
    buffer_load_dwordx4 a[68:71], v24, s[44:47], s19 offen
    s_add_u32 s19, s42, 1081344
    buffer_load_dwordx4 a[72:75], v24, s[44:47], s19 offen
    s_add_u32 s19, s42, 1097728
    buffer_load_dwordx4 a[76:79], v24, s[44:47], s19 offen
    s_add_u32 s19, s36, 20480
    v_mov_b32 v42, s19
    v_mov_b32 v43, s39
    v_cndmask_b32 v42, v43, v42, s[94:95]
    v_add_u32 v42, v42, v40
    s_waitcnt vmcnt(8)
    ds_write_b128 v42, v[68:71] offset:0
    ds_write_b128 v42, v[72:75] offset:512
    ds_write_b128 v42, v[76:79] offset:1024
    ds_write_b128 v42, v[80:83] offset:1536
    ds_write_b128 v42, a[0:3] offset:2048
    ds_write_b128 v42, a[4:7] offset:2560
    ds_write_b128 v42, a[8:11] offset:3072
    ds_write_b128 v42, a[12:15] offset:3584
    s_waitcnt lgkmcnt(0)
    s_barrier
    ds_read_b64_tr_b16 a[0:1], v38 offset:0
    ds_read_b64_tr_b16 a[2:3], v38 offset:1024
    ds_read_b64_tr_b16 a[4:5], v38 offset:2048
    ds_read_b64_tr_b16 a[6:7], v38 offset:3072
    ds_read_b64_tr_b16 a[8:9], v39 offset:0
    ds_read_b64_tr_b16 a[10:11], v39 offset:1024
    ds_read_b64_tr_b16 a[12:13], v39 offset:2048
    ds_read_b64_tr_b16 a[14:15], v39 offset:3072
    ds_read_b64_tr_b16 v[68:69], v27 offset:20480
    ds_read_b64_tr_b16 v[70:71], v27 offset:21504
    ds_read_b64_tr_b16 v[72:73], v27 offset:22528
    ds_read_b64_tr_b16 v[74:75], v27 offset:23552
    ds_read_b64_tr_b16 v[76:77], v28 offset:20480
    ds_read_b64_tr_b16 v[78:79], v28 offset:21504
    ds_read_b64_tr_b16 v[80:81], v28 offset:22528
    ds_read_b64_tr_b16 v[82:83], v28 offset:23552
    s_waitcnt lgkmcnt(8)
    s_barrier
    s_waitcnt lgkmcnt(0)
    ds_write_b128 v8, v[68:71] offset:20480
    ds_write_b128 v8, v[72:75] offset:21504
    ds_write_b128 v8, v[76:79] offset:22528
    ds_write_b128 v8, v[80:83] offset:23552
    v_readfirstlane_b32 s19, v30
    s_nop 0
    s_cmp_lg_u32 s19, 0
    s_cbranch_scc1 C_rdok
    s_mov_b64 s[22:23], vcc
    s_mov_b32 s21, 0
    PL_2:
    buffer_load_dword v30, v31, s[12:15], 0 offen sc1
    s_add_u32 s21, s21, 1
    s_cmp_gt_u32 s21, 400000
    s_cbranch_scc1 F_fail
    s_waitcnt vmcnt(0)
    v_cmp_gt_u32 vcc, 1, v30
    s_cbranch_vccz PL_2_ok
    s_sleep 1
    s_branch PL_2
    PL_2_ok:
    s_mov_b64 vcc, s[22:23]
    C_rdok:
    v_lshrrev_b32 v36, 2, v1
    v_and_b32 v36, 63, v36
    v_mov_b32 v31, 128
    buffer_load_dwordx2 v[46:47], v31, s[12:15], 0 offen sc1
    buffer_load_dword v37, v36, s[8:11], s29 offen sc1
    s_add_u32 s19, s40, 524288
    buffer_load_dwordx4 v[84:87], v24, s[44:47], s19 offen
    s_add_u32 s19, s40, 540672
    buffer_load_dwordx4 v[88:91], v24, s[44:47], s19 offen
    s_add_u32 s19, s40, 557056
    buffer_load_dwordx4 v[92:95], v24, s[44:47], s19 offen
    s_add_u32 s19, s40, 573440
    buffer_load_dwordx4 v[96:99], v24, s[44:47], s19 offen
    s_add_u32 s19, s40, 1572864
    buffer_load_dwordx4 a[16:19], v24, s[44:47], s19 offen
    s_add_u32 s19, s40, 1589248
    buffer_load_dwordx4 a[20:23], v24, s[44:47], s19 offen
    s_add_u32 s19, s40, 1605632
    buffer_load_dwordx4 a[24:27], v24, s[44:47], s19 offen
    s_add_u32 s19, s40, 1622016
    buffer_load_dwordx4 a[28:31], v24, s[44:47], s19 offen
    s_add_u32 s19, s36, 16384
    v_mov_b32 v42, s19
    v_mov_b32 v43, s39
    v_cndmask_b32 v42, v43, v42, s[94:95]
    v_add_u32 v42, v42, v40
    s_waitcnt vmcnt(10)
    ds_write_b128 v42, a[32:35] offset:0
    ds_write_b128 v42, a[36:39] offset:512
    ds_write_b128 v42, a[40:43] offset:1024
    ds_write_b128 v42, a[44:47] offset:1536
    ds_write_b128 v42, a[64:67] offset:2048
    ds_write_b128 v42, a[68:71] offset:2560
    ds_write_b128 v42, a[72:75] offset:3072
    ds_write_b128 v42, a[76:79] offset:3584
    s_waitcnt lgkmcnt(0)
    s_barrier
    ds_read_b64_tr_b16 a[64:65], v38 offset:0
    ds_read_b64_tr_b16 a[66:67], v38 offset:1024
    ds_read_b64_tr_b16 a[68:69], v38 offset:2048
    ds_read_b64_tr_b16 a[70:71], v38 offset:3072
    ds_read_b64_tr_b16 a[72:73], v39 offset:0
    ds_read_b64_tr_b16 a[74:75], v39 offset:1024
    ds_read_b64_tr_b16 a[76:77], v39 offset:2048
    ds_read_b64_tr_b16 a[78:79], v39 offset:3072
    ds_read_b64_tr_b16 a[32:33], v27 offset:16384
    ds_read_b64_tr_b16 a[34:35], v27 offset:17408
    ds_read_b64_tr_b16 a[36:37], v27 offset:18432
    ds_read_b64_tr_b16 a[38:39], v27 offset:19456
    ds_read_b64_tr_b16 a[40:41], v28 offset:16384
    ds_read_b64_tr_b16 a[42:43], v28 offset:17408
    ds_read_b64_tr_b16 a[44:45], v28 offset:18432
    ds_read_b64_tr_b16 a[46:47], v28 offset:19456
    s_waitcnt lgkmcnt(8)
    s_barrier
    s_waitcnt lgkmcnt(0)
    s_add_u32 s19, s42, 524288
    buffer_load_dwordx4 a[48:51], v24, s[44:47], s19 offen
    s_add_u32 s19, s42, 540672
    buffer_load_dwordx4 a[52:55], v24, s[44:47], s19 offen
    s_add_u32 s19, s42, 557056
    buffer_load_dwordx4 a[56:59], v24, s[44:47], s19 offen
    s_add_u32 s19, s42, 573440
    buffer_load_dwordx4 a[60:63], v24, s[44:47], s19 offen
    s_add_u32 s19, s42, 1572864
    buffer_load_dwordx4 a[80:83], v24, s[44:47], s19 offen
    s_add_u32 s19, s42, 1589248
    buffer_load_dwordx4 a[84:87], v24, s[44:47], s19 offen
    s_add_u32 s19, s42, 1605632
    buffer_load_dwordx4 a[88:91], v24, s[44:47], s19 offen
    s_add_u32 s19, s42, 1622016
    buffer_load_dwordx4 a[92:95], v24, s[44:47], s19 offen
    s_add_u32 s19, s36, 24576
    v_mov_b32 v42, s19
    v_mov_b32 v43, s39
    v_cndmask_b32 v42, v43, v42, s[94:95]
    v_add_u32 v42, v42, v40
    s_waitcnt vmcnt(8)
    ds_write_b128 v42, v[84:87] offset:0
    ds_write_b128 v42, v[88:91] offset:512
    ds_write_b128 v42, v[92:95] offset:1024
    ds_write_b128 v42, v[96:99] offset:1536
    ds_write_b128 v42, a[16:19] offset:2048
    ds_write_b128 v42, a[20:23] offset:2560
    ds_write_b128 v42, a[24:27] offset:3072
    ds_write_b128 v42, a[28:31] offset:3584
    s_waitcnt lgkmcnt(0)
    s_barrier
    ds_read_b64_tr_b16 a[16:17], v38 offset:0
    ds_read_b64_tr_b16 a[18:19], v38 offset:1024
    ds_read_b64_tr_b16 a[20:21], v38 offset:2048
    ds_read_b64_tr_b16 a[22:23], v38 offset:3072
    ds_read_b64_tr_b16 a[24:25], v39 offset:0
    ds_read_b64_tr_b16 a[26:27], v39 offset:1024
    ds_read_b64_tr_b16 a[28:29], v39 offset:2048
    ds_read_b64_tr_b16 a[30:31], v39 offset:3072
    ds_read_b64_tr_b16 v[84:85], v27 offset:24576
    ds_read_b64_tr_b16 v[86:87], v27 offset:25600
    ds_read_b64_tr_b16 v[88:89], v27 offset:26624
    ds_read_b64_tr_b16 v[90:91], v27 offset:27648
    ds_read_b64_tr_b16 v[92:93], v28 offset:24576
    ds_read_b64_tr_b16 v[94:95], v28 offset:25600
    ds_read_b64_tr_b16 v[96:97], v28 offset:26624
    ds_read_b64_tr_b16 v[98:99], v28 offset:27648
    s_waitcnt lgkmcnt(8)
    s_barrier
    s_waitcnt lgkmcnt(0)
    ds_write_b128 v8, v[84:87] offset:24576
    ds_write_b128 v8, v[88:91] offset:25600
    ds_write_b128 v8, v[92:95] offset:26624
    ds_write_b128 v8, v[96:99] offset:27648
    s_xor_b32 s19, s38, 0x10000
    s_add_u32 s19, s19, 128
    buffer_load_dwordx4 v[128:131], v25, s[56:59], s19 offen
    s_xor_b32 s19, s38, 0x18000
    s_add_u32 s19, s19, 128
    buffer_load_dwordx4 v[132:135], v25, s[56:59], s19 offen
    s_xor_b32 s19, s38, 0x10000
    s_add_u32 s19, s19, 2176
    buffer_load_dwordx4 v[136:139], v25, s[56:59], s19 offen
    s_xor_b32 s19, s38, 0x18000
    s_add_u32 s19, s19, 2176
    buffer_load_dwordx4 v[140:143], v25, s[56:59], s19 offen
    s_xor_b32 s19, s38, 0x10000
    s_add_u32 s19, s19, 8320
    buffer_load_dwordx4 v[52:55], v25, s[56:59], s19 offen
    s_xor_b32 s19, s38, 0x18000
    s_add_u32 s19, s19, 8320
    buffer_load_dwordx4 v[56:59], v25, s[56:59], s19 offen
    s_xor_b32 s19, s38, 0x10000
    s_add_u32 s19, s19, 10368
    buffer_load_dwordx4 v[60:63], v25, s[56:59], s19 offen
    s_xor_b32 s19, s38, 0x18000
    s_add_u32 s19, s19, 10368
    buffer_load_dwordx4 v[64:67], v25, s[56:59], s19 offen
    s_add_u32 s19, s36, 16384
    v_mov_b32 v42, s19
    v_mov_b32 v43, s39
    v_cndmask_b32 v42, v43, v42, s[94:95]
    v_add_u32 v42, v42, v40
    s_waitcnt vmcnt(8)
    ds_write_b128 v42, a[48:51] offset:0
    ds_write_b128 v42, a[52:55] offset:512
    ds_write_b128 v42, a[56:59] offset:1024
    ds_write_b128 v42, a[60:63] offset:1536
    ds_write_b128 v42, a[80:83] offset:2048
    ds_write_b128 v42, a[84:87] offset:2560
    ds_write_b128 v42, a[88:91] offset:3072
    ds_write_b128 v42, a[92:95] offset:3584
    s_waitcnt lgkmcnt(0)
    s_barrier
    ds_read_b64_tr_b16 a[80:81], v38 offset:0
    ds_read_b64_tr_b16 a[82:83], v38 offset:1024
    ds_read_b64_tr_b16 a[84:85], v38 offset:2048
    ds_read_b64_tr_b16 a[86:87], v38 offset:3072
    ds_read_b64_tr_b16 a[88:89], v39 offset:0
    ds_read_b64_tr_b16 a[90:91], v39 offset:1024
    ds_read_b64_tr_b16 a[92:93], v39 offset:2048
    ds_read_b64_tr_b16 a[94:95], v39 offset:3072
    ds_read_b64_tr_b16 a[48:49], v27 offset:16384
    ds_read_b64_tr_b16 a[50:51], v27 offset:17408
    ds_read_b64_tr_b16 a[52:53], v27 offset:18432
    ds_read_b64_tr_b16 a[54:55], v27 offset:19456
    ds_read_b64_tr_b16 a[56:57], v28 offset:16384
    ds_read_b64_tr_b16 a[58:59], v28 offset:17408
    ds_read_b64_tr_b16 a[60:61], v28 offset:18432
    ds_read_b64_tr_b16 a[62:63], v28 offset:19456
    s_waitcnt lgkmcnt(8)
    s_barrier
    s_waitcnt lgkmcnt(0)
    v_readfirstlane_b32 s19, v46
    v_readfirstlane_b32 s20, v47
    v_lshlrev_b32 v32, 2, v1
    s_lshl_b32 s21, s17, 13
    s_add_u32 s21, s21, 0x80000
    s_lshl_b32 s20, s20, 6
    s_add_u32 s19, s19, s20
    s_cmp_lg_u32 s19, 32
    s_cbranch_scc1 C_nowarm
    buffer_load_dword v33, v32, s[8:11], s25 offen
    buffer_load_dword v33, v32, s[8:11], s26 offen
    buffer_load_dword v33, v32, s[8:11], s21 offen
    s_add_u32 s21, s21, 0x1000
    buffer_load_dword v33, v32, s[8:11], s21 offen
    C_nowarm:
    s_mov_b32 s19, 0
    s_mov_b32 s21, 0
    s_branch C_kv0_chk
    v_lshrrev_b32 v36, 2, v1
    v_and_b32 v36, 63, v36
    s_mov_b32 s21, 0
    C_kv0:
    buffer_load_dword v37, v36, s[8:11], s29 offen sc1
    s_add_u32 s21, s21, 1
    s_cmp_gt_u32 s21, 400000
    s_cbranch_scc1 F_fail
    s_waitcnt vmcnt(0)
    C_kv0_chk:
    v_min_u32_dpp v37, v37, v37 row_ror:8 row_mask:0xf bank_mask:0xf
    s_nop 1
    v_min_u32_dpp v37, v37, v37 row_ror:4 row_mask:0xf bank_mask:0xf
    s_nop 1
    v_min_u32_dpp v37, v37, v37 row_ror:2 row_mask:0xf bank_mask:0xf
    s_nop 1
    v_min_u32_dpp v37, v37, v37 row_ror:1 row_mask:0xf bank_mask:0xf
    s_nop 0
    v_readfirstlane_b32 s37, v37
    s_nop 0
    s_lshl_b32 s37, s37, 2
    s_cmp_ge_u32 s19, s37
    s_cbranch_scc1 C_kv0
    s_cmp_ge_u32 s37, 12
    s_cselect_b32 s21, 12, 0
    s_cmp_ge_u32 s37, 44
    s_cselect_b32 s21, 44, s21
    s_cmp_ge_u32 s37, 64
    s_cselect_b32 s21, 1000, s21
    s_cmp_gt_u32 s21, s19
    s_cselect_b32 s37, s21, s37
    v_mov_b32 v31, 128
    buffer_load_dwordx2 v[46:47], v31, s[12:15], 0 offen sc1
    buffer_load_dwordx4 v[108:111], v9, s[8:11], s31 offen sc1
    buffer_load_dwordx4 v[112:115], v9, s[8:11], s31 offen offset:2048 sc1
    buffer_load_dwordx4 v[116:119], v1, s[8:11], s32 offen sc1
    buffer_load_dwordx4 v[120:123], v1, s[8:11], s32 offen offset:1024 sc1
    buffer_load_dword v37, v36, s[8:11], s29 offen sc1
    s_add_u32 s19, s36, 12288
    v_mov_b32 v42, s19
    s_add_u32 s19, s36, 16384
    v_mov_b32 v43, s19
    v_cndmask_b32 v42, v42, v43, vcc
    v_add_u32 v42, v42, v41
    v_xor_b32 v43, 32, v42
    s_waitcnt vmcnt(6)
    ds_write_b128 v42, v[128:131] offset:0
    ds_write_b128 v43, v[132:135] offset:0
    ds_write_b128 v42, v[136:139] offset:1024
    ds_write_b128 v43, v[140:143] offset:1024
    ds_write_b128 v42, v[52:55] offset:2048
    ds_write_b128 v43, v[56:59] offset:2048
    ds_write_b128 v42, v[60:63] offset:3072
    ds_write_b128 v43, v[64:67] offset:3072
    s_waitcnt lgkmcnt(0)
    ds_read_b64_tr_b16 v[52:53], v27 offset:16384
    ds_read_b64_tr_b16 v[54:55], v27 offset:17408
    ds_read_b64_tr_b16 v[56:57], v27 offset:18432
    ds_read_b64_tr_b16 v[58:59], v27 offset:19456
    ds_read_b64_tr_b16 v[60:61], v28 offset:16384
    ds_read_b64_tr_b16 v[62:63], v28 offset:17408
    ds_read_b64_tr_b16 v[64:65], v28 offset:18432
    ds_read_b64_tr_b16 v[66:67], v28 offset:19456
    ds_read_b64_tr_b16 v[128:129], v27 offset:12288
    ds_read_b64_tr_b16 v[130:131], v27 offset:13312
    ds_read_b64_tr_b16 v[132:133], v27 offset:14336
    ds_read_b64_tr_b16 v[134:135], v27 offset:15360
    ds_read_b64_tr_b16 v[136:137], v28 offset:12288
    ds_read_b64_tr_b16 v[138:139], v28 offset:13312
    ds_read_b64_tr_b16 v[140:141], v28 offset:14336
    ds_read_b64_tr_b16 v[142:143], v28 offset:15360
    s_waitcnt lgkmcnt(0)
    ds_write_b128 v8, v[128:131] offset:12288
    ds_write_b128 v8, v[132:135] offset:13312
    ds_write_b128 v8, v[136:139] offset:14336
    ds_write_b128 v8, v[140:143] offset:15360
    ds_write_b128 v8, v[52:55] offset:16384
    ds_write_b128 v8, v[56:59] offset:17408
    ds_write_b128 v8, v[60:63] offset:18432
    ds_write_b128 v8, v[64:67] offset:19456
    s_waitcnt lgkmcnt(0)
    s_mov_b32 s21, 0
    s_branch C_cbchk
    C_cbl:
    buffer_load_dwordx2 v[46:47], v31, s[12:15], 0 offen sc1
    s_add_u32 s21, s21, 1
    s_cmp_gt_u32 s21, 400000
    s_cbranch_scc1 F_fail
    C_cbchk:
    s_waitcnt vmcnt(0)
    v_readfirstlane_b32 s19, v46
    v_readfirstlane_b32 s20, v47
    s_cmp_lt_u32 s19, 32
    s_cbranch_scc1 C_cbl
    s_mov_b32 s19, 0
    s_branch C_kv1_chk
    v_lshrrev_b32 v36, 2, v1
    v_and_b32 v36, 63, v36
    s_mov_b32 s21, 0
    C_kv1:
    buffer_load_dword v37, v36, s[8:11], s29 offen sc1
    s_add_u32 s21, s21, 1
    s_cmp_gt_u32 s21, 400000
    s_cbranch_scc1 F_fail
    s_waitcnt vmcnt(0)
    C_kv1_chk:
    v_min_u32_dpp v37, v37, v37 row_ror:8 row_mask:0xf bank_mask:0xf
    s_nop 1
    v_min_u32_dpp v37, v37, v37 row_ror:4 row_mask:0xf bank_mask:0xf
    s_nop 1
    v_min_u32_dpp v37, v37, v37 row_ror:2 row_mask:0xf bank_mask:0xf
    s_nop 1
    v_min_u32_dpp v37, v37, v37 row_ror:1 row_mask:0xf bank_mask:0xf
    s_nop 0
    v_readfirstlane_b32 s37, v37
    s_nop 0
    s_lshl_b32 s37, s37, 2
    s_cmp_ge_u32 s19, s37
    s_cbranch_scc1 C_kv1
    s_cmp_ge_u32 s37, 12
    s_cselect_b32 s21, 12, 0
    s_cmp_ge_u32 s37, 44
    s_cselect_b32 s21, 44, s21
    s_cmp_ge_u32 s37, 64
    s_cselect_b32 s21, 1000, s21
    s_cmp_gt_u32 s21, s19
    s_cselect_b32 s37, s21, s37
    s_barrier
    s_cmp_lg_u32 s20, 0
    s_cbranch_scc1 CS_entry
    s_cmp_eq_u32 s17, 1
    s_cbranch_scc1 Cw1_entry
    s_cmp_eq_u32 s17, 2
    s_cbranch_scc1 Cw2_entry
    s_cmp_eq_u32 s17, 3
    s_cbranch_scc1 Cw3_entry
    Cw0_entry:
    s_mov_b32 s23, 0x86000
    s_mov_b32 s24, s23
    s_add_u32 s23, s23, 0x2000
    s_bitset0_b32 s23, 15
    s_add_u32 s30, s23, 0x1000
    buffer_load_dwordx4 v[20:23], v125, s[8:11], s23 offen offset:0 sc1
    buffer_load_dwordx4 v[24:27], v125, s[8:11], s30 offen offset:0 sc1
    s_mov_b32 s18, -1
    v_mov_b32 v136, 0x3f803f80
    v_mov_b32 v137, 0x3f803f80
    v_mov_b32 v138, 0x3f803f80
    v_mov_b32 v139, 0x3f803f80
    s_mov_b32 s64, 0x42700000
    v_lshlrev_b32 v124, v1, v136
    v_lshrrev_b32 v126, 16, v136
    v_bfe_i32 v52, v1, 4, 1
    v_bfi_b32 v124, v52, v124, v126
    v_bfe_u32 v126, v1, 6, 2
    v_cmp_eq_u32 vcc, 0, v126
    s_nop 1
    v_cndmask_b32 v52, 0, v124, vcc
    v_cmp_eq_u32 vcc, 1, v126
    s_nop 1
    v_cndmask_b32 v53, 0, v124, vcc
    v_cmp_eq_u32 vcc, 2, v126
    s_nop 1
    v_cndmask_b32 v54, 0, v124, vcc
    v_cmp_eq_u32 vcc, 3, v126
    s_nop 1
    v_cndmask_b32 v55, 0, v124, vcc
    ds_write_b128 v8, v[52:55] offset:7168
    s_waitcnt lgkmcnt(0)
    v_pk_mov_b32 v[140:141], v[60:61], v[62:63] op_sel:[0,0]
    ds_read_b128 v[28:31], v8 offset:34816
    v_pk_mov_b32 v[142:143], v[60:61], v[62:63] op_sel:[1,1]
    ds_read_b128 v[32:35], v8 offset:35840
    v_bfe_u32 v126, v1, 2, 6
    ds_read_b128 v[36:39], v8 offset:26624
    v_mov_b64 v[68:69], 0
    ds_read_b128 v[40:43], v8 offset:27648
    v_mov_b64 v[70:71], 0
    ds_read_b128 v[76:79], v8 offset:28672
    v_mfma_f32_16x16x1_4b_f32 v[52:67], v126, v126, 0
    ds_read_b128 v[80:83], v8 offset:29696
    ds_read_b128 v[84:87], v8 offset:30720
    ds_read_b128 v[88:91], v8 offset:31744
    ds_read_b128 v[92:95], v8 offset:32768
    s_waitcnt vmcnt(2)
    v_mov_b64 v[100:101], v[108:109]
    ds_read_b128 v[96:99], v8 offset:33792
    v_mov_b64 v[102:103], v[110:111]
    v_mov_b64 v[104:105], v[112:113]
    ds_read_b128 v[44:47], v8 offset:24576
    v_mov_b64 v[106:107], v[114:115]
    ds_read_b128 v[48:51], v8 offset:25600
    ds_read_b128 v[108:111], v8 offset:20480
    ds_read_b128 v[112:115], v8 offset:21504
    s_xor_b32 s25, s25, 0x40000
    s_xor_b32 s26, s26, 0x40000
    v_bfe_u32 v126, v1, 2, 6
    v_mov_b64 v[72:73], 0
    v_mov_b64 v[74:75], 0
    s_add_u32 s18, s18, 1
    s_xor_b32 s25, s25, 0x40000
    s_xor_b32 s26, s26, 0x40000
    s_add_u32 s19, s18, 2
    s_cmp_ge_u32 s19, s37
    s_cselect_b32 s36, s29, 0x7ff00000
    s_add_u32 s31, s31, 0x40000
    s_add_u32 s32, s32, 0x40000
    s_mov_b32 s21, 1
    s_mov_b32 s35, 1
    s_waitcnt vmcnt(2)
    v_mov_b64 v[128:129], v[116:117]
    v_mov_b64 v[130:131], v[118:119]
    v_mov_b64 v[132:133], v[120:121]
    v_mov_b64 v[134:135], v[122:123]
    ds_read_b128 v[116:119], v8 offset:22528
    ds_read_b128 v[120:123], v8 offset:23552
    s_waitcnt vmcnt(0)
    s_branch Cw0_Aw
    Cw0_Bf:
    s_add_u32 s35, s35, 1
    s_cmp_gt_u32 s35, 2
    s_cbranch_scc1 Cw0_Bre
    s_nop 6
    v_mov_b64 v[60:61], 0
    v_mov_b64 v[62:63], 0
    v_mov_b64 v[64:65], 0
    v_mov_b64 v[66:67], 0
    v_smfmac_f32_16x16x64_bf16 v[60:63], v[20:23], v[76:83], v3
    s_nop 0
    v_smfmac_f32_16x16x64_bf16 v[64:67], v[20:23], v[84:91], v3
    s_waitcnt vmcnt(3)
    s_branch Cw0_Bw
    Cw0_Are:
    s_waitcnt vmcnt(0)
    Cw0_Arl:
    s_mov_b64 exec, vcc
    buffer_load_dwordx4 v[20:23], v125, s[8:11], s23 offen offset:0 sc1
    s_mov_b64 exec, -1
    buffer_load_dwordx4 v[24:27], v125, s[8:11], s30 offen offset:0 sc1
    s_add_u32 s21, s21, 1
    s_cmp_gt_u32 s21, 400000
    s_cbranch_scc1 C_fail
    s_waitcnt vmcnt(6)
    v_mov_b64 v[52:53], 0
    v_mov_b64 v[54:55], 0
    v_mov_b64 v[56:57], 0
    v_mov_b64 v[58:59], 0
    v_mov_b64 v[60:61], 0
    v_mov_b64 v[62:63], 0
    v_max3_u32 v124, v20, v21, v22
    v_max_u32 v124, v124, v23
    v_cmp_eq_u32 vcc, -1, v124
    s_cbranch_vccz Cw0_Adn
    Cw0_Ack:
    v_max3_u32 v124, v20, v21, v22
    v_max_u32 v124, v124, v23
    v_cmp_eq_u32 vcc, -1, v124
    s_cbranch_vccnz Cw0_Arl
    Cw0_Adn:
    v_smfmac_f32_16x16x64_bf16 v[52:55], v[20:23], v[108:115], v3
    ds_write_b128 v2, v[20:23] offset:0
    v_smfmac_f32_16x16x64_bf16 v[56:59], v[20:23], v[116:123], v3
    buffer_load_dwordx4 v[24:27], v125, s[8:11], s30 offen offset:0 sc1
    v_smfmac_f32_16x16x64_bf16 v[60:63], v[20:23], v[76:83], v3
    s_barrier
    buffer_load_dwordx4 v[108:111], v9, s[8:11], s31 offen sc1
    v_smfmac_f32_16x16x64_bf16 v[64:67], v[20:23], v[84:91], v3
    buffer_load_dwordx4 v[112:115], v9, s[8:11], s31 offen offset:2048 sc1
    v_smfmac_f32_16x16x64_bf16 v[68:71], v[20:23], v[92:99], v3
    buffer_load_dwordx4 v[116:119], v1, s[8:11], s32 offen sc1
    v_smfmac_f32_16x16x64_bf16 v[72:75], v[20:23], v[28:35], v3
    s_waitcnt lgkmcnt(0)
    s_barrier
    ds_read_b128 v[28:31], v2 offset:2048
    ds_read_b128 v[32:35], v2 offset:4096
    s_branch Cw0_Bck
    Cw0_Bre:
    Cw0_Brl:
    s_mov_b64 exec, vcc
    buffer_load_dwordx4 v[24:27], v125, s[8:11], s30 offen offset:0 sc1
    s_mov_b64 exec, -1
    s_add_u32 s35, s35, 1
    s_cmp_gt_u32 s35, 400000
    s_cbranch_scc1 C_fail
    s_waitcnt vmcnt(6)
    v_max3_u32 v124, v24, v25, v26
    v_max_u32 v124, v124, v27
    v_cmp_eq_u32 vcc, -1, v124
    s_cbranch_vccz Cw0_Bdn
    Cw0_Bck:
    v_max3_u32 v124, v24, v25, v26
    v_max_u32 v124, v124, v27
    v_cmp_eq_u32 vcc, -1, v124
    s_cbranch_vccnz Cw0_Brl
    Cw0_Bdn:
    ds_write_b128 v2, v[24:27] offset:1024
    v_mov_b64 v[60:61], 0
    v_mov_b64 v[62:63], 0
    v_mov_b64 v[64:65], 0
    v_mov_b64 v[66:67], 0
    v_smfmac_f32_16x16x64_bf16 v[60:63], v[20:23], v[76:83], v3
    s_nop 0
    v_smfmac_f32_16x16x64_bf16 v[64:67], v[20:23], v[84:91], v3
    v_smfmac_f32_16x16x64_bf16 v[60:63], v[24:27], a[96:103], v3
    v_smfmac_f32_16x16x64_bf16 v[64:67], v[24:27], a[104:111], v3
    s_waitcnt vmcnt(0)
    s_waitcnt lgkmcnt(0)
    s_branch Cw0_Bok
    Cw0_Pre:
    Cw0_Prl:
    s_mov_b64 exec, vcc
    buffer_load_dwordx4 v[128:131], v1, s[8:11], s25 offen offset:0 sc1
    buffer_load_dwordx4 v[132:135], v1, s[8:11], s25 offen offset:1024 sc1
    s_mov_b64 exec, -1
    s_add_u32 s21, s21, 1
    s_cmp_gt_u32 s21, 400000
    s_cbranch_scc1 C_fail
    s_waitcnt vmcnt(8)
    v_max3_u32 v124, v128, v129, v130
    v_max3_u32 v126, v131, v132, v133
    v_max3_u32 v124, v124, v134, v135
    v_max_u32 v124, v124, v126
    v_cmp_eq_u32 vcc, -1, v124
    s_cbranch_vccz Cw0_Pdn
    Cw0_Pck:
    v_max3_u32 v124, v128, v129, v130
    v_max3_u32 v126, v131, v132, v133
    v_max3_u32 v124, v124, v134, v135
    v_max_u32 v124, v124, v126
    v_cmp_eq_u32 vcc, -1, v124
    s_cbranch_vccnz Cw0_Prl
    Cw0_Pdn:
    v_mfma_f32_16x16x32_bf16 v[24:27], v[72:75], v[128:131], 0
    v_mfma_f32_16x16x32_bf16 v[24:27], v[72:75], v[132:135], v[24:27]
    s_nop 7
    v_add_f32_dpp v24, v24, v24 row_ror:4 row_mask:0xf bank_mask:0xf
    v_add_f32_dpp v25, v25, v25 row_ror:4 row_mask:0xf bank_mask:0xf
    s_nop 0
    v_add_f32_dpp v24, v24, v24 row_ror:8 row_mask:0xf bank_mask:0xf
    v_add_f32_dpp v25, v25, v25 row_ror:8 row_mask:0xf bank_mask:0xf
    v_cvt_pk_bf16_f32 v124, v24, v25
    buffer_store_dword v124, v5, s[8:11], s23 offen
    s_waitcnt vmcnt(1)
    s_branch Cw0_w2
.p2align 6
    Cw0_step:
    v_bfe_u32 v126, v1, 2, 6
    v_mov_b64 v[72:73], 0
    v_mov_b64 v[74:75], 0
    s_add_u32 s18, s18, 1
    s_xor_b32 s25, s25, 0x40000
    s_xor_b32 s26, s26, 0x40000
    s_add_u32 s19, s18, 2
    s_cmp_ge_u32 s19, s37
    s_cselect_b32 s36, s29, 0x7ff00000
    s_add_u32 s31, s31, 0x40000
    s_add_u32 s32, s32, 0x40000
    s_mov_b32 s21, 1
    s_mov_b32 s35, 1
    s_waitcnt vmcnt(1)
    v_mov_b64 v[128:129], v[116:117]
    v_mov_b64 v[130:131], v[118:119]
    v_mov_b64 v[132:133], v[120:121]
    v_mov_b64 v[134:135], v[122:123]
    ds_read_b128 v[116:119], v8 offset:22528
    ds_read_b128 v[120:123], v8 offset:23552
    s_nop 0
    s_nop 0
    s_nop 0
    s_nop 0
    s_nop 0
    s_nop 0
    s_nop 0
    s_nop 0
    s_nop 0
    s_nop 0
    s_nop 0
    s_nop 0
    s_nop 0
    s_nop 0
    s_nop 0
    s_nop 0
    s_nop 0
    s_nop 0
    s_nop 0
    s_nop 0
    s_nop 0
    s_nop 0
    s_nop 0
    s_nop 0
    s_nop 0
    s_nop 0
    s_nop 0
    s_nop 0
    buffer_load_dwordx4 v[20:23], v125, s[8:11], s23 offen offset:0 sc1
    s_nop 0
    buffer_load_dword v127, off, s[8:11], s23
    s_nop 0
    s_nop 0
    s_nop 0
    s_nop 0
    s_nop 0
    s_nop 0
    s_nop 0
    s_nop 0
    s_nop 0
    s_nop 0
    s_nop 0
    s_nop 0
    s_nop 0
    s_nop 0
    s_nop 0
    s_nop 0
    s_nop 0
    s_nop 0
    s_nop 0
    s_nop 0
    s_nop 0
    buffer_load_dwordx4 v[20:23], v125, s[8:11], s23 offen offset:0 sc1
    s_nop 0
    s_nop 0
    s_nop 0
    s_nop 0
    s_nop 0
    s_nop 0
    s_nop 0
    s_nop 0
    s_nop 0
    s_nop 0
    s_nop 0
    buffer_load_dwordx4 v[24:27], v125, s[8:11], s30 offen offset:0 sc1
    s_branch Cw0_Aw
    Cw0_Af:
    v_mfma_f32_16x16x1_4b_f32 v[52:67], v126, v126, 0
    s_mov_b64 exec, vcc
    buffer_load_dwordx4 v[20:23], v125, s[8:11], s23 offen offset:0 sc1
    s_mov_b64 exec, -1
    buffer_load_dwordx4 v[24:27], v125, s[8:11], s30 offen offset:0 sc1
    s_add_u32 s21, s21, 1
    s_cmp_gt_u32 s21, 6
    s_cbranch_scc1 Cw0_Are
    s_nop 0
    s_nop 0
    s_nop 0
    Cw0_Aw:
    s_waitcnt vmcnt(3) lgkmcnt(0)
    v_fma_f32 v124, v20, v21, v22
    v_cmp_u_f32 vcc, v124, v23
    v_smfmac_f32_16x16x64_bf16 v[52:55], v[20:23], v[108:115], v3
    ds_write_b128 v2, v[20:23] offset:0
    v_smfmac_f32_16x16x64_bf16 v[56:59], v[20:23], v[116:123], v3
    s_cbranch_vccnz Cw0_Af
    buffer_load_dwordx4 v[24:27], v125, s[8:11], s30 offen offset:0 sc1
    v_smfmac_f32_16x16x64_bf16 v[60:63], v[20:23], v[76:83], v3
    s_barrier
    buffer_load_dwordx4 v[108:111], v9, s[8:11], s31 offen sc1
    v_smfmac_f32_16x16x64_bf16 v[64:67], v[20:23], v[84:91], v3
    buffer_load_dwordx4 v[112:115], v9, s[8:11], s31 offen offset:2048 sc1
    v_smfmac_f32_16x16x64_bf16 v[68:71], v[20:23], v[92:99], v3
    buffer_load_dwordx4 v[116:119], v1, s[8:11], s32 offen sc1
    v_smfmac_f32_16x16x64_bf16 v[72:75], v[20:23], v[28:35], v3
    s_waitcnt lgkmcnt(0)
    s_barrier
    ds_read_b128 v[28:31], v2 offset:2048
    ds_read_b128 v[32:35], v2 offset:4096
    Cw0_Bw:
    s_waitcnt vmcnt(4)
    v_fma_f32 v124, v24, v25, v26
    v_cmp_u_f32 vcc, v124, v27
    v_smfmac_f32_16x16x64_bf16 v[60:63], v[24:27], a[96:103], v3
    ds_write_b128 v2, v[24:27] offset:1024
    v_smfmac_f32_16x16x64_bf16 v[64:67], v[24:27], a[104:111], v3
    s_cbranch_vccnz Cw0_Bf
    Cw0_Bok:
    buffer_store_dwordx4 v[140:143], v1, s[8:11], s33 offen sc1
    buffer_load_dword v127, v126, s[8:11], s36 offen sc1
    v_smfmac_f32_16x16x64_bf16 v[52:55], v[24:27], v[44:51], v3
    s_mov_b32 s33, s34
    buffer_load_dwordx4 v[120:123], v1, s[8:11], s32 offen offset:1024 sc1
    v_mov_b64 v[140:141], -1
    v_smfmac_f32_16x16x64_bf16 v[56:59], v[24:27], v[36:43], v3
    ds_read_b128 v[36:39], v2 offset:6144
    s_waitcnt lgkmcnt(3)
    v_smfmac_f32_16x16x64_bf16 v[52:55], v[28:31], a[0:7], v3
    s_add_u32 s34, s34, 0x20000
    v_mov_b32 v126, s18
    v_smfmac_f32_16x16x64_bf16 v[56:59], v[28:31], a[8:15], v3
    s_waitcnt lgkmcnt(1)
    s_mov_b64 exec, 1
    buffer_store_dword v126, off, s[8:11], s28 sc1
    s_mov_b64 exec, -1
    v_smfmac_f32_16x16x64_bf16 v[52:55], v[32:35], a[32:39], v3
    s_barrier
    ds_read_b128 v[44:47], v2 offset:3072
    v_smfmac_f32_16x16x64_bf16 v[56:59], v[32:35], a[40:47], v3
    s_waitcnt lgkmcnt(1)
    s_mov_b32 s19, s27
    ds_read_b128 v[40:43], v2 offset:5120
    v_smfmac_f32_16x16x64_bf16 v[52:55], v[36:39], a[64:71], v3
    s_add_u32 s20, s27, 0x10000
    s_add_u32 s38, s27, 0x20000
    ds_read_b128 v[48:51], v2 offset:7168
    v_smfmac_f32_16x16x64_bf16 v[56:59], v[36:39], a[72:79], v3
    s_add_u32 s22, s27, 0x30000
    s_xor_b32 s27, s27, 0x40000
    v_mov_b64 v[142:143], -1
    v_smfmac_f32_16x16x64_bf16 v[60:63], v[28:31], a[112:119], v3
    v_smfmac_f32_16x16x64_bf16 v[60:63], v[36:39], a[144:151], v3
    ds_read_b128 v[76:79], v8 offset:0
    v_smfmac_f32_16x16x64_bf16 v[64:67], v[28:31], a[120:127], v3
    s_waitcnt lgkmcnt(2)
    v_smfmac_f32_16x16x64_bf16 v[52:55], v[44:47], a[16:23], v3
    ds_read_b128 v[80:83], v8 offset:1024
    v_smfmac_f32_16x16x64_bf16 v[52:55], v[40:43], a[48:55], v3
    s_waitcnt lgkmcnt(2)
    ds_read_b128 v[84:87], v8 offset:4096
    v_smfmac_f32_16x16x64_bf16 v[52:55], v[48:51], a[80:87], v3
    ds_read_b128 v[88:91], v8 offset:5120
    v_smfmac_f32_16x16x64_bf16 v[56:59], v[44:47], a[24:31], v3
    ds_read_b128 v[92:95], v8 offset:2048
    v_smfmac_f32_16x16x64_bf16 v[56:59], v[40:43], a[56:63], v3
    ds_read_b128 v[96:99], v8 offset:3072
    v_add_f32 v52, v52, v54
    v_smfmac_f32_16x16x64_bf16 v[56:59], v[48:51], a[88:95], v3
    s_waitcnt lgkmcnt(4)
    v_add_f32 v53, v53, v55
    v_smfmac_f32_16x16x64_bf16 v[60:63], v[32:35], v[76:83], v3
    s_waitcnt lgkmcnt(2)
    v_cvt_pk_bf16_f32 v54, v52, v53
    v_smfmac_f32_16x16x64_bf16 v[60:63], v[40:43], v[84:91], v3
    v_add_f32 v56, v56, v58
    v_add_f32 v57, v57, v59
    v_cvt_pk_bf16_f32 v55, v56, v57
    v_smfmac_f32_16x16x64_bf16 v[60:63], v[44:47], a[128:135], v3
    ds_write_b64 v6, v[54:55]
    v_smfmac_f32_16x16x64_bf16 v[60:63], v[48:51], a[160:167], v3
    s_waitcnt lgkmcnt(1)
    ds_read_b128 v[52:55], v8 offset:8192
    v_mov_b32 v88, v7
    v_smfmac_f32_16x16x64_bf16 v[64:67], v[32:35], v[92:99], v3
    ds_read_b128 v[56:59], v8 offset:9216
    v_mov_b32 v89, v7
    v_smfmac_f32_16x16x64_bf16 v[64:67], v[40:43], v[12:19], v3
    ds_read_b128 v[92:95], v8 offset:10240
    v_add_f32 v60, v60, v62
    v_smfmac_f32_16x16x64_bf16 v[64:67], v[36:39], a[152:159], v3
    s_waitcnt lgkmcnt(3)
    s_barrier
    ds_read_b64_tr_b16 v[76:77], v10 offset:0
    ds_read_b64_tr_b16 v[78:79], v10 offset:1024
    v_smfmac_f32_16x16x64_bf16 v[64:67], v[44:47], a[136:143], v3
    buffer_store_dword v140, v5, s[8:11], s24 offen
    ds_read_b64_tr_b16 v[80:81], v10 offset:2048
    ds_read_b64_tr_b16 v[82:83], v10 offset:3072
    v_smfmac_f32_16x16x64_bf16 v[64:67], v[48:51], a[168:175], v3
    ds_read_b128 v[96:99], v8 offset:11264
    v_add_f32 v61, v61, v63
    v_cvt_pk_bf16_f32 v60, v60, v61
    v_smfmac_f32_16x16x64_bf16 v[68:71], v[24:27], a[176:183], v3
    s_waitcnt lgkmcnt(3)
    v_mfma_f32_16x16x32_bf16 v[84:87], v[100:103], v[76:79], 0
    buffer_store_dwordx4 v[140:143], v1, s[8:11], s26 offen
    v_add_f32 v64, v64, v66
    v_add_f32 v65, v65, v67
    v_cvt_pk_bf16_f32 v62, v64, v65
    s_waitcnt lgkmcnt(1)
    v_mfma_f32_16x16x32_bf16 v[84:87], v[104:107], v[80:83], v[84:87]
    ds_write2_b32 v6, v60, v62 offset0:128 offset1:129
    v_smfmac_f32_16x16x64_bf16 v[72:75], v[24:27], a[184:191], v3
    ds_read_b128 v[100:103], v8 offset:6144
    v_mov_b64 v[104:105], 0
    v_mov_b64 v[106:107], 0
    v_smfmac_f32_16x16x64_bf16 v[68:71], v[40:43], v[52:59], v3
    s_waitcnt lgkmcnt(2)
    buffer_store_dwordx4 v[140:143], v1, s[8:11], s26 offen offset:1024
    v_fmac_f32_dpp v88, v84, v0 quad_perm:[0,1,0,1] row_mask:0xf bank_mask:0xf
    v_fmac_f32_dpp v89, v85, v0 quad_perm:[0,1,0,1] row_mask:0xf bank_mask:0xf
    v_smfmac_f32_16x16x64_bf16 v[72:75], v[40:43], v[92:99], v3
    s_waitcnt vmcnt(10)
    v_fmac_f32_dpp v88, v86, v0 quad_perm:[2,3,2,3] row_mask:0xf bank_mask:0xf
    v_fmac_f32_dpp v89, v87, v0 quad_perm:[2,3,2,3] row_mask:0xf bank_mask:0xf
    v_mov_b32 v140, 0
    v_smfmac_f32_16x16x64_bf16 v[68:71], v[36:39], a[240:247], v3
    v_mov_b32 v142, v7
    v_smfmac_f32_16x16x64_bf16 v[72:75], v[36:39], a[248:255], v3
    s_waitcnt lgkmcnt(1)
    s_barrier
    ds_read_b64_tr_b16 v[20:21], v10 offset:512
    v_exp_f32 v90, v88
    v_smfmac_f32_16x16x64_bf16 v[68:71], v[28:31], a[192:199], v3
    ds_read_b64_tr_b16 v[22:23], v10 offset:1536
    ds_read_b64_tr_b16 v[24:25], v10 offset:2560
    ds_read_b64_tr_b16 v[26:27], v10 offset:3584
    v_exp_f32 v91, v89
    s_nop 0
    v_cvt_pk_bf16_f32 v90, v90, v91
    v_mov_b64 v[40:41], 0
    v_mov_b64 v[42:43], 0
    v_smfmac_f32_16x16x64_bf16 v[72:75], v[28:31], a[200:207], v3
    ds_write_b32 v11, v90
    v_smfmac_f32_16x16x64_bf16 v[68:71], v[32:35], a[224:231], v3
    s_cmp_eq_u32 s18, 63
    s_waitcnt lgkmcnt(3)
    v_mfma_f32_16x16x32_bf16 v[92:95], v[20:23], v[76:79], 0
    v_mov_b32 v143, v7
    s_waitcnt lgkmcnt(1)
    v_mfma_f32_16x16x32_bf16 v[92:95], v[24:27], v[80:83], v[92:95]
    v_mov_b64 v[36:37], 0
    v_mov_b64 v[38:39], 0
    v_smfmac_f32_16x16x64_bf16 v[72:75], v[32:35], a[232:239], v3
    s_waitcnt lgkmcnt(0)
    s_barrier
    ds_read_b128 v[84:87], v2
    v_smfmac_f32_16x16x64_bf16 v[68:71], v[44:47], a[208:215], v3
    v_fmac_f32_dpp v142, v92, v0 quad_perm:[0,1,0,1] row_mask:0xf bank_mask:0xf
    v_smfmac_f32_16x16x64_bf16 v[68:71], v[48:51], v[144:151], v3
    v_fmac_f32_dpp v143, v93, v0 quad_perm:[0,1,0,1] row_mask:0xf bank_mask:0xf
    v_fmac_f32_dpp v142, v94, v0 quad_perm:[2,3,2,3] row_mask:0xf bank_mask:0xf
    v_smfmac_f32_16x16x64_bf16 v[72:75], v[44:47], a[216:223], v3
    s_waitcnt lgkmcnt(0)
    v_fmac_f32_dpp v143, v95, v0 quad_perm:[2,3,2,3] row_mask:0xf bank_mask:0xf
    v_mfma_f32_16x16x32_bf16 v[64:67], v[136:139], v[84:87], 0
    v_exp_f32 v142, v142
    v_mfma_f32_16x16x32_bf16 v[52:55], v[128:131], v[84:87], 0
    v_exp_f32 v143, v143
    v_mfma_f32_16x16x32_bf16 v[56:59], v[132:135], v[84:87], 0
    v_cvt_pk_bf16_f32 v141, v142, v143
    v_add_f32 v68, v68, v70
    v_smfmac_f32_16x16x64_bf16 v[72:75], v[48:51], v[152:159], v3
    ds_read_b128 v[28:31], v8 offset:12288
    v_add_f32 v69, v69, v71
    v_mfma_f32_16x16x16_bf16 v[64:67], v[136:137], v[140:141], v[64:67]
    ds_read_b128 v[32:35], v8 offset:13312
    v_cvt_pk_bf16_f32 v61, v68, v69
    s_nop 1
    v_mfma_f32_16x16x16_bf16 v[52:55], v[60:61], v[140:141], v[52:55]
    v_add_f32 v72, v72, v74
    v_add_f32 v73, v73, v75
    v_cvt_pk_bf16_f32 v63, v72, v73
    s_cbranch_scc1 Cw0_last
    s_nop 0
    v_mfma_f32_16x16x16_bf16 v[56:59], v[62:63], v[140:141], v[56:59]
    v_rcp_f32 v64, v64
    s_nop 0
    v_pk_mul_f32 v[52:53], v[52:53], v[64:65] op_sel_hi:[1,0]
    v_pk_mul_f32 v[54:55], v[54:55], v[64:65] op_sel_hi:[1,0]
    v_cvt_pk_bf16_f32 v52, v52, v53
    v_cvt_pk_bf16_f32 v53, v54, v55
    ds_write_b64 v2, v[52:53] offset:8192
    s_nop 0
    v_pk_mul_f32 v[56:57], v[56:57], v[64:65] op_sel_hi:[1,0]
    v_pk_mul_f32 v[58:59], v[58:59], v[64:65] op_sel_hi:[1,0]
    v_cvt_pk_bf16_f32 v54, v56, v57
    v_cvt_pk_bf16_f32 v55, v58, v59
    ds_write_b64 v2, v[54:55] offset:8200
    s_nop 0
    v_smfmac_f32_16x16x64_bf16 v[100:103], v[52:55], v[160:167], v3
    v_log_f32 v65, v65
    v_smfmac_f32_16x16x64_bf16 v[104:107], v[52:55], v[192:199], v3
    v_cmp_nle_f32 vcc, |v65|, s64
    v_smfmac_f32_16x16x64_bf16 v[36:39], v[52:55], v[224:231], v3
    s_cbranch_vccnz Cw0_fix
    Cw0_fixed:
    s_waitcnt lgkmcnt(0)
    s_barrier
    ds_read_b128 v[68:71], v2 offset:9216
    ds_read_b128 v[72:75], v2 offset:10240
    ds_read_b128 v[96:99], v2 offset:11264
    v_smfmac_f32_16x16x64_bf16 v[40:43], v[52:55], v[240:247], v3
    ds_read_b128 v[20:23], v8 offset:14336
    s_waitcnt lgkmcnt(3)
    v_smfmac_f32_16x16x64_bf16 v[100:103], v[68:71], v[168:175], v3
    ds_read_b128 v[24:27], v8 offset:15360
    s_waitcnt lgkmcnt(3)
    v_smfmac_f32_16x16x64_bf16 v[100:103], v[72:75], v[176:183], v3
    ds_read_b128 v[76:79], v8 offset:16384
    s_waitcnt lgkmcnt(3)
    v_smfmac_f32_16x16x64_bf16 v[100:103], v[96:99], v[184:191], v3
    ds_read_b128 v[44:47], v8 offset:18432
    ds_read_b128 v[80:83], v8 offset:17408
    v_smfmac_f32_16x16x64_bf16 v[104:107], v[68:71], v[200:207], v3
    s_mov_b32 s24, s23
    s_add_u32 s23, s23, 0x2000
    s_bitset0_b32 s23, 15
    v_smfmac_f32_16x16x64_bf16 v[104:107], v[72:75], v[208:215], v3
    s_add_u32 s30, s23, 0x1000
    ds_read_b128 v[48:51], v8 offset:19456
    v_cvt_pk_bf16_f32 v100, v100, v102
    v_cvt_pk_bf16_f32 v101, v101, v103
    v_smfmac_f32_16x16x64_bf16 v[104:107], v[96:99], v[216:223], v3
    buffer_store_dword v100, v4, s[8:11], s19 offen offset:0
    buffer_store_dword v101, v4, s[8:11], s19 offen offset:2048
    v_smfmac_f32_16x16x64_bf16 v[36:39], v[68:71], v[232:239], v3
    s_mov_b32 s21, 1
    v_sub_f32 v7, v7, v65
    v_smfmac_f32_16x16x64_bf16 v[36:39], v[72:75], v[28:35], v3
    s_waitcnt lgkmcnt(1)
    v_cvt_pk_bf16_f32 v104, v104, v106
    v_cvt_pk_bf16_f32 v105, v105, v107
    v_smfmac_f32_16x16x64_bf16 v[36:39], v[96:99], v[20:27], v3
    buffer_store_dword v104, v4, s[8:11], s20 offen offset:0
    buffer_store_dword v105, v4, s[8:11], s20 offen offset:2048
    v_smfmac_f32_16x16x64_bf16 v[40:43], v[68:71], v[248:255], v3
    v_smfmac_f32_16x16x64_bf16 v[40:43], v[72:75], v[76:83], v3
    s_waitcnt lgkmcnt(0)
    v_cvt_pk_bf16_f32 v36, v36, v38
    v_cvt_pk_bf16_f32 v37, v37, v39
    v_smfmac_f32_16x16x64_bf16 v[40:43], v[96:99], v[44:51], v3
    buffer_store_dword v36, v4, s[8:11], s38 offen offset:0
    buffer_store_dword v37, v4, s[8:11], s38 offen offset:2048
    s_nop 5
    v_cvt_pk_bf16_f32 v40, v40, v42
    v_cvt_pk_bf16_f32 v41, v41, v43
    buffer_store_dword v40, v4, s[8:11], s22 offen offset:0
    buffer_store_dword v41, v4, s[8:11], s22 offen offset:2048
    ds_read_b128 v[72:75], v8 offset:7168
    v_pk_mov_b32 v[140:141], v[60:61], v[62:63] op_sel:[0,0]
    ds_read_b128 v[28:31], v8 offset:34816
    v_pk_mov_b32 v[142:143], v[60:61], v[62:63] op_sel:[1,1]
    ds_read_b128 v[32:35], v8 offset:35840
    v_bfe_u32 v126, v1, 2, 6
    ds_read_b128 v[36:39], v8 offset:26624
    v_mov_b64 v[68:69], 0
    ds_read_b128 v[40:43], v8 offset:27648
    buffer_load_dwordx4 v[128:131], v1, s[8:11], s25 offen offset:0 sc1
    buffer_load_dwordx4 v[132:135], v1, s[8:11], s25 offen offset:1024 sc1
    v_mov_b64 v[70:71], 0
    ds_read_b128 v[76:79], v8 offset:28672
    v_mfma_f32_16x16x1_4b_f32 v[52:67], v126, v126, 0
    ds_read_b128 v[80:83], v8 offset:29696
    ds_read_b128 v[84:87], v8 offset:30720
    ds_read_b128 v[88:91], v8 offset:31744
    ds_read_b128 v[92:95], v8 offset:32768
    s_waitcnt vmcnt(18)
    v_mov_b64 v[100:101], v[108:109]
    ds_read_b128 v[96:99], v8 offset:33792
    v_mov_b64 v[102:103], v[110:111]
    v_mov_b64 v[104:105], v[112:113]
    ds_read_b128 v[44:47], v8 offset:24576
    v_mov_b64 v[106:107], v[114:115]
    ds_read_b128 v[48:51], v8 offset:25600
    ds_read_b128 v[108:111], v8 offset:20480
    ds_read_b128 v[112:115], v8 offset:21504
    s_add_u32 s19, s18, 2
    s_cmp_ge_u32 s19, s37
    s_cbranch_scc1 Cw0_kvw
    Cw0_kvok:
    s_nop 0
    s_nop 0
    s_nop 0
    s_nop 0
    s_nop 0
    s_nop 0
    s_nop 0
    s_nop 0
    buffer_load_dwordx4 v[128:131], v1, s[8:11], s25 offen offset:0 sc1
    buffer_load_dwordx4 v[132:135], v1, s[8:11], s25 offen offset:1024 sc1
    s_branch Cw0_Pw
    Cw0_Pf:
    s_add_u32 s21, s21, 1
    v_max3_u32 v124, v128, v129, v130
    v_max3_u32 v126, v131, v132, v133
    v_max3_u32 v124, v124, v134, v135
    v_max_u32 v124, v124, v126
    v_cmp_eq_u32 vcc, -1, v124
    s_nop 0
    s_mov_b64 exec, vcc
    buffer_load_dwordx4 v[128:131], v1, s[8:11], s25 offen offset:0 sc1
    buffer_load_dwordx4 v[132:135], v1, s[8:11], s25 offen offset:1024 sc1
    s_mov_b64 exec, -1
    s_cmp_gt_u32 s21, 4
    s_cbranch_scc1 Cw0_Pre
    Cw0_Pw:
    s_waitcnt vmcnt(3) lgkmcnt(0)
    Cw0_P:
    v_mfma_f32_16x16x32_bf16 v[24:27], v[72:75], v[128:131], 0
    s_waitcnt vmcnt(2)
    v_mfma_f32_16x16x32_bf16 v[24:27], v[72:75], v[132:135], v[24:27]
    s_nop 7
    v_cmp_u_f32 vcc, v24, v24
    v_add_f32_dpp v24, v24, v24 row_ror:4 row_mask:0xf bank_mask:0xf
    v_add_f32_dpp v25, v25, v25 row_ror:4 row_mask:0xf bank_mask:0xf
    s_nop 0
    v_add_f32_dpp v24, v24, v24 row_ror:8 row_mask:0xf bank_mask:0xf
    v_add_f32_dpp v25, v25, v25 row_ror:8 row_mask:0xf bank_mask:0xf
    v_cvt_pk_bf16_f32 v124, v24, v25
    s_cbranch_vccnz Cw0_Pf
    buffer_store_dword v124, v5, s[8:11], s23 offen
    Cw0_w2:
    s_branch Cw0_step
    Cw0_kvw:
    s_mov_b32 s21, 0
    s_waitcnt vmcnt(15)
    s_branch Cw0_kvl_chk
    v_lshrrev_b32 v126, 2, v1
    v_and_b32 v126, 63, v126
    s_mov_b32 s21, 0
    Cw0_kvl:
    buffer_load_dword v127, v126, s[8:11], s29 offen sc1
    s_add_u32 s21, s21, 1
    s_cmp_gt_u32 s21, 400000
    s_cbranch_scc1 C_fail
    s_waitcnt vmcnt(0)
    Cw0_kvl_chk:
    v_min_u32_dpp v127, v127, v127 row_ror:8 row_mask:0xf bank_mask:0xf
    s_nop 1
    v_min_u32_dpp v127, v127, v127 row_ror:4 row_mask:0xf bank_mask:0xf
    s_nop 1
    v_min_u32_dpp v127, v127, v127 row_ror:2 row_mask:0xf bank_mask:0xf
    s_nop 1
    v_min_u32_dpp v127, v127, v127 row_ror:1 row_mask:0xf bank_mask:0xf
    s_nop 0
    v_readfirstlane_b32 s37, v127
    s_nop 0
    s_lshl_b32 s37, s37, 2
    s_cmp_ge_u32 s19, s37
    s_cbranch_scc1 Cw0_kvl
    s_cmp_ge_u32 s37, 12
    s_cselect_b32 s21, 12, 0
    s_cmp_ge_u32 s37, 44
    s_cselect_b32 s21, 44, s21
    s_cmp_ge_u32 s37, 64
    s_cselect_b32 s21, 1000, s21
    s_cmp_gt_u32 s21, s19
    s_cselect_b32 s37, s21, s37
    s_mov_b32 s21, 1
    s_branch Cw0_kvok
    Cw0_last:
    v_mov_b32 v124, v61
    v_mov_b32 v61, v62
    v_mov_b32 v62, v124
    buffer_store_dwordx4 v[60:63], v1, s[8:11], s33 offen sc1
    s_branch C_done
    Cw0_fix:
    v_and_b32 v124, 0x3ff, v11
    v_lshlrev_b32 v124, 1, v124
    v_add_u32 v124, 0x24800, v124
    v_lshlrev_b32 v126, 1, v1
    v_add_u32 v126, 0x24800, v126
    ds_write_b64 v124, v[88:89]
    v_mov_b32 v142, v7
    v_mov_b32 v143, v7
    s_waitcnt lgkmcnt(0)
    s_barrier
    ds_read_b128 v[68:71], v126
    ds_read_b128 v[72:75], v126 offset:16
    v_fmac_f32_dpp v142, v92, v0 quad_perm:[0,1,0,1] row_mask:0xf bank_mask:0xf
    v_fmac_f32_dpp v143, v93, v0 quad_perm:[0,1,0,1] row_mask:0xf bank_mask:0xf
    s_nop 0
    v_fmac_f32_dpp v142, v94, v0 quad_perm:[2,3,2,3] row_mask:0xf bank_mask:0xf
    v_fmac_f32_dpp v143, v95, v0 quad_perm:[2,3,2,3] row_mask:0xf bank_mask:0xf
    s_waitcnt lgkmcnt(0)
    v_max3_f32 v124, v68, v69, v70
    v_max3_f32 v124, v124, v71, v72
    v_max3_f32 v124, v124, v73, v74
    v_max3_f32 v124, v124, v75, v142
    v_max_f32 v124, v124, v143
    v_mov_b32 v126, v124
    s_nop 1
    v_permlane32_swap_b32 v124, v126
    v_max_f32 v124, v124, v126
    v_mov_b32 v126, v124
    s_nop 1
    v_permlane16_swap_b32 v124, v126
    v_max_f32 v124, v124, v126
    v_sub_f32 v7, v7, v124
    v_sub_f32 v68, v68, v124
    v_sub_f32 v69, v69, v124
    v_sub_f32 v70, v70, v124
    v_sub_f32 v71, v71, v124
    v_sub_f32 v72, v72, v124
    v_sub_f32 v73, v73, v124
    v_sub_f32 v74, v74, v124
    v_sub_f32 v75, v75, v124
    v_sub_f32 v142, v142, v124
    v_sub_f32 v143, v143, v124
    v_exp_f32 v68, v68
    v_exp_f32 v69, v69
    v_exp_f32 v70, v70
    v_exp_f32 v71, v71
    v_exp_f32 v72, v72
    v_exp_f32 v73, v73
    v_exp_f32 v74, v74
    v_exp_f32 v75, v75
    v_exp_f32 v142, v142
    v_exp_f32 v143, v143
    v_cvt_pk_bf16_f32 v84, v68, v69
    v_cvt_pk_bf16_f32 v85, v70, v71
    v_cvt_pk_bf16_f32 v86, v72, v73
    v_cvt_pk_bf16_f32 v87, v74, v75
    v_cvt_pk_bf16_f32 v141, v142, v143
    s_nop 0
    v_mfma_f32_16x16x32_bf16 v[64:67], v[136:139], v[84:87], 0
    v_mfma_f32_16x16x32_bf16 v[52:55], v[128:131], v[84:87], 0
    v_mfma_f32_16x16x32_bf16 v[56:59], v[132:135], v[84:87], 0
    v_mfma_f32_16x16x16_bf16 v[64:67], v[136:137], v[140:141], v[64:67]
    v_mfma_f32_16x16x16_bf16 v[52:55], v[60:61], v[140:141], v[52:55]
    v_mfma_f32_16x16x16_bf16 v[56:59], v[62:63], v[140:141], v[56:59]
    v_rcp_f32 v64, v64
    s_nop 2
    v_pk_mul_f32 v[52:53], v[52:53], v[64:65] op_sel_hi:[1,0]
    v_pk_mul_f32 v[54:55], v[54:55], v[64:65] op_sel_hi:[1,0]
    v_cvt_pk_bf16_f32 v52, v52, v53
    v_cvt_pk_bf16_f32 v53, v54, v55
    v_pk_mul_f32 v[56:57], v[56:57], v[64:65] op_sel_hi:[1,0]
    v_pk_mul_f32 v[58:59], v[58:59], v[64:65] op_sel_hi:[1,0]
    v_cvt_pk_bf16_f32 v54, v56, v57
    v_cvt_pk_bf16_f32 v55, v58, v59
    ds_write_b64 v2, v[52:53] offset:8192
    ds_write_b64 v2, v[54:55] offset:8200
    v_mov_b64 v[100:101], 0
    v_mov_b64 v[102:103], 0
    v_mov_b64 v[104:105], 0
    v_mov_b64 v[106:107], 0
    v_mov_b64 v[36:37], 0
    v_mov_b64 v[38:39], 0
    v_log_f32 v65, v65
    v_smfmac_f32_16x16x64_bf16 v[100:103], v[52:55], v[160:167], v3
    v_smfmac_f32_16x16x64_bf16 v[104:107], v[52:55], v[192:199], v3
    v_smfmac_f32_16x16x64_bf16 v[36:39], v[52:55], v[224:231], v3
    s_waitcnt lgkmcnt(0)
    s_branch Cw0_fixed
    Cw1_entry:
    s_mov_b32 s23, 0x86000
    s_mov_b32 s24, s23
    s_add_u32 s23, s23, 0x2000
    s_bitset0_b32 s23, 15
    s_add_u32 s30, s23, 0x1000
    buffer_load_dwordx4 v[20:23], v125, s[8:11], s23 offen offset:1024 sc1
    buffer_load_dwordx4 v[24:27], v125, s[8:11], s30 offen offset:1024 sc1
    s_mov_b32 s18, -1
    v_mov_b32 v136, 0x3f803f80
    v_mov_b32 v137, 0x3f803f80
    v_mov_b32 v138, 0x3f803f80
    v_mov_b32 v139, 0x3f803f80
    s_mov_b32 s64, 0x42700000
    v_lshlrev_b32 v124, v1, v136
    v_lshrrev_b32 v126, 16, v136
    v_bfe_i32 v52, v1, 4, 1
    v_bfi_b32 v124, v52, v124, v126
    v_bfe_u32 v126, v1, 6, 2
    v_cmp_eq_u32 vcc, 0, v126
    s_nop 1
    v_cndmask_b32 v52, 0, v124, vcc
    v_cmp_eq_u32 vcc, 1, v126
    s_nop 1
    v_cndmask_b32 v53, 0, v124, vcc
    v_cmp_eq_u32 vcc, 2, v126
    s_nop 1
    v_cndmask_b32 v54, 0, v124, vcc
    v_cmp_eq_u32 vcc, 3, v126
    s_nop 1
    v_cndmask_b32 v55, 0, v124, vcc
    ds_write_b128 v8, v[52:55] offset:7168
    s_waitcnt lgkmcnt(0)
    v_pk_mov_b32 v[140:141], v[60:61], v[62:63] op_sel:[0,0]
    ds_read_b128 v[28:31], v8 offset:34816
    v_pk_mov_b32 v[142:143], v[60:61], v[62:63] op_sel:[1,1]
    ds_read_b128 v[32:35], v8 offset:35840
    v_bfe_u32 v126, v1, 2, 6
    ds_read_b128 v[36:39], v8 offset:26624
    v_mov_b64 v[68:69], 0
    ds_read_b128 v[40:43], v8 offset:27648
    v_mov_b64 v[70:71], 0
    ds_read_b128 v[76:79], v8 offset:28672
    v_mfma_f32_16x16x1_4b_f32 v[52:67], v126, v126, 0
    ds_read_b128 v[80:83], v8 offset:29696
    ds_read_b128 v[84:87], v8 offset:30720
    ds_read_b128 v[88:91], v8 offset:31744
    ds_read_b128 v[92:95], v8 offset:32768
    s_waitcnt vmcnt(2)
    v_mov_b64 v[100:101], v[108:109]
    ds_read_b128 v[96:99], v8 offset:33792
    v_mov_b64 v[102:103], v[110:111]
    v_mov_b64 v[104:105], v[112:113]
    ds_read_b128 v[44:47], v8 offset:24576
    v_mov_b64 v[106:107], v[114:115]
    ds_read_b128 v[48:51], v8 offset:25600
    ds_read_b128 v[108:111], v8 offset:20480
    ds_read_b128 v[112:115], v8 offset:21504
    s_mov_b32 s62, 0x00010001
    s_lshl_b32 s63, s16, 1
    s_add_u32 s63, s63, 0x88000
    s_and_b32 s65, s16, 3
    s_lshl_b32 s65, s65, 7
    s_add_u32 s65, s65, 0x88000
    s_xor_b32 s25, s25, 0x40000
    s_xor_b32 s26, s26, 0x40000
    v_bfe_u32 v126, v1, 2, 6
    v_mov_b64 v[72:73], 0
    v_mov_b64 v[74:75], 0
    s_add_u32 s18, s18, 1
    s_xor_b32 s25, s25, 0x40000
    s_xor_b32 s26, s26, 0x40000
    s_add_u32 s19, s18, 2
    s_cmp_ge_u32 s19, s37
    s_cselect_b32 s36, s29, 0x7ff00000
    s_add_u32 s31, s31, 0x40000
    s_add_u32 s32, s32, 0x40000
    s_mov_b32 s21, 1
    s_mov_b32 s35, 1
    s_waitcnt vmcnt(2)
    v_mov_b64 v[128:129], v[116:117]
    v_mov_b64 v[130:131], v[118:119]
    v_mov_b64 v[132:133], v[120:121]
    v_mov_b64 v[134:135], v[122:123]
    ds_read_b128 v[116:119], v8 offset:22528
    ds_read_b128 v[120:123], v8 offset:23552
    s_waitcnt vmcnt(0)
    s_branch Cw1_Aw
    Cw1_Bf:
    s_add_u32 s35, s35, 1
    s_cmp_gt_u32 s35, 2
    s_cbranch_scc1 Cw1_Bre
    s_nop 6
    v_mov_b64 v[60:61], 0
    v_mov_b64 v[62:63], 0
    v_mov_b64 v[64:65], 0
    v_mov_b64 v[66:67], 0
    v_smfmac_f32_16x16x64_bf16 v[60:63], v[20:23], v[76:83], v3
    s_nop 0
    v_smfmac_f32_16x16x64_bf16 v[64:67], v[20:23], v[84:91], v3
    s_waitcnt vmcnt(3)
    s_branch Cw1_Bw
    Cw1_Are:
    s_waitcnt vmcnt(0)
    Cw1_Arl:
    s_mov_b64 exec, vcc
    buffer_load_dwordx4 v[20:23], v125, s[8:11], s23 offen offset:1024 sc1
    s_mov_b64 exec, -1
    buffer_load_dwordx4 v[24:27], v125, s[8:11], s30 offen offset:1024 sc1
    s_add_u32 s21, s21, 1
    s_cmp_gt_u32 s21, 400000
    s_cbranch_scc1 C_fail
    s_waitcnt vmcnt(6)
    v_mov_b64 v[52:53], 0
    v_mov_b64 v[54:55], 0
    v_mov_b64 v[56:57], 0
    v_mov_b64 v[58:59], 0
    v_mov_b64 v[60:61], 0
    v_mov_b64 v[62:63], 0
    v_max3_u32 v124, v20, v21, v22
    v_max_u32 v124, v124, v23
    v_cmp_eq_u32 vcc, -1, v124
    s_cbranch_vccz Cw1_Adn
    Cw1_Ack:
    v_max3_u32 v124, v20, v21, v22
    v_max_u32 v124, v124, v23
    v_cmp_eq_u32 vcc, -1, v124
    s_cbranch_vccnz Cw1_Arl
    Cw1_Adn:
    v_smfmac_f32_16x16x64_bf16 v[52:55], v[20:23], v[108:115], v3
    ds_write_b128 v2, v[20:23] offset:2048
    v_smfmac_f32_16x16x64_bf16 v[56:59], v[20:23], v[116:123], v3
    buffer_load_dwordx4 v[24:27], v125, s[8:11], s30 offen offset:1024 sc1
    v_smfmac_f32_16x16x64_bf16 v[60:63], v[20:23], v[76:83], v3
    s_barrier
    buffer_load_dwordx4 v[108:111], v9, s[8:11], s31 offen sc1
    v_smfmac_f32_16x16x64_bf16 v[64:67], v[20:23], v[84:91], v3
    buffer_load_dwordx4 v[112:115], v9, s[8:11], s31 offen offset:2048 sc1
    v_smfmac_f32_16x16x64_bf16 v[68:71], v[20:23], v[92:99], v3
    buffer_load_dwordx4 v[116:119], v1, s[8:11], s32 offen sc1
    v_smfmac_f32_16x16x64_bf16 v[72:75], v[20:23], v[28:35], v3
    s_waitcnt lgkmcnt(0)
    s_barrier
    ds_read_b128 v[28:31], v2 offset:0
    ds_read_b128 v[32:35], v2 offset:6144
    s_branch Cw1_Bck
    Cw1_Bre:
    Cw1_Brl:
    s_mov_b64 exec, vcc
    buffer_load_dwordx4 v[24:27], v125, s[8:11], s30 offen offset:1024 sc1
    s_mov_b64 exec, -1
    s_add_u32 s35, s35, 1
    s_cmp_gt_u32 s35, 400000
    s_cbranch_scc1 C_fail
    s_waitcnt vmcnt(6)
    v_max3_u32 v124, v24, v25, v26
    v_max_u32 v124, v124, v27
    v_cmp_eq_u32 vcc, -1, v124
    s_cbranch_vccz Cw1_Bdn
    Cw1_Bck:
    v_max3_u32 v124, v24, v25, v26
    v_max_u32 v124, v124, v27
    v_cmp_eq_u32 vcc, -1, v124
    s_cbranch_vccnz Cw1_Brl
    Cw1_Bdn:
    ds_write_b128 v2, v[24:27] offset:3072
    v_mov_b64 v[60:61], 0
    v_mov_b64 v[62:63], 0
    v_mov_b64 v[64:65], 0
    v_mov_b64 v[66:67], 0
    v_smfmac_f32_16x16x64_bf16 v[60:63], v[20:23], v[76:83], v3
    s_nop 0
    v_smfmac_f32_16x16x64_bf16 v[64:67], v[20:23], v[84:91], v3
    v_smfmac_f32_16x16x64_bf16 v[60:63], v[24:27], a[96:103], v3
    v_smfmac_f32_16x16x64_bf16 v[64:67], v[24:27], a[104:111], v3
    s_waitcnt vmcnt(0)
    s_waitcnt lgkmcnt(0)
    s_branch Cw1_Bok
    Cw1_Pre:
    Cw1_Prl:
    s_mov_b64 exec, vcc
    buffer_load_dwordx4 v[128:131], v1, s[8:11], s25 offen offset:0 sc1
    buffer_load_dwordx4 v[132:135], v1, s[8:11], s25 offen offset:1024 sc1
    s_mov_b64 exec, -1
    s_add_u32 s21, s21, 1
    s_cmp_gt_u32 s21, 400000
    s_cbranch_scc1 C_fail
    s_waitcnt vmcnt(8)
    v_max3_u32 v124, v128, v129, v130
    v_max3_u32 v126, v131, v132, v133
    v_max3_u32 v124, v124, v134, v135
    v_max_u32 v124, v124, v126
    v_cmp_eq_u32 vcc, -1, v124
    s_cbranch_vccz Cw1_Pdn
    Cw1_Pck:
    v_max3_u32 v124, v128, v129, v130
    v_max3_u32 v126, v131, v132, v133
    v_max3_u32 v124, v124, v134, v135
    v_max_u32 v124, v124, v126
    v_cmp_eq_u32 vcc, -1, v124
    s_cbranch_vccnz Cw1_Prl
    Cw1_Pdn:
    v_mfma_f32_16x16x32_bf16 v[24:27], v[72:75], v[128:131], 0
    v_mfma_f32_16x16x32_bf16 v[24:27], v[72:75], v[132:135], v[24:27]
    s_nop 7
    v_add_f32_dpp v24, v24, v24 row_ror:4 row_mask:0xf bank_mask:0xf
    v_add_f32_dpp v25, v25, v25 row_ror:4 row_mask:0xf bank_mask:0xf
    s_nop 0
    v_add_f32_dpp v24, v24, v24 row_ror:8 row_mask:0xf bank_mask:0xf
    v_add_f32_dpp v25, v25, v25 row_ror:8 row_mask:0xf bank_mask:0xf
    v_cvt_pk_bf16_f32 v124, v24, v25
    buffer_store_dword v124, v5, s[8:11], s23 offen
    s_waitcnt vmcnt(1)
    s_branch Cw1_w2
.p2align 6
    Cw1_step:
    v_bfe_u32 v126, v1, 2, 6
    v_mov_b64 v[72:73], 0
    v_mov_b64 v[74:75], 0
    s_add_u32 s18, s18, 1
    s_xor_b32 s25, s25, 0x40000
    s_xor_b32 s26, s26, 0x40000
    s_add_u32 s19, s18, 2
    s_cmp_ge_u32 s19, s37
    s_cselect_b32 s36, s29, 0x7ff00000
    s_add_u32 s31, s31, 0x40000
    s_add_u32 s32, s32, 0x40000
    s_mov_b32 s21, 1
    s_mov_b32 s35, 1
    s_waitcnt vmcnt(1)
    v_mov_b64 v[128:129], v[116:117]
    v_mov_b64 v[130:131], v[118:119]
    v_mov_b64 v[132:133], v[120:121]
    v_mov_b64 v[134:135], v[122:123]
    ds_read_b128 v[116:119], v8 offset:22528
    ds_read_b128 v[120:123], v8 offset:23552
    s_nop 0
    s_nop 0
    s_nop 0
    s_nop 0
    s_nop 0
    s_nop 0
    s_nop 0
    s_nop 0
    s_nop 0
    s_nop 0
    s_nop 0
    s_nop 0
    s_nop 0
    s_nop 0
    s_nop 0
    buffer_load_dwordx4 v[20:23], v125, s[8:11], s23 offen offset:1024 sc1
    s_nop 0
    buffer_load_dword v127, off, s[8:11], s23
    s_nop 0
    s_nop 0
    s_nop 0
    s_nop 0
    s_nop 0
    s_nop 0
    s_nop 0
    s_nop 0
    s_nop 0
    s_nop 0
    s_nop 0
    s_nop 0
    s_nop 0
    s_nop 0
    s_nop 0
    s_nop 0
    s_nop 0
    s_nop 0
    s_nop 0
    s_nop 0
    s_nop 0
    buffer_load_dwordx4 v[20:23], v125, s[8:11], s23 offen offset:1024 sc1
    s_nop 0
    s_nop 0
    s_nop 0
    s_nop 0
    s_nop 0
    s_nop 0
    s_nop 0
    s_nop 0
    s_nop 0
    s_nop 0
    s_nop 0
    buffer_load_dwordx4 v[24:27], v125, s[8:11], s30 offen offset:1024 sc1
    s_branch Cw1_Aw
    Cw1_Af:
    v_mfma_f32_16x16x1_4b_f32 v[52:67], v126, v126, 0
    s_mov_b64 exec, vcc
    buffer_load_dwordx4 v[20:23], v125, s[8:11], s23 offen offset:1024 sc1
    s_mov_b64 exec, -1
    buffer_load_dwordx4 v[24:27], v125, s[8:11], s30 offen offset:1024 sc1
    s_add_u32 s21, s21, 1
    s_cmp_gt_u32 s21, 6
    s_cbranch_scc1 Cw1_Are
    s_nop 0
    s_nop 0
    s_nop 0
    Cw1_Aw:
    s_waitcnt vmcnt(3) lgkmcnt(0)
    v_fma_f32 v124, v20, v21, v22
    v_cmp_u_f32 vcc, v124, v23
    v_smfmac_f32_16x16x64_bf16 v[52:55], v[20:23], v[108:115], v3
    ds_write_b128 v2, v[20:23] offset:2048
    v_smfmac_f32_16x16x64_bf16 v[56:59], v[20:23], v[116:123], v3
    s_cbranch_vccnz Cw1_Af
    buffer_load_dwordx4 v[24:27], v125, s[8:11], s30 offen offset:1024 sc1
    v_smfmac_f32_16x16x64_bf16 v[60:63], v[20:23], v[76:83], v3
    s_barrier
    buffer_load_dwordx4 v[108:111], v9, s[8:11], s31 offen sc1
    v_smfmac_f32_16x16x64_bf16 v[64:67], v[20:23], v[84:91], v3
    buffer_load_dwordx4 v[112:115], v9, s[8:11], s31 offen offset:2048 sc1
    v_smfmac_f32_16x16x64_bf16 v[68:71], v[20:23], v[92:99], v3
    buffer_load_dwordx4 v[116:119], v1, s[8:11], s32 offen sc1
    v_smfmac_f32_16x16x64_bf16 v[72:75], v[20:23], v[28:35], v3
    s_waitcnt lgkmcnt(0)
    s_barrier
    ds_read_b128 v[28:31], v2 offset:0
    ds_read_b128 v[32:35], v2 offset:6144
    Cw1_Bw:
    s_waitcnt vmcnt(4)
    v_fma_f32 v124, v24, v25, v26
    v_cmp_u_f32 vcc, v124, v27
    v_smfmac_f32_16x16x64_bf16 v[60:63], v[24:27], a[96:103], v3
    ds_write_b128 v2, v[24:27] offset:3072
    v_smfmac_f32_16x16x64_bf16 v[64:67], v[24:27], a[104:111], v3
    s_cbranch_vccnz Cw1_Bf
    Cw1_Bok:
    buffer_store_dwordx4 v[140:143], v1, s[8:11], s33 offen sc1
    buffer_load_dword v127, v126, s[8:11], s36 offen sc1
    v_smfmac_f32_16x16x64_bf16 v[52:55], v[24:27], v[44:51], v3
    s_mov_b32 s33, s34
    buffer_load_dwordx4 v[120:123], v1, s[8:11], s32 offen offset:1024 sc1
    v_mov_b64 v[140:141], -1
    v_smfmac_f32_16x16x64_bf16 v[56:59], v[24:27], v[36:43], v3
    ds_read_b128 v[36:39], v2 offset:4096
    s_waitcnt lgkmcnt(3)
    v_smfmac_f32_16x16x64_bf16 v[52:55], v[28:31], a[0:7], v3
    s_add_u32 s34, s34, 0x20000
    v_mov_b64 v[142:143], -1
    v_smfmac_f32_16x16x64_bf16 v[56:59], v[28:31], a[8:15], v3
    s_waitcnt lgkmcnt(1)
    v_smfmac_f32_16x16x64_bf16 v[52:55], v[32:35], a[32:39], v3
    s_barrier
    ds_read_b128 v[44:47], v2 offset:1024
    v_smfmac_f32_16x16x64_bf16 v[56:59], v[32:35], a[40:47], v3
    s_waitcnt lgkmcnt(1)
    s_mov_b32 s19, s27
    ds_read_b128 v[40:43], v2 offset:7168
    v_smfmac_f32_16x16x64_bf16 v[52:55], v[36:39], a[64:71], v3
    s_add_u32 s20, s27, 0x10000
    s_add_u32 s38, s27, 0x20000
    ds_read_b128 v[48:51], v2 offset:5120
    v_smfmac_f32_16x16x64_bf16 v[56:59], v[36:39], a[72:79], v3
    s_add_u32 s22, s27, 0x30000
    s_xor_b32 s27, s27, 0x40000
    s_add_u32 s62, s62, 0x00010001
    v_smfmac_f32_16x16x64_bf16 v[60:63], v[28:31], a[112:119], v3
    v_smfmac_f32_16x16x64_bf16 v[60:63], v[36:39], a[144:151], v3
    ds_read_b128 v[76:79], v8 offset:0
    v_smfmac_f32_16x16x64_bf16 v[64:67], v[28:31], a[120:127], v3
    s_waitcnt lgkmcnt(2)
    v_smfmac_f32_16x16x64_bf16 v[52:55], v[44:47], a[16:23], v3
    ds_read_b128 v[80:83], v8 offset:1024
    v_smfmac_f32_16x16x64_bf16 v[52:55], v[40:43], a[48:55], v3
    s_waitcnt lgkmcnt(2)
    ds_read_b128 v[84:87], v8 offset:4096
    v_smfmac_f32_16x16x64_bf16 v[52:55], v[48:51], a[80:87], v3
    ds_read_b128 v[88:91], v8 offset:5120
    v_smfmac_f32_16x16x64_bf16 v[56:59], v[44:47], a[24:31], v3
    ds_read_b128 v[92:95], v8 offset:2048
    v_smfmac_f32_16x16x64_bf16 v[56:59], v[40:43], a[56:63], v3
    ds_read_b128 v[96:99], v8 offset:3072
    v_add_f32 v52, v52, v54
    v_smfmac_f32_16x16x64_bf16 v[56:59], v[48:51], a[88:95], v3
    s_waitcnt lgkmcnt(4)
    v_add_f32 v53, v53, v55
    v_smfmac_f32_16x16x64_bf16 v[60:63], v[32:35], v[76:83], v3
    s_waitcnt lgkmcnt(2)
    v_cvt_pk_bf16_f32 v54, v52, v53
    v_smfmac_f32_16x16x64_bf16 v[60:63], v[40:43], v[84:91], v3
    v_add_f32 v56, v56, v58
    v_add_f32 v57, v57, v59
    v_cvt_pk_bf16_f32 v55, v56, v57
    v_smfmac_f32_16x16x64_bf16 v[60:63], v[44:47], a[128:135], v3
    ds_write_b64 v6, v[54:55]
    v_smfmac_f32_16x16x64_bf16 v[60:63], v[48:51], a[160:167], v3
    s_waitcnt lgkmcnt(1)
    ds_read_b128 v[52:55], v8 offset:8192
    v_mov_b32 v88, v7
    v_smfmac_f32_16x16x64_bf16 v[64:67], v[32:35], v[92:99], v3
    ds_read_b128 v[56:59], v8 offset:9216
    v_mov_b32 v89, v7
    v_smfmac_f32_16x16x64_bf16 v[64:67], v[40:43], v[12:19], v3
    ds_read_b128 v[92:95], v8 offset:10240
    v_add_f32 v60, v60, v62
    v_add_f32 v61, v61, v63
    v_cvt_pk_bf16_f32 v60, v60, v61
    v_smfmac_f32_16x16x64_bf16 v[64:67], v[36:39], a[152:159], v3
    s_waitcnt lgkmcnt(3)
    s_barrier
    ds_read_b64_tr_b16 v[76:77], v10 offset:0
    ds_read_b64_tr_b16 v[78:79], v10 offset:1024
    v_smfmac_f32_16x16x64_bf16 v[64:67], v[44:47], a[136:143], v3
    ds_read_b64_tr_b16 v[80:81], v10 offset:2048
    ds_read_b64_tr_b16 v[82:83], v10 offset:3072
    v_smfmac_f32_16x16x64_bf16 v[64:67], v[48:51], a[168:175], v3
    buffer_store_dword v140, v5, s[8:11], s24 offen
    v_smfmac_f32_16x16x64_bf16 v[68:71], v[24:27], a[176:183], v3
    ds_read_b128 v[96:99], v8 offset:11264
    s_waitcnt lgkmcnt(3)
    v_mfma_f32_16x16x32_bf16 v[84:87], v[100:103], v[76:79], 0
    v_add_f32 v64, v64, v66
    v_add_f32 v65, v65, v67
    v_cvt_pk_bf16_f32 v62, v64, v65
    s_waitcnt lgkmcnt(1)
    v_mfma_f32_16x16x32_bf16 v[84:87], v[104:107], v[80:83], v[84:87]
    buffer_store_dwordx4 v[140:143], v1, s[8:11], s26 offen
    ds_write2_b32 v6, v60, v62 offset0:128 offset1:129
    v_smfmac_f32_16x16x64_bf16 v[72:75], v[24:27], a[184:191], v3
    ds_read_b128 v[100:103], v8 offset:6144
    v_mov_b64 v[104:105], 0
    v_mov_b64 v[106:107], 0
    v_smfmac_f32_16x16x64_bf16 v[68:71], v[40:43], v[52:59], v3
    s_waitcnt lgkmcnt(2)
    v_fmac_f32_dpp v88, v84, v0 quad_perm:[0,1,0,1] row_mask:0xf bank_mask:0xf
    v_fmac_f32_dpp v89, v85, v0 quad_perm:[0,1,0,1] row_mask:0xf bank_mask:0xf
    v_smfmac_f32_16x16x64_bf16 v[72:75], v[40:43], v[92:99], v3
    s_waitcnt vmcnt(8)
    buffer_store_dwordx4 v[140:143], v1, s[8:11], s26 offen offset:1024
    v_fmac_f32_dpp v88, v86, v0 quad_perm:[2,3,2,3] row_mask:0xf bank_mask:0xf
    v_fmac_f32_dpp v89, v87, v0 quad_perm:[2,3,2,3] row_mask:0xf bank_mask:0xf
    v_smfmac_f32_16x16x64_bf16 v[68:71], v[36:39], a[240:247], v3
    v_mov_b32 v142, v7
    v_mov_b32 v140, 0
    v_smfmac_f32_16x16x64_bf16 v[72:75], v[36:39], a[248:255], v3
    s_waitcnt lgkmcnt(1)
    s_barrier
    ds_read_b64_tr_b16 v[20:21], v10 offset:512
    v_exp_f32 v90, v88
    v_smfmac_f32_16x16x64_bf16 v[68:71], v[28:31], a[192:199], v3
    ds_read_b64_tr_b16 v[22:23], v10 offset:1536
    ds_read_b64_tr_b16 v[24:25], v10 offset:2560
    ds_read_b64_tr_b16 v[26:27], v10 offset:3584
    v_exp_f32 v91, v89
    s_nop 0
    v_cvt_pk_bf16_f32 v90, v90, v91
    v_mov_b64 v[40:41], 0
    v_mov_b64 v[42:43], 0
    v_smfmac_f32_16x16x64_bf16 v[72:75], v[28:31], a[200:207], v3
    ds_write_b32 v11, v90
    v_smfmac_f32_16x16x64_bf16 v[68:71], v[32:35], a[224:231], v3
    s_cmp_eq_u32 s18, 63
    s_waitcnt lgkmcnt(3)
    v_mfma_f32_16x16x32_bf16 v[92:95], v[20:23], v[76:79], 0
    v_mov_b32 v143, v7
    s_waitcnt lgkmcnt(1)
    v_mfma_f32_16x16x32_bf16 v[92:95], v[24:27], v[80:83], v[92:95]
    v_mov_b64 v[36:37], 0
    v_mov_b64 v[38:39], 0
    v_smfmac_f32_16x16x64_bf16 v[72:75], v[32:35], a[232:239], v3
    s_waitcnt lgkmcnt(0)
    s_barrier
    ds_read_b128 v[84:87], v2
    v_smfmac_f32_16x16x64_bf16 v[68:71], v[44:47], a[208:215], v3
    v_fmac_f32_dpp v142, v92, v0 quad_perm:[0,1,0,1] row_mask:0xf bank_mask:0xf
    v_smfmac_f32_16x16x64_bf16 v[68:71], v[48:51], v[144:151], v3
    v_fmac_f32_dpp v143, v93, v0 quad_perm:[0,1,0,1] row_mask:0xf bank_mask:0xf
    v_fmac_f32_dpp v142, v94, v0 quad_perm:[2,3,2,3] row_mask:0xf bank_mask:0xf
    v_smfmac_f32_16x16x64_bf16 v[72:75], v[44:47], a[216:223], v3
    s_waitcnt lgkmcnt(0)
    v_fmac_f32_dpp v143, v95, v0 quad_perm:[2,3,2,3] row_mask:0xf bank_mask:0xf
    v_mfma_f32_16x16x32_bf16 v[64:67], v[136:139], v[84:87], 0
    v_exp_f32 v142, v142
    v_mfma_f32_16x16x32_bf16 v[52:55], v[128:131], v[84:87], 0
    v_exp_f32 v143, v143
    v_mfma_f32_16x16x32_bf16 v[56:59], v[132:135], v[84:87], 0
    v_cvt_pk_bf16_f32 v141, v142, v143
    v_add_f32 v68, v68, v70
    v_smfmac_f32_16x16x64_bf16 v[72:75], v[48:51], v[152:159], v3
    ds_read_b128 v[28:31], v8 offset:12288
    v_add_f32 v69, v69, v71
    v_mfma_f32_16x16x16_bf16 v[64:67], v[136:137], v[140:141], v[64:67]
    ds_read_b128 v[32:35], v8 offset:13312
    v_cvt_pk_bf16_f32 v61, v68, v69
    s_nop 1
    v_mfma_f32_16x16x16_bf16 v[52:55], v[60:61], v[140:141], v[52:55]
    v_add_f32 v72, v72, v74
    v_add_f32 v73, v73, v75
    v_cvt_pk_bf16_f32 v63, v72, v73
    s_cbranch_scc1 Cw1_last
    s_nop 0
    v_mfma_f32_16x16x16_bf16 v[56:59], v[62:63], v[140:141], v[56:59]
    v_rcp_f32 v64, v64
    s_nop 0
    v_pk_mul_f32 v[52:53], v[52:53], v[64:65] op_sel_hi:[1,0]
    v_pk_mul_f32 v[54:55], v[54:55], v[64:65] op_sel_hi:[1,0]
    v_cvt_pk_bf16_f32 v52, v52, v53
    v_cvt_pk_bf16_f32 v53, v54, v55
    ds_write_b64 v2, v[52:53] offset:9216
    s_nop 0
    v_pk_mul_f32 v[56:57], v[56:57], v[64:65] op_sel_hi:[1,0]
    v_pk_mul_f32 v[58:59], v[58:59], v[64:65] op_sel_hi:[1,0]
    v_cvt_pk_bf16_f32 v54, v56, v57
    v_cvt_pk_bf16_f32 v55, v58, v59
    ds_write_b64 v2, v[54:55] offset:9224
    s_nop 0
    v_smfmac_f32_16x16x64_bf16 v[100:103], v[52:55], v[160:167], v3
    v_log_f32 v65, v65
    v_smfmac_f32_16x16x64_bf16 v[104:107], v[52:55], v[192:199], v3
    v_cmp_nle_f32 vcc, |v65|, s64
    v_smfmac_f32_16x16x64_bf16 v[36:39], v[52:55], v[224:231], v3
    s_cbranch_vccnz Cw1_fix
    Cw1_fixed:
    s_waitcnt lgkmcnt(0)
    s_barrier
    ds_read_b128 v[68:71], v2 offset:8192
    ds_read_b128 v[72:75], v2 offset:11264
    ds_read_b128 v[96:99], v2 offset:10240
    v_smfmac_f32_16x16x64_bf16 v[40:43], v[52:55], v[240:247], v3
    ds_read_b128 v[20:23], v8 offset:14336
    s_waitcnt lgkmcnt(3)
    v_smfmac_f32_16x16x64_bf16 v[100:103], v[68:71], v[168:175], v3
    ds_read_b128 v[24:27], v8 offset:15360
    s_waitcnt lgkmcnt(3)
    v_smfmac_f32_16x16x64_bf16 v[100:103], v[72:75], v[176:183], v3
    ds_read_b128 v[76:79], v8 offset:16384
    s_waitcnt lgkmcnt(3)
    v_smfmac_f32_16x16x64_bf16 v[100:103], v[96:99], v[184:191], v3
    ds_read_b128 v[44:47], v8 offset:18432
    ds_read_b128 v[80:83], v8 offset:17408
    v_smfmac_f32_16x16x64_bf16 v[104:107], v[68:71], v[200:207], v3
    s_mov_b32 s24, s23
    s_add_u32 s23, s23, 0x2000
    s_bitset0_b32 s23, 15
    v_smfmac_f32_16x16x64_bf16 v[104:107], v[72:75], v[208:215], v3
    s_add_u32 s30, s23, 0x1000
    ds_read_b128 v[48:51], v8 offset:19456
    v_cvt_pk_bf16_f32 v100, v100, v102
    v_cvt_pk_bf16_f32 v101, v101, v103
    v_smfmac_f32_16x16x64_bf16 v[104:107], v[96:99], v[216:223], v3
    buffer_store_dword v100, v4, s[8:11], s19 offen offset:0
    buffer_store_dword v101, v4, s[8:11], s19 offen offset:2048
    v_smfmac_f32_16x16x64_bf16 v[36:39], v[68:71], v[232:239], v3
    s_mov_b32 s21, 1
    v_sub_f32 v7, v7, v65
    v_smfmac_f32_16x16x64_bf16 v[36:39], v[72:75], v[28:35], v3
    s_waitcnt lgkmcnt(1)
    v_cvt_pk_bf16_f32 v104, v104, v106
    v_cvt_pk_bf16_f32 v105, v105, v107
    v_smfmac_f32_16x16x64_bf16 v[36:39], v[96:99], v[20:27], v3
    buffer_store_dword v104, v4, s[8:11], s20 offen offset:0
    buffer_store_dword v105, v4, s[8:11], s20 offen offset:2048
    v_smfmac_f32_16x16x64_bf16 v[40:43], v[68:71], v[248:255], v3
    v_smfmac_f32_16x16x64_bf16 v[40:43], v[72:75], v[76:83], v3
    s_waitcnt lgkmcnt(0)
    v_cvt_pk_bf16_f32 v36, v36, v38
    v_cvt_pk_bf16_f32 v37, v37, v39
    v_smfmac_f32_16x16x64_bf16 v[40:43], v[96:99], v[44:51], v3
    buffer_store_dword v36, v4, s[8:11], s38 offen offset:0
    buffer_store_dword v37, v4, s[8:11], s38 offen offset:2048
    s_nop 5
    v_cvt_pk_bf16_f32 v40, v40, v42
    v_cvt_pk_bf16_f32 v41, v41, v43
    buffer_store_dword v40, v4, s[8:11], s22 offen offset:0
    buffer_store_dword v41, v4, s[8:11], s22 offen offset:2048
    ds_read_b128 v[72:75], v8 offset:7168
    v_pk_mov_b32 v[140:141], v[60:61], v[62:63] op_sel:[0,0]
    ds_read_b128 v[28:31], v8 offset:34816
    v_pk_mov_b32 v[142:143], v[60:61], v[62:63] op_sel:[1,1]
    ds_read_b128 v[32:35], v8 offset:35840
    v_bfe_u32 v126, v1, 2, 6
    ds_read_b128 v[36:39], v8 offset:26624
    v_mov_b64 v[68:69], 0
    ds_read_b128 v[40:43], v8 offset:27648
    v_mov_b64 v[70:71], 0
    ds_read_b128 v[76:79], v8 offset:28672
    v_mfma_f32_16x16x1_4b_f32 v[52:67], v126, v126, 0
    ds_read_b128 v[80:83], v8 offset:29696
    ds_read_b128 v[84:87], v8 offset:30720
    ds_read_b128 v[88:91], v8 offset:31744
    s_nop 0
    s_nop 0
    s_nop 0
    s_nop 0
    s_nop 0
    s_nop 0
    buffer_load_dwordx4 v[128:131], v1, s[8:11], s25 offen offset:0 sc1
    buffer_load_dwordx4 v[132:135], v1, s[8:11], s25 offen offset:1024 sc1
    ds_read_b128 v[92:95], v8 offset:32768
    s_waitcnt vmcnt(17)
    v_mov_b64 v[100:101], v[108:109]
    ds_read_b128 v[96:99], v8 offset:33792
    v_mov_b64 v[102:103], v[110:111]
    v_mov_b64 v[104:105], v[112:113]
    ds_read_b128 v[44:47], v8 offset:24576
    v_mov_b64 v[106:107], v[114:115]
    ds_read_b128 v[48:51], v8 offset:25600
    ds_read_b128 v[108:111], v8 offset:20480
    ds_read_b128 v[112:115], v8 offset:21504
    s_add_u32 s19, s18, 2
    s_cmp_ge_u32 s19, s37
    s_cbranch_scc1 Cw1_kvw
    Cw1_kvok:
    s_nop 0
    s_nop 0
    s_nop 0
    s_nop 0
    s_nop 0
    s_nop 0
    s_nop 0
    s_nop 0
    s_nop 0
    s_nop 0
    s_nop 0
    s_nop 0
    s_nop 0
    s_nop 0
    buffer_load_dwordx4 v[128:131], v1, s[8:11], s25 offen offset:0 sc1
    buffer_load_dwordx4 v[132:135], v1, s[8:11], s25 offen offset:1024 sc1
    s_branch Cw1_Pw
    Cw1_Pf:
    s_add_u32 s21, s21, 1
    v_max3_u32 v124, v128, v129, v130
    v_max3_u32 v126, v131, v132, v133
    v_max3_u32 v124, v124, v134, v135
    v_max_u32 v124, v124, v126
    v_cmp_eq_u32 vcc, -1, v124
    s_nop 0
    s_mov_b64 exec, vcc
    buffer_load_dwordx4 v[128:131], v1, s[8:11], s25 offen offset:0 sc1
    buffer_load_dwordx4 v[132:135], v1, s[8:11], s25 offen offset:1024 sc1
    s_mov_b64 exec, -1
    s_cmp_gt_u32 s21, 4
    s_cbranch_scc1 Cw1_Pre
    Cw1_Pw:
    s_waitcnt vmcnt(3) lgkmcnt(0)
    Cw1_P:
    v_mfma_f32_16x16x32_bf16 v[24:27], v[72:75], v[128:131], 0
    s_waitcnt vmcnt(2)
    v_mfma_f32_16x16x32_bf16 v[24:27], v[72:75], v[132:135], v[24:27]
    s_nop 7
    v_cmp_u_f32 vcc, v24, v24
    v_add_f32_dpp v24, v24, v24 row_ror:4 row_mask:0xf bank_mask:0xf
    v_add_f32_dpp v25, v25, v25 row_ror:4 row_mask:0xf bank_mask:0xf
    s_nop 0
    v_add_f32_dpp v24, v24, v24 row_ror:8 row_mask:0xf bank_mask:0xf
    v_add_f32_dpp v25, v25, v25 row_ror:8 row_mask:0xf bank_mask:0xf
    v_cvt_pk_bf16_f32 v124, v24, v25
    s_cbranch_vccnz Cw1_Pf
    buffer_store_dword v124, v5, s[8:11], s23 offen
    Cw1_w2:
    s_branch Cw1_step
    Cw1_kvw:
    s_mov_b32 s21, 0
    s_waitcnt vmcnt(14)
    s_branch Cw1_kvl_chk
    v_lshrrev_b32 v126, 2, v1
    v_and_b32 v126, 63, v126
    s_mov_b32 s21, 0
    Cw1_kvl:
    buffer_load_dword v127, v126, s[8:11], s29 offen sc1
    s_add_u32 s21, s21, 1
    s_cmp_gt_u32 s21, 400000
    s_cbranch_scc1 C_fail
    s_waitcnt vmcnt(0)
    Cw1_kvl_chk:
    v_min_u32_dpp v127, v127, v127 row_ror:8 row_mask:0xf bank_mask:0xf
    s_nop 1
    v_min_u32_dpp v127, v127, v127 row_ror:4 row_mask:0xf bank_mask:0xf
    s_nop 1
    v_min_u32_dpp v127, v127, v127 row_ror:2 row_mask:0xf bank_mask:0xf
    s_nop 1
    v_min_u32_dpp v127, v127, v127 row_ror:1 row_mask:0xf bank_mask:0xf
    s_nop 0
    v_readfirstlane_b32 s37, v127
    s_nop 0
    s_lshl_b32 s37, s37, 2
    s_cmp_ge_u32 s19, s37
    s_cbranch_scc1 Cw1_kvl
    s_cmp_ge_u32 s37, 12
    s_cselect_b32 s21, 12, 0
    s_cmp_ge_u32 s37, 44
    s_cselect_b32 s21, 44, s21
    s_cmp_ge_u32 s37, 64
    s_cselect_b32 s21, 1000, s21
    s_cmp_gt_u32 s21, s19
    s_cselect_b32 s37, s21, s37
    s_mov_b32 s21, 1
    s_branch Cw1_kvok
    Cw1_last:
    v_mov_b32 v124, v61
    v_mov_b32 v61, v62
    v_mov_b32 v62, v124
    buffer_store_dwordx4 v[60:63], v1, s[8:11], s33 offen sc1
    s_branch C_done
    Cw1_fix:
    v_and_b32 v124, 0x3ff, v11
    v_lshlrev_b32 v124, 1, v124
    v_add_u32 v124, 0x24800, v124
    v_lshlrev_b32 v126, 1, v1
    v_add_u32 v126, 0x24800, v126
    ds_write_b64 v124, v[88:89]
    v_mov_b32 v142, v7
    v_mov_b32 v143, v7
    s_waitcnt lgkmcnt(0)
    s_barrier
    ds_read_b128 v[68:71], v126
    ds_read_b128 v[72:75], v126 offset:16
    v_fmac_f32_dpp v142, v92, v0 quad_perm:[0,1,0,1] row_mask:0xf bank_mask:0xf
    v_fmac_f32_dpp v143, v93, v0 quad_perm:[0,1,0,1] row_mask:0xf bank_mask:0xf
    s_nop 0
    v_fmac_f32_dpp v142, v94, v0 quad_perm:[2,3,2,3] row_mask:0xf bank_mask:0xf
    v_fmac_f32_dpp v143, v95, v0 quad_perm:[2,3,2,3] row_mask:0xf bank_mask:0xf
    s_waitcnt lgkmcnt(0)
    v_max3_f32 v124, v68, v69, v70
    v_max3_f32 v124, v124, v71, v72
    v_max3_f32 v124, v124, v73, v74
    v_max3_f32 v124, v124, v75, v142
    v_max_f32 v124, v124, v143
    v_mov_b32 v126, v124
    s_nop 1
    v_permlane32_swap_b32 v124, v126
    v_max_f32 v124, v124, v126
    v_mov_b32 v126, v124
    s_nop 1
    v_permlane16_swap_b32 v124, v126
    v_max_f32 v124, v124, v126
    v_sub_f32 v7, v7, v124
    v_sub_f32 v68, v68, v124
    v_sub_f32 v69, v69, v124
    v_sub_f32 v70, v70, v124
    v_sub_f32 v71, v71, v124
    v_sub_f32 v72, v72, v124
    v_sub_f32 v73, v73, v124
    v_sub_f32 v74, v74, v124
    v_sub_f32 v75, v75, v124
    v_sub_f32 v142, v142, v124
    v_sub_f32 v143, v143, v124
    v_exp_f32 v68, v68
    v_exp_f32 v69, v69
    v_exp_f32 v70, v70
    v_exp_f32 v71, v71
    v_exp_f32 v72, v72
    v_exp_f32 v73, v73
    v_exp_f32 v74, v74
    v_exp_f32 v75, v75
    v_exp_f32 v142, v142
    v_exp_f32 v143, v143
    v_cvt_pk_bf16_f32 v84, v68, v69
    v_cvt_pk_bf16_f32 v85, v70, v71
    v_cvt_pk_bf16_f32 v86, v72, v73
    v_cvt_pk_bf16_f32 v87, v74, v75
    v_cvt_pk_bf16_f32 v141, v142, v143
    s_nop 0
    v_mfma_f32_16x16x32_bf16 v[64:67], v[136:139], v[84:87], 0
    v_mfma_f32_16x16x32_bf16 v[52:55], v[128:131], v[84:87], 0
    v_mfma_f32_16x16x32_bf16 v[56:59], v[132:135], v[84:87], 0
    v_mfma_f32_16x16x16_bf16 v[64:67], v[136:137], v[140:141], v[64:67]
    v_mfma_f32_16x16x16_bf16 v[52:55], v[60:61], v[140:141], v[52:55]
    v_mfma_f32_16x16x16_bf16 v[56:59], v[62:63], v[140:141], v[56:59]
    v_rcp_f32 v64, v64
    s_nop 2
    v_pk_mul_f32 v[52:53], v[52:53], v[64:65] op_sel_hi:[1,0]
    v_pk_mul_f32 v[54:55], v[54:55], v[64:65] op_sel_hi:[1,0]
    v_cvt_pk_bf16_f32 v52, v52, v53
    v_cvt_pk_bf16_f32 v53, v54, v55
    v_pk_mul_f32 v[56:57], v[56:57], v[64:65] op_sel_hi:[1,0]
    v_pk_mul_f32 v[58:59], v[58:59], v[64:65] op_sel_hi:[1,0]
    v_cvt_pk_bf16_f32 v54, v56, v57
    v_cvt_pk_bf16_f32 v55, v58, v59
    ds_write_b64 v2, v[52:53] offset:9216
    ds_write_b64 v2, v[54:55] offset:9224
    v_mov_b64 v[100:101], 0
    v_mov_b64 v[102:103], 0
    v_mov_b64 v[104:105], 0
    v_mov_b64 v[106:107], 0
    v_mov_b64 v[36:37], 0
    v_mov_b64 v[38:39], 0
    v_log_f32 v65, v65
    v_smfmac_f32_16x16x64_bf16 v[100:103], v[52:55], v[160:167], v3
    v_smfmac_f32_16x16x64_bf16 v[104:107], v[52:55], v[192:199], v3
    v_smfmac_f32_16x16x64_bf16 v[36:39], v[52:55], v[224:231], v3
    s_waitcnt lgkmcnt(0)
    s_branch Cw1_fixed
    Cw2_entry:
    s_mov_b32 s23, 0x86000
    s_mov_b32 s24, s23
    s_add_u32 s23, s23, 0x2000
    s_bitset0_b32 s23, 15
    s_add_u32 s30, s23, 0x1000
    buffer_load_dwordx4 v[20:23], v125, s[8:11], s23 offen offset:2048 sc1
    buffer_load_dwordx4 v[24:27], v125, s[8:11], s30 offen offset:2048 sc1
    s_mov_b32 s18, -1
    v_mov_b32 v136, 0x3f803f80
    v_mov_b32 v137, 0x3f803f80
    v_mov_b32 v138, 0x3f803f80
    v_mov_b32 v139, 0x3f803f80
    s_mov_b32 s64, 0x42700000
    v_lshlrev_b32 v124, v1, v136
    v_lshrrev_b32 v126, 16, v136
    v_bfe_i32 v52, v1, 4, 1
    v_bfi_b32 v124, v52, v124, v126
    v_bfe_u32 v126, v1, 6, 2
    v_cmp_eq_u32 vcc, 0, v126
    s_nop 1
    v_cndmask_b32 v52, 0, v124, vcc
    v_cmp_eq_u32 vcc, 1, v126
    s_nop 1
    v_cndmask_b32 v53, 0, v124, vcc
    v_cmp_eq_u32 vcc, 2, v126
    s_nop 1
    v_cndmask_b32 v54, 0, v124, vcc
    v_cmp_eq_u32 vcc, 3, v126
    s_nop 1
    v_cndmask_b32 v55, 0, v124, vcc
    ds_write_b128 v8, v[52:55] offset:7168
    s_waitcnt lgkmcnt(0)
    v_pk_mov_b32 v[140:141], v[60:61], v[62:63] op_sel:[0,0]
    ds_read_b128 v[28:31], v8 offset:34816
    v_pk_mov_b32 v[142:143], v[60:61], v[62:63] op_sel:[1,1]
    ds_read_b128 v[32:35], v8 offset:35840
    v_bfe_u32 v126, v1, 2, 6
    ds_read_b128 v[36:39], v8 offset:26624
    v_mov_b64 v[68:69], 0
    ds_read_b128 v[40:43], v8 offset:27648
    v_mov_b64 v[70:71], 0
    ds_read_b128 v[76:79], v8 offset:28672
    v_mfma_f32_16x16x1_4b_f32 v[52:67], v126, v126, 0
    ds_read_b128 v[80:83], v8 offset:29696
    ds_read_b128 v[84:87], v8 offset:30720
    ds_read_b128 v[88:91], v8 offset:31744
    ds_read_b128 v[92:95], v8 offset:32768
    s_waitcnt vmcnt(2)
    v_mov_b64 v[100:101], v[108:109]
    ds_read_b128 v[96:99], v8 offset:33792
    v_mov_b64 v[102:103], v[110:111]
    v_mov_b64 v[104:105], v[112:113]
    ds_read_b128 v[44:47], v8 offset:24576
    v_mov_b64 v[106:107], v[114:115]
    ds_read_b128 v[48:51], v8 offset:25600
    ds_read_b128 v[108:111], v8 offset:20480
    ds_read_b128 v[112:115], v8 offset:21504
    s_xor_b32 s25, s25, 0x40000
    s_xor_b32 s26, s26, 0x40000
    v_bfe_u32 v126, v1, 2, 6
    v_mov_b64 v[72:73], 0
    v_mov_b64 v[74:75], 0
    s_add_u32 s18, s18, 1
    s_xor_b32 s25, s25, 0x40000
    s_xor_b32 s26, s26, 0x40000
    s_add_u32 s19, s18, 2
    s_cmp_ge_u32 s19, s37
    s_cselect_b32 s36, s29, 0x7ff00000
    s_add_u32 s31, s31, 0x40000
    s_add_u32 s32, s32, 0x40000
    s_mov_b32 s21, 1
    s_mov_b32 s35, 1
    s_waitcnt vmcnt(2)
    v_mov_b64 v[128:129], v[116:117]
    v_mov_b64 v[130:131], v[118:119]
    v_mov_b64 v[132:133], v[120:121]
    v_mov_b64 v[134:135], v[122:123]
    ds_read_b128 v[116:119], v8 offset:22528
    ds_read_b128 v[120:123], v8 offset:23552
    s_waitcnt vmcnt(0)
    s_branch Cw2_Aw
    Cw2_Bf:
    s_add_u32 s35, s35, 1
    s_cmp_gt_u32 s35, 2
    s_cbranch_scc1 Cw2_Bre
    s_nop 6
    v_mov_b64 v[60:61], 0
    v_mov_b64 v[62:63], 0
    v_mov_b64 v[64:65], 0
    v_mov_b64 v[66:67], 0
    v_smfmac_f32_16x16x64_bf16 v[60:63], v[20:23], v[76:83], v3
    s_nop 0
    v_smfmac_f32_16x16x64_bf16 v[64:67], v[20:23], v[84:91], v3
    s_waitcnt vmcnt(3)
    s_branch Cw2_Bw
    Cw2_Are:
    s_waitcnt vmcnt(0)
    Cw2_Arl:
    s_mov_b64 exec, vcc
    buffer_load_dwordx4 v[20:23], v125, s[8:11], s23 offen offset:2048 sc1
    s_mov_b64 exec, -1
    buffer_load_dwordx4 v[24:27], v125, s[8:11], s30 offen offset:2048 sc1
    s_add_u32 s21, s21, 1
    s_cmp_gt_u32 s21, 400000
    s_cbranch_scc1 C_fail
    s_waitcnt vmcnt(6)
    v_mov_b64 v[52:53], 0
    v_mov_b64 v[54:55], 0
    v_mov_b64 v[56:57], 0
    v_mov_b64 v[58:59], 0
    v_mov_b64 v[60:61], 0
    v_mov_b64 v[62:63], 0
    v_max3_u32 v124, v20, v21, v22
    v_max_u32 v124, v124, v23
    v_cmp_eq_u32 vcc, -1, v124
    s_cbranch_vccz Cw2_Adn
    Cw2_Ack:
    v_max3_u32 v124, v20, v21, v22
    v_max_u32 v124, v124, v23
    v_cmp_eq_u32 vcc, -1, v124
    s_cbranch_vccnz Cw2_Arl
    Cw2_Adn:
    v_smfmac_f32_16x16x64_bf16 v[52:55], v[20:23], v[108:115], v3
    ds_write_b128 v2, v[20:23] offset:4096
    v_smfmac_f32_16x16x64_bf16 v[56:59], v[20:23], v[116:123], v3
    buffer_load_dwordx4 v[24:27], v125, s[8:11], s30 offen offset:2048 sc1
    v_smfmac_f32_16x16x64_bf16 v[60:63], v[20:23], v[76:83], v3
    s_barrier
    buffer_load_dwordx4 v[108:111], v9, s[8:11], s31 offen sc1
    v_smfmac_f32_16x16x64_bf16 v[64:67], v[20:23], v[84:91], v3
    buffer_load_dwordx4 v[112:115], v9, s[8:11], s31 offen offset:2048 sc1
    v_smfmac_f32_16x16x64_bf16 v[68:71], v[20:23], v[92:99], v3
    buffer_load_dwordx4 v[116:119], v1, s[8:11], s32 offen sc1
    v_smfmac_f32_16x16x64_bf16 v[72:75], v[20:23], v[28:35], v3
    s_waitcnt lgkmcnt(0)
    s_barrier
    ds_read_b128 v[28:31], v2 offset:6144
    ds_read_b128 v[32:35], v2 offset:0
    s_branch Cw2_Bck
    Cw2_Bre:
    Cw2_Brl:
    s_mov_b64 exec, vcc
    buffer_load_dwordx4 v[24:27], v125, s[8:11], s30 offen offset:2048 sc1
    s_mov_b64 exec, -1
    s_add_u32 s35, s35, 1
    s_cmp_gt_u32 s35, 400000
    s_cbranch_scc1 C_fail
    s_waitcnt vmcnt(6)
    v_max3_u32 v124, v24, v25, v26
    v_max_u32 v124, v124, v27
    v_cmp_eq_u32 vcc, -1, v124
    s_cbranch_vccz Cw2_Bdn
    Cw2_Bck:
    v_max3_u32 v124, v24, v25, v26
    v_max_u32 v124, v124, v27
    v_cmp_eq_u32 vcc, -1, v124
    s_cbranch_vccnz Cw2_Brl
    Cw2_Bdn:
    ds_write_b128 v2, v[24:27] offset:5120
    v_mov_b64 v[60:61], 0
    v_mov_b64 v[62:63], 0
    v_mov_b64 v[64:65], 0
    v_mov_b64 v[66:67], 0
    v_smfmac_f32_16x16x64_bf16 v[60:63], v[20:23], v[76:83], v3
    s_nop 0
    v_smfmac_f32_16x16x64_bf16 v[64:67], v[20:23], v[84:91], v3
    v_smfmac_f32_16x16x64_bf16 v[60:63], v[24:27], a[96:103], v3
    v_smfmac_f32_16x16x64_bf16 v[64:67], v[24:27], a[104:111], v3
    s_waitcnt vmcnt(0)
    s_waitcnt lgkmcnt(0)
    s_branch Cw2_Bok
    Cw2_Pre:
    Cw2_Prl:
    s_mov_b64 exec, vcc
    buffer_load_dwordx4 v[128:131], v1, s[8:11], s25 offen offset:0 sc1
    buffer_load_dwordx4 v[132:135], v1, s[8:11], s25 offen offset:1024 sc1
    s_mov_b64 exec, -1
    s_add_u32 s21, s21, 1
    s_cmp_gt_u32 s21, 400000
    s_cbranch_scc1 C_fail
    s_waitcnt vmcnt(8)
    v_max3_u32 v124, v128, v129, v130
    v_max3_u32 v126, v131, v132, v133
    v_max3_u32 v124, v124, v134, v135
    v_max_u32 v124, v124, v126
    v_cmp_eq_u32 vcc, -1, v124
    s_cbranch_vccz Cw2_Pdn
    Cw2_Pck:
    v_max3_u32 v124, v128, v129, v130
    v_max3_u32 v126, v131, v132, v133
    v_max3_u32 v124, v124, v134, v135
    v_max_u32 v124, v124, v126
    v_cmp_eq_u32 vcc, -1, v124
    s_cbranch_vccnz Cw2_Prl
    Cw2_Pdn:
    v_mfma_f32_16x16x32_bf16 v[24:27], v[72:75], v[128:131], 0
    v_mfma_f32_16x16x32_bf16 v[24:27], v[72:75], v[132:135], v[24:27]
    s_nop 7
    v_add_f32_dpp v24, v24, v24 row_ror:4 row_mask:0xf bank_mask:0xf
    v_add_f32_dpp v25, v25, v25 row_ror:4 row_mask:0xf bank_mask:0xf
    s_nop 0
    v_add_f32_dpp v24, v24, v24 row_ror:8 row_mask:0xf bank_mask:0xf
    v_add_f32_dpp v25, v25, v25 row_ror:8 row_mask:0xf bank_mask:0xf
    v_cvt_pk_bf16_f32 v124, v24, v25
    buffer_store_dword v124, v5, s[8:11], s23 offen
    s_waitcnt vmcnt(1)
    s_branch Cw2_w2
.p2align 6
    Cw2_step:
    v_bfe_u32 v126, v1, 2, 6
    v_mov_b64 v[72:73], 0
    v_mov_b64 v[74:75], 0
    s_add_u32 s18, s18, 1
    s_xor_b32 s25, s25, 0x40000
    s_xor_b32 s26, s26, 0x40000
    s_add_u32 s19, s18, 2
    s_cmp_ge_u32 s19, s37
    s_cselect_b32 s36, s29, 0x7ff00000
    s_add_u32 s31, s31, 0x40000
    s_add_u32 s32, s32, 0x40000
    s_mov_b32 s21, 1
    s_mov_b32 s35, 1
    s_waitcnt vmcnt(1)
    v_mov_b64 v[128:129], v[116:117]
    v_mov_b64 v[130:131], v[118:119]
    v_mov_b64 v[132:133], v[120:121]
    buffer_load_dwordx4 v[20:23], v125, s[8:11], s23 offen offset:2048 sc1
    v_mov_b64 v[134:135], v[122:123]
    buffer_load_dword v127, off, s[8:11], s23
    ds_read_b128 v[116:119], v8 offset:22528
    ds_read_b128 v[120:123], v8 offset:23552
    s_nop 0
    s_nop 0
    s_nop 0
    s_nop 0
    s_nop 0
    s_nop 0
    s_nop 0
    s_nop 0
    s_nop 0
    s_nop 0
    s_nop 0
    s_nop 0
    s_nop 0
    s_nop 0
    s_nop 0
    s_nop 0
    s_nop 0
    s_nop 0
    s_nop 0
    buffer_load_dwordx4 v[20:23], v125, s[8:11], s23 offen offset:2048 sc1
    s_nop 0
    s_nop 0
    s_nop 0
    s_nop 0
    s_nop 0
    s_nop 0
    s_nop 0
    s_nop 0
    s_nop 0
    s_nop 0
    s_nop 0
    buffer_load_dwordx4 v[24:27], v125, s[8:11], s30 offen offset:2048 sc1
    s_branch Cw2_Aw
    Cw2_Af:
    v_mfma_f32_16x16x1_4b_f32 v[52:67], v126, v126, 0
    s_mov_b64 exec, vcc
    buffer_load_dwordx4 v[20:23], v125, s[8:11], s23 offen offset:2048 sc1
    s_mov_b64 exec, -1
    buffer_load_dwordx4 v[24:27], v125, s[8:11], s30 offen offset:2048 sc1
    s_add_u32 s21, s21, 1
    s_cmp_gt_u32 s21, 6
    s_cbranch_scc1 Cw2_Are
    s_nop 0
    s_nop 0
    s_nop 0
    Cw2_Aw:
    s_waitcnt vmcnt(3) lgkmcnt(0)
    v_fma_f32 v124, v20, v21, v22
    v_cmp_u_f32 vcc, v124, v23
    v_smfmac_f32_16x16x64_bf16 v[52:55], v[20:23], v[108:115], v3
    ds_write_b128 v2, v[20:23] offset:4096
    v_smfmac_f32_16x16x64_bf16 v[56:59], v[20:23], v[116:123], v3
    s_cbranch_vccnz Cw2_Af
    buffer_load_dwordx4 v[24:27], v125, s[8:11], s30 offen offset:2048 sc1
    v_smfmac_f32_16x16x64_bf16 v[60:63], v[20:23], v[76:83], v3
    s_barrier
    buffer_load_dwordx4 v[108:111], v9, s[8:11], s31 offen sc1
    v_smfmac_f32_16x16x64_bf16 v[64:67], v[20:23], v[84:91], v3
    buffer_load_dwordx4 v[112:115], v9, s[8:11], s31 offen offset:2048 sc1
    v_smfmac_f32_16x16x64_bf16 v[68:71], v[20:23], v[92:99], v3
    buffer_load_dwordx4 v[116:119], v1, s[8:11], s32 offen sc1
    v_smfmac_f32_16x16x64_bf16 v[72:75], v[20:23], v[28:35], v3
    s_waitcnt lgkmcnt(0)
    s_barrier
    ds_read_b128 v[28:31], v2 offset:6144
    ds_read_b128 v[32:35], v2 offset:0
    Cw2_Bw:
    s_waitcnt vmcnt(4)
    v_fma_f32 v124, v24, v25, v26
    v_cmp_u_f32 vcc, v124, v27
    v_smfmac_f32_16x16x64_bf16 v[60:63], v[24:27], a[96:103], v3
    ds_write_b128 v2, v[24:27] offset:5120
    v_smfmac_f32_16x16x64_bf16 v[64:67], v[24:27], a[104:111], v3
    s_cbranch_vccnz Cw2_Bf
    Cw2_Bok:
    buffer_store_dwordx4 v[140:143], v1, s[8:11], s33 offen sc1
    buffer_load_dword v127, v126, s[8:11], s36 offen sc1
    v_smfmac_f32_16x16x64_bf16 v[52:55], v[24:27], v[44:51], v3
    s_mov_b32 s33, s34
    buffer_load_dwordx4 v[120:123], v1, s[8:11], s32 offen offset:1024 sc1
    v_mov_b64 v[140:141], -1
    v_smfmac_f32_16x16x64_bf16 v[56:59], v[24:27], v[36:43], v3
    ds_read_b128 v[36:39], v2 offset:2048
    s_waitcnt lgkmcnt(3)
    v_smfmac_f32_16x16x64_bf16 v[52:55], v[28:31], a[0:7], v3
    s_add_u32 s34, s34, 0x20000
    v_mov_b64 v[142:143], -1
    v_smfmac_f32_16x16x64_bf16 v[56:59], v[28:31], a[8:15], v3
    s_waitcnt lgkmcnt(1)
    v_smfmac_f32_16x16x64_bf16 v[52:55], v[32:35], a[32:39], v3
    s_barrier
    ds_read_b128 v[44:47], v2 offset:7168
    v_smfmac_f32_16x16x64_bf16 v[56:59], v[32:35], a[40:47], v3
    s_waitcnt lgkmcnt(1)
    s_mov_b32 s19, s27
    ds_read_b128 v[40:43], v2 offset:1024
    v_smfmac_f32_16x16x64_bf16 v[52:55], v[36:39], a[64:71], v3
    s_add_u32 s20, s27, 0x10000
    s_add_u32 s38, s27, 0x20000
    ds_read_b128 v[48:51], v2 offset:3072
    v_smfmac_f32_16x16x64_bf16 v[56:59], v[36:39], a[72:79], v3
    s_add_u32 s22, s27, 0x30000
    s_xor_b32 s27, s27, 0x40000
    v_smfmac_f32_16x16x64_bf16 v[60:63], v[28:31], a[112:119], v3
    v_smfmac_f32_16x16x64_bf16 v[60:63], v[36:39], a[144:151], v3
    ds_read_b128 v[76:79], v8 offset:0
    v_smfmac_f32_16x16x64_bf16 v[64:67], v[28:31], a[120:127], v3
    s_waitcnt lgkmcnt(2)
    v_smfmac_f32_16x16x64_bf16 v[52:55], v[44:47], a[16:23], v3
    ds_read_b128 v[80:83], v8 offset:1024
    v_smfmac_f32_16x16x64_bf16 v[52:55], v[40:43], a[48:55], v3
    s_waitcnt lgkmcnt(2)
    ds_read_b128 v[84:87], v8 offset:4096
    v_smfmac_f32_16x16x64_bf16 v[52:55], v[48:51], a[80:87], v3
    ds_read_b128 v[88:91], v8 offset:5120
    v_smfmac_f32_16x16x64_bf16 v[56:59], v[44:47], a[24:31], v3
    ds_read_b128 v[92:95], v8 offset:2048
    v_smfmac_f32_16x16x64_bf16 v[56:59], v[40:43], a[56:63], v3
    ds_read_b128 v[96:99], v8 offset:3072
    v_add_f32 v52, v52, v54
    v_smfmac_f32_16x16x64_bf16 v[56:59], v[48:51], a[88:95], v3
    s_waitcnt lgkmcnt(4)
    v_add_f32 v53, v53, v55
    v_smfmac_f32_16x16x64_bf16 v[60:63], v[32:35], v[76:83], v3
    s_waitcnt lgkmcnt(2)
    v_cvt_pk_bf16_f32 v54, v52, v53
    v_smfmac_f32_16x16x64_bf16 v[60:63], v[40:43], v[84:91], v3
    v_add_f32 v56, v56, v58
    v_add_f32 v57, v57, v59
    v_cvt_pk_bf16_f32 v55, v56, v57
    v_smfmac_f32_16x16x64_bf16 v[60:63], v[44:47], a[128:135], v3
    ds_write_b64 v6, v[54:55]
    v_smfmac_f32_16x16x64_bf16 v[60:63], v[48:51], a[160:167], v3
    s_waitcnt lgkmcnt(1)
    ds_read_b128 v[52:55], v8 offset:8192
    v_mov_b32 v88, v7
    v_smfmac_f32_16x16x64_bf16 v[64:67], v[32:35], v[92:99], v3
    ds_read_b128 v[56:59], v8 offset:9216
    v_mov_b32 v89, v7
    v_smfmac_f32_16x16x64_bf16 v[64:67], v[40:43], v[12:19], v3
    ds_read_b128 v[92:95], v8 offset:10240
    v_add_f32 v60, v60, v62
    v_smfmac_f32_16x16x64_bf16 v[64:67], v[36:39], a[152:159], v3
    s_waitcnt lgkmcnt(3)
    s_barrier
    ds_read_b64_tr_b16 v[76:77], v10 offset:0
    ds_read_b64_tr_b16 v[78:79], v10 offset:1024
    v_smfmac_f32_16x16x64_bf16 v[64:67], v[44:47], a[136:143], v3
    ds_read_b64_tr_b16 v[80:81], v10 offset:2048
    ds_read_b64_tr_b16 v[82:83], v10 offset:3072
    v_smfmac_f32_16x16x64_bf16 v[64:67], v[48:51], a[168:175], v3
    ds_read_b128 v[96:99], v8 offset:11264
    v_smfmac_f32_16x16x64_bf16 v[68:71], v[24:27], a[176:183], v3
    buffer_store_dword v140, v5, s[8:11], s24 offen
    v_add_f32 v61, v61, v63
    v_cvt_pk_bf16_f32 v60, v60, v61
    s_waitcnt lgkmcnt(3)
    v_mfma_f32_16x16x32_bf16 v[84:87], v[100:103], v[76:79], 0
    v_add_f32 v64, v64, v66
    v_add_f32 v65, v65, v67
    v_cvt_pk_bf16_f32 v62, v64, v65
    s_waitcnt lgkmcnt(1)
    v_mfma_f32_16x16x32_bf16 v[84:87], v[104:107], v[80:83], v[84:87]
    ds_write2_b32 v6, v60, v62 offset0:128 offset1:129
    v_smfmac_f32_16x16x64_bf16 v[72:75], v[24:27], a[184:191], v3
    buffer_store_dwordx4 v[140:143], v1, s[8:11], s26 offen
    v_mov_b64 v[104:105], 0
    v_mov_b64 v[106:107], 0
    v_smfmac_f32_16x16x64_bf16 v[68:71], v[40:43], v[52:59], v3
    s_waitcnt lgkmcnt(1)
    ds_read_b128 v[100:103], v8 offset:6144
    v_fmac_f32_dpp v88, v84, v0 quad_perm:[0,1,0,1] row_mask:0xf bank_mask:0xf
    v_fmac_f32_dpp v89, v85, v0 quad_perm:[0,1,0,1] row_mask:0xf bank_mask:0xf
    v_smfmac_f32_16x16x64_bf16 v[72:75], v[40:43], v[92:99], v3
    s_waitcnt vmcnt(8)
    v_fmac_f32_dpp v88, v86, v0 quad_perm:[2,3,2,3] row_mask:0xf bank_mask:0xf
    v_fmac_f32_dpp v89, v87, v0 quad_perm:[2,3,2,3] row_mask:0xf bank_mask:0xf
    v_smfmac_f32_16x16x64_bf16 v[68:71], v[36:39], a[240:247], v3
    buffer_store_dwordx4 v[140:143], v1, s[8:11], s26 offen offset:1024
    v_smfmac_f32_16x16x64_bf16 v[72:75], v[36:39], a[248:255], v3
    s_waitcnt lgkmcnt(1)
    s_barrier
    ds_read_b64_tr_b16 v[20:21], v10 offset:512
    v_exp_f32 v90, v88
    v_mov_b32 v140, 0
    v_smfmac_f32_16x16x64_bf16 v[68:71], v[28:31], a[192:199], v3
    ds_read_b64_tr_b16 v[22:23], v10 offset:1536
    ds_read_b64_tr_b16 v[24:25], v10 offset:2560
    ds_read_b64_tr_b16 v[26:27], v10 offset:3584
    v_exp_f32 v91, v89
    s_nop 0
    v_cvt_pk_bf16_f32 v90, v90, v91
    v_mov_b64 v[40:41], 0
    v_mov_b64 v[42:43], 0
    v_smfmac_f32_16x16x64_bf16 v[72:75], v[28:31], a[200:207], v3
    ds_write_b32 v11, v90
    v_smfmac_f32_16x16x64_bf16 v[68:71], v[32:35], a[224:231], v3
    s_cmp_eq_u32 s18, 63
    s_waitcnt lgkmcnt(3)
    v_mfma_f32_16x16x32_bf16 v[92:95], v[20:23], v[76:79], 0
    v_mov_b32 v142, v7
    s_waitcnt lgkmcnt(1)
    v_mfma_f32_16x16x32_bf16 v[92:95], v[24:27], v[80:83], v[92:95]
    v_mov_b32 v143, v7
    v_mov_b64 v[36:37], 0
    v_mov_b64 v[38:39], 0
    v_smfmac_f32_16x16x64_bf16 v[72:75], v[32:35], a[232:239], v3
    s_waitcnt lgkmcnt(0)
    s_barrier
    ds_read_b128 v[84:87], v2
    v_smfmac_f32_16x16x64_bf16 v[68:71], v[44:47], a[208:215], v3
    v_fmac_f32_dpp v142, v92, v0 quad_perm:[0,1,0,1] row_mask:0xf bank_mask:0xf
    v_smfmac_f32_16x16x64_bf16 v[68:71], v[48:51], v[144:151], v3
    v_fmac_f32_dpp v143, v93, v0 quad_perm:[0,1,0,1] row_mask:0xf bank_mask:0xf
    v_fmac_f32_dpp v142, v94, v0 quad_perm:[2,3,2,3] row_mask:0xf bank_mask:0xf
    v_smfmac_f32_16x16x64_bf16 v[72:75], v[44:47], a[216:223], v3
    s_waitcnt lgkmcnt(0)
    v_fmac_f32_dpp v143, v95, v0 quad_perm:[2,3,2,3] row_mask:0xf bank_mask:0xf
    v_mfma_f32_16x16x32_bf16 v[64:67], v[136:139], v[84:87], 0
    v_exp_f32 v142, v142
    v_mfma_f32_16x16x32_bf16 v[52:55], v[128:131], v[84:87], 0
    v_exp_f32 v143, v143
    v_mfma_f32_16x16x32_bf16 v[56:59], v[132:135], v[84:87], 0
    v_cvt_pk_bf16_f32 v141, v142, v143
    v_add_f32 v68, v68, v70
    v_smfmac_f32_16x16x64_bf16 v[72:75], v[48:51], v[152:159], v3
    ds_read_b128 v[28:31], v8 offset:12288
    v_add_f32 v69, v69, v71
    v_mfma_f32_16x16x16_bf16 v[64:67], v[136:137], v[140:141], v[64:67]
    ds_read_b128 v[32:35], v8 offset:13312
    v_cvt_pk_bf16_f32 v61, v68, v69
    s_nop 1
    v_mfma_f32_16x16x16_bf16 v[52:55], v[60:61], v[140:141], v[52:55]
    v_add_f32 v72, v72, v74
    v_add_f32 v73, v73, v75
    v_cvt_pk_bf16_f32 v63, v72, v73
    s_cbranch_scc1 Cw2_last
    s_nop 0
    v_mfma_f32_16x16x16_bf16 v[56:59], v[62:63], v[140:141], v[56:59]
    v_rcp_f32 v64, v64
    s_nop 0
    v_pk_mul_f32 v[52:53], v[52:53], v[64:65] op_sel_hi:[1,0]
    v_pk_mul_f32 v[54:55], v[54:55], v[64:65] op_sel_hi:[1,0]
    v_cvt_pk_bf16_f32 v52, v52, v53
    v_cvt_pk_bf16_f32 v53, v54, v55
    ds_write_b64 v2, v[52:53] offset:10240
    s_nop 0
    v_pk_mul_f32 v[56:57], v[56:57], v[64:65] op_sel_hi:[1,0]
    v_pk_mul_f32 v[58:59], v[58:59], v[64:65] op_sel_hi:[1,0]
    v_cvt_pk_bf16_f32 v54, v56, v57
    v_cvt_pk_bf16_f32 v55, v58, v59
    ds_write_b64 v2, v[54:55] offset:10248
    s_nop 0
    v_smfmac_f32_16x16x64_bf16 v[100:103], v[52:55], v[160:167], v3
    v_log_f32 v65, v65
    v_smfmac_f32_16x16x64_bf16 v[104:107], v[52:55], v[192:199], v3
    v_cmp_nle_f32 vcc, |v65|, s64
    v_smfmac_f32_16x16x64_bf16 v[36:39], v[52:55], v[224:231], v3
    s_cbranch_vccnz Cw2_fix
    Cw2_fixed:
    s_waitcnt lgkmcnt(0)
    s_barrier
    ds_read_b128 v[68:71], v2 offset:11264
    ds_read_b128 v[72:75], v2 offset:8192
    ds_read_b128 v[96:99], v2 offset:9216
    v_smfmac_f32_16x16x64_bf16 v[40:43], v[52:55], v[240:247], v3
    ds_read_b128 v[20:23], v8 offset:14336
    s_waitcnt lgkmcnt(3)
    v_smfmac_f32_16x16x64_bf16 v[100:103], v[68:71], v[168:175], v3
    ds_read_b128 v[24:27], v8 offset:15360
    s_waitcnt lgkmcnt(3)
    v_smfmac_f32_16x16x64_bf16 v[100:103], v[72:75], v[176:183], v3
    ds_read_b128 v[76:79], v8 offset:16384
    s_waitcnt lgkmcnt(3)
    v_smfmac_f32_16x16x64_bf16 v[100:103], v[96:99], v[184:191], v3
    ds_read_b128 v[44:47], v8 offset:18432
    ds_read_b128 v[80:83], v8 offset:17408
    v_smfmac_f32_16x16x64_bf16 v[104:107], v[68:71], v[200:207], v3
    s_mov_b32 s24, s23
    s_add_u32 s23, s23, 0x2000
    s_bitset0_b32 s23, 15
    v_smfmac_f32_16x16x64_bf16 v[104:107], v[72:75], v[208:215], v3
    s_add_u32 s30, s23, 0x1000
    ds_read_b128 v[48:51], v8 offset:19456
    v_cvt_pk_bf16_f32 v100, v100, v102
    v_cvt_pk_bf16_f32 v101, v101, v103
    v_smfmac_f32_16x16x64_bf16 v[104:107], v[96:99], v[216:223], v3
    buffer_store_dword v100, v4, s[8:11], s19 offen offset:0
    buffer_store_dword v101, v4, s[8:11], s19 offen offset:2048
    v_smfmac_f32_16x16x64_bf16 v[36:39], v[68:71], v[232:239], v3
    s_mov_b32 s21, 1
    v_sub_f32 v7, v7, v65
    v_smfmac_f32_16x16x64_bf16 v[36:39], v[72:75], v[28:35], v3
    s_waitcnt lgkmcnt(1)
    v_cvt_pk_bf16_f32 v104, v104, v106
    v_cvt_pk_bf16_f32 v105, v105, v107
    v_smfmac_f32_16x16x64_bf16 v[36:39], v[96:99], v[20:27], v3
    buffer_store_dword v104, v4, s[8:11], s20 offen offset:0
    buffer_store_dword v105, v4, s[8:11], s20 offen offset:2048
    v_smfmac_f32_16x16x64_bf16 v[40:43], v[68:71], v[248:255], v3
    v_smfmac_f32_16x16x64_bf16 v[40:43], v[72:75], v[76:83], v3
    s_waitcnt lgkmcnt(0)
    v_cvt_pk_bf16_f32 v36, v36, v38
    v_cvt_pk_bf16_f32 v37, v37, v39
    v_smfmac_f32_16x16x64_bf16 v[40:43], v[96:99], v[44:51], v3
    buffer_store_dword v36, v4, s[8:11], s38 offen offset:0
    buffer_store_dword v37, v4, s[8:11], s38 offen offset:2048
    s_nop 5
    v_cvt_pk_bf16_f32 v40, v40, v42
    v_cvt_pk_bf16_f32 v41, v41, v43
    buffer_store_dword v40, v4, s[8:11], s22 offen offset:0
    buffer_store_dword v41, v4, s[8:11], s22 offen offset:2048
    ds_read_b128 v[72:75], v8 offset:7168
    v_pk_mov_b32 v[140:141], v[60:61], v[62:63] op_sel:[0,0]
    ds_read_b128 v[28:31], v8 offset:34816
    v_pk_mov_b32 v[142:143], v[60:61], v[62:63] op_sel:[1,1]
    ds_read_b128 v[32:35], v8 offset:35840
    v_bfe_u32 v126, v1, 2, 6
    ds_read_b128 v[36:39], v8 offset:26624
    v_mov_b64 v[68:69], 0
    ds_read_b128 v[40:43], v8 offset:27648
    v_mov_b64 v[70:71], 0
    ds_read_b128 v[76:79], v8 offset:28672
    v_mfma_f32_16x16x1_4b_f32 v[52:67], v126, v126, 0
    ds_read_b128 v[80:83], v8 offset:29696
    ds_read_b128 v[84:87], v8 offset:30720
    ds_read_b128 v[88:91], v8 offset:31744
    s_nop 0
    s_nop 0
    s_nop 0
    s_nop 0
    s_nop 0
    s_nop 0
    s_nop 0
    s_nop 0
    s_nop 0
    s_nop 0
    s_nop 0
    s_nop 0
    s_nop 0
    s_nop 0
    s_nop 0
    s_nop 0
    s_nop 0
    s_nop 0
    s_nop 0
    s_nop 0
    buffer_load_dwordx4 v[128:131], v1, s[8:11], s25 offen offset:0 sc1
    buffer_load_dwordx4 v[132:135], v1, s[8:11], s25 offen offset:1024 sc1
    ds_read_b128 v[92:95], v8 offset:32768
    s_waitcnt vmcnt(17)
    v_mov_b64 v[100:101], v[108:109]
    ds_read_b128 v[96:99], v8 offset:33792
    v_mov_b64 v[102:103], v[110:111]
    v_mov_b64 v[104:105], v[112:113]
    ds_read_b128 v[44:47], v8 offset:24576
    v_mov_b64 v[106:107], v[114:115]
    ds_read_b128 v[48:51], v8 offset:25600
    ds_read_b128 v[108:111], v8 offset:20480
    ds_read_b128 v[112:115], v8 offset:21504
    s_add_u32 s19, s18, 2
    s_cmp_ge_u32 s19, s37
    s_cbranch_scc1 Cw2_kvw
    Cw2_kvok:
    s_nop 0
    s_nop 0
    s_nop 0
    s_nop 0
    s_nop 0
    s_nop 0
    s_nop 0
    s_nop 0
    s_nop 0
    s_nop 0
    s_nop 0
    s_nop 0
    s_nop 0
    s_nop 0
    buffer_load_dwordx4 v[128:131], v1, s[8:11], s25 offen offset:0 sc1
    buffer_load_dwordx4 v[132:135], v1, s[8:11], s25 offen offset:1024 sc1
    s_branch Cw2_Pw
    Cw2_Pf:
    s_add_u32 s21, s21, 1
    v_max3_u32 v124, v128, v129, v130
    v_max3_u32 v126, v131, v132, v133
    v_max3_u32 v124, v124, v134, v135
    v_max_u32 v124, v124, v126
    v_cmp_eq_u32 vcc, -1, v124
    s_nop 0
    s_mov_b64 exec, vcc
    buffer_load_dwordx4 v[128:131], v1, s[8:11], s25 offen offset:0 sc1
    buffer_load_dwordx4 v[132:135], v1, s[8:11], s25 offen offset:1024 sc1
    s_mov_b64 exec, -1
    s_cmp_gt_u32 s21, 4
    s_cbranch_scc1 Cw2_Pre
    Cw2_Pw:
    s_waitcnt vmcnt(3) lgkmcnt(0)
    Cw2_P:
    v_mfma_f32_16x16x32_bf16 v[24:27], v[72:75], v[128:131], 0
    s_waitcnt vmcnt(2)
    v_mfma_f32_16x16x32_bf16 v[24:27], v[72:75], v[132:135], v[24:27]
    s_nop 7
    v_cmp_u_f32 vcc, v24, v24
    v_add_f32_dpp v24, v24, v24 row_ror:4 row_mask:0xf bank_mask:0xf
    v_add_f32_dpp v25, v25, v25 row_ror:4 row_mask:0xf bank_mask:0xf
    s_nop 0
    v_add_f32_dpp v24, v24, v24 row_ror:8 row_mask:0xf bank_mask:0xf
    v_add_f32_dpp v25, v25, v25 row_ror:8 row_mask:0xf bank_mask:0xf
    v_cvt_pk_bf16_f32 v124, v24, v25
    s_cbranch_vccnz Cw2_Pf
    buffer_store_dword v124, v5, s[8:11], s23 offen
    Cw2_w2:
    s_branch Cw2_step
    Cw2_kvw:
    s_mov_b32 s21, 0
    s_waitcnt vmcnt(14)
    s_branch Cw2_kvl_chk
    v_lshrrev_b32 v126, 2, v1
    v_and_b32 v126, 63, v126
    s_mov_b32 s21, 0
    Cw2_kvl:
    buffer_load_dword v127, v126, s[8:11], s29 offen sc1
    s_add_u32 s21, s21, 1
    s_cmp_gt_u32 s21, 400000
    s_cbranch_scc1 C_fail
    s_waitcnt vmcnt(0)
    Cw2_kvl_chk:
    v_min_u32_dpp v127, v127, v127 row_ror:8 row_mask:0xf bank_mask:0xf
    s_nop 1
    v_min_u32_dpp v127, v127, v127 row_ror:4 row_mask:0xf bank_mask:0xf
    s_nop 1
    v_min_u32_dpp v127, v127, v127 row_ror:2 row_mask:0xf bank_mask:0xf
    s_nop 1
    v_min_u32_dpp v127, v127, v127 row_ror:1 row_mask:0xf bank_mask:0xf
    s_nop 0
    v_readfirstlane_b32 s37, v127
    s_nop 0
    s_lshl_b32 s37, s37, 2
    s_cmp_ge_u32 s19, s37
    s_cbranch_scc1 Cw2_kvl
    s_cmp_ge_u32 s37, 12
    s_cselect_b32 s21, 12, 0
    s_cmp_ge_u32 s37, 44
    s_cselect_b32 s21, 44, s21
    s_cmp_ge_u32 s37, 64
    s_cselect_b32 s21, 1000, s21
    s_cmp_gt_u32 s21, s19
    s_cselect_b32 s37, s21, s37
    s_mov_b32 s21, 1
    s_branch Cw2_kvok
    Cw2_last:
    v_mov_b32 v124, v61
    v_mov_b32 v61, v62
    v_mov_b32 v62, v124
    buffer_store_dwordx4 v[60:63], v1, s[8:11], s33 offen sc1
    s_branch C_done
    Cw2_fix:
    v_and_b32 v124, 0x3ff, v11
    v_lshlrev_b32 v124, 1, v124
    v_add_u32 v124, 0x24800, v124
    v_lshlrev_b32 v126, 1, v1
    v_add_u32 v126, 0x24800, v126
    ds_write_b64 v124, v[88:89]
    v_mov_b32 v142, v7
    v_mov_b32 v143, v7
    s_waitcnt lgkmcnt(0)
    s_barrier
    ds_read_b128 v[68:71], v126
    ds_read_b128 v[72:75], v126 offset:16
    v_fmac_f32_dpp v142, v92, v0 quad_perm:[0,1,0,1] row_mask:0xf bank_mask:0xf
    v_fmac_f32_dpp v143, v93, v0 quad_perm:[0,1,0,1] row_mask:0xf bank_mask:0xf
    s_nop 0
    v_fmac_f32_dpp v142, v94, v0 quad_perm:[2,3,2,3] row_mask:0xf bank_mask:0xf
    v_fmac_f32_dpp v143, v95, v0 quad_perm:[2,3,2,3] row_mask:0xf bank_mask:0xf
    s_waitcnt lgkmcnt(0)
    v_max3_f32 v124, v68, v69, v70
    v_max3_f32 v124, v124, v71, v72
    v_max3_f32 v124, v124, v73, v74
    v_max3_f32 v124, v124, v75, v142
    v_max_f32 v124, v124, v143
    v_mov_b32 v126, v124
    s_nop 1
    v_permlane32_swap_b32 v124, v126
    v_max_f32 v124, v124, v126
    v_mov_b32 v126, v124
    s_nop 1
    v_permlane16_swap_b32 v124, v126
    v_max_f32 v124, v124, v126
    v_sub_f32 v7, v7, v124
    v_sub_f32 v68, v68, v124
    v_sub_f32 v69, v69, v124
    v_sub_f32 v70, v70, v124
    v_sub_f32 v71, v71, v124
    v_sub_f32 v72, v72, v124
    v_sub_f32 v73, v73, v124
    v_sub_f32 v74, v74, v124
    v_sub_f32 v75, v75, v124
    v_sub_f32 v142, v142, v124
    v_sub_f32 v143, v143, v124
    v_exp_f32 v68, v68
    v_exp_f32 v69, v69
    v_exp_f32 v70, v70
    v_exp_f32 v71, v71
    v_exp_f32 v72, v72
    v_exp_f32 v73, v73
    v_exp_f32 v74, v74
    v_exp_f32 v75, v75
    v_exp_f32 v142, v142
    v_exp_f32 v143, v143
    v_cvt_pk_bf16_f32 v84, v68, v69
    v_cvt_pk_bf16_f32 v85, v70, v71
    v_cvt_pk_bf16_f32 v86, v72, v73
    v_cvt_pk_bf16_f32 v87, v74, v75
    v_cvt_pk_bf16_f32 v141, v142, v143
    s_nop 0
    v_mfma_f32_16x16x32_bf16 v[64:67], v[136:139], v[84:87], 0
    v_mfma_f32_16x16x32_bf16 v[52:55], v[128:131], v[84:87], 0
    v_mfma_f32_16x16x32_bf16 v[56:59], v[132:135], v[84:87], 0
    v_mfma_f32_16x16x16_bf16 v[64:67], v[136:137], v[140:141], v[64:67]
    v_mfma_f32_16x16x16_bf16 v[52:55], v[60:61], v[140:141], v[52:55]
    v_mfma_f32_16x16x16_bf16 v[56:59], v[62:63], v[140:141], v[56:59]
    v_rcp_f32 v64, v64
    s_nop 2
    v_pk_mul_f32 v[52:53], v[52:53], v[64:65] op_sel_hi:[1,0]
    v_pk_mul_f32 v[54:55], v[54:55], v[64:65] op_sel_hi:[1,0]
    v_cvt_pk_bf16_f32 v52, v52, v53
    v_cvt_pk_bf16_f32 v53, v54, v55
    v_pk_mul_f32 v[56:57], v[56:57], v[64:65] op_sel_hi:[1,0]
    v_pk_mul_f32 v[58:59], v[58:59], v[64:65] op_sel_hi:[1,0]
    v_cvt_pk_bf16_f32 v54, v56, v57
    v_cvt_pk_bf16_f32 v55, v58, v59
    ds_write_b64 v2, v[52:53] offset:10240
    ds_write_b64 v2, v[54:55] offset:10248
    v_mov_b64 v[100:101], 0
    v_mov_b64 v[102:103], 0
    v_mov_b64 v[104:105], 0
    v_mov_b64 v[106:107], 0
    v_mov_b64 v[36:37], 0
    v_mov_b64 v[38:39], 0
    v_log_f32 v65, v65
    v_smfmac_f32_16x16x64_bf16 v[100:103], v[52:55], v[160:167], v3
    v_smfmac_f32_16x16x64_bf16 v[104:107], v[52:55], v[192:199], v3
    v_smfmac_f32_16x16x64_bf16 v[36:39], v[52:55], v[224:231], v3
    s_waitcnt lgkmcnt(0)
    s_branch Cw2_fixed
    Cw3_entry:
    s_mov_b32 s23, 0x86000
    s_mov_b32 s24, s23
    s_add_u32 s23, s23, 0x2000
    s_bitset0_b32 s23, 15
    s_add_u32 s30, s23, 0x1000
    buffer_load_dwordx4 v[20:23], v125, s[8:11], s23 offen offset:3072 sc1
    buffer_load_dwordx4 v[24:27], v125, s[8:11], s30 offen offset:3072 sc1
    s_mov_b32 s18, -1
    v_mov_b32 v136, 0x3f803f80
    v_mov_b32 v137, 0x3f803f80
    v_mov_b32 v138, 0x3f803f80
    v_mov_b32 v139, 0x3f803f80
    s_mov_b32 s64, 0x42700000
    v_lshlrev_b32 v124, v1, v136
    v_lshrrev_b32 v126, 16, v136
    v_bfe_i32 v52, v1, 4, 1
    v_bfi_b32 v124, v52, v124, v126
    v_bfe_u32 v126, v1, 6, 2
    v_cmp_eq_u32 vcc, 0, v126
    s_nop 1
    v_cndmask_b32 v52, 0, v124, vcc
    v_cmp_eq_u32 vcc, 1, v126
    s_nop 1
    v_cndmask_b32 v53, 0, v124, vcc
    v_cmp_eq_u32 vcc, 2, v126
    s_nop 1
    v_cndmask_b32 v54, 0, v124, vcc
    v_cmp_eq_u32 vcc, 3, v126
    s_nop 1
    v_cndmask_b32 v55, 0, v124, vcc
    ds_write_b128 v8, v[52:55] offset:7168
    s_waitcnt lgkmcnt(0)
    v_pk_mov_b32 v[140:141], v[60:61], v[62:63] op_sel:[0,0]
    ds_read_b128 v[28:31], v8 offset:34816
    v_pk_mov_b32 v[142:143], v[60:61], v[62:63] op_sel:[1,1]
    ds_read_b128 v[32:35], v8 offset:35840
    v_bfe_u32 v126, v1, 2, 6
    ds_read_b128 v[36:39], v8 offset:26624
    v_mov_b64 v[68:69], 0
    ds_read_b128 v[40:43], v8 offset:27648
    v_mov_b64 v[70:71], 0
    ds_read_b128 v[76:79], v8 offset:28672
    v_mfma_f32_16x16x1_4b_f32 v[52:67], v126, v126, 0
    ds_read_b128 v[80:83], v8 offset:29696
    ds_read_b128 v[84:87], v8 offset:30720
    ds_read_b128 v[88:91], v8 offset:31744
    ds_read_b128 v[92:95], v8 offset:32768
    s_waitcnt vmcnt(2)
    v_mov_b64 v[100:101], v[108:109]
    ds_read_b128 v[96:99], v8 offset:33792
    v_mov_b64 v[102:103], v[110:111]
    v_mov_b64 v[104:105], v[112:113]
    ds_read_b128 v[44:47], v8 offset:24576
    v_mov_b64 v[106:107], v[114:115]
    ds_read_b128 v[48:51], v8 offset:25600
    ds_read_b128 v[108:111], v8 offset:20480
    ds_read_b128 v[112:115], v8 offset:21504
    s_xor_b32 s25, s25, 0x40000
    s_xor_b32 s26, s26, 0x40000
    v_bfe_u32 v126, v1, 2, 6
    v_mov_b64 v[72:73], 0
    v_mov_b64 v[74:75], 0
    s_add_u32 s18, s18, 1
    s_xor_b32 s25, s25, 0x40000
    s_xor_b32 s26, s26, 0x40000
    s_add_u32 s19, s18, 2
    s_cmp_ge_u32 s19, s37
    s_cselect_b32 s36, s29, 0x7ff00000
    s_add_u32 s31, s31, 0x40000
    s_add_u32 s32, s32, 0x40000
    s_mov_b32 s21, 1
    s_mov_b32 s35, 1
    s_waitcnt vmcnt(2)
    v_mov_b64 v[128:129], v[116:117]
    v_mov_b64 v[130:131], v[118:119]
    v_mov_b64 v[132:133], v[120:121]
    v_mov_b64 v[134:135], v[122:123]
    ds_read_b128 v[116:119], v8 offset:22528
    ds_read_b128 v[120:123], v8 offset:23552
    s_waitcnt vmcnt(0)
    s_branch Cw3_Aw
    Cw3_Bf:
    s_add_u32 s35, s35, 1
    s_cmp_gt_u32 s35, 2
    s_cbranch_scc1 Cw3_Bre
    s_nop 6
    v_mov_b64 v[60:61], 0
    v_mov_b64 v[62:63], 0
    v_mov_b64 v[64:65], 0
    v_mov_b64 v[66:67], 0
    v_smfmac_f32_16x16x64_bf16 v[60:63], v[20:23], v[76:83], v3
    s_nop 0
    v_smfmac_f32_16x16x64_bf16 v[64:67], v[20:23], v[84:91], v3
    s_waitcnt vmcnt(3)
    s_branch Cw3_Bw
    Cw3_Are:
    s_waitcnt vmcnt(0)
    Cw3_Arl:
    s_mov_b64 exec, vcc
    buffer_load_dwordx4 v[20:23], v125, s[8:11], s23 offen offset:3072 sc1
    s_mov_b64 exec, -1
    buffer_load_dwordx4 v[24:27], v125, s[8:11], s30 offen offset:3072 sc1
    s_add_u32 s21, s21, 1
    s_cmp_gt_u32 s21, 400000
    s_cbranch_scc1 C_fail
    s_waitcnt vmcnt(6)
    v_mov_b64 v[52:53], 0
    v_mov_b64 v[54:55], 0
    v_mov_b64 v[56:57], 0
    v_mov_b64 v[58:59], 0
    v_mov_b64 v[60:61], 0
    v_mov_b64 v[62:63], 0
    v_max3_u32 v124, v20, v21, v22
    v_max_u32 v124, v124, v23
    v_cmp_eq_u32 vcc, -1, v124
    s_cbranch_vccz Cw3_Adn
    Cw3_Ack:
    v_max3_u32 v124, v20, v21, v22
    v_max_u32 v124, v124, v23
    v_cmp_eq_u32 vcc, -1, v124
    s_cbranch_vccnz Cw3_Arl
    Cw3_Adn:
    v_smfmac_f32_16x16x64_bf16 v[52:55], v[20:23], v[108:115], v3
    ds_write_b128 v2, v[20:23] offset:6144
    v_smfmac_f32_16x16x64_bf16 v[56:59], v[20:23], v[116:123], v3
    buffer_load_dwordx4 v[24:27], v125, s[8:11], s30 offen offset:3072 sc1
    v_smfmac_f32_16x16x64_bf16 v[60:63], v[20:23], v[76:83], v3
    s_barrier
    buffer_load_dwordx4 v[108:111], v9, s[8:11], s31 offen sc1
    v_smfmac_f32_16x16x64_bf16 v[64:67], v[20:23], v[84:91], v3
    buffer_load_dwordx4 v[112:115], v9, s[8:11], s31 offen offset:2048 sc1
    v_smfmac_f32_16x16x64_bf16 v[68:71], v[20:23], v[92:99], v3
    buffer_load_dwordx4 v[116:119], v1, s[8:11], s32 offen sc1
    v_smfmac_f32_16x16x64_bf16 v[72:75], v[20:23], v[28:35], v3
    s_waitcnt lgkmcnt(0)
    s_barrier
    ds_read_b128 v[28:31], v2 offset:4096
    ds_read_b128 v[32:35], v2 offset:2048
    s_branch Cw3_Bck
    Cw3_Bre:
    Cw3_Brl:
    s_mov_b64 exec, vcc
    buffer_load_dwordx4 v[24:27], v125, s[8:11], s30 offen offset:3072 sc1
    s_mov_b64 exec, -1
    s_add_u32 s35, s35, 1
    s_cmp_gt_u32 s35, 400000
    s_cbranch_scc1 C_fail
    s_waitcnt vmcnt(6)
    v_max3_u32 v124, v24, v25, v26
    v_max_u32 v124, v124, v27
    v_cmp_eq_u32 vcc, -1, v124
    s_cbranch_vccz Cw3_Bdn
    Cw3_Bck:
    v_max3_u32 v124, v24, v25, v26
    v_max_u32 v124, v124, v27
    v_cmp_eq_u32 vcc, -1, v124
    s_cbranch_vccnz Cw3_Brl
    Cw3_Bdn:
    ds_write_b128 v2, v[24:27] offset:7168
    v_mov_b64 v[60:61], 0
    v_mov_b64 v[62:63], 0
    v_mov_b64 v[64:65], 0
    v_mov_b64 v[66:67], 0
    v_smfmac_f32_16x16x64_bf16 v[60:63], v[20:23], v[76:83], v3
    s_nop 0
    v_smfmac_f32_16x16x64_bf16 v[64:67], v[20:23], v[84:91], v3
    v_smfmac_f32_16x16x64_bf16 v[60:63], v[24:27], a[96:103], v3
    v_smfmac_f32_16x16x64_bf16 v[64:67], v[24:27], a[104:111], v3
    s_waitcnt vmcnt(0)
    s_waitcnt lgkmcnt(0)
    s_branch Cw3_Bok
    Cw3_Pre:
    Cw3_Prl:
    s_mov_b64 exec, vcc
    buffer_load_dwordx4 v[128:131], v1, s[8:11], s25 offen offset:0 sc1
    buffer_load_dwordx4 v[132:135], v1, s[8:11], s25 offen offset:1024 sc1
    s_mov_b64 exec, -1
    s_add_u32 s21, s21, 1
    s_cmp_gt_u32 s21, 400000
    s_cbranch_scc1 C_fail
    s_waitcnt vmcnt(8)
    v_max3_u32 v124, v128, v129, v130
    v_max3_u32 v126, v131, v132, v133
    v_max3_u32 v124, v124, v134, v135
    v_max_u32 v124, v124, v126
    v_cmp_eq_u32 vcc, -1, v124
    s_cbranch_vccz Cw3_Pdn
    Cw3_Pck:
    v_max3_u32 v124, v128, v129, v130
    v_max3_u32 v126, v131, v132, v133
    v_max3_u32 v124, v124, v134, v135
    v_max_u32 v124, v124, v126
    v_cmp_eq_u32 vcc, -1, v124
    s_cbranch_vccnz Cw3_Prl
    Cw3_Pdn:
    v_mfma_f32_16x16x32_bf16 v[24:27], v[72:75], v[128:131], 0
    v_mfma_f32_16x16x32_bf16 v[24:27], v[72:75], v[132:135], v[24:27]
    s_nop 7
    v_add_f32_dpp v24, v24, v24 row_ror:4 row_mask:0xf bank_mask:0xf
    v_add_f32_dpp v25, v25, v25 row_ror:4 row_mask:0xf bank_mask:0xf
    s_nop 0
    v_add_f32_dpp v24, v24, v24 row_ror:8 row_mask:0xf bank_mask:0xf
    v_add_f32_dpp v25, v25, v25 row_ror:8 row_mask:0xf bank_mask:0xf
    v_cvt_pk_bf16_f32 v124, v24, v25
    buffer_store_dword v124, v5, s[8:11], s23 offen
    s_waitcnt vmcnt(1)
    s_branch Cw3_w2
.p2align 6
    Cw3_step:
    v_bfe_u32 v126, v1, 2, 6
    v_mov_b64 v[72:73], 0
    v_mov_b64 v[74:75], 0
    s_add_u32 s18, s18, 1
    buffer_load_dwordx4 v[20:23], v125, s[8:11], s23 offen offset:3072 sc1
    s_xor_b32 s25, s25, 0x40000
    buffer_load_dword v127, off, s[8:11], s23
    s_xor_b32 s26, s26, 0x40000
    s_add_u32 s19, s18, 2
    s_cmp_ge_u32 s19, s37
    s_cselect_b32 s36, s29, 0x7ff00000
    s_add_u32 s31, s31, 0x40000
    s_add_u32 s32, s32, 0x40000
    s_mov_b32 s21, 1
    s_mov_b32 s35, 1
    s_waitcnt vmcnt(3)
    v_mov_b64 v[128:129], v[116:117]
    v_mov_b64 v[130:131], v[118:119]
    v_mov_b64 v[132:133], v[120:121]
    v_mov_b64 v[134:135], v[122:123]
    ds_read_b128 v[116:119], v8 offset:22528
    ds_read_b128 v[120:123], v8 offset:23552
    s_nop 0
    s_nop 0
    s_nop 0
    s_nop 0
    s_nop 0
    s_nop 0
    s_nop 0
    buffer_load_dwordx4 v[20:23], v125, s[8:11], s23 offen offset:3072 sc1
    s_nop 0
    s_nop 0
    s_nop 0
    s_nop 0
    s_nop 0
    s_nop 0
    s_nop 0
    s_nop 0
    s_nop 0
    s_nop 0
    s_nop 0
    buffer_load_dwordx4 v[24:27], v125, s[8:11], s30 offen offset:3072 sc1
    s_branch Cw3_Aw
    Cw3_Af:
    v_mfma_f32_16x16x1_4b_f32 v[52:67], v126, v126, 0
    s_mov_b64 exec, vcc
    buffer_load_dwordx4 v[20:23], v125, s[8:11], s23 offen offset:3072 sc1
    s_mov_b64 exec, -1
    buffer_load_dwordx4 v[24:27], v125, s[8:11], s30 offen offset:3072 sc1
    s_add_u32 s21, s21, 1
    s_cmp_gt_u32 s21, 6
    s_cbranch_scc1 Cw3_Are
    s_nop 0
    s_nop 0
    s_nop 0
    Cw3_Aw:
    s_waitcnt vmcnt(3) lgkmcnt(0)
    v_fma_f32 v124, v20, v21, v22
    v_cmp_u_f32 vcc, v124, v23
    v_smfmac_f32_16x16x64_bf16 v[52:55], v[20:23], v[108:115], v3
    ds_write_b128 v2, v[20:23] offset:6144
    v_smfmac_f32_16x16x64_bf16 v[56:59], v[20:23], v[116:123], v3
    s_cbranch_vccnz Cw3_Af
    buffer_load_dwordx4 v[24:27], v125, s[8:11], s30 offen offset:3072 sc1
    v_smfmac_f32_16x16x64_bf16 v[60:63], v[20:23], v[76:83], v3
    s_barrier
    buffer_load_dwordx4 v[108:111], v9, s[8:11], s31 offen sc1
    v_smfmac_f32_16x16x64_bf16 v[64:67], v[20:23], v[84:91], v3
    buffer_load_dwordx4 v[112:115], v9, s[8:11], s31 offen offset:2048 sc1
    v_smfmac_f32_16x16x64_bf16 v[68:71], v[20:23], v[92:99], v3
    buffer_load_dwordx4 v[116:119], v1, s[8:11], s32 offen sc1
    v_smfmac_f32_16x16x64_bf16 v[72:75], v[20:23], v[28:35], v3
    s_waitcnt lgkmcnt(0)
    s_barrier
    ds_read_b128 v[28:31], v2 offset:4096
    ds_read_b128 v[32:35], v2 offset:2048
    Cw3_Bw:
    s_waitcnt vmcnt(4)
    v_fma_f32 v124, v24, v25, v26
    v_cmp_u_f32 vcc, v124, v27
    v_smfmac_f32_16x16x64_bf16 v[60:63], v[24:27], a[96:103], v3
    ds_write_b128 v2, v[24:27] offset:7168
    v_smfmac_f32_16x16x64_bf16 v[64:67], v[24:27], a[104:111], v3
    s_cbranch_vccnz Cw3_Bf
    Cw3_Bok:
    buffer_store_dwordx4 v[140:143], v1, s[8:11], s33 offen sc1
    buffer_load_dword v127, v126, s[8:11], s36 offen sc1
    v_smfmac_f32_16x16x64_bf16 v[52:55], v[24:27], v[44:51], v3
    s_mov_b32 s33, s34
    buffer_load_dwordx4 v[120:123], v1, s[8:11], s32 offen offset:1024 sc1
    v_mov_b64 v[140:141], -1
    v_smfmac_f32_16x16x64_bf16 v[56:59], v[24:27], v[36:43], v3
    ds_read_b128 v[36:39], v2 offset:0
    s_waitcnt lgkmcnt(3)
    v_smfmac_f32_16x16x64_bf16 v[52:55], v[28:31], a[0:7], v3
    s_add_u32 s34, s34, 0x20000
    v_mov_b64 v[142:143], -1
    v_smfmac_f32_16x16x64_bf16 v[56:59], v[28:31], a[8:15], v3
    s_waitcnt lgkmcnt(1)
    v_smfmac_f32_16x16x64_bf16 v[52:55], v[32:35], a[32:39], v3
    s_barrier
    ds_read_b128 v[44:47], v2 offset:5120
    v_smfmac_f32_16x16x64_bf16 v[56:59], v[32:35], a[40:47], v3
    s_waitcnt lgkmcnt(1)
    s_mov_b32 s19, s27
    ds_read_b128 v[40:43], v2 offset:3072
    v_smfmac_f32_16x16x64_bf16 v[52:55], v[36:39], a[64:71], v3
    s_add_u32 s20, s27, 0x10000
    s_add_u32 s38, s27, 0x20000
    ds_read_b128 v[48:51], v2 offset:1024
    v_smfmac_f32_16x16x64_bf16 v[56:59], v[36:39], a[72:79], v3
    s_add_u32 s22, s27, 0x30000
    s_xor_b32 s27, s27, 0x40000
    v_smfmac_f32_16x16x64_bf16 v[60:63], v[28:31], a[112:119], v3
    v_smfmac_f32_16x16x64_bf16 v[60:63], v[36:39], a[144:151], v3
    ds_read_b128 v[76:79], v8 offset:0
    v_smfmac_f32_16x16x64_bf16 v[64:67], v[28:31], a[120:127], v3
    s_waitcnt lgkmcnt(2)
    v_smfmac_f32_16x16x64_bf16 v[52:55], v[44:47], a[16:23], v3
    ds_read_b128 v[80:83], v8 offset:1024
    v_smfmac_f32_16x16x64_bf16 v[52:55], v[40:43], a[48:55], v3
    s_waitcnt lgkmcnt(2)
    ds_read_b128 v[84:87], v8 offset:4096
    v_smfmac_f32_16x16x64_bf16 v[52:55], v[48:51], a[80:87], v3
    ds_read_b128 v[88:91], v8 offset:5120
    v_smfmac_f32_16x16x64_bf16 v[56:59], v[44:47], a[24:31], v3
    ds_read_b128 v[92:95], v8 offset:2048
    v_smfmac_f32_16x16x64_bf16 v[56:59], v[40:43], a[56:63], v3
    ds_read_b128 v[96:99], v8 offset:3072
    v_add_f32 v52, v52, v54
    v_smfmac_f32_16x16x64_bf16 v[56:59], v[48:51], a[88:95], v3
    s_waitcnt lgkmcnt(4)
    v_add_f32 v53, v53, v55
    v_smfmac_f32_16x16x64_bf16 v[60:63], v[32:35], v[76:83], v3
    s_waitcnt lgkmcnt(2)
    v_cvt_pk_bf16_f32 v54, v52, v53
    v_smfmac_f32_16x16x64_bf16 v[60:63], v[40:43], v[84:91], v3
    v_add_f32 v56, v56, v58
    v_add_f32 v57, v57, v59
    v_cvt_pk_bf16_f32 v55, v56, v57
    v_smfmac_f32_16x16x64_bf16 v[60:63], v[44:47], a[128:135], v3
    ds_write_b64 v6, v[54:55]
    v_smfmac_f32_16x16x64_bf16 v[60:63], v[48:51], a[160:167], v3
    s_waitcnt lgkmcnt(1)
    ds_read_b128 v[52:55], v8 offset:8192
    v_mov_b32 v88, v7
    v_smfmac_f32_16x16x64_bf16 v[64:67], v[32:35], v[92:99], v3
    ds_read_b128 v[56:59], v8 offset:9216
    v_mov_b32 v89, v7
    v_smfmac_f32_16x16x64_bf16 v[64:67], v[40:43], v[12:19], v3
    ds_read_b128 v[92:95], v8 offset:10240
    v_add_f32 v60, v60, v62
    v_smfmac_f32_16x16x64_bf16 v[64:67], v[36:39], a[152:159], v3
    s_waitcnt lgkmcnt(3)
    s_barrier
    ds_read_b64_tr_b16 v[76:77], v10 offset:0
    ds_read_b64_tr_b16 v[78:79], v10 offset:1024
    v_smfmac_f32_16x16x64_bf16 v[64:67], v[44:47], a[136:143], v3
    ds_read_b64_tr_b16 v[80:81], v10 offset:2048
    ds_read_b64_tr_b16 v[82:83], v10 offset:3072
    v_smfmac_f32_16x16x64_bf16 v[64:67], v[48:51], a[168:175], v3
    ds_read_b128 v[96:99], v8 offset:11264
    v_add_f32 v61, v61, v63
    v_cvt_pk_bf16_f32 v60, v60, v61
    v_smfmac_f32_16x16x64_bf16 v[68:71], v[24:27], a[176:183], v3
    s_waitcnt lgkmcnt(3)
    v_mfma_f32_16x16x32_bf16 v[84:87], v[100:103], v[76:79], 0
    buffer_store_dword v140, v5, s[8:11], s24 offen
    v_add_f32 v64, v64, v66
    v_add_f32 v65, v65, v67
    v_cvt_pk_bf16_f32 v62, v64, v65
    s_waitcnt lgkmcnt(1)
    v_mfma_f32_16x16x32_bf16 v[84:87], v[104:107], v[80:83], v[84:87]
    ds_write2_b32 v6, v60, v62 offset0:128 offset1:129
    v_smfmac_f32_16x16x64_bf16 v[72:75], v[24:27], a[184:191], v3
    ds_read_b128 v[100:103], v8 offset:6144
    v_mov_b64 v[104:105], 0
    v_smfmac_f32_16x16x64_bf16 v[68:71], v[40:43], v[52:59], v3
    s_waitcnt lgkmcnt(2)
    buffer_store_dwordx4 v[140:143], v1, s[8:11], s26 offen
    v_fmac_f32_dpp v88, v84, v0 quad_perm:[0,1,0,1] row_mask:0xf bank_mask:0xf
    v_fmac_f32_dpp v89, v85, v0 quad_perm:[0,1,0,1] row_mask:0xf bank_mask:0xf
    v_smfmac_f32_16x16x64_bf16 v[72:75], v[40:43], v[92:99], v3
    s_waitcnt vmcnt(8)
    v_fmac_f32_dpp v88, v86, v0 quad_perm:[2,3,2,3] row_mask:0xf bank_mask:0xf
    v_fmac_f32_dpp v89, v87, v0 quad_perm:[2,3,2,3] row_mask:0xf bank_mask:0xf
    v_smfmac_f32_16x16x64_bf16 v[68:71], v[36:39], a[240:247], v3
    v_mov_b64 v[106:107], 0
    v_smfmac_f32_16x16x64_bf16 v[72:75], v[36:39], a[248:255], v3
    s_waitcnt lgkmcnt(1)
    s_barrier
    buffer_store_dwordx4 v[140:143], v1, s[8:11], s26 offen offset:1024
    ds_read_b64_tr_b16 v[20:21], v10 offset:512
    v_exp_f32 v90, v88
    v_smfmac_f32_16x16x64_bf16 v[68:71], v[28:31], a[192:199], v3
    ds_read_b64_tr_b16 v[22:23], v10 offset:1536
    ds_read_b64_tr_b16 v[24:25], v10 offset:2560
    ds_read_b64_tr_b16 v[26:27], v10 offset:3584
    v_exp_f32 v91, v89
    s_nop 0
    v_cvt_pk_bf16_f32 v90, v90, v91
    v_mov_b64 v[40:41], 0
    v_mov_b64 v[42:43], 0
    v_mov_b32 v140, 0
    v_smfmac_f32_16x16x64_bf16 v[72:75], v[28:31], a[200:207], v3
    ds_write_b32 v11, v90
    v_smfmac_f32_16x16x64_bf16 v[68:71], v[32:35], a[224:231], v3
    s_cmp_eq_u32 s18, 63
    s_waitcnt lgkmcnt(3)
    v_mfma_f32_16x16x32_bf16 v[92:95], v[20:23], v[76:79], 0
    v_mov_b32 v142, v7
    s_waitcnt lgkmcnt(1)
    v_mfma_f32_16x16x32_bf16 v[92:95], v[24:27], v[80:83], v[92:95]
    v_mov_b32 v143, v7
    v_mov_b64 v[36:37], 0
    v_mov_b64 v[38:39], 0
    v_smfmac_f32_16x16x64_bf16 v[72:75], v[32:35], a[232:239], v3
    s_waitcnt lgkmcnt(0)
    s_barrier
    ds_read_b128 v[84:87], v2
    v_smfmac_f32_16x16x64_bf16 v[68:71], v[44:47], a[208:215], v3
    v_fmac_f32_dpp v142, v92, v0 quad_perm:[0,1,0,1] row_mask:0xf bank_mask:0xf
    v_smfmac_f32_16x16x64_bf16 v[68:71], v[48:51], v[144:151], v3
    v_fmac_f32_dpp v143, v93, v0 quad_perm:[0,1,0,1] row_mask:0xf bank_mask:0xf
    v_fmac_f32_dpp v142, v94, v0 quad_perm:[2,3,2,3] row_mask:0xf bank_mask:0xf
    v_smfmac_f32_16x16x64_bf16 v[72:75], v[44:47], a[216:223], v3
    s_waitcnt lgkmcnt(0)
    v_fmac_f32_dpp v143, v95, v0 quad_perm:[2,3,2,3] row_mask:0xf bank_mask:0xf
    v_mfma_f32_16x16x32_bf16 v[64:67], v[136:139], v[84:87], 0
    v_exp_f32 v142, v142
    v_mfma_f32_16x16x32_bf16 v[52:55], v[128:131], v[84:87], 0
    v_exp_f32 v143, v143
    v_mfma_f32_16x16x32_bf16 v[56:59], v[132:135], v[84:87], 0
    v_cvt_pk_bf16_f32 v141, v142, v143
    v_add_f32 v68, v68, v70
    v_smfmac_f32_16x16x64_bf16 v[72:75], v[48:51], v[152:159], v3
    ds_read_b128 v[28:31], v8 offset:12288
    v_add_f32 v69, v69, v71
    v_mfma_f32_16x16x16_bf16 v[64:67], v[136:137], v[140:141], v[64:67]
    ds_read_b128 v[32:35], v8 offset:13312
    v_cvt_pk_bf16_f32 v61, v68, v69
    s_nop 1
    v_mfma_f32_16x16x16_bf16 v[52:55], v[60:61], v[140:141], v[52:55]
    v_add_f32 v72, v72, v74
    v_add_f32 v73, v73, v75
    v_cvt_pk_bf16_f32 v63, v72, v73
    s_cbranch_scc1 Cw3_last
    s_nop 0
    v_mfma_f32_16x16x16_bf16 v[56:59], v[62:63], v[140:141], v[56:59]
    v_rcp_f32 v64, v64
    s_nop 0
    v_pk_mul_f32 v[52:53], v[52:53], v[64:65] op_sel_hi:[1,0]
    v_pk_mul_f32 v[54:55], v[54:55], v[64:65] op_sel_hi:[1,0]
    v_cvt_pk_bf16_f32 v52, v52, v53
    v_cvt_pk_bf16_f32 v53, v54, v55
    ds_write_b64 v2, v[52:53] offset:11264
    s_nop 0
    v_pk_mul_f32 v[56:57], v[56:57], v[64:65] op_sel_hi:[1,0]
    v_pk_mul_f32 v[58:59], v[58:59], v[64:65] op_sel_hi:[1,0]
    v_cvt_pk_bf16_f32 v54, v56, v57
    v_cvt_pk_bf16_f32 v55, v58, v59
    ds_write_b64 v2, v[54:55] offset:11272
    s_nop 0
    v_smfmac_f32_16x16x64_bf16 v[100:103], v[52:55], v[160:167], v3
    v_log_f32 v65, v65
    v_smfmac_f32_16x16x64_bf16 v[104:107], v[52:55], v[192:199], v3
    v_cmp_nle_f32 vcc, |v65|, s64
    v_smfmac_f32_16x16x64_bf16 v[36:39], v[52:55], v[224:231], v3
    s_cbranch_vccnz Cw3_fix
    Cw3_fixed:
    s_waitcnt lgkmcnt(0)
    s_barrier
    ds_read_b128 v[68:71], v2 offset:10240
    ds_read_b128 v[72:75], v2 offset:9216
    ds_read_b128 v[96:99], v2 offset:8192
    v_smfmac_f32_16x16x64_bf16 v[40:43], v[52:55], v[240:247], v3
    ds_read_b128 v[20:23], v8 offset:14336
    s_waitcnt lgkmcnt(3)
    v_smfmac_f32_16x16x64_bf16 v[100:103], v[68:71], v[168:175], v3
    ds_read_b128 v[24:27], v8 offset:15360
    s_waitcnt lgkmcnt(3)
    v_smfmac_f32_16x16x64_bf16 v[100:103], v[72:75], v[176:183], v3
    ds_read_b128 v[76:79], v8 offset:16384
    s_waitcnt lgkmcnt(3)
    v_smfmac_f32_16x16x64_bf16 v[100:103], v[96:99], v[184:191], v3
    ds_read_b128 v[44:47], v8 offset:18432
    ds_read_b128 v[80:83], v8 offset:17408
    v_smfmac_f32_16x16x64_bf16 v[104:107], v[68:71], v[200:207], v3
    s_mov_b32 s24, s23
    s_add_u32 s23, s23, 0x2000
    s_bitset0_b32 s23, 15
    v_smfmac_f32_16x16x64_bf16 v[104:107], v[72:75], v[208:215], v3
    s_add_u32 s30, s23, 0x1000
    ds_read_b128 v[48:51], v8 offset:19456
    v_cvt_pk_bf16_f32 v100, v100, v102
    v_cvt_pk_bf16_f32 v101, v101, v103
    v_smfmac_f32_16x16x64_bf16 v[104:107], v[96:99], v[216:223], v3
    buffer_store_dword v100, v4, s[8:11], s19 offen offset:0
    buffer_store_dword v101, v4, s[8:11], s19 offen offset:2048
    v_smfmac_f32_16x16x64_bf16 v[36:39], v[68:71], v[232:239], v3
    s_mov_b32 s21, 1
    v_sub_f32 v7, v7, v65
    v_smfmac_f32_16x16x64_bf16 v[36:39], v[72:75], v[28:35], v3
    s_waitcnt lgkmcnt(1)
    v_cvt_pk_bf16_f32 v104, v104, v106
    v_cvt_pk_bf16_f32 v105, v105, v107
    v_smfmac_f32_16x16x64_bf16 v[36:39], v[96:99], v[20:27], v3
    buffer_store_dword v104, v4, s[8:11], s20 offen offset:0
    buffer_store_dword v105, v4, s[8:11], s20 offen offset:2048
    v_smfmac_f32_16x16x64_bf16 v[40:43], v[68:71], v[248:255], v3
    v_smfmac_f32_16x16x64_bf16 v[40:43], v[72:75], v[76:83], v3
    s_waitcnt lgkmcnt(0)
    v_cvt_pk_bf16_f32 v36, v36, v38
    v_cvt_pk_bf16_f32 v37, v37, v39
    v_smfmac_f32_16x16x64_bf16 v[40:43], v[96:99], v[44:51], v3
    buffer_store_dword v36, v4, s[8:11], s38 offen offset:0
    buffer_store_dword v37, v4, s[8:11], s38 offen offset:2048
    s_nop 5
    v_cvt_pk_bf16_f32 v40, v40, v42
    v_cvt_pk_bf16_f32 v41, v41, v43
    buffer_store_dword v40, v4, s[8:11], s22 offen offset:0
    buffer_store_dword v41, v4, s[8:11], s22 offen offset:2048
    ds_read_b128 v[72:75], v8 offset:7168
    v_pk_mov_b32 v[140:141], v[60:61], v[62:63] op_sel:[0,0]
    ds_read_b128 v[28:31], v8 offset:34816
    v_pk_mov_b32 v[142:143], v[60:61], v[62:63] op_sel:[1,1]
    ds_read_b128 v[32:35], v8 offset:35840
    v_bfe_u32 v126, v1, 2, 6
    ds_read_b128 v[36:39], v8 offset:26624
    v_mov_b64 v[68:69], 0
    ds_read_b128 v[40:43], v8 offset:27648
    v_mov_b64 v[70:71], 0
    ds_read_b128 v[76:79], v8 offset:28672
    v_mfma_f32_16x16x1_4b_f32 v[52:67], v126, v126, 0
    ds_read_b128 v[80:83], v8 offset:29696
    ds_read_b128 v[84:87], v8 offset:30720
    ds_read_b128 v[88:91], v8 offset:31744
    s_nop 0
    s_nop 0
    s_nop 0
    s_nop 0
    s_nop 0
    s_nop 0
    s_nop 0
    s_nop 0
    s_nop 0
    s_nop 0
    s_nop 0
    s_nop 0
    s_nop 0
    s_nop 0
    s_nop 0
    s_nop 0
    s_nop 0
    s_nop 0
    s_nop 0
    s_nop 0
    s_nop 0
    s_nop 0
    s_nop 0
    s_nop 0
    s_nop 0
    s_nop 0
    s_nop 0
    s_nop 0
    s_nop 0
    s_nop 0
    s_nop 0
    s_nop 0
    buffer_load_dwordx4 v[128:131], v1, s[8:11], s25 offen offset:0 sc1
    buffer_load_dwordx4 v[132:135], v1, s[8:11], s25 offen offset:1024 sc1
    ds_read_b128 v[92:95], v8 offset:32768
    s_waitcnt vmcnt(17)
    v_mov_b64 v[100:101], v[108:109]
    ds_read_b128 v[96:99], v8 offset:33792
    v_mov_b64 v[102:103], v[110:111]
    v_mov_b64 v[104:105], v[112:113]
    ds_read_b128 v[44:47], v8 offset:24576
    v_mov_b64 v[106:107], v[114:115]
    ds_read_b128 v[48:51], v8 offset:25600
    ds_read_b128 v[108:111], v8 offset:20480
    ds_read_b128 v[112:115], v8 offset:21504
    s_add_u32 s19, s18, 2
    s_cmp_ge_u32 s19, s37
    s_cbranch_scc1 Cw3_kvw
    Cw3_kvok:
    s_nop 0
    s_nop 0
    s_nop 0
    s_nop 0
    s_nop 0
    s_nop 0
    s_nop 0
    s_nop 0
    s_nop 0
    s_nop 0
    s_nop 0
    s_nop 0
    s_nop 0
    s_nop 0
    buffer_load_dwordx4 v[128:131], v1, s[8:11], s25 offen offset:0 sc1
    buffer_load_dwordx4 v[132:135], v1, s[8:11], s25 offen offset:1024 sc1
    s_branch Cw3_Pw
    Cw3_Pf:
    s_add_u32 s21, s21, 1
    v_max3_u32 v124, v128, v129, v130
    v_max3_u32 v126, v131, v132, v133
    v_max3_u32 v124, v124, v134, v135
    v_max_u32 v124, v124, v126
    v_cmp_eq_u32 vcc, -1, v124
    s_nop 0
    s_mov_b64 exec, vcc
    buffer_load_dwordx4 v[128:131], v1, s[8:11], s25 offen offset:0 sc1
    buffer_load_dwordx4 v[132:135], v1, s[8:11], s25 offen offset:1024 sc1
    s_mov_b64 exec, -1
    s_cmp_gt_u32 s21, 4
    s_cbranch_scc1 Cw3_Pre
    Cw3_Pw:
    s_waitcnt vmcnt(3) lgkmcnt(0)
    Cw3_P:
    v_mfma_f32_16x16x32_bf16 v[24:27], v[72:75], v[128:131], 0
    s_waitcnt vmcnt(2)
    v_mfma_f32_16x16x32_bf16 v[24:27], v[72:75], v[132:135], v[24:27]
    s_nop 7
    v_cmp_u_f32 vcc, v24, v24
    v_add_f32_dpp v24, v24, v24 row_ror:4 row_mask:0xf bank_mask:0xf
    v_add_f32_dpp v25, v25, v25 row_ror:4 row_mask:0xf bank_mask:0xf
    s_nop 0
    v_add_f32_dpp v24, v24, v24 row_ror:8 row_mask:0xf bank_mask:0xf
    v_add_f32_dpp v25, v25, v25 row_ror:8 row_mask:0xf bank_mask:0xf
    v_cvt_pk_bf16_f32 v124, v24, v25
    s_cbranch_vccnz Cw3_Pf
    buffer_store_dword v124, v5, s[8:11], s23 offen
    Cw3_w2:
    s_branch Cw3_step
    Cw3_kvw:
    s_mov_b32 s21, 0
    s_waitcnt vmcnt(14)
    s_branch Cw3_kvl_chk
    v_lshrrev_b32 v126, 2, v1
    v_and_b32 v126, 63, v126
    s_mov_b32 s21, 0
    Cw3_kvl:
    buffer_load_dword v127, v126, s[8:11], s29 offen sc1
    s_add_u32 s21, s21, 1
    s_cmp_gt_u32 s21, 400000
    s_cbranch_scc1 C_fail
    s_waitcnt vmcnt(0)
    Cw3_kvl_chk:
    v_min_u32_dpp v127, v127, v127 row_ror:8 row_mask:0xf bank_mask:0xf
    s_nop 1
    v_min_u32_dpp v127, v127, v127 row_ror:4 row_mask:0xf bank_mask:0xf
    s_nop 1
    v_min_u32_dpp v127, v127, v127 row_ror:2 row_mask:0xf bank_mask:0xf
    s_nop 1
    v_min_u32_dpp v127, v127, v127 row_ror:1 row_mask:0xf bank_mask:0xf
    s_nop 0
    v_readfirstlane_b32 s37, v127
    s_nop 0
    s_lshl_b32 s37, s37, 2
    s_cmp_ge_u32 s19, s37
    s_cbranch_scc1 Cw3_kvl
    s_cmp_ge_u32 s37, 12
    s_cselect_b32 s21, 12, 0
    s_cmp_ge_u32 s37, 44
    s_cselect_b32 s21, 44, s21
    s_cmp_ge_u32 s37, 64
    s_cselect_b32 s21, 1000, s21
    s_cmp_gt_u32 s21, s19
    s_cselect_b32 s37, s21, s37
    s_mov_b32 s21, 1
    s_branch Cw3_kvok
    Cw3_last:
    v_mov_b32 v124, v61
    v_mov_b32 v61, v62
    v_mov_b32 v62, v124
    buffer_store_dwordx4 v[60:63], v1, s[8:11], s33 offen sc1
    s_branch C_done
    Cw3_fix:
    v_and_b32 v124, 0x3ff, v11
    v_lshlrev_b32 v124, 1, v124
    v_add_u32 v124, 0x24800, v124
    v_lshlrev_b32 v126, 1, v1
    v_add_u32 v126, 0x24800, v126
    ds_write_b64 v124, v[88:89]
    v_mov_b32 v142, v7
    v_mov_b32 v143, v7
    s_waitcnt lgkmcnt(0)
    s_barrier
    ds_read_b128 v[68:71], v126
    ds_read_b128 v[72:75], v126 offset:16
    v_fmac_f32_dpp v142, v92, v0 quad_perm:[0,1,0,1] row_mask:0xf bank_mask:0xf
    v_fmac_f32_dpp v143, v93, v0 quad_perm:[0,1,0,1] row_mask:0xf bank_mask:0xf
    s_nop 0
    v_fmac_f32_dpp v142, v94, v0 quad_perm:[2,3,2,3] row_mask:0xf bank_mask:0xf
    v_fmac_f32_dpp v143, v95, v0 quad_perm:[2,3,2,3] row_mask:0xf bank_mask:0xf
    s_waitcnt lgkmcnt(0)
    v_max3_f32 v124, v68, v69, v70
    v_max3_f32 v124, v124, v71, v72
    v_max3_f32 v124, v124, v73, v74
    v_max3_f32 v124, v124, v75, v142
    v_max_f32 v124, v124, v143
    v_mov_b32 v126, v124
    s_nop 1
    v_permlane32_swap_b32 v124, v126
    v_max_f32 v124, v124, v126
    v_mov_b32 v126, v124
    s_nop 1
    v_permlane16_swap_b32 v124, v126
    v_max_f32 v124, v124, v126
    v_sub_f32 v7, v7, v124
    v_sub_f32 v68, v68, v124
    v_sub_f32 v69, v69, v124
    v_sub_f32 v70, v70, v124
    v_sub_f32 v71, v71, v124
    v_sub_f32 v72, v72, v124
    v_sub_f32 v73, v73, v124
    v_sub_f32 v74, v74, v124
    v_sub_f32 v75, v75, v124
    v_sub_f32 v142, v142, v124
    v_sub_f32 v143, v143, v124
    v_exp_f32 v68, v68
    v_exp_f32 v69, v69
    v_exp_f32 v70, v70
    v_exp_f32 v71, v71
    v_exp_f32 v72, v72
    v_exp_f32 v73, v73
    v_exp_f32 v74, v74
    v_exp_f32 v75, v75
    v_exp_f32 v142, v142
    v_exp_f32 v143, v143
    v_cvt_pk_bf16_f32 v84, v68, v69
    v_cvt_pk_bf16_f32 v85, v70, v71
    v_cvt_pk_bf16_f32 v86, v72, v73
    v_cvt_pk_bf16_f32 v87, v74, v75
    v_cvt_pk_bf16_f32 v141, v142, v143
    s_nop 0
    v_mfma_f32_16x16x32_bf16 v[64:67], v[136:139], v[84:87], 0
    v_mfma_f32_16x16x32_bf16 v[52:55], v[128:131], v[84:87], 0
    v_mfma_f32_16x16x32_bf16 v[56:59], v[132:135], v[84:87], 0
    v_mfma_f32_16x16x16_bf16 v[64:67], v[136:137], v[140:141], v[64:67]
    v_mfma_f32_16x16x16_bf16 v[52:55], v[60:61], v[140:141], v[52:55]
    v_mfma_f32_16x16x16_bf16 v[56:59], v[62:63], v[140:141], v[56:59]
    v_rcp_f32 v64, v64
    s_nop 2
    v_pk_mul_f32 v[52:53], v[52:53], v[64:65] op_sel_hi:[1,0]
    v_pk_mul_f32 v[54:55], v[54:55], v[64:65] op_sel_hi:[1,0]
    v_cvt_pk_bf16_f32 v52, v52, v53
    v_cvt_pk_bf16_f32 v53, v54, v55
    v_pk_mul_f32 v[56:57], v[56:57], v[64:65] op_sel_hi:[1,0]
    v_pk_mul_f32 v[58:59], v[58:59], v[64:65] op_sel_hi:[1,0]
    v_cvt_pk_bf16_f32 v54, v56, v57
    v_cvt_pk_bf16_f32 v55, v58, v59
    ds_write_b64 v2, v[52:53] offset:11264
    ds_write_b64 v2, v[54:55] offset:11272
    v_mov_b64 v[100:101], 0
    v_mov_b64 v[102:103], 0
    v_mov_b64 v[104:105], 0
    v_mov_b64 v[106:107], 0
    v_mov_b64 v[36:37], 0
    v_mov_b64 v[38:39], 0
    v_log_f32 v65, v65
    v_smfmac_f32_16x16x64_bf16 v[100:103], v[52:55], v[160:167], v3
    v_smfmac_f32_16x16x64_bf16 v[104:107], v[52:55], v[192:199], v3
    v_smfmac_f32_16x16x64_bf16 v[36:39], v[52:55], v[224:231], v3
    s_waitcnt lgkmcnt(0)
    s_branch Cw3_fixed
    C_fail:
    s_branch F_fail
    C_done:
    v_mov_b32 v32, 64
    s_waitcnt vmcnt(0)
    s_mov_b64 exec, 1
    buffer_store_dword v32, v1, s[8:11], s28 offen sc1
    s_mov_b64 exec, -1
    s_endpgm
    CS_entry:
    s_cmp_eq_u32 s17, 1
    s_cbranch_scc1 CSw1_entry
    s_cmp_eq_u32 s17, 2
    s_cbranch_scc1 CSw2_entry
    s_cmp_eq_u32 s17, 3
    s_cbranch_scc1 CSw3_entry
    CSw0_entry:
    s_mov_b32 s23, 0x86000
    s_mov_b32 s24, s23
    s_add_u32 s23, s23, 0x2000
    s_bitset0_b32 s23, 15
    s_add_u32 s30, s23, 0x1000
    buffer_load_dwordx4 v[20:23], v125, s[8:11], s23 offen offset:0 sc1
    buffer_load_dwordx4 v[24:27], v125, s[8:11], s30 offen offset:0 sc1
    s_mov_b32 s18, -1
    v_mov_b32 v136, 0x3f803f80
    v_mov_b32 v137, 0x3f803f80
    v_mov_b32 v138, 0x3f803f80
    v_mov_b32 v139, 0x3f803f80
    s_mov_b32 s64, 0x42700000
    v_lshlrev_b32 v124, v1, v136
    v_lshrrev_b32 v126, 16, v136
    v_bfe_i32 v52, v1, 4, 1
    v_bfi_b32 v124, v52, v124, v126
    v_bfe_u32 v126, v1, 6, 2
    v_cmp_eq_u32 vcc, 0, v126
    s_nop 1
    v_cndmask_b32 v52, 0, v124, vcc
    v_cmp_eq_u32 vcc, 1, v126
    s_nop 1
    v_cndmask_b32 v53, 0, v124, vcc
    v_cmp_eq_u32 vcc, 2, v126
    s_nop 1
    v_cndmask_b32 v54, 0, v124, vcc
    v_cmp_eq_u32 vcc, 3, v126
    s_nop 1
    v_cndmask_b32 v55, 0, v124, vcc
    ds_write_b128 v8, v[52:55] offset:7168
    s_waitcnt lgkmcnt(0)
    v_pk_mov_b32 v[140:141], v[60:61], v[62:63] op_sel:[0,0]
    ds_read_b128 v[28:31], v8 offset:34816
    v_pk_mov_b32 v[142:143], v[60:61], v[62:63] op_sel:[1,1]
    ds_read_b128 v[32:35], v8 offset:35840
    v_bfe_u32 v126, v1, 2, 6
    ds_read_b128 v[36:39], v8 offset:26624
    v_mov_b64 v[68:69], 0
    ds_read_b128 v[40:43], v8 offset:27648
    v_mov_b64 v[70:71], 0
    ds_read_b128 v[76:79], v8 offset:28672
    v_mfma_f32_16x16x1_4b_f32 v[52:67], v126, v126, 0
    ds_read_b128 v[80:83], v8 offset:29696
    ds_read_b128 v[84:87], v8 offset:30720
    ds_read_b128 v[88:91], v8 offset:31744
    ds_read_b128 v[92:95], v8 offset:32768
    s_waitcnt vmcnt(2)
    v_mov_b64 v[100:101], v[108:109]
    ds_read_b128 v[96:99], v8 offset:33792
    v_mov_b64 v[102:103], v[110:111]
    v_mov_b64 v[104:105], v[112:113]
    ds_read_b128 v[44:47], v8 offset:24576
    v_mov_b64 v[106:107], v[114:115]
    ds_read_b128 v[48:51], v8 offset:25600
    ds_read_b128 v[108:111], v8 offset:20480
    ds_read_b128 v[112:115], v8 offset:21504
    s_xor_b32 s25, s25, 0x40000
    s_xor_b32 s26, s26, 0x40000
    v_bfe_u32 v126, v1, 2, 6
    v_mov_b64 v[72:73], 0
    v_mov_b64 v[74:75], 0
    s_add_u32 s18, s18, 1
    s_xor_b32 s25, s25, 0x40000
    s_xor_b32 s26, s26, 0x40000
    s_add_u32 s19, s18, 2
    s_cmp_ge_u32 s19, s37
    s_cselect_b32 s36, s29, 0x7ff00000
    s_add_u32 s31, s31, 0x40000
    s_add_u32 s32, s32, 0x40000
    s_mov_b32 s21, 1
    s_mov_b32 s35, 1
    s_waitcnt vmcnt(2)
    v_mov_b64 v[128:129], v[116:117]
    v_mov_b64 v[130:131], v[118:119]
    v_mov_b64 v[132:133], v[120:121]
    v_mov_b64 v[134:135], v[122:123]
    ds_read_b128 v[116:119], v8 offset:22528
    ds_read_b128 v[120:123], v8 offset:23552
    s_waitcnt vmcnt(0)
    s_branch CSw0_Aw
    CSw0_Bf:
    s_add_u32 s35, s35, 1
    s_cmp_gt_u32 s35, 2
    s_cbranch_scc1 CSw0_Bre
    s_nop 6
    v_mov_b64 v[60:61], 0
    v_mov_b64 v[62:63], 0
    v_mov_b64 v[64:65], 0
    v_mov_b64 v[66:67], 0
    v_smfmac_f32_16x16x64_bf16 v[60:63], v[20:23], v[76:83], v3
    s_nop 0
    v_smfmac_f32_16x16x64_bf16 v[64:67], v[20:23], v[84:91], v3
    s_waitcnt vmcnt(3)
    s_branch CSw0_Bw
    CSw0_Are:
    s_waitcnt vmcnt(0)
    CSw0_Arl:
    s_mov_b64 exec, vcc
    buffer_load_dwordx4 v[20:23], v125, s[8:11], s23 offen offset:0 sc1
    s_mov_b64 exec, -1
    buffer_load_dwordx4 v[24:27], v125, s[8:11], s30 offen offset:0 sc1
    s_add_u32 s21, s21, 1
    s_cmp_gt_u32 s21, 400000
    s_cbranch_scc1 CS_fail
    s_waitcnt vmcnt(6)
    v_mov_b64 v[52:53], 0
    v_mov_b64 v[54:55], 0
    v_mov_b64 v[56:57], 0
    v_mov_b64 v[58:59], 0
    v_mov_b64 v[60:61], 0
    v_mov_b64 v[62:63], 0
    v_max3_u32 v124, v20, v21, v22
    v_max_u32 v124, v124, v23
    v_cmp_eq_u32 vcc, -1, v124
    s_cbranch_vccz CSw0_Adn
    CSw0_Ack:
    v_max3_u32 v124, v20, v21, v22
    v_max_u32 v124, v124, v23
    v_cmp_eq_u32 vcc, -1, v124
    s_cbranch_vccnz CSw0_Arl
    CSw0_Adn:
    v_smfmac_f32_16x16x64_bf16 v[52:55], v[20:23], v[108:115], v3
    ds_write_b128 v2, v[20:23] offset:0
    v_smfmac_f32_16x16x64_bf16 v[56:59], v[20:23], v[116:123], v3
    buffer_load_dwordx4 v[24:27], v125, s[8:11], s30 offen offset:0 sc1
    v_smfmac_f32_16x16x64_bf16 v[60:63], v[20:23], v[76:83], v3
    s_barrier
    buffer_load_dwordx4 v[108:111], v9, s[8:11], s31 offen sc1
    v_smfmac_f32_16x16x64_bf16 v[64:67], v[20:23], v[84:91], v3
    buffer_load_dwordx4 v[112:115], v9, s[8:11], s31 offen offset:2048 sc1
    v_smfmac_f32_16x16x64_bf16 v[68:71], v[20:23], v[92:99], v3
    buffer_load_dwordx4 v[116:119], v1, s[8:11], s32 offen sc1
    v_smfmac_f32_16x16x64_bf16 v[72:75], v[20:23], v[28:35], v3
    s_waitcnt lgkmcnt(0)
    s_barrier
    ds_read_b128 v[28:31], v2 offset:2048
    ds_read_b128 v[32:35], v2 offset:4096
    s_branch CSw0_Bck
    CSw0_Bre:
    CSw0_Brl:
    s_mov_b64 exec, vcc
    buffer_load_dwordx4 v[24:27], v125, s[8:11], s30 offen offset:0 sc1
    s_mov_b64 exec, -1
    s_add_u32 s35, s35, 1
    s_cmp_gt_u32 s35, 400000
    s_cbranch_scc1 CS_fail
    s_waitcnt vmcnt(6)
    v_max3_u32 v124, v24, v25, v26
    v_max_u32 v124, v124, v27
    v_cmp_eq_u32 vcc, -1, v124
    s_cbranch_vccz CSw0_Bdn
    CSw0_Bck:
    v_max3_u32 v124, v24, v25, v26
    v_max_u32 v124, v124, v27
    v_cmp_eq_u32 vcc, -1, v124
    s_cbranch_vccnz CSw0_Brl
    CSw0_Bdn:
    ds_write_b128 v2, v[24:27] offset:1024
    v_mov_b64 v[60:61], 0
    v_mov_b64 v[62:63], 0
    v_mov_b64 v[64:65], 0
    v_mov_b64 v[66:67], 0
    v_smfmac_f32_16x16x64_bf16 v[60:63], v[20:23], v[76:83], v3
    s_nop 0
    v_smfmac_f32_16x16x64_bf16 v[64:67], v[20:23], v[84:91], v3
    v_smfmac_f32_16x16x64_bf16 v[60:63], v[24:27], a[96:103], v3
    v_smfmac_f32_16x16x64_bf16 v[64:67], v[24:27], a[104:111], v3
    s_waitcnt vmcnt(0)
    s_waitcnt lgkmcnt(0)
    s_branch CSw0_Bok
    CSw0_Pre:
    CSw0_Prl:
    s_mov_b64 exec, vcc
    buffer_load_dwordx4 v[128:131], v1, s[8:11], s25 offen offset:0 sc1
    buffer_load_dwordx4 v[132:135], v1, s[8:11], s25 offen offset:1024 sc1
    s_mov_b64 exec, -1
    s_add_u32 s21, s21, 1
    s_cmp_gt_u32 s21, 400000
    s_cbranch_scc1 CS_fail
    s_waitcnt vmcnt(8)
    v_max3_u32 v124, v128, v129, v130
    v_max3_u32 v126, v131, v132, v133
    v_max3_u32 v124, v124, v134, v135
    v_max_u32 v124, v124, v126
    v_cmp_eq_u32 vcc, -1, v124
    s_cbranch_vccz CSw0_Pdn
    CSw0_Pck:
    v_max3_u32 v124, v128, v129, v130
    v_max3_u32 v126, v131, v132, v133
    v_max3_u32 v124, v124, v134, v135
    v_max_u32 v124, v124, v126
    v_cmp_eq_u32 vcc, -1, v124
    s_cbranch_vccnz CSw0_Prl
    CSw0_Pdn:
    v_mfma_f32_16x16x32_bf16 v[24:27], v[72:75], v[128:131], 0
    v_mfma_f32_16x16x32_bf16 v[24:27], v[72:75], v[132:135], v[24:27]
    s_nop 7
    v_add_f32_dpp v24, v24, v24 row_ror:4 row_mask:0xf bank_mask:0xf
    v_add_f32_dpp v25, v25, v25 row_ror:4 row_mask:0xf bank_mask:0xf
    s_nop 0
    v_add_f32_dpp v24, v24, v24 row_ror:8 row_mask:0xf bank_mask:0xf
    v_add_f32_dpp v25, v25, v25 row_ror:8 row_mask:0xf bank_mask:0xf
    v_cvt_pk_bf16_f32 v124, v24, v25
    buffer_store_dword v124, v5, s[8:11], s23 offen sc1
    s_waitcnt vmcnt(1)
    s_branch CSw0_w2
.p2align 6
    CSw0_step:
    v_bfe_u32 v126, v1, 2, 6
    v_mov_b64 v[72:73], 0
    v_mov_b64 v[74:75], 0
    s_add_u32 s18, s18, 1
    s_xor_b32 s25, s25, 0x40000
    s_xor_b32 s26, s26, 0x40000
    s_add_u32 s19, s18, 2
    s_cmp_ge_u32 s19, s37
    s_cselect_b32 s36, s29, 0x7ff00000
    s_add_u32 s31, s31, 0x40000
    s_add_u32 s32, s32, 0x40000
    s_mov_b32 s21, 1
    s_mov_b32 s35, 1
    s_waitcnt vmcnt(1)
    v_mov_b64 v[128:129], v[116:117]
    v_mov_b64 v[130:131], v[118:119]
    v_mov_b64 v[132:133], v[120:121]
    v_mov_b64 v[134:135], v[122:123]
    ds_read_b128 v[116:119], v8 offset:22528
    ds_read_b128 v[120:123], v8 offset:23552
    s_nop 0
    s_nop 0
    s_nop 0
    s_nop 0
    s_nop 0
    s_nop 0
    s_nop 0
    s_nop 0
    s_nop 0
    s_nop 0
    s_nop 0
    s_nop 0
    s_nop 0
    s_nop 0
    s_nop 0
    s_nop 0
    s_nop 0
    s_nop 0
    s_nop 0
    s_nop 0
    s_nop 0
    s_nop 0
    s_nop 0
    s_nop 0
    s_nop 0
    s_nop 0
    s_nop 0
    s_nop 0
    buffer_load_dwordx4 v[20:23], v125, s[8:11], s23 offen offset:0 sc1
    s_nop 0
    buffer_load_dword v127, off, s[8:11], s23
    s_nop 0
    s_nop 0
    s_nop 0
    s_nop 0
    s_nop 0
    s_nop 0
    s_nop 0
    s_nop 0
    s_nop 0
    s_nop 0
    s_nop 0
    s_nop 0
    s_nop 0
    s_nop 0
    s_nop 0
    s_nop 0
    s_nop 0
    s_nop 0
    s_nop 0
    s_nop 0
    s_nop 0
    buffer_load_dwordx4 v[20:23], v125, s[8:11], s23 offen offset:0 sc1
    s_nop 0
    s_nop 0
    s_nop 0
    s_nop 0
    s_nop 0
    s_nop 0
    s_nop 0
    s_nop 0
    s_nop 0
    s_nop 0
    s_nop 0
    buffer_load_dwordx4 v[24:27], v125, s[8:11], s30 offen offset:0 sc1
    s_branch CSw0_Aw
    CSw0_Af:
    v_mfma_f32_16x16x1_4b_f32 v[52:67], v126, v126, 0
    s_mov_b64 exec, vcc
    buffer_load_dwordx4 v[20:23], v125, s[8:11], s23 offen offset:0 sc1
    s_mov_b64 exec, -1
    buffer_load_dwordx4 v[24:27], v125, s[8:11], s30 offen offset:0 sc1
    s_add_u32 s21, s21, 1
    s_cmp_gt_u32 s21, 6
    s_cbranch_scc1 CSw0_Are
    s_nop 0
    s_nop 0
    s_nop 0
    CSw0_Aw:
    s_waitcnt vmcnt(3) lgkmcnt(0)
    v_fma_f32 v124, v20, v21, v22
    v_cmp_u_f32 vcc, v124, v23
    v_smfmac_f32_16x16x64_bf16 v[52:55], v[20:23], v[108:115], v3
    ds_write_b128 v2, v[20:23] offset:0
    v_smfmac_f32_16x16x64_bf16 v[56:59], v[20:23], v[116:123], v3
    s_cbranch_vccnz CSw0_Af
    buffer_load_dwordx4 v[24:27], v125, s[8:11], s30 offen offset:0 sc1
    v_smfmac_f32_16x16x64_bf16 v[60:63], v[20:23], v[76:83], v3
    s_barrier
    buffer_load_dwordx4 v[108:111], v9, s[8:11], s31 offen sc1
    v_smfmac_f32_16x16x64_bf16 v[64:67], v[20:23], v[84:91], v3
    buffer_load_dwordx4 v[112:115], v9, s[8:11], s31 offen offset:2048 sc1
    v_smfmac_f32_16x16x64_bf16 v[68:71], v[20:23], v[92:99], v3
    buffer_load_dwordx4 v[116:119], v1, s[8:11], s32 offen sc1
    v_smfmac_f32_16x16x64_bf16 v[72:75], v[20:23], v[28:35], v3
    s_waitcnt lgkmcnt(0)
    s_barrier
    ds_read_b128 v[28:31], v2 offset:2048
    ds_read_b128 v[32:35], v2 offset:4096
    CSw0_Bw:
    s_waitcnt vmcnt(4)
    v_fma_f32 v124, v24, v25, v26
    v_cmp_u_f32 vcc, v124, v27
    v_smfmac_f32_16x16x64_bf16 v[60:63], v[24:27], a[96:103], v3
    ds_write_b128 v2, v[24:27] offset:1024
    v_smfmac_f32_16x16x64_bf16 v[64:67], v[24:27], a[104:111], v3
    s_cbranch_vccnz CSw0_Bf
    CSw0_Bok:
    buffer_store_dwordx4 v[140:143], v1, s[8:11], s33 offen sc1
    buffer_load_dword v127, v126, s[8:11], s36 offen sc1
    v_smfmac_f32_16x16x64_bf16 v[52:55], v[24:27], v[44:51], v3
    s_mov_b32 s33, s34
    buffer_load_dwordx4 v[120:123], v1, s[8:11], s32 offen offset:1024 sc1
    v_mov_b64 v[140:141], -1
    v_smfmac_f32_16x16x64_bf16 v[56:59], v[24:27], v[36:43], v3
    ds_read_b128 v[36:39], v2 offset:6144
    s_waitcnt lgkmcnt(3)
    v_smfmac_f32_16x16x64_bf16 v[52:55], v[28:31], a[0:7], v3
    s_add_u32 s34, s34, 0x20000
    v_mov_b32 v126, s18
    v_smfmac_f32_16x16x64_bf16 v[56:59], v[28:31], a[8:15], v3
    s_waitcnt lgkmcnt(1)
    s_mov_b64 exec, 1
    buffer_store_dword v126, off, s[8:11], s28 sc1
    s_mov_b64 exec, -1
    v_smfmac_f32_16x16x64_bf16 v[52:55], v[32:35], a[32:39], v3
    s_barrier
    ds_read_b128 v[44:47], v2 offset:3072
    v_smfmac_f32_16x16x64_bf16 v[56:59], v[32:35], a[40:47], v3
    s_waitcnt lgkmcnt(1)
    s_mov_b32 s19, s27
    ds_read_b128 v[40:43], v2 offset:5120
    v_smfmac_f32_16x16x64_bf16 v[52:55], v[36:39], a[64:71], v3
    s_add_u32 s20, s27, 0x10000
    s_add_u32 s38, s27, 0x20000
    ds_read_b128 v[48:51], v2 offset:7168
    v_smfmac_f32_16x16x64_bf16 v[56:59], v[36:39], a[72:79], v3
    s_add_u32 s22, s27, 0x30000
    s_xor_b32 s27, s27, 0x40000
    v_mov_b64 v[142:143], -1
    v_smfmac_f32_16x16x64_bf16 v[60:63], v[28:31], a[112:119], v3
    v_smfmac_f32_16x16x64_bf16 v[60:63], v[36:39], a[144:151], v3
    ds_read_b128 v[76:79], v8 offset:0
    v_smfmac_f32_16x16x64_bf16 v[64:67], v[28:31], a[120:127], v3
    s_waitcnt lgkmcnt(2)
    v_smfmac_f32_16x16x64_bf16 v[52:55], v[44:47], a[16:23], v3
    ds_read_b128 v[80:83], v8 offset:1024
    v_smfmac_f32_16x16x64_bf16 v[52:55], v[40:43], a[48:55], v3
    s_waitcnt lgkmcnt(2)
    ds_read_b128 v[84:87], v8 offset:4096
    v_smfmac_f32_16x16x64_bf16 v[52:55], v[48:51], a[80:87], v3
    ds_read_b128 v[88:91], v8 offset:5120
    v_smfmac_f32_16x16x64_bf16 v[56:59], v[44:47], a[24:31], v3
    ds_read_b128 v[92:95], v8 offset:2048
    v_smfmac_f32_16x16x64_bf16 v[56:59], v[40:43], a[56:63], v3
    ds_read_b128 v[96:99], v8 offset:3072
    v_add_f32 v52, v52, v54
    v_smfmac_f32_16x16x64_bf16 v[56:59], v[48:51], a[88:95], v3
    s_waitcnt lgkmcnt(4)
    v_add_f32 v53, v53, v55
    v_smfmac_f32_16x16x64_bf16 v[60:63], v[32:35], v[76:83], v3
    s_waitcnt lgkmcnt(2)
    v_cvt_pk_bf16_f32 v54, v52, v53
    v_smfmac_f32_16x16x64_bf16 v[60:63], v[40:43], v[84:91], v3
    v_add_f32 v56, v56, v58
    v_add_f32 v57, v57, v59
    v_cvt_pk_bf16_f32 v55, v56, v57
    v_smfmac_f32_16x16x64_bf16 v[60:63], v[44:47], a[128:135], v3
    ds_write_b64 v6, v[54:55]
    v_smfmac_f32_16x16x64_bf16 v[60:63], v[48:51], a[160:167], v3
    s_waitcnt lgkmcnt(1)
    ds_read_b128 v[52:55], v8 offset:8192
    v_mov_b32 v88, v7
    v_smfmac_f32_16x16x64_bf16 v[64:67], v[32:35], v[92:99], v3
    ds_read_b128 v[56:59], v8 offset:9216
    v_mov_b32 v89, v7
    v_smfmac_f32_16x16x64_bf16 v[64:67], v[40:43], v[12:19], v3
    ds_read_b128 v[92:95], v8 offset:10240
    v_add_f32 v60, v60, v62
    v_smfmac_f32_16x16x64_bf16 v[64:67], v[36:39], a[152:159], v3
    s_waitcnt lgkmcnt(3)
    s_barrier
    ds_read_b64_tr_b16 v[76:77], v10 offset:0
    ds_read_b64_tr_b16 v[78:79], v10 offset:1024
    v_smfmac_f32_16x16x64_bf16 v[64:67], v[44:47], a[136:143], v3
    buffer_store_dword v140, v5, s[8:11], s24 offen sc1
    ds_read_b64_tr_b16 v[80:81], v10 offset:2048
    ds_read_b64_tr_b16 v[82:83], v10 offset:3072
    v_smfmac_f32_16x16x64_bf16 v[64:67], v[48:51], a[168:175], v3
    ds_read_b128 v[96:99], v8 offset:11264
    v_add_f32 v61, v61, v63
    v_cvt_pk_bf16_f32 v60, v60, v61
    v_smfmac_f32_16x16x64_bf16 v[68:71], v[24:27], a[176:183], v3
    s_waitcnt lgkmcnt(3)
    v_mfma_f32_16x16x32_bf16 v[84:87], v[100:103], v[76:79], 0
    buffer_store_dwordx4 v[140:143], v1, s[8:11], s26 offen sc1
    v_add_f32 v64, v64, v66
    v_add_f32 v65, v65, v67
    v_cvt_pk_bf16_f32 v62, v64, v65
    s_waitcnt lgkmcnt(1)
    v_mfma_f32_16x16x32_bf16 v[84:87], v[104:107], v[80:83], v[84:87]
    ds_write2_b32 v6, v60, v62 offset0:128 offset1:129
    v_smfmac_f32_16x16x64_bf16 v[72:75], v[24:27], a[184:191], v3
    ds_read_b128 v[100:103], v8 offset:6144
    v_mov_b64 v[104:105], 0
    v_mov_b64 v[106:107], 0
    v_smfmac_f32_16x16x64_bf16 v[68:71], v[40:43], v[52:59], v3
    s_waitcnt lgkmcnt(2)
    buffer_store_dwordx4 v[140:143], v1, s[8:11], s26 offen offset:1024 sc1
    v_fmac_f32_dpp v88, v84, v0 quad_perm:[0,1,0,1] row_mask:0xf bank_mask:0xf
    v_fmac_f32_dpp v89, v85, v0 quad_perm:[0,1,0,1] row_mask:0xf bank_mask:0xf
    v_smfmac_f32_16x16x64_bf16 v[72:75], v[40:43], v[92:99], v3
    s_waitcnt vmcnt(10)
    v_fmac_f32_dpp v88, v86, v0 quad_perm:[2,3,2,3] row_mask:0xf bank_mask:0xf
    v_fmac_f32_dpp v89, v87, v0 quad_perm:[2,3,2,3] row_mask:0xf bank_mask:0xf
    v_mov_b32 v140, 0
    v_smfmac_f32_16x16x64_bf16 v[68:71], v[36:39], a[240:247], v3
    v_mov_b32 v142, v7
    v_smfmac_f32_16x16x64_bf16 v[72:75], v[36:39], a[248:255], v3
    s_waitcnt lgkmcnt(1)
    s_barrier
    ds_read_b64_tr_b16 v[20:21], v10 offset:512
    v_exp_f32 v90, v88
    v_smfmac_f32_16x16x64_bf16 v[68:71], v[28:31], a[192:199], v3
    ds_read_b64_tr_b16 v[22:23], v10 offset:1536
    ds_read_b64_tr_b16 v[24:25], v10 offset:2560
    ds_read_b64_tr_b16 v[26:27], v10 offset:3584
    v_exp_f32 v91, v89
    s_nop 0
    v_cvt_pk_bf16_f32 v90, v90, v91
    v_mov_b64 v[40:41], 0
    v_mov_b64 v[42:43], 0
    v_smfmac_f32_16x16x64_bf16 v[72:75], v[28:31], a[200:207], v3
    ds_write_b32 v11, v90
    v_smfmac_f32_16x16x64_bf16 v[68:71], v[32:35], a[224:231], v3
    s_cmp_eq_u32 s18, 63
    s_waitcnt lgkmcnt(3)
    v_mfma_f32_16x16x32_bf16 v[92:95], v[20:23], v[76:79], 0
    v_mov_b32 v143, v7
    s_waitcnt lgkmcnt(1)
    v_mfma_f32_16x16x32_bf16 v[92:95], v[24:27], v[80:83], v[92:95]
    v_mov_b64 v[36:37], 0
    v_mov_b64 v[38:39], 0
    v_smfmac_f32_16x16x64_bf16 v[72:75], v[32:35], a[232:239], v3
    s_waitcnt lgkmcnt(0)
    s_barrier
    ds_read_b128 v[84:87], v2
    v_smfmac_f32_16x16x64_bf16 v[68:71], v[44:47], a[208:215], v3
    v_fmac_f32_dpp v142, v92, v0 quad_perm:[0,1,0,1] row_mask:0xf bank_mask:0xf
    v_smfmac_f32_16x16x64_bf16 v[68:71], v[48:51], v[144:151], v3
    v_fmac_f32_dpp v143, v93, v0 quad_perm:[0,1,0,1] row_mask:0xf bank_mask:0xf
    v_fmac_f32_dpp v142, v94, v0 quad_perm:[2,3,2,3] row_mask:0xf bank_mask:0xf
    v_smfmac_f32_16x16x64_bf16 v[72:75], v[44:47], a[216:223], v3
    s_waitcnt lgkmcnt(0)
    v_fmac_f32_dpp v143, v95, v0 quad_perm:[2,3,2,3] row_mask:0xf bank_mask:0xf
    v_mfma_f32_16x16x32_bf16 v[64:67], v[136:139], v[84:87], 0
    v_exp_f32 v142, v142
    v_mfma_f32_16x16x32_bf16 v[52:55], v[128:131], v[84:87], 0
    v_exp_f32 v143, v143
    v_mfma_f32_16x16x32_bf16 v[56:59], v[132:135], v[84:87], 0
    v_cvt_pk_bf16_f32 v141, v142, v143
    v_add_f32 v68, v68, v70
    v_smfmac_f32_16x16x64_bf16 v[72:75], v[48:51], v[152:159], v3
    ds_read_b128 v[28:31], v8 offset:12288
    v_add_f32 v69, v69, v71
    v_mfma_f32_16x16x16_bf16 v[64:67], v[136:137], v[140:141], v[64:67]
    ds_read_b128 v[32:35], v8 offset:13312
    v_cvt_pk_bf16_f32 v61, v68, v69
    s_nop 1
    v_mfma_f32_16x16x16_bf16 v[52:55], v[60:61], v[140:141], v[52:55]
    v_add_f32 v72, v72, v74
    v_add_f32 v73, v73, v75
    v_cvt_pk_bf16_f32 v63, v72, v73
    s_cbranch_scc1 CSw0_last
    s_nop 0
    v_mfma_f32_16x16x16_bf16 v[56:59], v[62:63], v[140:141], v[56:59]
    v_rcp_f32 v64, v64
    s_nop 0
    v_pk_mul_f32 v[52:53], v[52:53], v[64:65] op_sel_hi:[1,0]
    v_pk_mul_f32 v[54:55], v[54:55], v[64:65] op_sel_hi:[1,0]
    v_cvt_pk_bf16_f32 v52, v52, v53
    v_cvt_pk_bf16_f32 v53, v54, v55
    ds_write_b64 v2, v[52:53] offset:8192
    s_nop 0
    v_pk_mul_f32 v[56:57], v[56:57], v[64:65] op_sel_hi:[1,0]
    v_pk_mul_f32 v[58:59], v[58:59], v[64:65] op_sel_hi:[1,0]
    v_cvt_pk_bf16_f32 v54, v56, v57
    v_cvt_pk_bf16_f32 v55, v58, v59
    ds_write_b64 v2, v[54:55] offset:8200
    s_nop 0
    v_smfmac_f32_16x16x64_bf16 v[100:103], v[52:55], v[160:167], v3
    v_log_f32 v65, v65
    v_smfmac_f32_16x16x64_bf16 v[104:107], v[52:55], v[192:199], v3
    v_cmp_nle_f32 vcc, |v65|, s64
    v_smfmac_f32_16x16x64_bf16 v[36:39], v[52:55], v[224:231], v3
    s_cbranch_vccnz CSw0_fix
    CSw0_fixed:
    s_waitcnt lgkmcnt(0)
    s_barrier
    ds_read_b128 v[68:71], v2 offset:9216
    ds_read_b128 v[72:75], v2 offset:10240
    ds_read_b128 v[96:99], v2 offset:11264
    v_smfmac_f32_16x16x64_bf16 v[40:43], v[52:55], v[240:247], v3
    ds_read_b128 v[20:23], v8 offset:14336
    s_waitcnt lgkmcnt(3)
    v_smfmac_f32_16x16x64_bf16 v[100:103], v[68:71], v[168:175], v3
    ds_read_b128 v[24:27], v8 offset:15360
    s_waitcnt lgkmcnt(3)
    v_smfmac_f32_16x16x64_bf16 v[100:103], v[72:75], v[176:183], v3
    ds_read_b128 v[76:79], v8 offset:16384
    s_waitcnt lgkmcnt(3)
    v_smfmac_f32_16x16x64_bf16 v[100:103], v[96:99], v[184:191], v3
    ds_read_b128 v[44:47], v8 offset:18432
    ds_read_b128 v[80:83], v8 offset:17408
    v_smfmac_f32_16x16x64_bf16 v[104:107], v[68:71], v[200:207], v3
    s_mov_b32 s24, s23
    s_add_u32 s23, s23, 0x2000
    s_bitset0_b32 s23, 15
    v_smfmac_f32_16x16x64_bf16 v[104:107], v[72:75], v[208:215], v3
    s_add_u32 s30, s23, 0x1000
    ds_read_b128 v[48:51], v8 offset:19456
    v_cvt_pk_bf16_f32 v100, v100, v102
    v_cvt_pk_bf16_f32 v101, v101, v103
    v_smfmac_f32_16x16x64_bf16 v[104:107], v[96:99], v[216:223], v3
    buffer_store_dword v100, v4, s[8:11], s19 offen offset:0 sc1
    buffer_store_dword v101, v4, s[8:11], s19 offen offset:2048 sc1
    v_smfmac_f32_16x16x64_bf16 v[36:39], v[68:71], v[232:239], v3
    s_mov_b32 s21, 1
    v_sub_f32 v7, v7, v65
    v_smfmac_f32_16x16x64_bf16 v[36:39], v[72:75], v[28:35], v3
    s_waitcnt lgkmcnt(1)
    v_cvt_pk_bf16_f32 v104, v104, v106
    v_cvt_pk_bf16_f32 v105, v105, v107
    v_smfmac_f32_16x16x64_bf16 v[36:39], v[96:99], v[20:27], v3
    buffer_store_dword v104, v4, s[8:11], s20 offen offset:0 sc1
    buffer_store_dword v105, v4, s[8:11], s20 offen offset:2048 sc1
    v_smfmac_f32_16x16x64_bf16 v[40:43], v[68:71], v[248:255], v3
    v_smfmac_f32_16x16x64_bf16 v[40:43], v[72:75], v[76:83], v3
    s_waitcnt lgkmcnt(0)
    v_cvt_pk_bf16_f32 v36, v36, v38
    v_cvt_pk_bf16_f32 v37, v37, v39
    v_smfmac_f32_16x16x64_bf16 v[40:43], v[96:99], v[44:51], v3
    buffer_store_dword v36, v4, s[8:11], s38 offen offset:0 sc1
    buffer_store_dword v37, v4, s[8:11], s38 offen offset:2048 sc1
    s_nop 5
    v_cvt_pk_bf16_f32 v40, v40, v42
    v_cvt_pk_bf16_f32 v41, v41, v43
    buffer_store_dword v40, v4, s[8:11], s22 offen offset:0 sc1
    buffer_store_dword v41, v4, s[8:11], s22 offen offset:2048 sc1
    ds_read_b128 v[72:75], v8 offset:7168
    v_pk_mov_b32 v[140:141], v[60:61], v[62:63] op_sel:[0,0]
    ds_read_b128 v[28:31], v8 offset:34816
    v_pk_mov_b32 v[142:143], v[60:61], v[62:63] op_sel:[1,1]
    ds_read_b128 v[32:35], v8 offset:35840
    v_bfe_u32 v126, v1, 2, 6
    ds_read_b128 v[36:39], v8 offset:26624
    v_mov_b64 v[68:69], 0
    ds_read_b128 v[40:43], v8 offset:27648
    buffer_load_dwordx4 v[128:131], v1, s[8:11], s25 offen offset:0 sc1
    buffer_load_dwordx4 v[132:135], v1, s[8:11], s25 offen offset:1024 sc1
    v_mov_b64 v[70:71], 0
    ds_read_b128 v[76:79], v8 offset:28672
    v_mfma_f32_16x16x1_4b_f32 v[52:67], v126, v126, 0
    ds_read_b128 v[80:83], v8 offset:29696
    ds_read_b128 v[84:87], v8 offset:30720
    ds_read_b128 v[88:91], v8 offset:31744
    ds_read_b128 v[92:95], v8 offset:32768
    s_waitcnt vmcnt(18)
    v_mov_b64 v[100:101], v[108:109]
    ds_read_b128 v[96:99], v8 offset:33792
    v_mov_b64 v[102:103], v[110:111]
    v_mov_b64 v[104:105], v[112:113]
    ds_read_b128 v[44:47], v8 offset:24576
    v_mov_b64 v[106:107], v[114:115]
    ds_read_b128 v[48:51], v8 offset:25600
    ds_read_b128 v[108:111], v8 offset:20480
    ds_read_b128 v[112:115], v8 offset:21504
    s_add_u32 s19, s18, 2
    s_cmp_ge_u32 s19, s37
    s_cbranch_scc1 CSw0_kvw
    CSw0_kvok:
    s_nop 0
    s_nop 0
    s_nop 0
    s_nop 0
    s_nop 0
    s_nop 0
    s_nop 0
    s_nop 0
    buffer_load_dwordx4 v[128:131], v1, s[8:11], s25 offen offset:0 sc1
    buffer_load_dwordx4 v[132:135], v1, s[8:11], s25 offen offset:1024 sc1
    s_branch CSw0_Pw
    CSw0_Pf:
    s_add_u32 s21, s21, 1
    v_max3_u32 v124, v128, v129, v130
    v_max3_u32 v126, v131, v132, v133
    v_max3_u32 v124, v124, v134, v135
    v_max_u32 v124, v124, v126
    v_cmp_eq_u32 vcc, -1, v124
    s_nop 0
    s_mov_b64 exec, vcc
    buffer_load_dwordx4 v[128:131], v1, s[8:11], s25 offen offset:0 sc1
    buffer_load_dwordx4 v[132:135], v1, s[8:11], s25 offen offset:1024 sc1
    s_mov_b64 exec, -1
    s_cmp_gt_u32 s21, 4
    s_cbranch_scc1 CSw0_Pre
    CSw0_Pw:
    s_waitcnt vmcnt(3) lgkmcnt(0)
    CSw0_P:
    v_mfma_f32_16x16x32_bf16 v[24:27], v[72:75], v[128:131], 0
    s_waitcnt vmcnt(2)
    v_mfma_f32_16x16x32_bf16 v[24:27], v[72:75], v[132:135], v[24:27]
    s_nop 7
    v_cmp_u_f32 vcc, v24, v24
    v_add_f32_dpp v24, v24, v24 row_ror:4 row_mask:0xf bank_mask:0xf
    v_add_f32_dpp v25, v25, v25 row_ror:4 row_mask:0xf bank_mask:0xf
    s_nop 0
    v_add_f32_dpp v24, v24, v24 row_ror:8 row_mask:0xf bank_mask:0xf
    v_add_f32_dpp v25, v25, v25 row_ror:8 row_mask:0xf bank_mask:0xf
    v_cvt_pk_bf16_f32 v124, v24, v25
    s_cbranch_vccnz CSw0_Pf
    buffer_store_dword v124, v5, s[8:11], s23 offen sc1
    CSw0_w2:
    s_branch CSw0_step
    CSw0_kvw:
    s_mov_b32 s21, 0
    s_waitcnt vmcnt(15)
    s_branch CSw0_kvl_chk
    v_lshrrev_b32 v126, 2, v1
    v_and_b32 v126, 63, v126
    s_mov_b32 s21, 0
    CSw0_kvl:
    buffer_load_dword v127, v126, s[8:11], s29 offen sc1
    s_add_u32 s21, s21, 1
    s_cmp_gt_u32 s21, 400000
    s_cbranch_scc1 CS_fail
    s_waitcnt vmcnt(0)
    CSw0_kvl_chk:
    v_min_u32_dpp v127, v127, v127 row_ror:8 row_mask:0xf bank_mask:0xf
    s_nop 1
    v_min_u32_dpp v127, v127, v127 row_ror:4 row_mask:0xf bank_mask:0xf
    s_nop 1
    v_min_u32_dpp v127, v127, v127 row_ror:2 row_mask:0xf bank_mask:0xf
    s_nop 1
    v_min_u32_dpp v127, v127, v127 row_ror:1 row_mask:0xf bank_mask:0xf
    s_nop 0
    v_readfirstlane_b32 s37, v127
    s_nop 0
    s_lshl_b32 s37, s37, 2
    s_cmp_ge_u32 s19, s37
    s_cbranch_scc1 CSw0_kvl
    s_cmp_ge_u32 s37, 12
    s_cselect_b32 s21, 12, 0
    s_cmp_ge_u32 s37, 44
    s_cselect_b32 s21, 44, s21
    s_cmp_ge_u32 s37, 64
    s_cselect_b32 s21, 1000, s21
    s_cmp_gt_u32 s21, s19
    s_cselect_b32 s37, s21, s37
    s_mov_b32 s21, 1
    s_branch CSw0_kvok
    CSw0_last:
    v_mov_b32 v124, v61
    v_mov_b32 v61, v62
    v_mov_b32 v62, v124
    buffer_store_dwordx4 v[60:63], v1, s[8:11], s33 offen sc1
    s_branch CS_done
    CSw0_fix:
    v_and_b32 v124, 0x3ff, v11
    v_lshlrev_b32 v124, 1, v124
    v_add_u32 v124, 0x24800, v124
    v_lshlrev_b32 v126, 1, v1
    v_add_u32 v126, 0x24800, v126
    ds_write_b64 v124, v[88:89]
    v_mov_b32 v142, v7
    v_mov_b32 v143, v7
    s_waitcnt lgkmcnt(0)
    s_barrier
    ds_read_b128 v[68:71], v126
    ds_read_b128 v[72:75], v126 offset:16
    v_fmac_f32_dpp v142, v92, v0 quad_perm:[0,1,0,1] row_mask:0xf bank_mask:0xf
    v_fmac_f32_dpp v143, v93, v0 quad_perm:[0,1,0,1] row_mask:0xf bank_mask:0xf
    s_nop 0
    v_fmac_f32_dpp v142, v94, v0 quad_perm:[2,3,2,3] row_mask:0xf bank_mask:0xf
    v_fmac_f32_dpp v143, v95, v0 quad_perm:[2,3,2,3] row_mask:0xf bank_mask:0xf
    s_waitcnt lgkmcnt(0)
    v_max3_f32 v124, v68, v69, v70
    v_max3_f32 v124, v124, v71, v72
    v_max3_f32 v124, v124, v73, v74
    v_max3_f32 v124, v124, v75, v142
    v_max_f32 v124, v124, v143
    v_mov_b32 v126, v124
    s_nop 1
    v_permlane32_swap_b32 v124, v126
    v_max_f32 v124, v124, v126
    v_mov_b32 v126, v124
    s_nop 1
    v_permlane16_swap_b32 v124, v126
    v_max_f32 v124, v124, v126
    v_sub_f32 v7, v7, v124
    v_sub_f32 v68, v68, v124
    v_sub_f32 v69, v69, v124
    v_sub_f32 v70, v70, v124
    v_sub_f32 v71, v71, v124
    v_sub_f32 v72, v72, v124
    v_sub_f32 v73, v73, v124
    v_sub_f32 v74, v74, v124
    v_sub_f32 v75, v75, v124
    v_sub_f32 v142, v142, v124
    v_sub_f32 v143, v143, v124
    v_exp_f32 v68, v68
    v_exp_f32 v69, v69
    v_exp_f32 v70, v70
    v_exp_f32 v71, v71
    v_exp_f32 v72, v72
    v_exp_f32 v73, v73
    v_exp_f32 v74, v74
    v_exp_f32 v75, v75
    v_exp_f32 v142, v142
    v_exp_f32 v143, v143
    v_cvt_pk_bf16_f32 v84, v68, v69
    v_cvt_pk_bf16_f32 v85, v70, v71
    v_cvt_pk_bf16_f32 v86, v72, v73
    v_cvt_pk_bf16_f32 v87, v74, v75
    v_cvt_pk_bf16_f32 v141, v142, v143
    s_nop 0
    v_mfma_f32_16x16x32_bf16 v[64:67], v[136:139], v[84:87], 0
    v_mfma_f32_16x16x32_bf16 v[52:55], v[128:131], v[84:87], 0
    v_mfma_f32_16x16x32_bf16 v[56:59], v[132:135], v[84:87], 0
    v_mfma_f32_16x16x16_bf16 v[64:67], v[136:137], v[140:141], v[64:67]
    v_mfma_f32_16x16x16_bf16 v[52:55], v[60:61], v[140:141], v[52:55]
    v_mfma_f32_16x16x16_bf16 v[56:59], v[62:63], v[140:141], v[56:59]
    v_rcp_f32 v64, v64
    s_nop 2
    v_pk_mul_f32 v[52:53], v[52:53], v[64:65] op_sel_hi:[1,0]
    v_pk_mul_f32 v[54:55], v[54:55], v[64:65] op_sel_hi:[1,0]
    v_cvt_pk_bf16_f32 v52, v52, v53
    v_cvt_pk_bf16_f32 v53, v54, v55
    v_pk_mul_f32 v[56:57], v[56:57], v[64:65] op_sel_hi:[1,0]
    v_pk_mul_f32 v[58:59], v[58:59], v[64:65] op_sel_hi:[1,0]
    v_cvt_pk_bf16_f32 v54, v56, v57
    v_cvt_pk_bf16_f32 v55, v58, v59
    ds_write_b64 v2, v[52:53] offset:8192
    ds_write_b64 v2, v[54:55] offset:8200
    v_mov_b64 v[100:101], 0
    v_mov_b64 v[102:103], 0
    v_mov_b64 v[104:105], 0
    v_mov_b64 v[106:107], 0
    v_mov_b64 v[36:37], 0
    v_mov_b64 v[38:39], 0
    v_log_f32 v65, v65
    v_smfmac_f32_16x16x64_bf16 v[100:103], v[52:55], v[160:167], v3
    v_smfmac_f32_16x16x64_bf16 v[104:107], v[52:55], v[192:199], v3
    v_smfmac_f32_16x16x64_bf16 v[36:39], v[52:55], v[224:231], v3
    s_waitcnt lgkmcnt(0)
    s_branch CSw0_fixed
    CSw1_entry:
    s_mov_b32 s23, 0x86000
    s_mov_b32 s24, s23
    s_add_u32 s23, s23, 0x2000
    s_bitset0_b32 s23, 15
    s_add_u32 s30, s23, 0x1000
    buffer_load_dwordx4 v[20:23], v125, s[8:11], s23 offen offset:1024 sc1
    buffer_load_dwordx4 v[24:27], v125, s[8:11], s30 offen offset:1024 sc1
    s_mov_b32 s18, -1
    v_mov_b32 v136, 0x3f803f80
    v_mov_b32 v137, 0x3f803f80
    v_mov_b32 v138, 0x3f803f80
    v_mov_b32 v139, 0x3f803f80
    s_mov_b32 s64, 0x42700000
    v_lshlrev_b32 v124, v1, v136
    v_lshrrev_b32 v126, 16, v136
    v_bfe_i32 v52, v1, 4, 1
    v_bfi_b32 v124, v52, v124, v126
    v_bfe_u32 v126, v1, 6, 2
    v_cmp_eq_u32 vcc, 0, v126
    s_nop 1
    v_cndmask_b32 v52, 0, v124, vcc
    v_cmp_eq_u32 vcc, 1, v126
    s_nop 1
    v_cndmask_b32 v53, 0, v124, vcc
    v_cmp_eq_u32 vcc, 2, v126
    s_nop 1
    v_cndmask_b32 v54, 0, v124, vcc
    v_cmp_eq_u32 vcc, 3, v126
    s_nop 1
    v_cndmask_b32 v55, 0, v124, vcc
    ds_write_b128 v8, v[52:55] offset:7168
    s_waitcnt lgkmcnt(0)
    v_pk_mov_b32 v[140:141], v[60:61], v[62:63] op_sel:[0,0]
    ds_read_b128 v[28:31], v8 offset:34816
    v_pk_mov_b32 v[142:143], v[60:61], v[62:63] op_sel:[1,1]
    ds_read_b128 v[32:35], v8 offset:35840
    v_bfe_u32 v126, v1, 2, 6
    ds_read_b128 v[36:39], v8 offset:26624
    v_mov_b64 v[68:69], 0
    ds_read_b128 v[40:43], v8 offset:27648
    v_mov_b64 v[70:71], 0
    ds_read_b128 v[76:79], v8 offset:28672
    v_mfma_f32_16x16x1_4b_f32 v[52:67], v126, v126, 0
    ds_read_b128 v[80:83], v8 offset:29696
    ds_read_b128 v[84:87], v8 offset:30720
    ds_read_b128 v[88:91], v8 offset:31744
    ds_read_b128 v[92:95], v8 offset:32768
    s_waitcnt vmcnt(2)
    v_mov_b64 v[100:101], v[108:109]
    ds_read_b128 v[96:99], v8 offset:33792
    v_mov_b64 v[102:103], v[110:111]
    v_mov_b64 v[104:105], v[112:113]
    ds_read_b128 v[44:47], v8 offset:24576
    v_mov_b64 v[106:107], v[114:115]
    ds_read_b128 v[48:51], v8 offset:25600
    ds_read_b128 v[108:111], v8 offset:20480
    ds_read_b128 v[112:115], v8 offset:21504
    s_mov_b32 s62, 0x00010001
    s_lshl_b32 s63, s16, 1
    s_add_u32 s63, s63, 0x88000
    s_and_b32 s65, s16, 3
    s_lshl_b32 s65, s65, 7
    s_add_u32 s65, s65, 0x88000
    s_xor_b32 s25, s25, 0x40000
    s_xor_b32 s26, s26, 0x40000
    v_bfe_u32 v126, v1, 2, 6
    v_mov_b64 v[72:73], 0
    v_mov_b64 v[74:75], 0
    s_add_u32 s18, s18, 1
    s_xor_b32 s25, s25, 0x40000
    s_xor_b32 s26, s26, 0x40000
    s_add_u32 s19, s18, 2
    s_cmp_ge_u32 s19, s37
    s_cselect_b32 s36, s29, 0x7ff00000
    s_add_u32 s31, s31, 0x40000
    s_add_u32 s32, s32, 0x40000
    s_mov_b32 s21, 1
    s_mov_b32 s35, 1
    s_waitcnt vmcnt(2)
    v_mov_b64 v[128:129], v[116:117]
    v_mov_b64 v[130:131], v[118:119]
    v_mov_b64 v[132:133], v[120:121]
    v_mov_b64 v[134:135], v[122:123]
    ds_read_b128 v[116:119], v8 offset:22528
    ds_read_b128 v[120:123], v8 offset:23552
    s_waitcnt vmcnt(0)
    s_branch CSw1_Aw
    CSw1_Bf:
    s_add_u32 s35, s35, 1
    s_cmp_gt_u32 s35, 2
    s_cbranch_scc1 CSw1_Bre
    s_nop 6
    v_mov_b64 v[60:61], 0
    v_mov_b64 v[62:63], 0
    v_mov_b64 v[64:65], 0
    v_mov_b64 v[66:67], 0
    v_smfmac_f32_16x16x64_bf16 v[60:63], v[20:23], v[76:83], v3
    s_nop 0
    v_smfmac_f32_16x16x64_bf16 v[64:67], v[20:23], v[84:91], v3
    s_waitcnt vmcnt(3)
    s_branch CSw1_Bw
    CSw1_Are:
    s_waitcnt vmcnt(0)
    CSw1_Arl:
    s_mov_b64 exec, vcc
    buffer_load_dwordx4 v[20:23], v125, s[8:11], s23 offen offset:1024 sc1
    s_mov_b64 exec, -1
    buffer_load_dwordx4 v[24:27], v125, s[8:11], s30 offen offset:1024 sc1
    s_add_u32 s21, s21, 1
    s_cmp_gt_u32 s21, 400000
    s_cbranch_scc1 CS_fail
    s_waitcnt vmcnt(6)
    v_mov_b64 v[52:53], 0
    v_mov_b64 v[54:55], 0
    v_mov_b64 v[56:57], 0
    v_mov_b64 v[58:59], 0
    v_mov_b64 v[60:61], 0
    v_mov_b64 v[62:63], 0
    v_max3_u32 v124, v20, v21, v22
    v_max_u32 v124, v124, v23
    v_cmp_eq_u32 vcc, -1, v124
    s_cbranch_vccz CSw1_Adn
    CSw1_Ack:
    v_max3_u32 v124, v20, v21, v22
    v_max_u32 v124, v124, v23
    v_cmp_eq_u32 vcc, -1, v124
    s_cbranch_vccnz CSw1_Arl
    CSw1_Adn:
    v_smfmac_f32_16x16x64_bf16 v[52:55], v[20:23], v[108:115], v3
    ds_write_b128 v2, v[20:23] offset:2048
    v_smfmac_f32_16x16x64_bf16 v[56:59], v[20:23], v[116:123], v3
    buffer_load_dwordx4 v[24:27], v125, s[8:11], s30 offen offset:1024 sc1
    v_smfmac_f32_16x16x64_bf16 v[60:63], v[20:23], v[76:83], v3
    s_barrier
    buffer_load_dwordx4 v[108:111], v9, s[8:11], s31 offen sc1
    v_smfmac_f32_16x16x64_bf16 v[64:67], v[20:23], v[84:91], v3
    buffer_load_dwordx4 v[112:115], v9, s[8:11], s31 offen offset:2048 sc1
    v_smfmac_f32_16x16x64_bf16 v[68:71], v[20:23], v[92:99], v3
    buffer_load_dwordx4 v[116:119], v1, s[8:11], s32 offen sc1
    v_smfmac_f32_16x16x64_bf16 v[72:75], v[20:23], v[28:35], v3
    s_waitcnt lgkmcnt(0)
    s_barrier
    ds_read_b128 v[28:31], v2 offset:0
    ds_read_b128 v[32:35], v2 offset:6144
    s_branch CSw1_Bck
    CSw1_Bre:
    CSw1_Brl:
    s_mov_b64 exec, vcc
    buffer_load_dwordx4 v[24:27], v125, s[8:11], s30 offen offset:1024 sc1
    s_mov_b64 exec, -1
    s_add_u32 s35, s35, 1
    s_cmp_gt_u32 s35, 400000
    s_cbranch_scc1 CS_fail
    s_waitcnt vmcnt(6)
    v_max3_u32 v124, v24, v25, v26
    v_max_u32 v124, v124, v27
    v_cmp_eq_u32 vcc, -1, v124
    s_cbranch_vccz CSw1_Bdn
    CSw1_Bck:
    v_max3_u32 v124, v24, v25, v26
    v_max_u32 v124, v124, v27
    v_cmp_eq_u32 vcc, -1, v124
    s_cbranch_vccnz CSw1_Brl
    CSw1_Bdn:
    ds_write_b128 v2, v[24:27] offset:3072
    v_mov_b64 v[60:61], 0
    v_mov_b64 v[62:63], 0
    v_mov_b64 v[64:65], 0
    v_mov_b64 v[66:67], 0
    v_smfmac_f32_16x16x64_bf16 v[60:63], v[20:23], v[76:83], v3
    s_nop 0
    v_smfmac_f32_16x16x64_bf16 v[64:67], v[20:23], v[84:91], v3
    v_smfmac_f32_16x16x64_bf16 v[60:63], v[24:27], a[96:103], v3
    v_smfmac_f32_16x16x64_bf16 v[64:67], v[24:27], a[104:111], v3
    s_waitcnt vmcnt(0)
    s_waitcnt lgkmcnt(0)
    s_branch CSw1_Bok
    CSw1_Pre:
    CSw1_Prl:
    s_mov_b64 exec, vcc
    buffer_load_dwordx4 v[128:131], v1, s[8:11], s25 offen offset:0 sc1
    buffer_load_dwordx4 v[132:135], v1, s[8:11], s25 offen offset:1024 sc1
    s_mov_b64 exec, -1
    s_add_u32 s21, s21, 1
    s_cmp_gt_u32 s21, 400000
    s_cbranch_scc1 CS_fail
    s_waitcnt vmcnt(8)
    v_max3_u32 v124, v128, v129, v130
    v_max3_u32 v126, v131, v132, v133
    v_max3_u32 v124, v124, v134, v135
    v_max_u32 v124, v124, v126
    v_cmp_eq_u32 vcc, -1, v124
    s_cbranch_vccz CSw1_Pdn
    CSw1_Pck:
    v_max3_u32 v124, v128, v129, v130
    v_max3_u32 v126, v131, v132, v133
    v_max3_u32 v124, v124, v134, v135
    v_max_u32 v124, v124, v126
    v_cmp_eq_u32 vcc, -1, v124
    s_cbranch_vccnz CSw1_Prl
    CSw1_Pdn:
    v_mfma_f32_16x16x32_bf16 v[24:27], v[72:75], v[128:131], 0
    v_mfma_f32_16x16x32_bf16 v[24:27], v[72:75], v[132:135], v[24:27]
    s_nop 7
    v_add_f32_dpp v24, v24, v24 row_ror:4 row_mask:0xf bank_mask:0xf
    v_add_f32_dpp v25, v25, v25 row_ror:4 row_mask:0xf bank_mask:0xf
    s_nop 0
    v_add_f32_dpp v24, v24, v24 row_ror:8 row_mask:0xf bank_mask:0xf
    v_add_f32_dpp v25, v25, v25 row_ror:8 row_mask:0xf bank_mask:0xf
    v_cvt_pk_bf16_f32 v124, v24, v25
    buffer_store_dword v124, v5, s[8:11], s23 offen sc1
    s_waitcnt vmcnt(1)
    s_branch CSw1_w2
.p2align 6
    CSw1_step:
    v_bfe_u32 v126, v1, 2, 6
    v_mov_b64 v[72:73], 0
    v_mov_b64 v[74:75], 0
    s_add_u32 s18, s18, 1
    s_xor_b32 s25, s25, 0x40000
    s_xor_b32 s26, s26, 0x40000
    s_add_u32 s19, s18, 2
    s_cmp_ge_u32 s19, s37
    s_cselect_b32 s36, s29, 0x7ff00000
    s_add_u32 s31, s31, 0x40000
    s_add_u32 s32, s32, 0x40000
    s_mov_b32 s21, 1
    s_mov_b32 s35, 1
    s_waitcnt vmcnt(1)
    v_mov_b64 v[128:129], v[116:117]
    v_mov_b64 v[130:131], v[118:119]
    v_mov_b64 v[132:133], v[120:121]
    v_mov_b64 v[134:135], v[122:123]
    ds_read_b128 v[116:119], v8 offset:22528
    ds_read_b128 v[120:123], v8 offset:23552
    s_nop 0
    s_nop 0
    s_nop 0
    s_nop 0
    s_nop 0
    s_nop 0
    s_nop 0
    s_nop 0
    s_nop 0
    s_nop 0
    s_nop 0
    s_nop 0
    s_nop 0
    s_nop 0
    s_nop 0
    buffer_load_dwordx4 v[20:23], v125, s[8:11], s23 offen offset:1024 sc1
    s_nop 0
    buffer_load_dword v127, off, s[8:11], s23
    s_nop 0
    s_nop 0
    s_nop 0
    s_nop 0
    s_nop 0
    s_nop 0
    s_nop 0
    s_nop 0
    s_nop 0
    s_nop 0
    s_nop 0
    s_nop 0
    s_nop 0
    s_nop 0
    s_nop 0
    s_nop 0
    s_nop 0
    s_nop 0
    s_nop 0
    s_nop 0
    s_nop 0
    buffer_load_dwordx4 v[20:23], v125, s[8:11], s23 offen offset:1024 sc1
    s_nop 0
    s_nop 0
    s_nop 0
    s_nop 0
    s_nop 0
    s_nop 0
    s_nop 0
    s_nop 0
    s_nop 0
    s_nop 0
    s_nop 0
    buffer_load_dwordx4 v[24:27], v125, s[8:11], s30 offen offset:1024 sc1
    s_branch CSw1_Aw
    CSw1_Af:
    v_mfma_f32_16x16x1_4b_f32 v[52:67], v126, v126, 0
    s_mov_b64 exec, vcc
    buffer_load_dwordx4 v[20:23], v125, s[8:11], s23 offen offset:1024 sc1
    s_mov_b64 exec, -1
    buffer_load_dwordx4 v[24:27], v125, s[8:11], s30 offen offset:1024 sc1
    s_add_u32 s21, s21, 1
    s_cmp_gt_u32 s21, 6
    s_cbranch_scc1 CSw1_Are
    s_nop 0
    s_nop 0
    s_nop 0
    CSw1_Aw:
    s_waitcnt vmcnt(3) lgkmcnt(0)
    v_fma_f32 v124, v20, v21, v22
    v_cmp_u_f32 vcc, v124, v23
    v_smfmac_f32_16x16x64_bf16 v[52:55], v[20:23], v[108:115], v3
    ds_write_b128 v2, v[20:23] offset:2048
    v_smfmac_f32_16x16x64_bf16 v[56:59], v[20:23], v[116:123], v3
    s_cbranch_vccnz CSw1_Af
    buffer_load_dwordx4 v[24:27], v125, s[8:11], s30 offen offset:1024 sc1
    v_smfmac_f32_16x16x64_bf16 v[60:63], v[20:23], v[76:83], v3
    s_barrier
    buffer_load_dwordx4 v[108:111], v9, s[8:11], s31 offen sc1
    v_smfmac_f32_16x16x64_bf16 v[64:67], v[20:23], v[84:91], v3
    buffer_load_dwordx4 v[112:115], v9, s[8:11], s31 offen offset:2048 sc1
    v_smfmac_f32_16x16x64_bf16 v[68:71], v[20:23], v[92:99], v3
    buffer_load_dwordx4 v[116:119], v1, s[8:11], s32 offen sc1
    v_smfmac_f32_16x16x64_bf16 v[72:75], v[20:23], v[28:35], v3
    s_waitcnt lgkmcnt(0)
    s_barrier
    ds_read_b128 v[28:31], v2 offset:0
    ds_read_b128 v[32:35], v2 offset:6144
    CSw1_Bw:
    s_waitcnt vmcnt(4)
    v_fma_f32 v124, v24, v25, v26
    v_cmp_u_f32 vcc, v124, v27
    v_smfmac_f32_16x16x64_bf16 v[60:63], v[24:27], a[96:103], v3
    ds_write_b128 v2, v[24:27] offset:3072
    v_smfmac_f32_16x16x64_bf16 v[64:67], v[24:27], a[104:111], v3
    s_cbranch_vccnz CSw1_Bf
    CSw1_Bok:
    buffer_store_dwordx4 v[140:143], v1, s[8:11], s33 offen sc1
    buffer_load_dword v127, v126, s[8:11], s36 offen sc1
    v_smfmac_f32_16x16x64_bf16 v[52:55], v[24:27], v[44:51], v3
    s_mov_b32 s33, s34
    buffer_load_dwordx4 v[120:123], v1, s[8:11], s32 offen offset:1024 sc1
    v_mov_b64 v[140:141], -1
    v_smfmac_f32_16x16x64_bf16 v[56:59], v[24:27], v[36:43], v3
    ds_read_b128 v[36:39], v2 offset:4096
    s_waitcnt lgkmcnt(3)
    v_smfmac_f32_16x16x64_bf16 v[52:55], v[28:31], a[0:7], v3
    s_add_u32 s34, s34, 0x20000
    v_mov_b64 v[142:143], -1
    v_smfmac_f32_16x16x64_bf16 v[56:59], v[28:31], a[8:15], v3
    s_waitcnt lgkmcnt(1)
    v_smfmac_f32_16x16x64_bf16 v[52:55], v[32:35], a[32:39], v3
    s_barrier
    ds_read_b128 v[44:47], v2 offset:1024
    v_smfmac_f32_16x16x64_bf16 v[56:59], v[32:35], a[40:47], v3
    s_waitcnt lgkmcnt(1)
    s_mov_b32 s19, s27
    ds_read_b128 v[40:43], v2 offset:7168
    v_smfmac_f32_16x16x64_bf16 v[52:55], v[36:39], a[64:71], v3
    s_add_u32 s20, s27, 0x10000
    s_add_u32 s38, s27, 0x20000
    ds_read_b128 v[48:51], v2 offset:5120
    v_smfmac_f32_16x16x64_bf16 v[56:59], v[36:39], a[72:79], v3
    s_add_u32 s22, s27, 0x30000
    s_xor_b32 s27, s27, 0x40000
    s_add_u32 s62, s62, 0x00010001
    v_smfmac_f32_16x16x64_bf16 v[60:63], v[28:31], a[112:119], v3
    v_smfmac_f32_16x16x64_bf16 v[60:63], v[36:39], a[144:151], v3
    ds_read_b128 v[76:79], v8 offset:0
    v_smfmac_f32_16x16x64_bf16 v[64:67], v[28:31], a[120:127], v3
    s_waitcnt lgkmcnt(2)
    v_smfmac_f32_16x16x64_bf16 v[52:55], v[44:47], a[16:23], v3
    ds_read_b128 v[80:83], v8 offset:1024
    v_smfmac_f32_16x16x64_bf16 v[52:55], v[40:43], a[48:55], v3
    s_waitcnt lgkmcnt(2)
    ds_read_b128 v[84:87], v8 offset:4096
    v_smfmac_f32_16x16x64_bf16 v[52:55], v[48:51], a[80:87], v3
    ds_read_b128 v[88:91], v8 offset:5120
    v_smfmac_f32_16x16x64_bf16 v[56:59], v[44:47], a[24:31], v3
    ds_read_b128 v[92:95], v8 offset:2048
    v_smfmac_f32_16x16x64_bf16 v[56:59], v[40:43], a[56:63], v3
    ds_read_b128 v[96:99], v8 offset:3072
    v_add_f32 v52, v52, v54
    v_smfmac_f32_16x16x64_bf16 v[56:59], v[48:51], a[88:95], v3
    s_waitcnt lgkmcnt(4)
    v_add_f32 v53, v53, v55
    v_smfmac_f32_16x16x64_bf16 v[60:63], v[32:35], v[76:83], v3
    s_waitcnt lgkmcnt(2)
    v_cvt_pk_bf16_f32 v54, v52, v53
    v_smfmac_f32_16x16x64_bf16 v[60:63], v[40:43], v[84:91], v3
    v_add_f32 v56, v56, v58
    v_add_f32 v57, v57, v59
    v_cvt_pk_bf16_f32 v55, v56, v57
    v_smfmac_f32_16x16x64_bf16 v[60:63], v[44:47], a[128:135], v3
    ds_write_b64 v6, v[54:55]
    v_smfmac_f32_16x16x64_bf16 v[60:63], v[48:51], a[160:167], v3
    s_waitcnt lgkmcnt(1)
    ds_read_b128 v[52:55], v8 offset:8192
    v_mov_b32 v88, v7
    v_smfmac_f32_16x16x64_bf16 v[64:67], v[32:35], v[92:99], v3
    ds_read_b128 v[56:59], v8 offset:9216
    v_mov_b32 v89, v7
    v_smfmac_f32_16x16x64_bf16 v[64:67], v[40:43], v[12:19], v3
    ds_read_b128 v[92:95], v8 offset:10240
    v_add_f32 v60, v60, v62
    v_add_f32 v61, v61, v63
    v_cvt_pk_bf16_f32 v60, v60, v61
    v_smfmac_f32_16x16x64_bf16 v[64:67], v[36:39], a[152:159], v3
    s_waitcnt lgkmcnt(3)
    s_barrier
    ds_read_b64_tr_b16 v[76:77], v10 offset:0
    ds_read_b64_tr_b16 v[78:79], v10 offset:1024
    v_smfmac_f32_16x16x64_bf16 v[64:67], v[44:47], a[136:143], v3
    ds_read_b64_tr_b16 v[80:81], v10 offset:2048
    ds_read_b64_tr_b16 v[82:83], v10 offset:3072
    v_smfmac_f32_16x16x64_bf16 v[64:67], v[48:51], a[168:175], v3
    buffer_store_dword v140, v5, s[8:11], s24 offen sc1
    v_smfmac_f32_16x16x64_bf16 v[68:71], v[24:27], a[176:183], v3
    ds_read_b128 v[96:99], v8 offset:11264
    s_waitcnt lgkmcnt(3)
    v_mfma_f32_16x16x32_bf16 v[84:87], v[100:103], v[76:79], 0
    v_add_f32 v64, v64, v66
    v_add_f32 v65, v65, v67
    v_cvt_pk_bf16_f32 v62, v64, v65
    s_waitcnt lgkmcnt(1)
    v_mfma_f32_16x16x32_bf16 v[84:87], v[104:107], v[80:83], v[84:87]
    buffer_store_dwordx4 v[140:143], v1, s[8:11], s26 offen sc1
    ds_write2_b32 v6, v60, v62 offset0:128 offset1:129
    v_smfmac_f32_16x16x64_bf16 v[72:75], v[24:27], a[184:191], v3
    ds_read_b128 v[100:103], v8 offset:6144
    v_mov_b64 v[104:105], 0
    v_mov_b64 v[106:107], 0
    v_smfmac_f32_16x16x64_bf16 v[68:71], v[40:43], v[52:59], v3
    s_waitcnt lgkmcnt(2)
    v_fmac_f32_dpp v88, v84, v0 quad_perm:[0,1,0,1] row_mask:0xf bank_mask:0xf
    v_fmac_f32_dpp v89, v85, v0 quad_perm:[0,1,0,1] row_mask:0xf bank_mask:0xf
    v_smfmac_f32_16x16x64_bf16 v[72:75], v[40:43], v[92:99], v3
    s_waitcnt vmcnt(8)
    buffer_store_dwordx4 v[140:143], v1, s[8:11], s26 offen offset:1024 sc1
    v_fmac_f32_dpp v88, v86, v0 quad_perm:[2,3,2,3] row_mask:0xf bank_mask:0xf
    v_fmac_f32_dpp v89, v87, v0 quad_perm:[2,3,2,3] row_mask:0xf bank_mask:0xf
    v_smfmac_f32_16x16x64_bf16 v[68:71], v[36:39], a[240:247], v3
    v_mov_b32 v142, v7
    v_mov_b32 v140, 0
    v_smfmac_f32_16x16x64_bf16 v[72:75], v[36:39], a[248:255], v3
    s_waitcnt lgkmcnt(1)
    s_barrier
    ds_read_b64_tr_b16 v[20:21], v10 offset:512
    v_exp_f32 v90, v88
    v_smfmac_f32_16x16x64_bf16 v[68:71], v[28:31], a[192:199], v3
    ds_read_b64_tr_b16 v[22:23], v10 offset:1536
    ds_read_b64_tr_b16 v[24:25], v10 offset:2560
    ds_read_b64_tr_b16 v[26:27], v10 offset:3584
    v_exp_f32 v91, v89
    s_nop 0
    v_cvt_pk_bf16_f32 v90, v90, v91
    v_mov_b64 v[40:41], 0
    v_mov_b64 v[42:43], 0
    v_smfmac_f32_16x16x64_bf16 v[72:75], v[28:31], a[200:207], v3
    ds_write_b32 v11, v90
    v_smfmac_f32_16x16x64_bf16 v[68:71], v[32:35], a[224:231], v3
    s_cmp_eq_u32 s18, 63
    s_waitcnt lgkmcnt(3)
    v_mfma_f32_16x16x32_bf16 v[92:95], v[20:23], v[76:79], 0
    v_mov_b32 v143, v7
    s_waitcnt lgkmcnt(1)
    v_mfma_f32_16x16x32_bf16 v[92:95], v[24:27], v[80:83], v[92:95]
    v_mov_b64 v[36:37], 0
    v_mov_b64 v[38:39], 0
    v_smfmac_f32_16x16x64_bf16 v[72:75], v[32:35], a[232:239], v3
    s_waitcnt lgkmcnt(0)
    s_barrier
    ds_read_b128 v[84:87], v2
    v_smfmac_f32_16x16x64_bf16 v[68:71], v[44:47], a[208:215], v3
    v_fmac_f32_dpp v142, v92, v0 quad_perm:[0,1,0,1] row_mask:0xf bank_mask:0xf
    v_smfmac_f32_16x16x64_bf16 v[68:71], v[48:51], v[144:151], v3
    v_fmac_f32_dpp v143, v93, v0 quad_perm:[0,1,0,1] row_mask:0xf bank_mask:0xf
    v_fmac_f32_dpp v142, v94, v0 quad_perm:[2,3,2,3] row_mask:0xf bank_mask:0xf
    v_smfmac_f32_16x16x64_bf16 v[72:75], v[44:47], a[216:223], v3
    s_waitcnt lgkmcnt(0)
    v_fmac_f32_dpp v143, v95, v0 quad_perm:[2,3,2,3] row_mask:0xf bank_mask:0xf
    v_mfma_f32_16x16x32_bf16 v[64:67], v[136:139], v[84:87], 0
    v_exp_f32 v142, v142
    v_mfma_f32_16x16x32_bf16 v[52:55], v[128:131], v[84:87], 0
    v_exp_f32 v143, v143
    v_mfma_f32_16x16x32_bf16 v[56:59], v[132:135], v[84:87], 0
    v_cvt_pk_bf16_f32 v141, v142, v143
    v_add_f32 v68, v68, v70
    v_smfmac_f32_16x16x64_bf16 v[72:75], v[48:51], v[152:159], v3
    ds_read_b128 v[28:31], v8 offset:12288
    v_add_f32 v69, v69, v71
    v_mfma_f32_16x16x16_bf16 v[64:67], v[136:137], v[140:141], v[64:67]
    ds_read_b128 v[32:35], v8 offset:13312
    v_cvt_pk_bf16_f32 v61, v68, v69
    s_nop 1
    v_mfma_f32_16x16x16_bf16 v[52:55], v[60:61], v[140:141], v[52:55]
    v_add_f32 v72, v72, v74
    v_add_f32 v73, v73, v75
    v_cvt_pk_bf16_f32 v63, v72, v73
    s_cbranch_scc1 CSw1_last
    s_nop 0
    v_mfma_f32_16x16x16_bf16 v[56:59], v[62:63], v[140:141], v[56:59]
    v_rcp_f32 v64, v64
    s_nop 0
    v_pk_mul_f32 v[52:53], v[52:53], v[64:65] op_sel_hi:[1,0]
    v_pk_mul_f32 v[54:55], v[54:55], v[64:65] op_sel_hi:[1,0]
    v_cvt_pk_bf16_f32 v52, v52, v53
    v_cvt_pk_bf16_f32 v53, v54, v55
    ds_write_b64 v2, v[52:53] offset:9216
    s_nop 0
    v_pk_mul_f32 v[56:57], v[56:57], v[64:65] op_sel_hi:[1,0]
    v_pk_mul_f32 v[58:59], v[58:59], v[64:65] op_sel_hi:[1,0]
    v_cvt_pk_bf16_f32 v54, v56, v57
    v_cvt_pk_bf16_f32 v55, v58, v59
    ds_write_b64 v2, v[54:55] offset:9224
    s_nop 0
    v_smfmac_f32_16x16x64_bf16 v[100:103], v[52:55], v[160:167], v3
    v_log_f32 v65, v65
    v_smfmac_f32_16x16x64_bf16 v[104:107], v[52:55], v[192:199], v3
    v_cmp_nle_f32 vcc, |v65|, s64
    v_smfmac_f32_16x16x64_bf16 v[36:39], v[52:55], v[224:231], v3
    s_cbranch_vccnz CSw1_fix
    CSw1_fixed:
    s_waitcnt lgkmcnt(0)
    s_barrier
    ds_read_b128 v[68:71], v2 offset:8192
    ds_read_b128 v[72:75], v2 offset:11264
    ds_read_b128 v[96:99], v2 offset:10240
    v_smfmac_f32_16x16x64_bf16 v[40:43], v[52:55], v[240:247], v3
    ds_read_b128 v[20:23], v8 offset:14336
    s_waitcnt lgkmcnt(3)
    v_smfmac_f32_16x16x64_bf16 v[100:103], v[68:71], v[168:175], v3
    ds_read_b128 v[24:27], v8 offset:15360
    s_waitcnt lgkmcnt(3)
    v_smfmac_f32_16x16x64_bf16 v[100:103], v[72:75], v[176:183], v3
    ds_read_b128 v[76:79], v8 offset:16384
    s_waitcnt lgkmcnt(3)
    v_smfmac_f32_16x16x64_bf16 v[100:103], v[96:99], v[184:191], v3
    ds_read_b128 v[44:47], v8 offset:18432
    ds_read_b128 v[80:83], v8 offset:17408
    v_smfmac_f32_16x16x64_bf16 v[104:107], v[68:71], v[200:207], v3
    s_mov_b32 s24, s23
    s_add_u32 s23, s23, 0x2000
    s_bitset0_b32 s23, 15
    v_smfmac_f32_16x16x64_bf16 v[104:107], v[72:75], v[208:215], v3
    s_add_u32 s30, s23, 0x1000
    ds_read_b128 v[48:51], v8 offset:19456
    v_cvt_pk_bf16_f32 v100, v100, v102
    v_cvt_pk_bf16_f32 v101, v101, v103
    v_smfmac_f32_16x16x64_bf16 v[104:107], v[96:99], v[216:223], v3
    buffer_store_dword v100, v4, s[8:11], s19 offen offset:0 sc1
    buffer_store_dword v101, v4, s[8:11], s19 offen offset:2048 sc1
    v_smfmac_f32_16x16x64_bf16 v[36:39], v[68:71], v[232:239], v3
    s_mov_b32 s21, 1
    v_sub_f32 v7, v7, v65
    v_smfmac_f32_16x16x64_bf16 v[36:39], v[72:75], v[28:35], v3
    s_waitcnt lgkmcnt(1)
    v_cvt_pk_bf16_f32 v104, v104, v106
    v_cvt_pk_bf16_f32 v105, v105, v107
    v_smfmac_f32_16x16x64_bf16 v[36:39], v[96:99], v[20:27], v3
    buffer_store_dword v104, v4, s[8:11], s20 offen offset:0 sc1
    buffer_store_dword v105, v4, s[8:11], s20 offen offset:2048 sc1
    v_smfmac_f32_16x16x64_bf16 v[40:43], v[68:71], v[248:255], v3
    v_smfmac_f32_16x16x64_bf16 v[40:43], v[72:75], v[76:83], v3
    s_waitcnt lgkmcnt(0)
    v_cvt_pk_bf16_f32 v36, v36, v38
    v_cvt_pk_bf16_f32 v37, v37, v39
    v_smfmac_f32_16x16x64_bf16 v[40:43], v[96:99], v[44:51], v3
    buffer_store_dword v36, v4, s[8:11], s38 offen offset:0 sc1
    buffer_store_dword v37, v4, s[8:11], s38 offen offset:2048 sc1
    s_nop 5
    v_cvt_pk_bf16_f32 v40, v40, v42
    v_cvt_pk_bf16_f32 v41, v41, v43
    buffer_store_dword v40, v4, s[8:11], s22 offen offset:0 sc1
    buffer_store_dword v41, v4, s[8:11], s22 offen offset:2048 sc1
    ds_read_b128 v[72:75], v8 offset:7168
    v_pk_mov_b32 v[140:141], v[60:61], v[62:63] op_sel:[0,0]
    ds_read_b128 v[28:31], v8 offset:34816
    v_pk_mov_b32 v[142:143], v[60:61], v[62:63] op_sel:[1,1]
    ds_read_b128 v[32:35], v8 offset:35840
    v_bfe_u32 v126, v1, 2, 6
    ds_read_b128 v[36:39], v8 offset:26624
    v_mov_b64 v[68:69], 0
    ds_read_b128 v[40:43], v8 offset:27648
    v_mov_b64 v[70:71], 0
    ds_read_b128 v[76:79], v8 offset:28672
    v_mfma_f32_16x16x1_4b_f32 v[52:67], v126, v126, 0
    ds_read_b128 v[80:83], v8 offset:29696
    ds_read_b128 v[84:87], v8 offset:30720
    ds_read_b128 v[88:91], v8 offset:31744
    s_nop 0
    s_nop 0
    s_nop 0
    s_nop 0
    s_nop 0
    s_nop 0
    buffer_load_dwordx4 v[128:131], v1, s[8:11], s25 offen offset:0 sc1
    buffer_load_dwordx4 v[132:135], v1, s[8:11], s25 offen offset:1024 sc1
    ds_read_b128 v[92:95], v8 offset:32768
    s_waitcnt vmcnt(17)
    v_mov_b64 v[100:101], v[108:109]
    ds_read_b128 v[96:99], v8 offset:33792
    v_mov_b64 v[102:103], v[110:111]
    v_mov_b64 v[104:105], v[112:113]
    ds_read_b128 v[44:47], v8 offset:24576
    v_mov_b64 v[106:107], v[114:115]
    ds_read_b128 v[48:51], v8 offset:25600
    ds_read_b128 v[108:111], v8 offset:20480
    ds_read_b128 v[112:115], v8 offset:21504
    s_add_u32 s19, s18, 2
    s_cmp_ge_u32 s19, s37
    s_cbranch_scc1 CSw1_kvw
    CSw1_kvok:
    s_nop 0
    s_nop 0
    s_nop 0
    s_nop 0
    s_nop 0
    s_nop 0
    s_nop 0
    s_nop 0
    s_nop 0
    s_nop 0
    s_nop 0
    s_nop 0
    s_nop 0
    s_nop 0
    buffer_load_dwordx4 v[128:131], v1, s[8:11], s25 offen offset:0 sc1
    buffer_load_dwordx4 v[132:135], v1, s[8:11], s25 offen offset:1024 sc1
    s_branch CSw1_Pw
    CSw1_Pf:
    s_add_u32 s21, s21, 1
    v_max3_u32 v124, v128, v129, v130
    v_max3_u32 v126, v131, v132, v133
    v_max3_u32 v124, v124, v134, v135
    v_max_u32 v124, v124, v126
    v_cmp_eq_u32 vcc, -1, v124
    s_nop 0
    s_mov_b64 exec, vcc
    buffer_load_dwordx4 v[128:131], v1, s[8:11], s25 offen offset:0 sc1
    buffer_load_dwordx4 v[132:135], v1, s[8:11], s25 offen offset:1024 sc1
    s_mov_b64 exec, -1
    s_cmp_gt_u32 s21, 4
    s_cbranch_scc1 CSw1_Pre
    CSw1_Pw:
    s_waitcnt vmcnt(3) lgkmcnt(0)
    CSw1_P:
    v_mfma_f32_16x16x32_bf16 v[24:27], v[72:75], v[128:131], 0
    s_waitcnt vmcnt(2)
    v_mfma_f32_16x16x32_bf16 v[24:27], v[72:75], v[132:135], v[24:27]
    s_nop 7
    v_cmp_u_f32 vcc, v24, v24
    v_add_f32_dpp v24, v24, v24 row_ror:4 row_mask:0xf bank_mask:0xf
    v_add_f32_dpp v25, v25, v25 row_ror:4 row_mask:0xf bank_mask:0xf
    s_nop 0
    v_add_f32_dpp v24, v24, v24 row_ror:8 row_mask:0xf bank_mask:0xf
    v_add_f32_dpp v25, v25, v25 row_ror:8 row_mask:0xf bank_mask:0xf
    v_cvt_pk_bf16_f32 v124, v24, v25
    s_cbranch_vccnz CSw1_Pf
    buffer_store_dword v124, v5, s[8:11], s23 offen sc1
    CSw1_w2:
    s_branch CSw1_step
    CSw1_kvw:
    s_mov_b32 s21, 0
    s_waitcnt vmcnt(14)
    s_branch CSw1_kvl_chk
    v_lshrrev_b32 v126, 2, v1
    v_and_b32 v126, 63, v126
    s_mov_b32 s21, 0
    CSw1_kvl:
    buffer_load_dword v127, v126, s[8:11], s29 offen sc1
    s_add_u32 s21, s21, 1
    s_cmp_gt_u32 s21, 400000
    s_cbranch_scc1 CS_fail
    s_waitcnt vmcnt(0)
    CSw1_kvl_chk:
    v_min_u32_dpp v127, v127, v127 row_ror:8 row_mask:0xf bank_mask:0xf
    s_nop 1
    v_min_u32_dpp v127, v127, v127 row_ror:4 row_mask:0xf bank_mask:0xf
    s_nop 1
    v_min_u32_dpp v127, v127, v127 row_ror:2 row_mask:0xf bank_mask:0xf
    s_nop 1
    v_min_u32_dpp v127, v127, v127 row_ror:1 row_mask:0xf bank_mask:0xf
    s_nop 0
    v_readfirstlane_b32 s37, v127
    s_nop 0
    s_lshl_b32 s37, s37, 2
    s_cmp_ge_u32 s19, s37
    s_cbranch_scc1 CSw1_kvl
    s_cmp_ge_u32 s37, 12
    s_cselect_b32 s21, 12, 0
    s_cmp_ge_u32 s37, 44
    s_cselect_b32 s21, 44, s21
    s_cmp_ge_u32 s37, 64
    s_cselect_b32 s21, 1000, s21
    s_cmp_gt_u32 s21, s19
    s_cselect_b32 s37, s21, s37
    s_mov_b32 s21, 1
    s_branch CSw1_kvok
    CSw1_last:
    v_mov_b32 v124, v61
    v_mov_b32 v61, v62
    v_mov_b32 v62, v124
    buffer_store_dwordx4 v[60:63], v1, s[8:11], s33 offen sc1
    s_branch CS_done
    CSw1_fix:
    v_and_b32 v124, 0x3ff, v11
    v_lshlrev_b32 v124, 1, v124
    v_add_u32 v124, 0x24800, v124
    v_lshlrev_b32 v126, 1, v1
    v_add_u32 v126, 0x24800, v126
    ds_write_b64 v124, v[88:89]
    v_mov_b32 v142, v7
    v_mov_b32 v143, v7
    s_waitcnt lgkmcnt(0)
    s_barrier
    ds_read_b128 v[68:71], v126
    ds_read_b128 v[72:75], v126 offset:16
    v_fmac_f32_dpp v142, v92, v0 quad_perm:[0,1,0,1] row_mask:0xf bank_mask:0xf
    v_fmac_f32_dpp v143, v93, v0 quad_perm:[0,1,0,1] row_mask:0xf bank_mask:0xf
    s_nop 0
    v_fmac_f32_dpp v142, v94, v0 quad_perm:[2,3,2,3] row_mask:0xf bank_mask:0xf
    v_fmac_f32_dpp v143, v95, v0 quad_perm:[2,3,2,3] row_mask:0xf bank_mask:0xf
    s_waitcnt lgkmcnt(0)
    v_max3_f32 v124, v68, v69, v70
    v_max3_f32 v124, v124, v71, v72
    v_max3_f32 v124, v124, v73, v74
    v_max3_f32 v124, v124, v75, v142
    v_max_f32 v124, v124, v143
    v_mov_b32 v126, v124
    s_nop 1
    v_permlane32_swap_b32 v124, v126
    v_max_f32 v124, v124, v126
    v_mov_b32 v126, v124
    s_nop 1
    v_permlane16_swap_b32 v124, v126
    v_max_f32 v124, v124, v126
    v_sub_f32 v7, v7, v124
    v_sub_f32 v68, v68, v124
    v_sub_f32 v69, v69, v124
    v_sub_f32 v70, v70, v124
    v_sub_f32 v71, v71, v124
    v_sub_f32 v72, v72, v124
    v_sub_f32 v73, v73, v124
    v_sub_f32 v74, v74, v124
    v_sub_f32 v75, v75, v124
    v_sub_f32 v142, v142, v124
    v_sub_f32 v143, v143, v124
    v_exp_f32 v68, v68
    v_exp_f32 v69, v69
    v_exp_f32 v70, v70
    v_exp_f32 v71, v71
    v_exp_f32 v72, v72
    v_exp_f32 v73, v73
    v_exp_f32 v74, v74
    v_exp_f32 v75, v75
    v_exp_f32 v142, v142
    v_exp_f32 v143, v143
    v_cvt_pk_bf16_f32 v84, v68, v69
    v_cvt_pk_bf16_f32 v85, v70, v71
    v_cvt_pk_bf16_f32 v86, v72, v73
    v_cvt_pk_bf16_f32 v87, v74, v75
    v_cvt_pk_bf16_f32 v141, v142, v143
    s_nop 0
    v_mfma_f32_16x16x32_bf16 v[64:67], v[136:139], v[84:87], 0
    v_mfma_f32_16x16x32_bf16 v[52:55], v[128:131], v[84:87], 0
    v_mfma_f32_16x16x32_bf16 v[56:59], v[132:135], v[84:87], 0
    v_mfma_f32_16x16x16_bf16 v[64:67], v[136:137], v[140:141], v[64:67]
    v_mfma_f32_16x16x16_bf16 v[52:55], v[60:61], v[140:141], v[52:55]
    v_mfma_f32_16x16x16_bf16 v[56:59], v[62:63], v[140:141], v[56:59]
    v_rcp_f32 v64, v64
    s_nop 2
    v_pk_mul_f32 v[52:53], v[52:53], v[64:65] op_sel_hi:[1,0]
    v_pk_mul_f32 v[54:55], v[54:55], v[64:65] op_sel_hi:[1,0]
    v_cvt_pk_bf16_f32 v52, v52, v53
    v_cvt_pk_bf16_f32 v53, v54, v55
    v_pk_mul_f32 v[56:57], v[56:57], v[64:65] op_sel_hi:[1,0]
    v_pk_mul_f32 v[58:59], v[58:59], v[64:65] op_sel_hi:[1,0]
    v_cvt_pk_bf16_f32 v54, v56, v57
    v_cvt_pk_bf16_f32 v55, v58, v59
    ds_write_b64 v2, v[52:53] offset:9216
    ds_write_b64 v2, v[54:55] offset:9224
    v_mov_b64 v[100:101], 0
    v_mov_b64 v[102:103], 0
    v_mov_b64 v[104:105], 0
    v_mov_b64 v[106:107], 0
    v_mov_b64 v[36:37], 0
    v_mov_b64 v[38:39], 0
    v_log_f32 v65, v65
    v_smfmac_f32_16x16x64_bf16 v[100:103], v[52:55], v[160:167], v3
    v_smfmac_f32_16x16x64_bf16 v[104:107], v[52:55], v[192:199], v3
    v_smfmac_f32_16x16x64_bf16 v[36:39], v[52:55], v[224:231], v3
    s_waitcnt lgkmcnt(0)
    s_branch CSw1_fixed
    CSw2_entry:
    s_mov_b32 s23, 0x86000
    s_mov_b32 s24, s23
    s_add_u32 s23, s23, 0x2000
    s_bitset0_b32 s23, 15
    s_add_u32 s30, s23, 0x1000
    buffer_load_dwordx4 v[20:23], v125, s[8:11], s23 offen offset:2048 sc1
    buffer_load_dwordx4 v[24:27], v125, s[8:11], s30 offen offset:2048 sc1
    s_mov_b32 s18, -1
    v_mov_b32 v136, 0x3f803f80
    v_mov_b32 v137, 0x3f803f80
    v_mov_b32 v138, 0x3f803f80
    v_mov_b32 v139, 0x3f803f80
    s_mov_b32 s64, 0x42700000
    v_lshlrev_b32 v124, v1, v136
    v_lshrrev_b32 v126, 16, v136
    v_bfe_i32 v52, v1, 4, 1
    v_bfi_b32 v124, v52, v124, v126
    v_bfe_u32 v126, v1, 6, 2
    v_cmp_eq_u32 vcc, 0, v126
    s_nop 1
    v_cndmask_b32 v52, 0, v124, vcc
    v_cmp_eq_u32 vcc, 1, v126
    s_nop 1
    v_cndmask_b32 v53, 0, v124, vcc
    v_cmp_eq_u32 vcc, 2, v126
    s_nop 1
    v_cndmask_b32 v54, 0, v124, vcc
    v_cmp_eq_u32 vcc, 3, v126
    s_nop 1
    v_cndmask_b32 v55, 0, v124, vcc
    ds_write_b128 v8, v[52:55] offset:7168
    s_waitcnt lgkmcnt(0)
    v_pk_mov_b32 v[140:141], v[60:61], v[62:63] op_sel:[0,0]
    ds_read_b128 v[28:31], v8 offset:34816
    v_pk_mov_b32 v[142:143], v[60:61], v[62:63] op_sel:[1,1]
    ds_read_b128 v[32:35], v8 offset:35840
    v_bfe_u32 v126, v1, 2, 6
    ds_read_b128 v[36:39], v8 offset:26624
    v_mov_b64 v[68:69], 0
    ds_read_b128 v[40:43], v8 offset:27648
    v_mov_b64 v[70:71], 0
    ds_read_b128 v[76:79], v8 offset:28672
    v_mfma_f32_16x16x1_4b_f32 v[52:67], v126, v126, 0
    ds_read_b128 v[80:83], v8 offset:29696
    ds_read_b128 v[84:87], v8 offset:30720
    ds_read_b128 v[88:91], v8 offset:31744
    ds_read_b128 v[92:95], v8 offset:32768
    s_waitcnt vmcnt(2)
    v_mov_b64 v[100:101], v[108:109]
    ds_read_b128 v[96:99], v8 offset:33792
    v_mov_b64 v[102:103], v[110:111]
    v_mov_b64 v[104:105], v[112:113]
    ds_read_b128 v[44:47], v8 offset:24576
    v_mov_b64 v[106:107], v[114:115]
    ds_read_b128 v[48:51], v8 offset:25600
    ds_read_b128 v[108:111], v8 offset:20480
    ds_read_b128 v[112:115], v8 offset:21504
    s_xor_b32 s25, s25, 0x40000
    s_xor_b32 s26, s26, 0x40000
    v_bfe_u32 v126, v1, 2, 6
    v_mov_b64 v[72:73], 0
    v_mov_b64 v[74:75], 0
    s_add_u32 s18, s18, 1
    s_xor_b32 s25, s25, 0x40000
    s_xor_b32 s26, s26, 0x40000
    s_add_u32 s19, s18, 2
    s_cmp_ge_u32 s19, s37
    s_cselect_b32 s36, s29, 0x7ff00000
    s_add_u32 s31, s31, 0x40000
    s_add_u32 s32, s32, 0x40000
    s_mov_b32 s21, 1
    s_mov_b32 s35, 1
    s_waitcnt vmcnt(2)
    v_mov_b64 v[128:129], v[116:117]
    v_mov_b64 v[130:131], v[118:119]
    v_mov_b64 v[132:133], v[120:121]
    v_mov_b64 v[134:135], v[122:123]
    ds_read_b128 v[116:119], v8 offset:22528
    ds_read_b128 v[120:123], v8 offset:23552
    s_waitcnt vmcnt(0)
    s_branch CSw2_Aw
    CSw2_Bf:
    s_add_u32 s35, s35, 1
    s_cmp_gt_u32 s35, 2
    s_cbranch_scc1 CSw2_Bre
    s_nop 6
    v_mov_b64 v[60:61], 0
    v_mov_b64 v[62:63], 0
    v_mov_b64 v[64:65], 0
    v_mov_b64 v[66:67], 0
    v_smfmac_f32_16x16x64_bf16 v[60:63], v[20:23], v[76:83], v3
    s_nop 0
    v_smfmac_f32_16x16x64_bf16 v[64:67], v[20:23], v[84:91], v3
    s_waitcnt vmcnt(3)
    s_branch CSw2_Bw
    CSw2_Are:
    s_waitcnt vmcnt(0)
    CSw2_Arl:
    s_mov_b64 exec, vcc
    buffer_load_dwordx4 v[20:23], v125, s[8:11], s23 offen offset:2048 sc1
    s_mov_b64 exec, -1
    buffer_load_dwordx4 v[24:27], v125, s[8:11], s30 offen offset:2048 sc1
    s_add_u32 s21, s21, 1
    s_cmp_gt_u32 s21, 400000
    s_cbranch_scc1 CS_fail
    s_waitcnt vmcnt(6)
    v_mov_b64 v[52:53], 0
    v_mov_b64 v[54:55], 0
    v_mov_b64 v[56:57], 0
    v_mov_b64 v[58:59], 0
    v_mov_b64 v[60:61], 0
    v_mov_b64 v[62:63], 0
    v_max3_u32 v124, v20, v21, v22
    v_max_u32 v124, v124, v23
    v_cmp_eq_u32 vcc, -1, v124
    s_cbranch_vccz CSw2_Adn
    CSw2_Ack:
    v_max3_u32 v124, v20, v21, v22
    v_max_u32 v124, v124, v23
    v_cmp_eq_u32 vcc, -1, v124
    s_cbranch_vccnz CSw2_Arl
    CSw2_Adn:
    v_smfmac_f32_16x16x64_bf16 v[52:55], v[20:23], v[108:115], v3
    ds_write_b128 v2, v[20:23] offset:4096
    v_smfmac_f32_16x16x64_bf16 v[56:59], v[20:23], v[116:123], v3
    buffer_load_dwordx4 v[24:27], v125, s[8:11], s30 offen offset:2048 sc1
    v_smfmac_f32_16x16x64_bf16 v[60:63], v[20:23], v[76:83], v3
    s_barrier
    buffer_load_dwordx4 v[108:111], v9, s[8:11], s31 offen sc1
    v_smfmac_f32_16x16x64_bf16 v[64:67], v[20:23], v[84:91], v3
    buffer_load_dwordx4 v[112:115], v9, s[8:11], s31 offen offset:2048 sc1
    v_smfmac_f32_16x16x64_bf16 v[68:71], v[20:23], v[92:99], v3
    buffer_load_dwordx4 v[116:119], v1, s[8:11], s32 offen sc1
    v_smfmac_f32_16x16x64_bf16 v[72:75], v[20:23], v[28:35], v3
    s_waitcnt lgkmcnt(0)
    s_barrier
    ds_read_b128 v[28:31], v2 offset:6144
    ds_read_b128 v[32:35], v2 offset:0
    s_branch CSw2_Bck
    CSw2_Bre:
    CSw2_Brl:
    s_mov_b64 exec, vcc
    buffer_load_dwordx4 v[24:27], v125, s[8:11], s30 offen offset:2048 sc1
    s_mov_b64 exec, -1
    s_add_u32 s35, s35, 1
    s_cmp_gt_u32 s35, 400000
    s_cbranch_scc1 CS_fail
    s_waitcnt vmcnt(6)
    v_max3_u32 v124, v24, v25, v26
    v_max_u32 v124, v124, v27
    v_cmp_eq_u32 vcc, -1, v124
    s_cbranch_vccz CSw2_Bdn
    CSw2_Bck:
    v_max3_u32 v124, v24, v25, v26
    v_max_u32 v124, v124, v27
    v_cmp_eq_u32 vcc, -1, v124
    s_cbranch_vccnz CSw2_Brl
    CSw2_Bdn:
    ds_write_b128 v2, v[24:27] offset:5120
    v_mov_b64 v[60:61], 0
    v_mov_b64 v[62:63], 0
    v_mov_b64 v[64:65], 0
    v_mov_b64 v[66:67], 0
    v_smfmac_f32_16x16x64_bf16 v[60:63], v[20:23], v[76:83], v3
    s_nop 0
    v_smfmac_f32_16x16x64_bf16 v[64:67], v[20:23], v[84:91], v3
    v_smfmac_f32_16x16x64_bf16 v[60:63], v[24:27], a[96:103], v3
    v_smfmac_f32_16x16x64_bf16 v[64:67], v[24:27], a[104:111], v3
    s_waitcnt vmcnt(0)
    s_waitcnt lgkmcnt(0)
    s_branch CSw2_Bok
    CSw2_Pre:
    CSw2_Prl:
    s_mov_b64 exec, vcc
    buffer_load_dwordx4 v[128:131], v1, s[8:11], s25 offen offset:0 sc1
    buffer_load_dwordx4 v[132:135], v1, s[8:11], s25 offen offset:1024 sc1
    s_mov_b64 exec, -1
    s_add_u32 s21, s21, 1
    s_cmp_gt_u32 s21, 400000
    s_cbranch_scc1 CS_fail
    s_waitcnt vmcnt(8)
    v_max3_u32 v124, v128, v129, v130
    v_max3_u32 v126, v131, v132, v133
    v_max3_u32 v124, v124, v134, v135
    v_max_u32 v124, v124, v126
    v_cmp_eq_u32 vcc, -1, v124
    s_cbranch_vccz CSw2_Pdn
    CSw2_Pck:
    v_max3_u32 v124, v128, v129, v130
    v_max3_u32 v126, v131, v132, v133
    v_max3_u32 v124, v124, v134, v135
    v_max_u32 v124, v124, v126
    v_cmp_eq_u32 vcc, -1, v124
    s_cbranch_vccnz CSw2_Prl
    CSw2_Pdn:
    v_mfma_f32_16x16x32_bf16 v[24:27], v[72:75], v[128:131], 0
    v_mfma_f32_16x16x32_bf16 v[24:27], v[72:75], v[132:135], v[24:27]
    s_nop 7
    v_add_f32_dpp v24, v24, v24 row_ror:4 row_mask:0xf bank_mask:0xf
    v_add_f32_dpp v25, v25, v25 row_ror:4 row_mask:0xf bank_mask:0xf
    s_nop 0
    v_add_f32_dpp v24, v24, v24 row_ror:8 row_mask:0xf bank_mask:0xf
    v_add_f32_dpp v25, v25, v25 row_ror:8 row_mask:0xf bank_mask:0xf
    v_cvt_pk_bf16_f32 v124, v24, v25
    buffer_store_dword v124, v5, s[8:11], s23 offen sc1
    s_waitcnt vmcnt(1)
    s_branch CSw2_w2
.p2align 6
    CSw2_step:
    v_bfe_u32 v126, v1, 2, 6
    v_mov_b64 v[72:73], 0
    v_mov_b64 v[74:75], 0
    s_add_u32 s18, s18, 1
    s_xor_b32 s25, s25, 0x40000
    s_xor_b32 s26, s26, 0x40000
    s_add_u32 s19, s18, 2
    s_cmp_ge_u32 s19, s37
    s_cselect_b32 s36, s29, 0x7ff00000
    s_add_u32 s31, s31, 0x40000
    s_add_u32 s32, s32, 0x40000
    s_mov_b32 s21, 1
    s_mov_b32 s35, 1
    s_waitcnt vmcnt(1)
    v_mov_b64 v[128:129], v[116:117]
    v_mov_b64 v[130:131], v[118:119]
    v_mov_b64 v[132:133], v[120:121]
    buffer_load_dwordx4 v[20:23], v125, s[8:11], s23 offen offset:2048 sc1
    v_mov_b64 v[134:135], v[122:123]
    buffer_load_dword v127, off, s[8:11], s23
    ds_read_b128 v[116:119], v8 offset:22528
    ds_read_b128 v[120:123], v8 offset:23552
    s_nop 0
    s_nop 0
    s_nop 0
    s_nop 0
    s_nop 0
    s_nop 0
    s_nop 0
    s_nop 0
    s_nop 0
    s_nop 0
    s_nop 0
    s_nop 0
    s_nop 0
    s_nop 0
    s_nop 0
    s_nop 0
    s_nop 0
    s_nop 0
    s_nop 0
    buffer_load_dwordx4 v[20:23], v125, s[8:11], s23 offen offset:2048 sc1
    s_nop 0
    s_nop 0
    s_nop 0
    s_nop 0
    s_nop 0
    s_nop 0
    s_nop 0
    s_nop 0
    s_nop 0
    s_nop 0
    s_nop 0
    buffer_load_dwordx4 v[24:27], v125, s[8:11], s30 offen offset:2048 sc1
    s_branch CSw2_Aw
    CSw2_Af:
    v_mfma_f32_16x16x1_4b_f32 v[52:67], v126, v126, 0
    s_mov_b64 exec, vcc
    buffer_load_dwordx4 v[20:23], v125, s[8:11], s23 offen offset:2048 sc1
    s_mov_b64 exec, -1
    buffer_load_dwordx4 v[24:27], v125, s[8:11], s30 offen offset:2048 sc1
    s_add_u32 s21, s21, 1
    s_cmp_gt_u32 s21, 6
    s_cbranch_scc1 CSw2_Are
    s_nop 0
    s_nop 0
    s_nop 0
    CSw2_Aw:
    s_waitcnt vmcnt(3) lgkmcnt(0)
    v_fma_f32 v124, v20, v21, v22
    v_cmp_u_f32 vcc, v124, v23
    v_smfmac_f32_16x16x64_bf16 v[52:55], v[20:23], v[108:115], v3
    ds_write_b128 v2, v[20:23] offset:4096
    v_smfmac_f32_16x16x64_bf16 v[56:59], v[20:23], v[116:123], v3
    s_cbranch_vccnz CSw2_Af
    buffer_load_dwordx4 v[24:27], v125, s[8:11], s30 offen offset:2048 sc1
    v_smfmac_f32_16x16x64_bf16 v[60:63], v[20:23], v[76:83], v3
    s_barrier
    buffer_load_dwordx4 v[108:111], v9, s[8:11], s31 offen sc1
    v_smfmac_f32_16x16x64_bf16 v[64:67], v[20:23], v[84:91], v3
    buffer_load_dwordx4 v[112:115], v9, s[8:11], s31 offen offset:2048 sc1
    v_smfmac_f32_16x16x64_bf16 v[68:71], v[20:23], v[92:99], v3
    buffer_load_dwordx4 v[116:119], v1, s[8:11], s32 offen sc1
    v_smfmac_f32_16x16x64_bf16 v[72:75], v[20:23], v[28:35], v3
    s_waitcnt lgkmcnt(0)
    s_barrier
    ds_read_b128 v[28:31], v2 offset:6144
    ds_read_b128 v[32:35], v2 offset:0
    CSw2_Bw:
    s_waitcnt vmcnt(4)
    v_fma_f32 v124, v24, v25, v26
    v_cmp_u_f32 vcc, v124, v27
    v_smfmac_f32_16x16x64_bf16 v[60:63], v[24:27], a[96:103], v3
    ds_write_b128 v2, v[24:27] offset:5120
    v_smfmac_f32_16x16x64_bf16 v[64:67], v[24:27], a[104:111], v3
    s_cbranch_vccnz CSw2_Bf
    CSw2_Bok:
    buffer_store_dwordx4 v[140:143], v1, s[8:11], s33 offen sc1
    buffer_load_dword v127, v126, s[8:11], s36 offen sc1
    v_smfmac_f32_16x16x64_bf16 v[52:55], v[24:27], v[44:51], v3
    s_mov_b32 s33, s34
    buffer_load_dwordx4 v[120:123], v1, s[8:11], s32 offen offset:1024 sc1
    v_mov_b64 v[140:141], -1
    v_smfmac_f32_16x16x64_bf16 v[56:59], v[24:27], v[36:43], v3
    ds_read_b128 v[36:39], v2 offset:2048
    s_waitcnt lgkmcnt(3)
    v_smfmac_f32_16x16x64_bf16 v[52:55], v[28:31], a[0:7], v3
    s_add_u32 s34, s34, 0x20000
    v_mov_b64 v[142:143], -1
    v_smfmac_f32_16x16x64_bf16 v[56:59], v[28:31], a[8:15], v3
    s_waitcnt lgkmcnt(1)
    v_smfmac_f32_16x16x64_bf16 v[52:55], v[32:35], a[32:39], v3
    s_barrier
    ds_read_b128 v[44:47], v2 offset:7168
    v_smfmac_f32_16x16x64_bf16 v[56:59], v[32:35], a[40:47], v3
    s_waitcnt lgkmcnt(1)
    s_mov_b32 s19, s27
    ds_read_b128 v[40:43], v2 offset:1024
    v_smfmac_f32_16x16x64_bf16 v[52:55], v[36:39], a[64:71], v3
    s_add_u32 s20, s27, 0x10000
    s_add_u32 s38, s27, 0x20000
    ds_read_b128 v[48:51], v2 offset:3072
    v_smfmac_f32_16x16x64_bf16 v[56:59], v[36:39], a[72:79], v3
    s_add_u32 s22, s27, 0x30000
    s_xor_b32 s27, s27, 0x40000
    v_smfmac_f32_16x16x64_bf16 v[60:63], v[28:31], a[112:119], v3
    v_smfmac_f32_16x16x64_bf16 v[60:63], v[36:39], a[144:151], v3
    ds_read_b128 v[76:79], v8 offset:0
    v_smfmac_f32_16x16x64_bf16 v[64:67], v[28:31], a[120:127], v3
    s_waitcnt lgkmcnt(2)
    v_smfmac_f32_16x16x64_bf16 v[52:55], v[44:47], a[16:23], v3
    ds_read_b128 v[80:83], v8 offset:1024
    v_smfmac_f32_16x16x64_bf16 v[52:55], v[40:43], a[48:55], v3
    s_waitcnt lgkmcnt(2)
    ds_read_b128 v[84:87], v8 offset:4096
    v_smfmac_f32_16x16x64_bf16 v[52:55], v[48:51], a[80:87], v3
    ds_read_b128 v[88:91], v8 offset:5120
    v_smfmac_f32_16x16x64_bf16 v[56:59], v[44:47], a[24:31], v3
    ds_read_b128 v[92:95], v8 offset:2048
    v_smfmac_f32_16x16x64_bf16 v[56:59], v[40:43], a[56:63], v3
    ds_read_b128 v[96:99], v8 offset:3072
    v_add_f32 v52, v52, v54
    v_smfmac_f32_16x16x64_bf16 v[56:59], v[48:51], a[88:95], v3
    s_waitcnt lgkmcnt(4)
    v_add_f32 v53, v53, v55
    v_smfmac_f32_16x16x64_bf16 v[60:63], v[32:35], v[76:83], v3
    s_waitcnt lgkmcnt(2)
    v_cvt_pk_bf16_f32 v54, v52, v53
    v_smfmac_f32_16x16x64_bf16 v[60:63], v[40:43], v[84:91], v3
    v_add_f32 v56, v56, v58
    v_add_f32 v57, v57, v59
    v_cvt_pk_bf16_f32 v55, v56, v57
    v_smfmac_f32_16x16x64_bf16 v[60:63], v[44:47], a[128:135], v3
    ds_write_b64 v6, v[54:55]
    v_smfmac_f32_16x16x64_bf16 v[60:63], v[48:51], a[160:167], v3
    s_waitcnt lgkmcnt(1)
    ds_read_b128 v[52:55], v8 offset:8192
    v_mov_b32 v88, v7
    v_smfmac_f32_16x16x64_bf16 v[64:67], v[32:35], v[92:99], v3
    ds_read_b128 v[56:59], v8 offset:9216
    v_mov_b32 v89, v7
    v_smfmac_f32_16x16x64_bf16 v[64:67], v[40:43], v[12:19], v3
    ds_read_b128 v[92:95], v8 offset:10240
    v_add_f32 v60, v60, v62
    v_smfmac_f32_16x16x64_bf16 v[64:67], v[36:39], a[152:159], v3
    s_waitcnt lgkmcnt(3)
    s_barrier
    ds_read_b64_tr_b16 v[76:77], v10 offset:0
    ds_read_b64_tr_b16 v[78:79], v10 offset:1024
    v_smfmac_f32_16x16x64_bf16 v[64:67], v[44:47], a[136:143], v3
    ds_read_b64_tr_b16 v[80:81], v10 offset:2048
    ds_read_b64_tr_b16 v[82:83], v10 offset:3072
    v_smfmac_f32_16x16x64_bf16 v[64:67], v[48:51], a[168:175], v3
    ds_read_b128 v[96:99], v8 offset:11264
    v_smfmac_f32_16x16x64_bf16 v[68:71], v[24:27], a[176:183], v3
    buffer_store_dword v140, v5, s[8:11], s24 offen sc1
    v_add_f32 v61, v61, v63
    v_cvt_pk_bf16_f32 v60, v60, v61
    s_waitcnt lgkmcnt(3)
    v_mfma_f32_16x16x32_bf16 v[84:87], v[100:103], v[76:79], 0
    v_add_f32 v64, v64, v66
    v_add_f32 v65, v65, v67
    v_cvt_pk_bf16_f32 v62, v64, v65
    s_waitcnt lgkmcnt(1)
    v_mfma_f32_16x16x32_bf16 v[84:87], v[104:107], v[80:83], v[84:87]
    ds_write2_b32 v6, v60, v62 offset0:128 offset1:129
    v_smfmac_f32_16x16x64_bf16 v[72:75], v[24:27], a[184:191], v3
    buffer_store_dwordx4 v[140:143], v1, s[8:11], s26 offen sc1
    v_mov_b64 v[104:105], 0
    v_mov_b64 v[106:107], 0
    v_smfmac_f32_16x16x64_bf16 v[68:71], v[40:43], v[52:59], v3
    s_waitcnt lgkmcnt(1)
    ds_read_b128 v[100:103], v8 offset:6144
    v_fmac_f32_dpp v88, v84, v0 quad_perm:[0,1,0,1] row_mask:0xf bank_mask:0xf
    v_fmac_f32_dpp v89, v85, v0 quad_perm:[0,1,0,1] row_mask:0xf bank_mask:0xf
    v_smfmac_f32_16x16x64_bf16 v[72:75], v[40:43], v[92:99], v3
    s_waitcnt vmcnt(8)
    v_fmac_f32_dpp v88, v86, v0 quad_perm:[2,3,2,3] row_mask:0xf bank_mask:0xf
    v_fmac_f32_dpp v89, v87, v0 quad_perm:[2,3,2,3] row_mask:0xf bank_mask:0xf
    v_smfmac_f32_16x16x64_bf16 v[68:71], v[36:39], a[240:247], v3
    buffer_store_dwordx4 v[140:143], v1, s[8:11], s26 offen offset:1024 sc1
    v_smfmac_f32_16x16x64_bf16 v[72:75], v[36:39], a[248:255], v3
    s_waitcnt lgkmcnt(1)
    s_barrier
    ds_read_b64_tr_b16 v[20:21], v10 offset:512
    v_exp_f32 v90, v88
    v_mov_b32 v140, 0
    v_smfmac_f32_16x16x64_bf16 v[68:71], v[28:31], a[192:199], v3
    ds_read_b64_tr_b16 v[22:23], v10 offset:1536
    ds_read_b64_tr_b16 v[24:25], v10 offset:2560
    ds_read_b64_tr_b16 v[26:27], v10 offset:3584
    v_exp_f32 v91, v89
    s_nop 0
    v_cvt_pk_bf16_f32 v90, v90, v91
    v_mov_b64 v[40:41], 0
    v_mov_b64 v[42:43], 0
    v_smfmac_f32_16x16x64_bf16 v[72:75], v[28:31], a[200:207], v3
    ds_write_b32 v11, v90
    v_smfmac_f32_16x16x64_bf16 v[68:71], v[32:35], a[224:231], v3
    s_cmp_eq_u32 s18, 63
    s_waitcnt lgkmcnt(3)
    v_mfma_f32_16x16x32_bf16 v[92:95], v[20:23], v[76:79], 0
    v_mov_b32 v142, v7
    s_waitcnt lgkmcnt(1)
    v_mfma_f32_16x16x32_bf16 v[92:95], v[24:27], v[80:83], v[92:95]
    v_mov_b32 v143, v7
    v_mov_b64 v[36:37], 0
    v_mov_b64 v[38:39], 0
    v_smfmac_f32_16x16x64_bf16 v[72:75], v[32:35], a[232:239], v3
    s_waitcnt lgkmcnt(0)
    s_barrier
    ds_read_b128 v[84:87], v2
    v_smfmac_f32_16x16x64_bf16 v[68:71], v[44:47], a[208:215], v3
    v_fmac_f32_dpp v142, v92, v0 quad_perm:[0,1,0,1] row_mask:0xf bank_mask:0xf
    v_smfmac_f32_16x16x64_bf16 v[68:71], v[48:51], v[144:151], v3
    v_fmac_f32_dpp v143, v93, v0 quad_perm:[0,1,0,1] row_mask:0xf bank_mask:0xf
    v_fmac_f32_dpp v142, v94, v0 quad_perm:[2,3,2,3] row_mask:0xf bank_mask:0xf
    v_smfmac_f32_16x16x64_bf16 v[72:75], v[44:47], a[216:223], v3
    s_waitcnt lgkmcnt(0)
    v_fmac_f32_dpp v143, v95, v0 quad_perm:[2,3,2,3] row_mask:0xf bank_mask:0xf
    v_mfma_f32_16x16x32_bf16 v[64:67], v[136:139], v[84:87], 0
    v_exp_f32 v142, v142
    v_mfma_f32_16x16x32_bf16 v[52:55], v[128:131], v[84:87], 0
    v_exp_f32 v143, v143
    v_mfma_f32_16x16x32_bf16 v[56:59], v[132:135], v[84:87], 0
    v_cvt_pk_bf16_f32 v141, v142, v143
    v_add_f32 v68, v68, v70
    v_smfmac_f32_16x16x64_bf16 v[72:75], v[48:51], v[152:159], v3
    ds_read_b128 v[28:31], v8 offset:12288
    v_add_f32 v69, v69, v71
    v_mfma_f32_16x16x16_bf16 v[64:67], v[136:137], v[140:141], v[64:67]
    ds_read_b128 v[32:35], v8 offset:13312
    v_cvt_pk_bf16_f32 v61, v68, v69
    s_nop 1
    v_mfma_f32_16x16x16_bf16 v[52:55], v[60:61], v[140:141], v[52:55]
    v_add_f32 v72, v72, v74
    v_add_f32 v73, v73, v75
    v_cvt_pk_bf16_f32 v63, v72, v73
    s_cbranch_scc1 CSw2_last
    s_nop 0
    v_mfma_f32_16x16x16_bf16 v[56:59], v[62:63], v[140:141], v[56:59]
    v_rcp_f32 v64, v64
    s_nop 0
    v_pk_mul_f32 v[52:53], v[52:53], v[64:65] op_sel_hi:[1,0]
    v_pk_mul_f32 v[54:55], v[54:55], v[64:65] op_sel_hi:[1,0]
    v_cvt_pk_bf16_f32 v52, v52, v53
    v_cvt_pk_bf16_f32 v53, v54, v55
    ds_write_b64 v2, v[52:53] offset:10240
    s_nop 0
    v_pk_mul_f32 v[56:57], v[56:57], v[64:65] op_sel_hi:[1,0]
    v_pk_mul_f32 v[58:59], v[58:59], v[64:65] op_sel_hi:[1,0]
    v_cvt_pk_bf16_f32 v54, v56, v57
    v_cvt_pk_bf16_f32 v55, v58, v59
    ds_write_b64 v2, v[54:55] offset:10248
    s_nop 0
    v_smfmac_f32_16x16x64_bf16 v[100:103], v[52:55], v[160:167], v3
    v_log_f32 v65, v65
    v_smfmac_f32_16x16x64_bf16 v[104:107], v[52:55], v[192:199], v3
    v_cmp_nle_f32 vcc, |v65|, s64
    v_smfmac_f32_16x16x64_bf16 v[36:39], v[52:55], v[224:231], v3
    s_cbranch_vccnz CSw2_fix
    CSw2_fixed:
    s_waitcnt lgkmcnt(0)
    s_barrier
    ds_read_b128 v[68:71], v2 offset:11264
    ds_read_b128 v[72:75], v2 offset:8192
    ds_read_b128 v[96:99], v2 offset:9216
    v_smfmac_f32_16x16x64_bf16 v[40:43], v[52:55], v[240:247], v3
    ds_read_b128 v[20:23], v8 offset:14336
    s_waitcnt lgkmcnt(3)
    v_smfmac_f32_16x16x64_bf16 v[100:103], v[68:71], v[168:175], v3
    ds_read_b128 v[24:27], v8 offset:15360
    s_waitcnt lgkmcnt(3)
    v_smfmac_f32_16x16x64_bf16 v[100:103], v[72:75], v[176:183], v3
    ds_read_b128 v[76:79], v8 offset:16384
    s_waitcnt lgkmcnt(3)
    v_smfmac_f32_16x16x64_bf16 v[100:103], v[96:99], v[184:191], v3
    ds_read_b128 v[44:47], v8 offset:18432
    ds_read_b128 v[80:83], v8 offset:17408
    v_smfmac_f32_16x16x64_bf16 v[104:107], v[68:71], v[200:207], v3
    s_mov_b32 s24, s23
    s_add_u32 s23, s23, 0x2000
    s_bitset0_b32 s23, 15
    v_smfmac_f32_16x16x64_bf16 v[104:107], v[72:75], v[208:215], v3
    s_add_u32 s30, s23, 0x1000
    ds_read_b128 v[48:51], v8 offset:19456
    v_cvt_pk_bf16_f32 v100, v100, v102
    v_cvt_pk_bf16_f32 v101, v101, v103
    v_smfmac_f32_16x16x64_bf16 v[104:107], v[96:99], v[216:223], v3
    buffer_store_dword v100, v4, s[8:11], s19 offen offset:0 sc1
    buffer_store_dword v101, v4, s[8:11], s19 offen offset:2048 sc1
    v_smfmac_f32_16x16x64_bf16 v[36:39], v[68:71], v[232:239], v3
    s_mov_b32 s21, 1
    v_sub_f32 v7, v7, v65
    v_smfmac_f32_16x16x64_bf16 v[36:39], v[72:75], v[28:35], v3
    s_waitcnt lgkmcnt(1)
    v_cvt_pk_bf16_f32 v104, v104, v106
    v_cvt_pk_bf16_f32 v105, v105, v107
    v_smfmac_f32_16x16x64_bf16 v[36:39], v[96:99], v[20:27], v3
    buffer_store_dword v104, v4, s[8:11], s20 offen offset:0 sc1
    buffer_store_dword v105, v4, s[8:11], s20 offen offset:2048 sc1
    v_smfmac_f32_16x16x64_bf16 v[40:43], v[68:71], v[248:255], v3
    v_smfmac_f32_16x16x64_bf16 v[40:43], v[72:75], v[76:83], v3
    s_waitcnt lgkmcnt(0)
    v_cvt_pk_bf16_f32 v36, v36, v38
    v_cvt_pk_bf16_f32 v37, v37, v39
    v_smfmac_f32_16x16x64_bf16 v[40:43], v[96:99], v[44:51], v3
    buffer_store_dword v36, v4, s[8:11], s38 offen offset:0 sc1
    buffer_store_dword v37, v4, s[8:11], s38 offen offset:2048 sc1
    s_nop 5
    v_cvt_pk_bf16_f32 v40, v40, v42
    v_cvt_pk_bf16_f32 v41, v41, v43
    buffer_store_dword v40, v4, s[8:11], s22 offen offset:0 sc1
    buffer_store_dword v41, v4, s[8:11], s22 offen offset:2048 sc1
    ds_read_b128 v[72:75], v8 offset:7168
    v_pk_mov_b32 v[140:141], v[60:61], v[62:63] op_sel:[0,0]
    ds_read_b128 v[28:31], v8 offset:34816
    v_pk_mov_b32 v[142:143], v[60:61], v[62:63] op_sel:[1,1]
    ds_read_b128 v[32:35], v8 offset:35840
    v_bfe_u32 v126, v1, 2, 6
    ds_read_b128 v[36:39], v8 offset:26624
    v_mov_b64 v[68:69], 0
    ds_read_b128 v[40:43], v8 offset:27648
    v_mov_b64 v[70:71], 0
    ds_read_b128 v[76:79], v8 offset:28672
    v_mfma_f32_16x16x1_4b_f32 v[52:67], v126, v126, 0
    ds_read_b128 v[80:83], v8 offset:29696
    ds_read_b128 v[84:87], v8 offset:30720
    ds_read_b128 v[88:91], v8 offset:31744
    s_nop 0
    s_nop 0
    s_nop 0
    s_nop 0
    s_nop 0
    s_nop 0
    s_nop 0
    s_nop 0
    s_nop 0
    s_nop 0
    s_nop 0
    s_nop 0
    s_nop 0
    s_nop 0
    s_nop 0
    s_nop 0
    s_nop 0
    s_nop 0
    s_nop 0
    s_nop 0
    buffer_load_dwordx4 v[128:131], v1, s[8:11], s25 offen offset:0 sc1
    buffer_load_dwordx4 v[132:135], v1, s[8:11], s25 offen offset:1024 sc1
    ds_read_b128 v[92:95], v8 offset:32768
    s_waitcnt vmcnt(17)
    v_mov_b64 v[100:101], v[108:109]
    ds_read_b128 v[96:99], v8 offset:33792
    v_mov_b64 v[102:103], v[110:111]
    v_mov_b64 v[104:105], v[112:113]
    ds_read_b128 v[44:47], v8 offset:24576
    v_mov_b64 v[106:107], v[114:115]
    ds_read_b128 v[48:51], v8 offset:25600
    ds_read_b128 v[108:111], v8 offset:20480
    ds_read_b128 v[112:115], v8 offset:21504
    s_add_u32 s19, s18, 2
    s_cmp_ge_u32 s19, s37
    s_cbranch_scc1 CSw2_kvw
    CSw2_kvok:
    s_nop 0
    s_nop 0
    s_nop 0
    s_nop 0
    s_nop 0
    s_nop 0
    s_nop 0
    s_nop 0
    s_nop 0
    s_nop 0
    s_nop 0
    s_nop 0
    s_nop 0
    s_nop 0
    buffer_load_dwordx4 v[128:131], v1, s[8:11], s25 offen offset:0 sc1
    buffer_load_dwordx4 v[132:135], v1, s[8:11], s25 offen offset:1024 sc1
    s_branch CSw2_Pw
    CSw2_Pf:
    s_add_u32 s21, s21, 1
    v_max3_u32 v124, v128, v129, v130
    v_max3_u32 v126, v131, v132, v133
    v_max3_u32 v124, v124, v134, v135
    v_max_u32 v124, v124, v126
    v_cmp_eq_u32 vcc, -1, v124
    s_nop 0
    s_mov_b64 exec, vcc
    buffer_load_dwordx4 v[128:131], v1, s[8:11], s25 offen offset:0 sc1
    buffer_load_dwordx4 v[132:135], v1, s[8:11], s25 offen offset:1024 sc1
    s_mov_b64 exec, -1
    s_cmp_gt_u32 s21, 4
    s_cbranch_scc1 CSw2_Pre
    CSw2_Pw:
    s_waitcnt vmcnt(3) lgkmcnt(0)
    CSw2_P:
    v_mfma_f32_16x16x32_bf16 v[24:27], v[72:75], v[128:131], 0
    s_waitcnt vmcnt(2)
    v_mfma_f32_16x16x32_bf16 v[24:27], v[72:75], v[132:135], v[24:27]
    s_nop 7
    v_cmp_u_f32 vcc, v24, v24
    v_add_f32_dpp v24, v24, v24 row_ror:4 row_mask:0xf bank_mask:0xf
    v_add_f32_dpp v25, v25, v25 row_ror:4 row_mask:0xf bank_mask:0xf
    s_nop 0
    v_add_f32_dpp v24, v24, v24 row_ror:8 row_mask:0xf bank_mask:0xf
    v_add_f32_dpp v25, v25, v25 row_ror:8 row_mask:0xf bank_mask:0xf
    v_cvt_pk_bf16_f32 v124, v24, v25
    s_cbranch_vccnz CSw2_Pf
    buffer_store_dword v124, v5, s[8:11], s23 offen sc1
    CSw2_w2:
    s_branch CSw2_step
    CSw2_kvw:
    s_mov_b32 s21, 0
    s_waitcnt vmcnt(14)
    s_branch CSw2_kvl_chk
    v_lshrrev_b32 v126, 2, v1
    v_and_b32 v126, 63, v126
    s_mov_b32 s21, 0
    CSw2_kvl:
    buffer_load_dword v127, v126, s[8:11], s29 offen sc1
    s_add_u32 s21, s21, 1
    s_cmp_gt_u32 s21, 400000
    s_cbranch_scc1 CS_fail
    s_waitcnt vmcnt(0)
    CSw2_kvl_chk:
    v_min_u32_dpp v127, v127, v127 row_ror:8 row_mask:0xf bank_mask:0xf
    s_nop 1
    v_min_u32_dpp v127, v127, v127 row_ror:4 row_mask:0xf bank_mask:0xf
    s_nop 1
    v_min_u32_dpp v127, v127, v127 row_ror:2 row_mask:0xf bank_mask:0xf
    s_nop 1
    v_min_u32_dpp v127, v127, v127 row_ror:1 row_mask:0xf bank_mask:0xf
    s_nop 0
    v_readfirstlane_b32 s37, v127
    s_nop 0
    s_lshl_b32 s37, s37, 2
    s_cmp_ge_u32 s19, s37
    s_cbranch_scc1 CSw2_kvl
    s_cmp_ge_u32 s37, 12
    s_cselect_b32 s21, 12, 0
    s_cmp_ge_u32 s37, 44
    s_cselect_b32 s21, 44, s21
    s_cmp_ge_u32 s37, 64
    s_cselect_b32 s21, 1000, s21
    s_cmp_gt_u32 s21, s19
    s_cselect_b32 s37, s21, s37
    s_mov_b32 s21, 1
    s_branch CSw2_kvok
    CSw2_last:
    v_mov_b32 v124, v61
    v_mov_b32 v61, v62
    v_mov_b32 v62, v124
    buffer_store_dwordx4 v[60:63], v1, s[8:11], s33 offen sc1
    s_branch CS_done
    CSw2_fix:
    v_and_b32 v124, 0x3ff, v11
    v_lshlrev_b32 v124, 1, v124
    v_add_u32 v124, 0x24800, v124
    v_lshlrev_b32 v126, 1, v1
    v_add_u32 v126, 0x24800, v126
    ds_write_b64 v124, v[88:89]
    v_mov_b32 v142, v7
    v_mov_b32 v143, v7
    s_waitcnt lgkmcnt(0)
    s_barrier
    ds_read_b128 v[68:71], v126
    ds_read_b128 v[72:75], v126 offset:16
    v_fmac_f32_dpp v142, v92, v0 quad_perm:[0,1,0,1] row_mask:0xf bank_mask:0xf
    v_fmac_f32_dpp v143, v93, v0 quad_perm:[0,1,0,1] row_mask:0xf bank_mask:0xf
    s_nop 0
    v_fmac_f32_dpp v142, v94, v0 quad_perm:[2,3,2,3] row_mask:0xf bank_mask:0xf
    v_fmac_f32_dpp v143, v95, v0 quad_perm:[2,3,2,3] row_mask:0xf bank_mask:0xf
    s_waitcnt lgkmcnt(0)
    v_max3_f32 v124, v68, v69, v70
    v_max3_f32 v124, v124, v71, v72
    v_max3_f32 v124, v124, v73, v74
    v_max3_f32 v124, v124, v75, v142
    v_max_f32 v124, v124, v143
    v_mov_b32 v126, v124
    s_nop 1
    v_permlane32_swap_b32 v124, v126
    v_max_f32 v124, v124, v126
    v_mov_b32 v126, v124
    s_nop 1
    v_permlane16_swap_b32 v124, v126
    v_max_f32 v124, v124, v126
    v_sub_f32 v7, v7, v124
    v_sub_f32 v68, v68, v124
    v_sub_f32 v69, v69, v124
    v_sub_f32 v70, v70, v124
    v_sub_f32 v71, v71, v124
    v_sub_f32 v72, v72, v124
    v_sub_f32 v73, v73, v124
    v_sub_f32 v74, v74, v124
    v_sub_f32 v75, v75, v124
    v_sub_f32 v142, v142, v124
    v_sub_f32 v143, v143, v124
    v_exp_f32 v68, v68
    v_exp_f32 v69, v69
    v_exp_f32 v70, v70
    v_exp_f32 v71, v71
    v_exp_f32 v72, v72
    v_exp_f32 v73, v73
    v_exp_f32 v74, v74
    v_exp_f32 v75, v75
    v_exp_f32 v142, v142
    v_exp_f32 v143, v143
    v_cvt_pk_bf16_f32 v84, v68, v69
    v_cvt_pk_bf16_f32 v85, v70, v71
    v_cvt_pk_bf16_f32 v86, v72, v73
    v_cvt_pk_bf16_f32 v87, v74, v75
    v_cvt_pk_bf16_f32 v141, v142, v143
    s_nop 0
    v_mfma_f32_16x16x32_bf16 v[64:67], v[136:139], v[84:87], 0
    v_mfma_f32_16x16x32_bf16 v[52:55], v[128:131], v[84:87], 0
    v_mfma_f32_16x16x32_bf16 v[56:59], v[132:135], v[84:87], 0
    v_mfma_f32_16x16x16_bf16 v[64:67], v[136:137], v[140:141], v[64:67]
    v_mfma_f32_16x16x16_bf16 v[52:55], v[60:61], v[140:141], v[52:55]
    v_mfma_f32_16x16x16_bf16 v[56:59], v[62:63], v[140:141], v[56:59]
    v_rcp_f32 v64, v64
    s_nop 2
    v_pk_mul_f32 v[52:53], v[52:53], v[64:65] op_sel_hi:[1,0]
    v_pk_mul_f32 v[54:55], v[54:55], v[64:65] op_sel_hi:[1,0]
    v_cvt_pk_bf16_f32 v52, v52, v53
    v_cvt_pk_bf16_f32 v53, v54, v55
    v_pk_mul_f32 v[56:57], v[56:57], v[64:65] op_sel_hi:[1,0]
    v_pk_mul_f32 v[58:59], v[58:59], v[64:65] op_sel_hi:[1,0]
    v_cvt_pk_bf16_f32 v54, v56, v57
    v_cvt_pk_bf16_f32 v55, v58, v59
    ds_write_b64 v2, v[52:53] offset:10240
    ds_write_b64 v2, v[54:55] offset:10248
    v_mov_b64 v[100:101], 0
    v_mov_b64 v[102:103], 0
    v_mov_b64 v[104:105], 0
    v_mov_b64 v[106:107], 0
    v_mov_b64 v[36:37], 0
    v_mov_b64 v[38:39], 0
    v_log_f32 v65, v65
    v_smfmac_f32_16x16x64_bf16 v[100:103], v[52:55], v[160:167], v3
    v_smfmac_f32_16x16x64_bf16 v[104:107], v[52:55], v[192:199], v3
    v_smfmac_f32_16x16x64_bf16 v[36:39], v[52:55], v[224:231], v3
    s_waitcnt lgkmcnt(0)
    s_branch CSw2_fixed
    CSw3_entry:
    s_mov_b32 s23, 0x86000
    s_mov_b32 s24, s23
    s_add_u32 s23, s23, 0x2000
    s_bitset0_b32 s23, 15
    s_add_u32 s30, s23, 0x1000
    buffer_load_dwordx4 v[20:23], v125, s[8:11], s23 offen offset:3072 sc1
    buffer_load_dwordx4 v[24:27], v125, s[8:11], s30 offen offset:3072 sc1
    s_mov_b32 s18, -1
    v_mov_b32 v136, 0x3f803f80
    v_mov_b32 v137, 0x3f803f80
    v_mov_b32 v138, 0x3f803f80
    v_mov_b32 v139, 0x3f803f80
    s_mov_b32 s64, 0x42700000
    v_lshlrev_b32 v124, v1, v136
    v_lshrrev_b32 v126, 16, v136
    v_bfe_i32 v52, v1, 4, 1
    v_bfi_b32 v124, v52, v124, v126
    v_bfe_u32 v126, v1, 6, 2
    v_cmp_eq_u32 vcc, 0, v126
    s_nop 1
    v_cndmask_b32 v52, 0, v124, vcc
    v_cmp_eq_u32 vcc, 1, v126
    s_nop 1
    v_cndmask_b32 v53, 0, v124, vcc
    v_cmp_eq_u32 vcc, 2, v126
    s_nop 1
    v_cndmask_b32 v54, 0, v124, vcc
    v_cmp_eq_u32 vcc, 3, v126
    s_nop 1
    v_cndmask_b32 v55, 0, v124, vcc
    ds_write_b128 v8, v[52:55] offset:7168
    s_waitcnt lgkmcnt(0)
    v_pk_mov_b32 v[140:141], v[60:61], v[62:63] op_sel:[0,0]
    ds_read_b128 v[28:31], v8 offset:34816
    v_pk_mov_b32 v[142:143], v[60:61], v[62:63] op_sel:[1,1]
    ds_read_b128 v[32:35], v8 offset:35840
    v_bfe_u32 v126, v1, 2, 6
    ds_read_b128 v[36:39], v8 offset:26624
    v_mov_b64 v[68:69], 0
    ds_read_b128 v[40:43], v8 offset:27648
    v_mov_b64 v[70:71], 0
    ds_read_b128 v[76:79], v8 offset:28672
    v_mfma_f32_16x16x1_4b_f32 v[52:67], v126, v126, 0
    ds_read_b128 v[80:83], v8 offset:29696
    ds_read_b128 v[84:87], v8 offset:30720
    ds_read_b128 v[88:91], v8 offset:31744
    ds_read_b128 v[92:95], v8 offset:32768
    s_waitcnt vmcnt(2)
    v_mov_b64 v[100:101], v[108:109]
    ds_read_b128 v[96:99], v8 offset:33792
    v_mov_b64 v[102:103], v[110:111]
    v_mov_b64 v[104:105], v[112:113]
    ds_read_b128 v[44:47], v8 offset:24576
    v_mov_b64 v[106:107], v[114:115]
    ds_read_b128 v[48:51], v8 offset:25600
    ds_read_b128 v[108:111], v8 offset:20480
    ds_read_b128 v[112:115], v8 offset:21504
    s_xor_b32 s25, s25, 0x40000
    s_xor_b32 s26, s26, 0x40000
    v_bfe_u32 v126, v1, 2, 6
    v_mov_b64 v[72:73], 0
    v_mov_b64 v[74:75], 0
    s_add_u32 s18, s18, 1
    s_xor_b32 s25, s25, 0x40000
    s_xor_b32 s26, s26, 0x40000
    s_add_u32 s19, s18, 2
    s_cmp_ge_u32 s19, s37
    s_cselect_b32 s36, s29, 0x7ff00000
    s_add_u32 s31, s31, 0x40000
    s_add_u32 s32, s32, 0x40000
    s_mov_b32 s21, 1
    s_mov_b32 s35, 1
    s_waitcnt vmcnt(2)
    v_mov_b64 v[128:129], v[116:117]
    v_mov_b64 v[130:131], v[118:119]
    v_mov_b64 v[132:133], v[120:121]
    v_mov_b64 v[134:135], v[122:123]
    ds_read_b128 v[116:119], v8 offset:22528
    ds_read_b128 v[120:123], v8 offset:23552
    s_waitcnt vmcnt(0)
    s_branch CSw3_Aw
    CSw3_Bf:
    s_add_u32 s35, s35, 1
    s_cmp_gt_u32 s35, 2
    s_cbranch_scc1 CSw3_Bre
    s_nop 6
    v_mov_b64 v[60:61], 0
    v_mov_b64 v[62:63], 0
    v_mov_b64 v[64:65], 0
    v_mov_b64 v[66:67], 0
    v_smfmac_f32_16x16x64_bf16 v[60:63], v[20:23], v[76:83], v3
    s_nop 0
    v_smfmac_f32_16x16x64_bf16 v[64:67], v[20:23], v[84:91], v3
    s_waitcnt vmcnt(3)
    s_branch CSw3_Bw
    CSw3_Are:
    s_waitcnt vmcnt(0)
    CSw3_Arl:
    s_mov_b64 exec, vcc
    buffer_load_dwordx4 v[20:23], v125, s[8:11], s23 offen offset:3072 sc1
    s_mov_b64 exec, -1
    buffer_load_dwordx4 v[24:27], v125, s[8:11], s30 offen offset:3072 sc1
    s_add_u32 s21, s21, 1
    s_cmp_gt_u32 s21, 400000
    s_cbranch_scc1 CS_fail
    s_waitcnt vmcnt(6)
    v_mov_b64 v[52:53], 0
    v_mov_b64 v[54:55], 0
    v_mov_b64 v[56:57], 0
    v_mov_b64 v[58:59], 0
    v_mov_b64 v[60:61], 0
    v_mov_b64 v[62:63], 0
    v_max3_u32 v124, v20, v21, v22
    v_max_u32 v124, v124, v23
    v_cmp_eq_u32 vcc, -1, v124
    s_cbranch_vccz CSw3_Adn
    CSw3_Ack:
    v_max3_u32 v124, v20, v21, v22
    v_max_u32 v124, v124, v23
    v_cmp_eq_u32 vcc, -1, v124
    s_cbranch_vccnz CSw3_Arl
    CSw3_Adn:
    v_smfmac_f32_16x16x64_bf16 v[52:55], v[20:23], v[108:115], v3
    ds_write_b128 v2, v[20:23] offset:6144
    v_smfmac_f32_16x16x64_bf16 v[56:59], v[20:23], v[116:123], v3
    buffer_load_dwordx4 v[24:27], v125, s[8:11], s30 offen offset:3072 sc1
    v_smfmac_f32_16x16x64_bf16 v[60:63], v[20:23], v[76:83], v3
    s_barrier
    buffer_load_dwordx4 v[108:111], v9, s[8:11], s31 offen sc1
    v_smfmac_f32_16x16x64_bf16 v[64:67], v[20:23], v[84:91], v3
    buffer_load_dwordx4 v[112:115], v9, s[8:11], s31 offen offset:2048 sc1
    v_smfmac_f32_16x16x64_bf16 v[68:71], v[20:23], v[92:99], v3
    buffer_load_dwordx4 v[116:119], v1, s[8:11], s32 offen sc1
    v_smfmac_f32_16x16x64_bf16 v[72:75], v[20:23], v[28:35], v3
    s_waitcnt lgkmcnt(0)
    s_barrier
    ds_read_b128 v[28:31], v2 offset:4096
    ds_read_b128 v[32:35], v2 offset:2048
    s_branch CSw3_Bck
    CSw3_Bre:
    CSw3_Brl:
    s_mov_b64 exec, vcc
    buffer_load_dwordx4 v[24:27], v125, s[8:11], s30 offen offset:3072 sc1
    s_mov_b64 exec, -1
    s_add_u32 s35, s35, 1
    s_cmp_gt_u32 s35, 400000
    s_cbranch_scc1 CS_fail
    s_waitcnt vmcnt(6)
    v_max3_u32 v124, v24, v25, v26
    v_max_u32 v124, v124, v27
    v_cmp_eq_u32 vcc, -1, v124
    s_cbranch_vccz CSw3_Bdn
    CSw3_Bck:
    v_max3_u32 v124, v24, v25, v26
    v_max_u32 v124, v124, v27
    v_cmp_eq_u32 vcc, -1, v124
    s_cbranch_vccnz CSw3_Brl
    CSw3_Bdn:
    ds_write_b128 v2, v[24:27] offset:7168
    v_mov_b64 v[60:61], 0
    v_mov_b64 v[62:63], 0
    v_mov_b64 v[64:65], 0
    v_mov_b64 v[66:67], 0
    v_smfmac_f32_16x16x64_bf16 v[60:63], v[20:23], v[76:83], v3
    s_nop 0
    v_smfmac_f32_16x16x64_bf16 v[64:67], v[20:23], v[84:91], v3
    v_smfmac_f32_16x16x64_bf16 v[60:63], v[24:27], a[96:103], v3
    v_smfmac_f32_16x16x64_bf16 v[64:67], v[24:27], a[104:111], v3
    s_waitcnt vmcnt(0)
    s_waitcnt lgkmcnt(0)
    s_branch CSw3_Bok
    CSw3_Pre:
    CSw3_Prl:
    s_mov_b64 exec, vcc
    buffer_load_dwordx4 v[128:131], v1, s[8:11], s25 offen offset:0 sc1
    buffer_load_dwordx4 v[132:135], v1, s[8:11], s25 offen offset:1024 sc1
    s_mov_b64 exec, -1
    s_add_u32 s21, s21, 1
    s_cmp_gt_u32 s21, 400000
    s_cbranch_scc1 CS_fail
    s_waitcnt vmcnt(8)
    v_max3_u32 v124, v128, v129, v130
    v_max3_u32 v126, v131, v132, v133
    v_max3_u32 v124, v124, v134, v135
    v_max_u32 v124, v124, v126
    v_cmp_eq_u32 vcc, -1, v124
    s_cbranch_vccz CSw3_Pdn
    CSw3_Pck:
    v_max3_u32 v124, v128, v129, v130
    v_max3_u32 v126, v131, v132, v133
    v_max3_u32 v124, v124, v134, v135
    v_max_u32 v124, v124, v126
    v_cmp_eq_u32 vcc, -1, v124
    s_cbranch_vccnz CSw3_Prl
    CSw3_Pdn:
    v_mfma_f32_16x16x32_bf16 v[24:27], v[72:75], v[128:131], 0
    v_mfma_f32_16x16x32_bf16 v[24:27], v[72:75], v[132:135], v[24:27]
    s_nop 7
    v_add_f32_dpp v24, v24, v24 row_ror:4 row_mask:0xf bank_mask:0xf
    v_add_f32_dpp v25, v25, v25 row_ror:4 row_mask:0xf bank_mask:0xf
    s_nop 0
    v_add_f32_dpp v24, v24, v24 row_ror:8 row_mask:0xf bank_mask:0xf
    v_add_f32_dpp v25, v25, v25 row_ror:8 row_mask:0xf bank_mask:0xf
    v_cvt_pk_bf16_f32 v124, v24, v25
    buffer_store_dword v124, v5, s[8:11], s23 offen sc1
    s_waitcnt vmcnt(1)
    s_branch CSw3_w2
.p2align 6
    CSw3_step:
    v_bfe_u32 v126, v1, 2, 6
    v_mov_b64 v[72:73], 0
    v_mov_b64 v[74:75], 0
    s_add_u32 s18, s18, 1
    buffer_load_dwordx4 v[20:23], v125, s[8:11], s23 offen offset:3072 sc1
    s_xor_b32 s25, s25, 0x40000
    buffer_load_dword v127, off, s[8:11], s23
    s_xor_b32 s26, s26, 0x40000
    s_add_u32 s19, s18, 2
    s_cmp_ge_u32 s19, s37
    s_cselect_b32 s36, s29, 0x7ff00000
    s_add_u32 s31, s31, 0x40000
    s_add_u32 s32, s32, 0x40000
    s_mov_b32 s21, 1
    s_mov_b32 s35, 1
    s_waitcnt vmcnt(3)
    v_mov_b64 v[128:129], v[116:117]
    v_mov_b64 v[130:131], v[118:119]
    v_mov_b64 v[132:133], v[120:121]
    v_mov_b64 v[134:135], v[122:123]
    ds_read_b128 v[116:119], v8 offset:22528
    ds_read_b128 v[120:123], v8 offset:23552
    s_nop 0
    s_nop 0
    s_nop 0
    s_nop 0
    s_nop 0
    s_nop 0
    s_nop 0
    buffer_load_dwordx4 v[20:23], v125, s[8:11], s23 offen offset:3072 sc1
    s_nop 0
    s_nop 0
    s_nop 0
    s_nop 0
    s_nop 0
    s_nop 0
    s_nop 0
    s_nop 0
    s_nop 0
    s_nop 0
    s_nop 0
    buffer_load_dwordx4 v[24:27], v125, s[8:11], s30 offen offset:3072 sc1
    s_branch CSw3_Aw
    CSw3_Af:
    v_mfma_f32_16x16x1_4b_f32 v[52:67], v126, v126, 0
    s_mov_b64 exec, vcc
    buffer_load_dwordx4 v[20:23], v125, s[8:11], s23 offen offset:3072 sc1
    s_mov_b64 exec, -1
    buffer_load_dwordx4 v[24:27], v125, s[8:11], s30 offen offset:3072 sc1
    s_add_u32 s21, s21, 1
    s_cmp_gt_u32 s21, 6
    s_cbranch_scc1 CSw3_Are
    s_nop 0
    s_nop 0
    s_nop 0
    CSw3_Aw:
    s_waitcnt vmcnt(3) lgkmcnt(0)
    v_fma_f32 v124, v20, v21, v22
    v_cmp_u_f32 vcc, v124, v23
    v_smfmac_f32_16x16x64_bf16 v[52:55], v[20:23], v[108:115], v3
    ds_write_b128 v2, v[20:23] offset:6144
    v_smfmac_f32_16x16x64_bf16 v[56:59], v[20:23], v[116:123], v3
    s_cbranch_vccnz CSw3_Af
    buffer_load_dwordx4 v[24:27], v125, s[8:11], s30 offen offset:3072 sc1
    v_smfmac_f32_16x16x64_bf16 v[60:63], v[20:23], v[76:83], v3
    s_barrier
    buffer_load_dwordx4 v[108:111], v9, s[8:11], s31 offen sc1
    v_smfmac_f32_16x16x64_bf16 v[64:67], v[20:23], v[84:91], v3
    buffer_load_dwordx4 v[112:115], v9, s[8:11], s31 offen offset:2048 sc1
    v_smfmac_f32_16x16x64_bf16 v[68:71], v[20:23], v[92:99], v3
    buffer_load_dwordx4 v[116:119], v1, s[8:11], s32 offen sc1
    v_smfmac_f32_16x16x64_bf16 v[72:75], v[20:23], v[28:35], v3
    s_waitcnt lgkmcnt(0)
    s_barrier
    ds_read_b128 v[28:31], v2 offset:4096
    ds_read_b128 v[32:35], v2 offset:2048
    CSw3_Bw:
    s_waitcnt vmcnt(4)
    v_fma_f32 v124, v24, v25, v26
    v_cmp_u_f32 vcc, v124, v27
    v_smfmac_f32_16x16x64_bf16 v[60:63], v[24:27], a[96:103], v3
    ds_write_b128 v2, v[24:27] offset:7168
    v_smfmac_f32_16x16x64_bf16 v[64:67], v[24:27], a[104:111], v3
    s_cbranch_vccnz CSw3_Bf
    CSw3_Bok:
    buffer_store_dwordx4 v[140:143], v1, s[8:11], s33 offen sc1
    buffer_load_dword v127, v126, s[8:11], s36 offen sc1
    v_smfmac_f32_16x16x64_bf16 v[52:55], v[24:27], v[44:51], v3
    s_mov_b32 s33, s34
    buffer_load_dwordx4 v[120:123], v1, s[8:11], s32 offen offset:1024 sc1
    v_mov_b64 v[140:141], -1
    v_smfmac_f32_16x16x64_bf16 v[56:59], v[24:27], v[36:43], v3
    ds_read_b128 v[36:39], v2 offset:0
    s_waitcnt lgkmcnt(3)
    v_smfmac_f32_16x16x64_bf16 v[52:55], v[28:31], a[0:7], v3
    s_add_u32 s34, s34, 0x20000
    v_mov_b64 v[142:143], -1
    v_smfmac_f32_16x16x64_bf16 v[56:59], v[28:31], a[8:15], v3
    s_waitcnt lgkmcnt(1)
    v_smfmac_f32_16x16x64_bf16 v[52:55], v[32:35], a[32:39], v3
    s_barrier
    ds_read_b128 v[44:47], v2 offset:5120
    v_smfmac_f32_16x16x64_bf16 v[56:59], v[32:35], a[40:47], v3
    s_waitcnt lgkmcnt(1)
    s_mov_b32 s19, s27
    ds_read_b128 v[40:43], v2 offset:3072
    v_smfmac_f32_16x16x64_bf16 v[52:55], v[36:39], a[64:71], v3
    s_add_u32 s20, s27, 0x10000
    s_add_u32 s38, s27, 0x20000
    ds_read_b128 v[48:51], v2 offset:1024
    v_smfmac_f32_16x16x64_bf16 v[56:59], v[36:39], a[72:79], v3
    s_add_u32 s22, s27, 0x30000
    s_xor_b32 s27, s27, 0x40000
    v_smfmac_f32_16x16x64_bf16 v[60:63], v[28:31], a[112:119], v3
    v_smfmac_f32_16x16x64_bf16 v[60:63], v[36:39], a[144:151], v3
    ds_read_b128 v[76:79], v8 offset:0
    v_smfmac_f32_16x16x64_bf16 v[64:67], v[28:31], a[120:127], v3
    s_waitcnt lgkmcnt(2)
    v_smfmac_f32_16x16x64_bf16 v[52:55], v[44:47], a[16:23], v3
    ds_read_b128 v[80:83], v8 offset:1024
    v_smfmac_f32_16x16x64_bf16 v[52:55], v[40:43], a[48:55], v3
    s_waitcnt lgkmcnt(2)
    ds_read_b128 v[84:87], v8 offset:4096
    v_smfmac_f32_16x16x64_bf16 v[52:55], v[48:51], a[80:87], v3
    ds_read_b128 v[88:91], v8 offset:5120
    v_smfmac_f32_16x16x64_bf16 v[56:59], v[44:47], a[24:31], v3
    ds_read_b128 v[92:95], v8 offset:2048
    v_smfmac_f32_16x16x64_bf16 v[56:59], v[40:43], a[56:63], v3
    ds_read_b128 v[96:99], v8 offset:3072
    v_add_f32 v52, v52, v54
    v_smfmac_f32_16x16x64_bf16 v[56:59], v[48:51], a[88:95], v3
    s_waitcnt lgkmcnt(4)
    v_add_f32 v53, v53, v55
    v_smfmac_f32_16x16x64_bf16 v[60:63], v[32:35], v[76:83], v3
    s_waitcnt lgkmcnt(2)
    v_cvt_pk_bf16_f32 v54, v52, v53
    v_smfmac_f32_16x16x64_bf16 v[60:63], v[40:43], v[84:91], v3
    v_add_f32 v56, v56, v58
    v_add_f32 v57, v57, v59
    v_cvt_pk_bf16_f32 v55, v56, v57
    v_smfmac_f32_16x16x64_bf16 v[60:63], v[44:47], a[128:135], v3
    ds_write_b64 v6, v[54:55]
    v_smfmac_f32_16x16x64_bf16 v[60:63], v[48:51], a[160:167], v3
    s_waitcnt lgkmcnt(1)
    ds_read_b128 v[52:55], v8 offset:8192
    v_mov_b32 v88, v7
    v_smfmac_f32_16x16x64_bf16 v[64:67], v[32:35], v[92:99], v3
    ds_read_b128 v[56:59], v8 offset:9216
    v_mov_b32 v89, v7
    v_smfmac_f32_16x16x64_bf16 v[64:67], v[40:43], v[12:19], v3
    ds_read_b128 v[92:95], v8 offset:10240
    v_add_f32 v60, v60, v62
    v_smfmac_f32_16x16x64_bf16 v[64:67], v[36:39], a[152:159], v3
    s_waitcnt lgkmcnt(3)
    s_barrier
    ds_read_b64_tr_b16 v[76:77], v10 offset:0
    ds_read_b64_tr_b16 v[78:79], v10 offset:1024
    v_smfmac_f32_16x16x64_bf16 v[64:67], v[44:47], a[136:143], v3
    ds_read_b64_tr_b16 v[80:81], v10 offset:2048
    ds_read_b64_tr_b16 v[82:83], v10 offset:3072
    v_smfmac_f32_16x16x64_bf16 v[64:67], v[48:51], a[168:175], v3
    ds_read_b128 v[96:99], v8 offset:11264
    v_add_f32 v61, v61, v63
    v_cvt_pk_bf16_f32 v60, v60, v61
    v_smfmac_f32_16x16x64_bf16 v[68:71], v[24:27], a[176:183], v3
    s_waitcnt lgkmcnt(3)
    v_mfma_f32_16x16x32_bf16 v[84:87], v[100:103], v[76:79], 0
    buffer_store_dword v140, v5, s[8:11], s24 offen sc1
    v_add_f32 v64, v64, v66
    v_add_f32 v65, v65, v67
    v_cvt_pk_bf16_f32 v62, v64, v65
    s_waitcnt lgkmcnt(1)
    v_mfma_f32_16x16x32_bf16 v[84:87], v[104:107], v[80:83], v[84:87]
    ds_write2_b32 v6, v60, v62 offset0:128 offset1:129
    v_smfmac_f32_16x16x64_bf16 v[72:75], v[24:27], a[184:191], v3
    ds_read_b128 v[100:103], v8 offset:6144
    v_mov_b64 v[104:105], 0
    v_smfmac_f32_16x16x64_bf16 v[68:71], v[40:43], v[52:59], v3
    s_waitcnt lgkmcnt(2)
    buffer_store_dwordx4 v[140:143], v1, s[8:11], s26 offen sc1
    v_fmac_f32_dpp v88, v84, v0 quad_perm:[0,1,0,1] row_mask:0xf bank_mask:0xf
    v_fmac_f32_dpp v89, v85, v0 quad_perm:[0,1,0,1] row_mask:0xf bank_mask:0xf
    v_smfmac_f32_16x16x64_bf16 v[72:75], v[40:43], v[92:99], v3
    s_waitcnt vmcnt(8)
    v_fmac_f32_dpp v88, v86, v0 quad_perm:[2,3,2,3] row_mask:0xf bank_mask:0xf
    v_fmac_f32_dpp v89, v87, v0 quad_perm:[2,3,2,3] row_mask:0xf bank_mask:0xf
    v_smfmac_f32_16x16x64_bf16 v[68:71], v[36:39], a[240:247], v3
    v_mov_b64 v[106:107], 0
    v_smfmac_f32_16x16x64_bf16 v[72:75], v[36:39], a[248:255], v3
    s_waitcnt lgkmcnt(1)
    s_barrier
    buffer_store_dwordx4 v[140:143], v1, s[8:11], s26 offen offset:1024 sc1
    ds_read_b64_tr_b16 v[20:21], v10 offset:512
    v_exp_f32 v90, v88
    v_smfmac_f32_16x16x64_bf16 v[68:71], v[28:31], a[192:199], v3
    ds_read_b64_tr_b16 v[22:23], v10 offset:1536
    ds_read_b64_tr_b16 v[24:25], v10 offset:2560
    ds_read_b64_tr_b16 v[26:27], v10 offset:3584
    v_exp_f32 v91, v89
    s_nop 0
    v_cvt_pk_bf16_f32 v90, v90, v91
    v_mov_b64 v[40:41], 0
    v_mov_b64 v[42:43], 0
    v_mov_b32 v140, 0
    v_smfmac_f32_16x16x64_bf16 v[72:75], v[28:31], a[200:207], v3
    ds_write_b32 v11, v90
    v_smfmac_f32_16x16x64_bf16 v[68:71], v[32:35], a[224:231], v3
    s_cmp_eq_u32 s18, 63
    s_waitcnt lgkmcnt(3)
    v_mfma_f32_16x16x32_bf16 v[92:95], v[20:23], v[76:79], 0
    v_mov_b32 v142, v7
    s_waitcnt lgkmcnt(1)
    v_mfma_f32_16x16x32_bf16 v[92:95], v[24:27], v[80:83], v[92:95]
    v_mov_b32 v143, v7
    v_mov_b64 v[36:37], 0
    v_mov_b64 v[38:39], 0
    v_smfmac_f32_16x16x64_bf16 v[72:75], v[32:35], a[232:239], v3
    s_waitcnt lgkmcnt(0)
    s_barrier
    ds_read_b128 v[84:87], v2
    v_smfmac_f32_16x16x64_bf16 v[68:71], v[44:47], a[208:215], v3
    v_fmac_f32_dpp v142, v92, v0 quad_perm:[0,1,0,1] row_mask:0xf bank_mask:0xf
    v_smfmac_f32_16x16x64_bf16 v[68:71], v[48:51], v[144:151], v3
    v_fmac_f32_dpp v143, v93, v0 quad_perm:[0,1,0,1] row_mask:0xf bank_mask:0xf
    v_fmac_f32_dpp v142, v94, v0 quad_perm:[2,3,2,3] row_mask:0xf bank_mask:0xf
    v_smfmac_f32_16x16x64_bf16 v[72:75], v[44:47], a[216:223], v3
    s_waitcnt lgkmcnt(0)
    v_fmac_f32_dpp v143, v95, v0 quad_perm:[2,3,2,3] row_mask:0xf bank_mask:0xf
    v_mfma_f32_16x16x32_bf16 v[64:67], v[136:139], v[84:87], 0
    v_exp_f32 v142, v142
    v_mfma_f32_16x16x32_bf16 v[52:55], v[128:131], v[84:87], 0
    v_exp_f32 v143, v143
    v_mfma_f32_16x16x32_bf16 v[56:59], v[132:135], v[84:87], 0
    v_cvt_pk_bf16_f32 v141, v142, v143
    v_add_f32 v68, v68, v70
    v_smfmac_f32_16x16x64_bf16 v[72:75], v[48:51], v[152:159], v3
    ds_read_b128 v[28:31], v8 offset:12288
    v_add_f32 v69, v69, v71
    v_mfma_f32_16x16x16_bf16 v[64:67], v[136:137], v[140:141], v[64:67]
    ds_read_b128 v[32:35], v8 offset:13312
    v_cvt_pk_bf16_f32 v61, v68, v69
    s_nop 1
    v_mfma_f32_16x16x16_bf16 v[52:55], v[60:61], v[140:141], v[52:55]
    v_add_f32 v72, v72, v74
    v_add_f32 v73, v73, v75
    v_cvt_pk_bf16_f32 v63, v72, v73
    s_cbranch_scc1 CSw3_last
    s_nop 0
    v_mfma_f32_16x16x16_bf16 v[56:59], v[62:63], v[140:141], v[56:59]
    v_rcp_f32 v64, v64
    s_nop 0
    v_pk_mul_f32 v[52:53], v[52:53], v[64:65] op_sel_hi:[1,0]
    v_pk_mul_f32 v[54:55], v[54:55], v[64:65] op_sel_hi:[1,0]
    v_cvt_pk_bf16_f32 v52, v52, v53
    v_cvt_pk_bf16_f32 v53, v54, v55
    ds_write_b64 v2, v[52:53] offset:11264
    s_nop 0
    v_pk_mul_f32 v[56:57], v[56:57], v[64:65] op_sel_hi:[1,0]
    v_pk_mul_f32 v[58:59], v[58:59], v[64:65] op_sel_hi:[1,0]
    v_cvt_pk_bf16_f32 v54, v56, v57
    v_cvt_pk_bf16_f32 v55, v58, v59
    ds_write_b64 v2, v[54:55] offset:11272
    s_nop 0
    v_smfmac_f32_16x16x64_bf16 v[100:103], v[52:55], v[160:167], v3
    v_log_f32 v65, v65
    v_smfmac_f32_16x16x64_bf16 v[104:107], v[52:55], v[192:199], v3
    v_cmp_nle_f32 vcc, |v65|, s64
    v_smfmac_f32_16x16x64_bf16 v[36:39], v[52:55], v[224:231], v3
    s_cbranch_vccnz CSw3_fix
    CSw3_fixed:
    s_waitcnt lgkmcnt(0)
    s_barrier
    ds_read_b128 v[68:71], v2 offset:10240
    ds_read_b128 v[72:75], v2 offset:9216
    ds_read_b128 v[96:99], v2 offset:8192
    v_smfmac_f32_16x16x64_bf16 v[40:43], v[52:55], v[240:247], v3
    ds_read_b128 v[20:23], v8 offset:14336
    s_waitcnt lgkmcnt(3)
    v_smfmac_f32_16x16x64_bf16 v[100:103], v[68:71], v[168:175], v3
    ds_read_b128 v[24:27], v8 offset:15360
    s_waitcnt lgkmcnt(3)
    v_smfmac_f32_16x16x64_bf16 v[100:103], v[72:75], v[176:183], v3
    ds_read_b128 v[76:79], v8 offset:16384
    s_waitcnt lgkmcnt(3)
    v_smfmac_f32_16x16x64_bf16 v[100:103], v[96:99], v[184:191], v3
    ds_read_b128 v[44:47], v8 offset:18432
    ds_read_b128 v[80:83], v8 offset:17408
    v_smfmac_f32_16x16x64_bf16 v[104:107], v[68:71], v[200:207], v3
    s_mov_b32 s24, s23
    s_add_u32 s23, s23, 0x2000
    s_bitset0_b32 s23, 15
    v_smfmac_f32_16x16x64_bf16 v[104:107], v[72:75], v[208:215], v3
    s_add_u32 s30, s23, 0x1000
    ds_read_b128 v[48:51], v8 offset:19456
    v_cvt_pk_bf16_f32 v100, v100, v102
    v_cvt_pk_bf16_f32 v101, v101, v103
    v_smfmac_f32_16x16x64_bf16 v[104:107], v[96:99], v[216:223], v3
    buffer_store_dword v100, v4, s[8:11], s19 offen offset:0 sc1
    buffer_store_dword v101, v4, s[8:11], s19 offen offset:2048 sc1
    v_smfmac_f32_16x16x64_bf16 v[36:39], v[68:71], v[232:239], v3
    s_mov_b32 s21, 1
    v_sub_f32 v7, v7, v65
    v_smfmac_f32_16x16x64_bf16 v[36:39], v[72:75], v[28:35], v3
    s_waitcnt lgkmcnt(1)
    v_cvt_pk_bf16_f32 v104, v104, v106
    v_cvt_pk_bf16_f32 v105, v105, v107
    v_smfmac_f32_16x16x64_bf16 v[36:39], v[96:99], v[20:27], v3
    buffer_store_dword v104, v4, s[8:11], s20 offen offset:0 sc1
    buffer_store_dword v105, v4, s[8:11], s20 offen offset:2048 sc1
    v_smfmac_f32_16x16x64_bf16 v[40:43], v[68:71], v[248:255], v3
    v_smfmac_f32_16x16x64_bf16 v[40:43], v[72:75], v[76:83], v3
    s_waitcnt lgkmcnt(0)
    v_cvt_pk_bf16_f32 v36, v36, v38
    v_cvt_pk_bf16_f32 v37, v37, v39
    v_smfmac_f32_16x16x64_bf16 v[40:43], v[96:99], v[44:51], v3
    buffer_store_dword v36, v4, s[8:11], s38 offen offset:0 sc1
    buffer_store_dword v37, v4, s[8:11], s38 offen offset:2048 sc1
    s_nop 5
    v_cvt_pk_bf16_f32 v40, v40, v42
    v_cvt_pk_bf16_f32 v41, v41, v43
    buffer_store_dword v40, v4, s[8:11], s22 offen offset:0 sc1
    buffer_store_dword v41, v4, s[8:11], s22 offen offset:2048 sc1
    ds_read_b128 v[72:75], v8 offset:7168
    v_pk_mov_b32 v[140:141], v[60:61], v[62:63] op_sel:[0,0]
    ds_read_b128 v[28:31], v8 offset:34816
    v_pk_mov_b32 v[142:143], v[60:61], v[62:63] op_sel:[1,1]
    ds_read_b128 v[32:35], v8 offset:35840
    v_bfe_u32 v126, v1, 2, 6
    ds_read_b128 v[36:39], v8 offset:26624
    v_mov_b64 v[68:69], 0
    ds_read_b128 v[40:43], v8 offset:27648
    v_mov_b64 v[70:71], 0
    ds_read_b128 v[76:79], v8 offset:28672
    v_mfma_f32_16x16x1_4b_f32 v[52:67], v126, v126, 0
    ds_read_b128 v[80:83], v8 offset:29696
    ds_read_b128 v[84:87], v8 offset:30720
    ds_read_b128 v[88:91], v8 offset:31744
    s_nop 0
    s_nop 0
    s_nop 0
    s_nop 0
    s_nop 0
    s_nop 0
    s_nop 0
    s_nop 0
    s_nop 0
    s_nop 0
    s_nop 0
    s_nop 0
    s_nop 0
    s_nop 0
    s_nop 0
    s_nop 0
    s_nop 0
    s_nop 0
    s_nop 0
    s_nop 0
    s_nop 0
    s_nop 0
    s_nop 0
    s_nop 0
    s_nop 0
    s_nop 0
    s_nop 0
    s_nop 0
    s_nop 0
    s_nop 0
    s_nop 0
    s_nop 0
    buffer_load_dwordx4 v[128:131], v1, s[8:11], s25 offen offset:0 sc1
    buffer_load_dwordx4 v[132:135], v1, s[8:11], s25 offen offset:1024 sc1
    ds_read_b128 v[92:95], v8 offset:32768
    s_waitcnt vmcnt(17)
    v_mov_b64 v[100:101], v[108:109]
    ds_read_b128 v[96:99], v8 offset:33792
    v_mov_b64 v[102:103], v[110:111]
    v_mov_b64 v[104:105], v[112:113]
    ds_read_b128 v[44:47], v8 offset:24576
    v_mov_b64 v[106:107], v[114:115]
    ds_read_b128 v[48:51], v8 offset:25600
    ds_read_b128 v[108:111], v8 offset:20480
    ds_read_b128 v[112:115], v8 offset:21504
    s_add_u32 s19, s18, 2
    s_cmp_ge_u32 s19, s37
    s_cbranch_scc1 CSw3_kvw
    CSw3_kvok:
    s_nop 0
    s_nop 0
    s_nop 0
    s_nop 0
    s_nop 0
    s_nop 0
    s_nop 0
    s_nop 0
    s_nop 0
    s_nop 0
    s_nop 0
    s_nop 0
    s_nop 0
    s_nop 0
    buffer_load_dwordx4 v[128:131], v1, s[8:11], s25 offen offset:0 sc1
    buffer_load_dwordx4 v[132:135], v1, s[8:11], s25 offen offset:1024 sc1
    s_branch CSw3_Pw
    CSw3_Pf:
    s_add_u32 s21, s21, 1
    v_max3_u32 v124, v128, v129, v130
    v_max3_u32 v126, v131, v132, v133
    v_max3_u32 v124, v124, v134, v135
    v_max_u32 v124, v124, v126
    v_cmp_eq_u32 vcc, -1, v124
    s_nop 0
    s_mov_b64 exec, vcc
    buffer_load_dwordx4 v[128:131], v1, s[8:11], s25 offen offset:0 sc1
    buffer_load_dwordx4 v[132:135], v1, s[8:11], s25 offen offset:1024 sc1
    s_mov_b64 exec, -1
    s_cmp_gt_u32 s21, 4
    s_cbranch_scc1 CSw3_Pre
    CSw3_Pw:
    s_waitcnt vmcnt(3) lgkmcnt(0)
    CSw3_P:
    v_mfma_f32_16x16x32_bf16 v[24:27], v[72:75], v[128:131], 0
    s_waitcnt vmcnt(2)
    v_mfma_f32_16x16x32_bf16 v[24:27], v[72:75], v[132:135], v[24:27]
    s_nop 7
    v_cmp_u_f32 vcc, v24, v24
    v_add_f32_dpp v24, v24, v24 row_ror:4 row_mask:0xf bank_mask:0xf
    v_add_f32_dpp v25, v25, v25 row_ror:4 row_mask:0xf bank_mask:0xf
    s_nop 0
    v_add_f32_dpp v24, v24, v24 row_ror:8 row_mask:0xf bank_mask:0xf
    v_add_f32_dpp v25, v25, v25 row_ror:8 row_mask:0xf bank_mask:0xf
    v_cvt_pk_bf16_f32 v124, v24, v25
    s_cbranch_vccnz CSw3_Pf
    buffer_store_dword v124, v5, s[8:11], s23 offen sc1
    CSw3_w2:
    s_branch CSw3_step
    CSw3_kvw:
    s_mov_b32 s21, 0
    s_waitcnt vmcnt(14)
    s_branch CSw3_kvl_chk
    v_lshrrev_b32 v126, 2, v1
    v_and_b32 v126, 63, v126
    s_mov_b32 s21, 0
    CSw3_kvl:
    buffer_load_dword v127, v126, s[8:11], s29 offen sc1
    s_add_u32 s21, s21, 1
    s_cmp_gt_u32 s21, 400000
    s_cbranch_scc1 CS_fail
    s_waitcnt vmcnt(0)
    CSw3_kvl_chk:
    v_min_u32_dpp v127, v127, v127 row_ror:8 row_mask:0xf bank_mask:0xf
    s_nop 1
    v_min_u32_dpp v127, v127, v127 row_ror:4 row_mask:0xf bank_mask:0xf
    s_nop 1
    v_min_u32_dpp v127, v127, v127 row_ror:2 row_mask:0xf bank_mask:0xf
    s_nop 1
    v_min_u32_dpp v127, v127, v127 row_ror:1 row_mask:0xf bank_mask:0xf
    s_nop 0
    v_readfirstlane_b32 s37, v127
    s_nop 0
    s_lshl_b32 s37, s37, 2
    s_cmp_ge_u32 s19, s37
    s_cbranch_scc1 CSw3_kvl
    s_cmp_ge_u32 s37, 12
    s_cselect_b32 s21, 12, 0
    s_cmp_ge_u32 s37, 44
    s_cselect_b32 s21, 44, s21
    s_cmp_ge_u32 s37, 64
    s_cselect_b32 s21, 1000, s21
    s_cmp_gt_u32 s21, s19
    s_cselect_b32 s37, s21, s37
    s_mov_b32 s21, 1
    s_branch CSw3_kvok
    CSw3_last:
    v_mov_b32 v124, v61
    v_mov_b32 v61, v62
    v_mov_b32 v62, v124
    buffer_store_dwordx4 v[60:63], v1, s[8:11], s33 offen sc1
    s_branch CS_done
    CSw3_fix:
    v_and_b32 v124, 0x3ff, v11
    v_lshlrev_b32 v124, 1, v124
    v_add_u32 v124, 0x24800, v124
    v_lshlrev_b32 v126, 1, v1
    v_add_u32 v126, 0x24800, v126
    ds_write_b64 v124, v[88:89]
    v_mov_b32 v142, v7
    v_mov_b32 v143, v7
    s_waitcnt lgkmcnt(0)
    s_barrier
    ds_read_b128 v[68:71], v126
    ds_read_b128 v[72:75], v126 offset:16
    v_fmac_f32_dpp v142, v92, v0 quad_perm:[0,1,0,1] row_mask:0xf bank_mask:0xf
    v_fmac_f32_dpp v143, v93, v0 quad_perm:[0,1,0,1] row_mask:0xf bank_mask:0xf
    s_nop 0
    v_fmac_f32_dpp v142, v94, v0 quad_perm:[2,3,2,3] row_mask:0xf bank_mask:0xf
    v_fmac_f32_dpp v143, v95, v0 quad_perm:[2,3,2,3] row_mask:0xf bank_mask:0xf
    s_waitcnt lgkmcnt(0)
    v_max3_f32 v124, v68, v69, v70
    v_max3_f32 v124, v124, v71, v72
    v_max3_f32 v124, v124, v73, v74
    v_max3_f32 v124, v124, v75, v142
    v_max_f32 v124, v124, v143
    v_mov_b32 v126, v124
    s_nop 1
    v_permlane32_swap_b32 v124, v126
    v_max_f32 v124, v124, v126
    v_mov_b32 v126, v124
    s_nop 1
    v_permlane16_swap_b32 v124, v126
    v_max_f32 v124, v124, v126
    v_sub_f32 v7, v7, v124
    v_sub_f32 v68, v68, v124
    v_sub_f32 v69, v69, v124
    v_sub_f32 v70, v70, v124
    v_sub_f32 v71, v71, v124
    v_sub_f32 v72, v72, v124
    v_sub_f32 v73, v73, v124
    v_sub_f32 v74, v74, v124
    v_sub_f32 v75, v75, v124
    v_sub_f32 v142, v142, v124
    v_sub_f32 v143, v143, v124
    v_exp_f32 v68, v68
    v_exp_f32 v69, v69
    v_exp_f32 v70, v70
    v_exp_f32 v71, v71
    v_exp_f32 v72, v72
    v_exp_f32 v73, v73
    v_exp_f32 v74, v74
    v_exp_f32 v75, v75
    v_exp_f32 v142, v142
    v_exp_f32 v143, v143
    v_cvt_pk_bf16_f32 v84, v68, v69
    v_cvt_pk_bf16_f32 v85, v70, v71
    v_cvt_pk_bf16_f32 v86, v72, v73
    v_cvt_pk_bf16_f32 v87, v74, v75
    v_cvt_pk_bf16_f32 v141, v142, v143
    s_nop 0
    v_mfma_f32_16x16x32_bf16 v[64:67], v[136:139], v[84:87], 0
    v_mfma_f32_16x16x32_bf16 v[52:55], v[128:131], v[84:87], 0
    v_mfma_f32_16x16x32_bf16 v[56:59], v[132:135], v[84:87], 0
    v_mfma_f32_16x16x16_bf16 v[64:67], v[136:137], v[140:141], v[64:67]
    v_mfma_f32_16x16x16_bf16 v[52:55], v[60:61], v[140:141], v[52:55]
    v_mfma_f32_16x16x16_bf16 v[56:59], v[62:63], v[140:141], v[56:59]
    v_rcp_f32 v64, v64
    s_nop 2
    v_pk_mul_f32 v[52:53], v[52:53], v[64:65] op_sel_hi:[1,0]
    v_pk_mul_f32 v[54:55], v[54:55], v[64:65] op_sel_hi:[1,0]
    v_cvt_pk_bf16_f32 v52, v52, v53
    v_cvt_pk_bf16_f32 v53, v54, v55
    v_pk_mul_f32 v[56:57], v[56:57], v[64:65] op_sel_hi:[1,0]
    v_pk_mul_f32 v[58:59], v[58:59], v[64:65] op_sel_hi:[1,0]
    v_cvt_pk_bf16_f32 v54, v56, v57
    v_cvt_pk_bf16_f32 v55, v58, v59
    ds_write_b64 v2, v[52:53] offset:11264
    ds_write_b64 v2, v[54:55] offset:11272
    v_mov_b64 v[100:101], 0
    v_mov_b64 v[102:103], 0
    v_mov_b64 v[104:105], 0
    v_mov_b64 v[106:107], 0
    v_mov_b64 v[36:37], 0
    v_mov_b64 v[38:39], 0
    v_log_f32 v65, v65
    v_smfmac_f32_16x16x64_bf16 v[100:103], v[52:55], v[160:167], v3
    v_smfmac_f32_16x16x64_bf16 v[104:107], v[52:55], v[192:199], v3
    v_smfmac_f32_16x16x64_bf16 v[36:39], v[52:55], v[224:231], v3
    s_waitcnt lgkmcnt(0)
    s_branch CSw3_fixed
    CS_fail:
    s_branch F_fail
    CS_done:
    v_mov_b32 v32, 64
    s_waitcnt vmcnt(0)
    s_mov_b64 exec, 1
    buffer_store_dword v32, v1, s[8:11], s28 offen sc1
    s_mov_b64 exec, -1
    s_endpgm
    F_worker:
    s_sub_u32 s40, s16, 32
    v_and_b32 v120, 15, v1
    v_lshrrev_b32 v121, 4, v1
    v_lshrrev_b32 v122, 2, v120
    v_and_b32 v123, 3, v120
    s_load_dwordx2 s[20:21], s[0:1], 0
    s_waitcnt lgkmcnt(0)
    s_mov_b32 s76, s20
    s_and_b32 s77, s21, 0xffff
    s_mov_b32 s78, 0x200000
    s_mov_b32 s79, 0x00020000
    s_sub_u32 s41, 223, s40
    s_cmp_lt_u32 s40, 128
    s_cbranch_scc1 W_kv
    s_lshl_b32 s19, s41, 14
    s_lshl_b32 s20, s17, 8
    s_add_u32 s19, s19, s20
    v_lshlrev_b32 v72, 10, v120
    v_lshl_add_u32 v72, v121, 4, v72
    buffer_load_dwordx4 v[24:27], v72, s[76:79], s19 offen offset:0
    buffer_load_dwordx4 v[28:31], v72, s[76:79], s19 offen offset:64
    buffer_load_dwordx4 v[32:35], v72, s[76:79], s19 offen offset:128
    buffer_load_dwordx4 v[36:39], v72, s[76:79], s19 offen offset:192
    s_load_dwordx2 s[20:21], s[0:1], 40
    s_waitcnt lgkmcnt(0)
    s_mov_b32 s76, s20
    s_and_b32 s77, s21, 0xffff
    s_mov_b32 s78, 0x400000
    s_mov_b32 s79, 0x00020000
    s_sub_u32 s19, s40, 128
    s_lshl_b32 s19, s19, 16
    v_lshlrev_b32 v76, 7, v0
    buffer_load_dword v77, v76, s[76:79], s19 offen
    s_add_u32 s19, s19, 0x8000
    buffer_load_dword v78, v76, s[76:79], s19 offen
    s_lshl_b32 s20, s17, 6
    v_lshlrev_b32 v73, 2, v120
    v_add_u32 v73, 0x27040, v73
    v_add_u32 v74, s20, v73
    s_waitcnt vmcnt(2)
    v_lshlrev_b32 v40, 16, v24
    v_and_b32 v41, 0xffff0000, v24
    v_lshlrev_b32 v42, 16, v25
    v_and_b32 v43, 0xffff0000, v25
    v_lshlrev_b32 v44, 16, v26
    v_and_b32 v45, 0xffff0000, v26
    v_lshlrev_b32 v46, 16, v27
    v_and_b32 v47, 0xffff0000, v27
    v_lshlrev_b32 v48, 16, v28
    v_and_b32 v49, 0xffff0000, v28
    v_lshlrev_b32 v50, 16, v29
    v_and_b32 v51, 0xffff0000, v29
    v_lshlrev_b32 v52, 16, v30
    v_and_b32 v53, 0xffff0000, v30
    v_lshlrev_b32 v54, 16, v31
    v_and_b32 v55, 0xffff0000, v31
    v_lshlrev_b32 v56, 16, v32
    v_and_b32 v57, 0xffff0000, v32
    v_lshlrev_b32 v58, 16, v33
    v_and_b32 v59, 0xffff0000, v33
    v_lshlrev_b32 v60, 16, v34
    v_and_b32 v61, 0xffff0000, v34
    v_lshlrev_b32 v62, 16, v35
    v_and_b32 v63, 0xffff0000, v35
    v_lshlrev_b32 v64, 16, v36
    v_and_b32 v65, 0xffff0000, v36
    v_lshlrev_b32 v66, 16, v37
    v_and_b32 v67, 0xffff0000, v37
    v_lshlrev_b32 v68, 16, v38
    v_and_b32 v69, 0xffff0000, v38
    v_lshlrev_b32 v70, 16, v39
    v_and_b32 v71, 0xffff0000, v39
    v_pk_add_f32 v[24:25], v[40:41], v[42:43]
    v_pk_add_f32 v[24:25], v[24:25], v[44:45]
    v_pk_add_f32 v[24:25], v[24:25], v[46:47]
    v_pk_add_f32 v[24:25], v[24:25], v[48:49]
    v_pk_add_f32 v[24:25], v[24:25], v[50:51]
    v_pk_add_f32 v[24:25], v[24:25], v[52:53]
    v_pk_add_f32 v[24:25], v[24:25], v[54:55]
    v_pk_add_f32 v[24:25], v[24:25], v[56:57]
    v_pk_add_f32 v[24:25], v[24:25], v[58:59]
    v_pk_add_f32 v[24:25], v[24:25], v[60:61]
    v_pk_add_f32 v[24:25], v[24:25], v[62:63]
    v_pk_add_f32 v[24:25], v[24:25], v[64:65]
    v_pk_add_f32 v[24:25], v[24:25], v[66:67]
    v_pk_add_f32 v[24:25], v[24:25], v[68:69]
    v_pk_add_f32 v[24:25], v[24:25], v[70:71]
    v_add_f32 v24, v24, v25
    v_mov_b32 v25, v24
    s_nop 1
    v_permlane32_swap_b32 v24, v25
    v_add_f32 v24, v24, v25
    v_mov_b32 v25, v24
    s_nop 1
    v_permlane16_swap_b32 v24, v25
    v_add_f32 v24, v24, v25
    ds_write_b32 v74, v24
    s_waitcnt lgkmcnt(0)
    s_barrier
    ds_read_b32 v24, v73
    ds_read_b32 v25, v73 offset:64
    ds_read_b32 v26, v73 offset:128
    ds_read_b32 v27, v73 offset:192
    s_waitcnt lgkmcnt(0)
    v_add_f32 v24, v24, v25
    v_add_f32 v26, v26, v27
    v_add_f32 v24, v24, v26
    v_mul_f32 v24, 0x3b000000, v24
    v_mov_b32 v26, 0
    v_mov_b32 v27, 0
    v_sub_f32 v28, v40, v24
    v_fmac_f32 v26, v28, v28
    v_sub_f32 v28, v41, v24
    v_fmac_f32 v27, v28, v28
    v_sub_f32 v28, v42, v24
    v_fmac_f32 v26, v28, v28
    v_sub_f32 v28, v43, v24
    v_fmac_f32 v27, v28, v28
    v_sub_f32 v28, v44, v24
    v_fmac_f32 v26, v28, v28
    v_sub_f32 v28, v45, v24
    v_fmac_f32 v27, v28, v28
    v_sub_f32 v28, v46, v24
    v_fmac_f32 v26, v28, v28
    v_sub_f32 v28, v47, v24
    v_fmac_f32 v27, v28, v28
    v_sub_f32 v28, v48, v24
    v_fmac_f32 v26, v28, v28
    v_sub_f32 v28, v49, v24
    v_fmac_f32 v27, v28, v28
    v_sub_f32 v28, v50, v24
    v_fmac_f32 v26, v28, v28
    v_sub_f32 v28, v51, v24
    v_fmac_f32 v27, v28, v28
    v_sub_f32 v28, v52, v24
    v_fmac_f32 v26, v28, v28
    v_sub_f32 v28, v53, v24
    v_fmac_f32 v27, v28, v28
    v_sub_f32 v28, v54, v24
    v_fmac_f32 v26, v28, v28
    v_sub_f32 v28, v55, v24
    v_fmac_f32 v27, v28, v28
    v_sub_f32 v28, v56, v24
    v_fmac_f32 v26, v28, v28
    v_sub_f32 v28, v57, v24
    v_fmac_f32 v27, v28, v28
    v_sub_f32 v28, v58, v24
    v_fmac_f32 v26, v28, v28
    v_sub_f32 v28, v59, v24
    v_fmac_f32 v27, v28, v28
    v_sub_f32 v28, v60, v24
    v_fmac_f32 v26, v28, v28
    v_sub_f32 v28, v61, v24
    v_fmac_f32 v27, v28, v28
    v_sub_f32 v28, v62, v24
    v_fmac_f32 v26, v28, v28
    v_sub_f32 v28, v63, v24
    v_fmac_f32 v27, v28, v28
    v_sub_f32 v28, v64, v24
    v_fmac_f32 v26, v28, v28
    v_sub_f32 v28, v65, v24
    v_fmac_f32 v27, v28, v28
    v_sub_f32 v28, v66, v24
    v_fmac_f32 v26, v28, v28
    v_sub_f32 v28, v67, v24
    v_fmac_f32 v27, v28, v28
    v_sub_f32 v28, v68, v24
    v_fmac_f32 v26, v28, v28
    v_sub_f32 v28, v69, v24
    v_fmac_f32 v27, v28, v28
    v_sub_f32 v28, v70, v24
    v_fmac_f32 v26, v28, v28
    v_sub_f32 v28, v71, v24
    v_fmac_f32 v27, v28, v28
    v_add_f32 v26, v26, v27
    v_mov_b32 v27, v26
    s_nop 1
    v_permlane32_swap_b32 v26, v27
    v_add_f32 v26, v26, v27
    v_mov_b32 v27, v26
    s_nop 1
    v_permlane16_swap_b32 v26, v27
    v_add_f32 v26, v26, v27
    ds_write_b32 v74, v26 offset:256
    s_waitcnt lgkmcnt(0)
    s_barrier
    ds_read_b32 v26, v73 offset:256
    ds_read_b32 v27, v73 offset:320
    ds_read_b32 v28, v73 offset:384
    ds_read_b32 v29, v73 offset:448
    s_waitcnt lgkmcnt(0)
    v_add_f32 v26, v26, v27
    v_add_f32 v28, v28, v29
    v_add_f32 v26, v26, v28
    v_mul_f32 v26, 0x3b000000, v26
    v_cvt_pk_bf16_f32 v24, v24, v24
    v_lshlrev_b32 v24, 16, v24
    v_cvt_pk_bf16_f32 v26, v26, v26
    v_lshlrev_b32 v26, 16, v26
    v_add_f32 v26, 0x3727c5ac, v26
    v_cvt_pk_bf16_f32 v26, v26, v26
    v_lshlrev_b32 v26, 16, v26
    v_sqrt_f32 v26, v26
    s_nop 0
    v_cvt_pk_bf16_f32 v26, v26, v26
    v_lshlrev_b32 v26, 16, v26
    v_rcp_f32 v26, v26
    v_sub_f32 v40, v40, v24
    v_sub_f32 v41, v41, v24
    v_cvt_pk_bf16_f32 v41, v40, v41
    v_lshlrev_b32 v40, 16, v41
    v_and_b32 v41, 0xffff0000, v41
    v_mul_f32 v40, v40, v26
    v_mul_f32 v41, v41, v26
    v_cvt_pk_bf16_f32 v40, v40, v41
    v_sub_f32 v42, v42, v24
    v_sub_f32 v43, v43, v24
    v_cvt_pk_bf16_f32 v43, v42, v43
    v_lshlrev_b32 v42, 16, v43
    v_and_b32 v43, 0xffff0000, v43
    v_mul_f32 v42, v42, v26
    v_mul_f32 v43, v43, v26
    v_cvt_pk_bf16_f32 v41, v42, v43
    v_sub_f32 v44, v44, v24
    v_sub_f32 v45, v45, v24
    v_cvt_pk_bf16_f32 v45, v44, v45
    v_lshlrev_b32 v44, 16, v45
    v_and_b32 v45, 0xffff0000, v45
    v_mul_f32 v44, v44, v26
    v_mul_f32 v45, v45, v26
    v_cvt_pk_bf16_f32 v42, v44, v45
    v_sub_f32 v46, v46, v24
    v_sub_f32 v47, v47, v24
    v_cvt_pk_bf16_f32 v47, v46, v47
    v_lshlrev_b32 v46, 16, v47
    v_and_b32 v47, 0xffff0000, v47
    v_mul_f32 v46, v46, v26
    v_mul_f32 v47, v47, v26
    v_cvt_pk_bf16_f32 v43, v46, v47
    v_sub_f32 v48, v48, v24
    v_sub_f32 v49, v49, v24
    v_cvt_pk_bf16_f32 v49, v48, v49
    v_lshlrev_b32 v48, 16, v49
    v_and_b32 v49, 0xffff0000, v49
    v_mul_f32 v48, v48, v26
    v_mul_f32 v49, v49, v26
    v_cvt_pk_bf16_f32 v44, v48, v49
    v_sub_f32 v50, v50, v24
    v_sub_f32 v51, v51, v24
    v_cvt_pk_bf16_f32 v51, v50, v51
    v_lshlrev_b32 v50, 16, v51
    v_and_b32 v51, 0xffff0000, v51
    v_mul_f32 v50, v50, v26
    v_mul_f32 v51, v51, v26
    v_cvt_pk_bf16_f32 v45, v50, v51
    v_sub_f32 v52, v52, v24
    v_sub_f32 v53, v53, v24
    v_cvt_pk_bf16_f32 v53, v52, v53
    v_lshlrev_b32 v52, 16, v53
    v_and_b32 v53, 0xffff0000, v53
    v_mul_f32 v52, v52, v26
    v_mul_f32 v53, v53, v26
    v_cvt_pk_bf16_f32 v46, v52, v53
    v_sub_f32 v54, v54, v24
    v_sub_f32 v55, v55, v24
    v_cvt_pk_bf16_f32 v55, v54, v55
    v_lshlrev_b32 v54, 16, v55
    v_and_b32 v55, 0xffff0000, v55
    v_mul_f32 v54, v54, v26
    v_mul_f32 v55, v55, v26
    v_cvt_pk_bf16_f32 v47, v54, v55
    v_sub_f32 v56, v56, v24
    v_sub_f32 v57, v57, v24
    v_cvt_pk_bf16_f32 v57, v56, v57
    v_lshlrev_b32 v56, 16, v57
    v_and_b32 v57, 0xffff0000, v57
    v_mul_f32 v56, v56, v26
    v_mul_f32 v57, v57, v26
    v_cvt_pk_bf16_f32 v48, v56, v57
    v_sub_f32 v58, v58, v24
    v_sub_f32 v59, v59, v24
    v_cvt_pk_bf16_f32 v59, v58, v59
    v_lshlrev_b32 v58, 16, v59
    v_and_b32 v59, 0xffff0000, v59
    v_mul_f32 v58, v58, v26
    v_mul_f32 v59, v59, v26
    v_cvt_pk_bf16_f32 v49, v58, v59
    v_sub_f32 v60, v60, v24
    v_sub_f32 v61, v61, v24
    v_cvt_pk_bf16_f32 v61, v60, v61
    v_lshlrev_b32 v60, 16, v61
    v_and_b32 v61, 0xffff0000, v61
    v_mul_f32 v60, v60, v26
    v_mul_f32 v61, v61, v26
    v_cvt_pk_bf16_f32 v50, v60, v61
    v_sub_f32 v62, v62, v24
    v_sub_f32 v63, v63, v24
    v_cvt_pk_bf16_f32 v63, v62, v63
    v_lshlrev_b32 v62, 16, v63
    v_and_b32 v63, 0xffff0000, v63
    v_mul_f32 v62, v62, v26
    v_mul_f32 v63, v63, v26
    v_cvt_pk_bf16_f32 v51, v62, v63
    v_sub_f32 v64, v64, v24
    v_sub_f32 v65, v65, v24
    v_cvt_pk_bf16_f32 v65, v64, v65
    v_lshlrev_b32 v64, 16, v65
    v_and_b32 v65, 0xffff0000, v65
    v_mul_f32 v64, v64, v26
    v_mul_f32 v65, v65, v26
    v_cvt_pk_bf16_f32 v52, v64, v65
    v_sub_f32 v66, v66, v24
    v_sub_f32 v67, v67, v24
    v_cvt_pk_bf16_f32 v67, v66, v67
    v_lshlrev_b32 v66, 16, v67
    v_and_b32 v67, 0xffff0000, v67
    v_mul_f32 v66, v66, v26
    v_mul_f32 v67, v67, v26
    v_cvt_pk_bf16_f32 v53, v66, v67
    v_sub_f32 v68, v68, v24
    v_sub_f32 v69, v69, v24
    v_cvt_pk_bf16_f32 v69, v68, v69
    v_lshlrev_b32 v68, 16, v69
    v_and_b32 v69, 0xffff0000, v69
    v_mul_f32 v68, v68, v26
    v_mul_f32 v69, v69, v26
    v_cvt_pk_bf16_f32 v54, v68, v69
    v_sub_f32 v70, v70, v24
    v_sub_f32 v71, v71, v24
    v_cvt_pk_bf16_f32 v71, v70, v71
    v_lshlrev_b32 v70, 16, v71
    v_and_b32 v71, 0xffff0000, v71
    v_mul_f32 v70, v70, v26
    v_mul_f32 v71, v71, v26
    v_cvt_pk_bf16_f32 v55, v70, v71
    s_lshl_b32 s19, s41, 14
    s_lshl_b32 s20, s17, 12
    s_add_u32 s19, s19, s20
    s_add_u32 s19, s19, 0x100000
    buffer_store_dwordx4 v[40:43], v4, s[8:11], s19 offen offset:0 sc1
    buffer_store_dwordx4 v[44:47], v4, s[8:11], s19 offen offset:1024 sc1
    buffer_store_dwordx4 v[48:51], v4, s[8:11], s19 offen offset:2048 sc1
    buffer_store_dwordx4 v[52:55], v4, s[8:11], s19 offen offset:3072 sc1
    s_cmp_lg_u32 s18, 0
    s_cbranch_scc1 CN_3_ok
    v_mov_b32 v20, 0x27000
    s_cmp_lg_u32 s17, 0
    s_cbranch_scc1 CN_3_a
    s_mov_b64 exec, 1
    ds_write_b32 v20, v124
    s_mov_b64 exec, -1
    CN_3_a:
    s_waitcnt lgkmcnt(0)
    s_barrier
    ds_read_b32 v21, v20
    s_cmp_lg_u32 s2, 255
    s_cbranch_scc1 CN_3_b
    s_cmp_lg_u32 s17, 0
    s_cbranch_scc1 CN_3_b
    v_mov_b32 v20, 192
    v_mov_b32 v124, 1
    s_mov_b64 exec, 1
    buffer_store_dword v124, v20, s[12:15], 0 offen sc1
    s_mov_b64 exec, -1
    CN_3_b:
    s_waitcnt lgkmcnt(0)
    v_readfirstlane_b32 s19, v21
    s_nop 0
    s_bitcmp1_b32 s19, s16
    s_cbranch_scc1 F_loser
    CN_3_ok:
    v_mov_b32 v252, 192
    s_mov_b32 s21, 0
    PL_4:
    buffer_load_dword v253, v252, s[12:15], 0 offen sc1
    s_add_u32 s21, s21, 1
    s_cmp_gt_u32 s21, 400000
    s_cbranch_scc1 F_fail
    s_waitcnt vmcnt(0)
    v_cmp_gt_u32 vcc, 1, v253
    s_cbranch_vccz PL_4_ok
    s_sleep 2
    s_branch PL_4
    PL_4_ok:
    s_barrier
    s_cmp_lg_u32 s17, 0
    s_cbranch_scc1 LF_5
    s_lshl_b32 s19, s41, 2
    s_add_u32 s19, s19, 0x91000
    v_mov_b32 v21, 1
    s_mov_b64 exec, 1
    buffer_store_dword v21, v4, s[8:11], s19 offen sc1
    s_mov_b64 exec, -1
    LF_5:
    v_mov_b64 v[212:213], -1
    v_mov_b64 v[214:215], -1
    s_mov_b32 s44, 0x7ff00000
    s_cmp_lt_u32 s40, 214
    s_cbranch_scc0 G_end
    s_load_dwordx2 s[20:21], s[0:1], 24
    s_waitcnt lgkmcnt(0)
    s_mov_b32 s44, s20
    s_and_b32 s45, s21, 0xffff
    s_mov_b32 s46, 0x400000
    s_mov_b32 s47, 0x00020000
    s_load_dwordx2 s[20:21], s[0:1], 32
    s_waitcnt lgkmcnt(0)
    s_mov_b32 s48, s20
    s_and_b32 s49, s21, 0xffff
    s_mov_b32 s50, 0x400000
    s_mov_b32 s51, 0x00020000
    s_load_dwordx2 s[20:21], s[0:1], 16
    s_waitcnt lgkmcnt(0)
    s_mov_b32 s52, s20
    s_and_b32 s53, s21, 0xffff
    s_mov_b32 s54, 0x400000
    s_mov_b32 s55, 0x00020000
    s_load_dwordx2 s[20:21], s[0:1], 64
    s_waitcnt lgkmcnt(0)
    s_mov_b32 s56, s20
    s_and_b32 s57, s21, 0xffff
    s_mov_b32 s58, 0x158000
    s_mov_b32 s59, 0x00020000
    s_load_dwordx2 s[20:21], s[0:1], 72
    s_waitcnt lgkmcnt(0)
    s_mov_b32 s60, s20
    s_and_b32 s61, s21, 0xffff
    s_mov_b32 s62, 0xac0
    s_mov_b32 s63, 0x00020000
    s_mov_b32 s67, 0x00020000
    v_bfe_u32 v5, v1, 1, 2
    v_bfe_u32 v6, v1, 4, 1
    v_xor_b32 v5, v5, v6
    v_lshlrev_b32 v5, 5, v5
    v_and_b32 v6, 1, v1
    v_lshl_add_u32 v5, v6, 4, v5
    v_xor_b32 v6, 64, v5
    v_lshrrev_b32 v7, 3, v1
    v_lshl_add_u32 v8, v7, 13, v5
    v_lshl_add_u32 v9, v7, 13, v6
    v_mul_u32_u24 v7, 2752, v7
    v_add_u32 v10, v7, v5
    v_add_u32 v11, v7, v6
    v_lshl_add_u32 v14, v121, 3, v122
    v_lshlrev_b32 v14, 7, v14
    v_lshrrev_b32 v5, 1, v122
    v_and_b32 v6, 1, v121
    v_lshl_add_u32 v5, v6, 1, v5
    v_lshl_add_u32 v14, v5, 5, v14
    v_lshl_add_u32 v14, v123, 3, v14
    v_xor_b32 v15, 32, v14
    v_xor_b32 v16, 64, v14
    v_xor_b32 v17, 96, v14
    v_lshlrev_b32 v18, 3, v121
    s_mov_b32 s69, s40
    s_min_u32 s19, s69, 213
    s_cmp_ge_u32 s19, 192
    s_cbranch_scc1 G1_n_6
    s_cmp_lt_u32 s19, 64
    s_cselect_b32 s64, s44, s48
    s_cselect_b32 s65, s45, s49
    s_cmp_ge_u32 s19, 128
    s_cselect_b32 s64, s52, s64
    s_cselect_b32 s65, s53, s65
    s_mov_b32 s66, 0x400000
    s_and_b32 s19, s19, 63
    s_lshl_b32 s70, s19, 7
    s_lshl_b32 s20, s17, 20
    s_add_u32 s70, s70, s20
    s_mov_b32 s71, 65536
    v_mov_b32 v12, v8
    v_mov_b32 v13, v9
    s_branch G1_n_7
    G1_n_6:
    s_mov_b32 s64, s56
    s_mov_b32 s65, s57
    s_mov_b32 s66, 0x158000
    s_sub_u32 s19, s19, 192
    s_lshl_b32 s70, s19, 7
    s_mul_i32 s20, s17, 352256
    s_add_u32 s70, s70, s20
    s_mov_b32 s71, 22016
    v_mov_b32 v12, v10
    v_mov_b32 v13, v11
    G1_n_7:
    s_lshl_b32 s72, s17, 14
    s_add_u32 m0, s72, 0
    s_nop 0
    buffer_load_dwordx4 v12, s[64:67], s70 offen lds
    s_add_u32 s70, s70, s71
    s_add_u32 m0, s72, 1024
    s_nop 0
    buffer_load_dwordx4 v13, s[64:67], s70 offen lds
    s_add_u32 s70, s70, s71
    s_add_u32 m0, s72, 2048
    s_nop 0
    buffer_load_dwordx4 v12, s[64:67], s70 offen lds
    s_add_u32 s70, s70, s71
    s_add_u32 m0, s72, 3072
    s_nop 0
    buffer_load_dwordx4 v13, s[64:67], s70 offen lds
    s_add_u32 s70, s70, s71
    s_add_u32 m0, s72, 4096
    s_nop 0
    buffer_load_dwordx4 v12, s[64:67], s70 offen lds
    s_add_u32 s70, s70, s71
    s_add_u32 m0, s72, 5120
    s_nop 0
    buffer_load_dwordx4 v13, s[64:67], s70 offen lds
    s_add_u32 s70, s70, s71
    s_add_u32 m0, s72, 6144
    s_nop 0
    buffer_load_dwordx4 v12, s[64:67], s70 offen lds
    s_add_u32 s70, s70, s71
    s_add_u32 m0, s72, 7168
    s_nop 0
    buffer_load_dwordx4 v13, s[64:67], s70 offen lds
    s_add_u32 s70, s70, s71
    s_add_u32 m0, s72, 8192
    s_nop 0
    buffer_load_dwordx4 v12, s[64:67], s70 offen lds
    s_add_u32 s70, s70, s71
    s_add_u32 m0, s72, 9216
    s_nop 0
    buffer_load_dwordx4 v13, s[64:67], s70 offen lds
    s_add_u32 s70, s70, s71
    s_add_u32 m0, s72, 10240
    s_nop 0
    buffer_load_dwordx4 v12, s[64:67], s70 offen lds
    s_add_u32 s70, s70, s71
    s_add_u32 m0, s72, 11264
    s_nop 0
    buffer_load_dwordx4 v13, s[64:67], s70 offen lds
    s_add_u32 s70, s70, s71
    s_add_u32 m0, s72, 12288
    s_nop 0
    buffer_load_dwordx4 v12, s[64:67], s70 offen lds
    s_add_u32 s70, s70, s71
    s_add_u32 m0, s72, 13312
    s_nop 0
    buffer_load_dwordx4 v13, s[64:67], s70 offen lds
    s_add_u32 s70, s70, s71
    s_add_u32 m0, s72, 14336
    s_nop 0
    buffer_load_dwordx4 v12, s[64:67], s70 offen lds
    s_add_u32 s70, s70, s71
    s_add_u32 m0, s72, 15360
    s_nop 0
    buffer_load_dwordx4 v13, s[64:67], s70 offen lds
    s_add_u32 s70, s70, s71
    s_branch W_main
    W_kv:
    s_cmp_lt_u32 s40, 96
    s_cbranch_scc1 W_noln
    s_lshl_b32 s19, s41, 14
    s_lshl_b32 s20, s17, 8
    s_add_u32 s19, s19, s20
    v_lshlrev_b32 v72, 10, v120
    v_lshl_add_u32 v72, v121, 4, v72
    buffer_load_dwordx4 v[24:27], v72, s[76:79], s19 offen offset:0
    buffer_load_dwordx4 v[28:31], v72, s[76:79], s19 offen offset:64
    buffer_load_dwordx4 v[32:35], v72, s[76:79], s19 offen offset:128
    buffer_load_dwordx4 v[36:39], v72, s[76:79], s19 offen offset:192
    W_noln:
    s_load_dwordx2 s[20:21], s[0:1], 24
    s_waitcnt lgkmcnt(0)
    s_mov_b32 s44, s20
    s_and_b32 s45, s21, 0xffff
    s_mov_b32 s46, 0x400000
    s_mov_b32 s47, 0x00020000
    s_load_dwordx2 s[20:21], s[0:1], 32
    s_waitcnt lgkmcnt(0)
    s_mov_b32 s48, s20
    s_and_b32 s49, s21, 0xffff
    s_mov_b32 s50, 0x400000
    s_mov_b32 s51, 0x00020000
    s_load_dwordx2 s[20:21], s[0:1], 16
    s_waitcnt lgkmcnt(0)
    s_mov_b32 s52, s20
    s_and_b32 s53, s21, 0xffff
    s_mov_b32 s54, 0x400000
    s_mov_b32 s55, 0x00020000
    s_load_dwordx2 s[20:21], s[0:1], 64
    s_waitcnt lgkmcnt(0)
    s_mov_b32 s56, s20
    s_and_b32 s57, s21, 0xffff
    s_mov_b32 s58, 0x158000
    s_mov_b32 s59, 0x00020000
    s_load_dwordx2 s[20:21], s[0:1], 72
    s_waitcnt lgkmcnt(0)
    s_mov_b32 s60, s20
    s_and_b32 s61, s21, 0xffff
    s_mov_b32 s62, 0xac0
    s_mov_b32 s63, 0x00020000
    s_mov_b32 s67, 0x00020000
    v_bfe_u32 v5, v1, 1, 2
    v_bfe_u32 v6, v1, 4, 1
    v_xor_b32 v5, v5, v6
    v_lshlrev_b32 v5, 5, v5
    v_and_b32 v6, 1, v1
    v_lshl_add_u32 v5, v6, 4, v5
    v_xor_b32 v6, 64, v5
    v_lshrrev_b32 v7, 3, v1
    v_lshl_add_u32 v8, v7, 13, v5
    v_lshl_add_u32 v9, v7, 13, v6
    v_mul_u32_u24 v7, 2752, v7
    v_add_u32 v10, v7, v5
    v_add_u32 v11, v7, v6
    v_lshl_add_u32 v14, v121, 3, v122
    v_lshlrev_b32 v14, 7, v14
    v_lshrrev_b32 v5, 1, v122
    v_and_b32 v6, 1, v121
    v_lshl_add_u32 v5, v6, 1, v5
    v_lshl_add_u32 v14, v5, 5, v14
    v_lshl_add_u32 v14, v123, 3, v14
    v_xor_b32 v15, 32, v14
    v_xor_b32 v16, 64, v14
    v_xor_b32 v17, 96, v14
    v_lshlrev_b32 v18, 3, v121
    s_mov_b32 s69, s40
    s_min_u32 s19, s69, 213
    s_cmp_ge_u32 s19, 192
    s_cbranch_scc1 G1_n_8
    s_cmp_lt_u32 s19, 64
    s_cselect_b32 s64, s44, s48
    s_cselect_b32 s65, s45, s49
    s_cmp_ge_u32 s19, 128
    s_cselect_b32 s64, s52, s64
    s_cselect_b32 s65, s53, s65
    s_mov_b32 s66, 0x400000
    s_and_b32 s19, s19, 63
    s_lshl_b32 s70, s19, 7
    s_lshl_b32 s20, s17, 20
    s_add_u32 s70, s70, s20
    s_mov_b32 s71, 65536
    v_mov_b32 v12, v8
    v_mov_b32 v13, v9
    s_branch G1_n_9
    G1_n_8:
    s_mov_b32 s64, s56
    s_mov_b32 s65, s57
    s_mov_b32 s66, 0x158000
    s_sub_u32 s19, s19, 192
    s_lshl_b32 s70, s19, 7
    s_mul_i32 s20, s17, 352256
    s_add_u32 s70, s70, s20
    s_mov_b32 s71, 22016
    v_mov_b32 v12, v10
    v_mov_b32 v13, v11
    G1_n_9:
    s_lshl_b32 s72, s17, 14
    s_add_u32 m0, s72, 0
    s_nop 0
    buffer_load_dwordx4 v12, s[64:67], s70 offen lds
    s_add_u32 s70, s70, s71
    s_add_u32 m0, s72, 1024
    s_nop 0
    buffer_load_dwordx4 v13, s[64:67], s70 offen lds
    s_add_u32 s70, s70, s71
    s_add_u32 m0, s72, 2048
    s_nop 0
    buffer_load_dwordx4 v12, s[64:67], s70 offen lds
    s_add_u32 s70, s70, s71
    s_add_u32 m0, s72, 3072
    s_nop 0
    buffer_load_dwordx4 v13, s[64:67], s70 offen lds
    s_add_u32 s70, s70, s71
    s_add_u32 m0, s72, 4096
    s_nop 0
    buffer_load_dwordx4 v12, s[64:67], s70 offen lds
    s_add_u32 s70, s70, s71
    s_add_u32 m0, s72, 5120
    s_nop 0
    buffer_load_dwordx4 v13, s[64:67], s70 offen lds
    s_add_u32 s70, s70, s71
    s_add_u32 m0, s72, 6144
    s_nop 0
    buffer_load_dwordx4 v12, s[64:67], s70 offen lds
    s_add_u32 s70, s70, s71
    s_add_u32 m0, s72, 7168
    s_nop 0
    buffer_load_dwordx4 v13, s[64:67], s70 offen lds
    s_add_u32 s70, s70, s71
    s_add_u32 m0, s72, 8192
    s_nop 0
    buffer_load_dwordx4 v12, s[64:67], s70 offen lds
    s_add_u32 s70, s70, s71
    s_add_u32 m0, s72, 9216
    s_nop 0
    buffer_load_dwordx4 v13, s[64:67], s70 offen lds
    s_add_u32 s70, s70, s71
    s_add_u32 m0, s72, 10240
    s_nop 0
    buffer_load_dwordx4 v12, s[64:67], s70 offen lds
    s_add_u32 s70, s70, s71
    s_add_u32 m0, s72, 11264
    s_nop 0
    buffer_load_dwordx4 v13, s[64:67], s70 offen lds
    s_add_u32 s70, s70, s71
    s_add_u32 m0, s72, 12288
    s_nop 0
    buffer_load_dwordx4 v12, s[64:67], s70 offen lds
    s_add_u32 s70, s70, s71
    s_add_u32 m0, s72, 13312
    s_nop 0
    buffer_load_dwordx4 v13, s[64:67], s70 offen lds
    s_add_u32 s70, s70, s71
    s_add_u32 m0, s72, 14336
    s_nop 0
    buffer_load_dwordx4 v12, s[64:67], s70 offen lds
    s_add_u32 s70, s70, s71
    s_add_u32 m0, s72, 15360
    s_nop 0
    buffer_load_dwordx4 v13, s[64:67], s70 offen lds
    s_add_u32 s70, s70, s71
    s_waitcnt vmcnt(16)
    s_cmp_lg_u32 s18, 0
    s_cbranch_scc1 CN_10_ok
    v_mov_b32 v20, 0x27000
    s_cmp_lg_u32 s17, 0
    s_cbranch_scc1 CN_10_a
    s_mov_b64 exec, 1
    ds_write_b32 v20, v124
    s_mov_b64 exec, -1
    CN_10_a:
    s_waitcnt lgkmcnt(0)
    s_barrier
    ds_read_b32 v21, v20
    s_cmp_lg_u32 s2, 255
    s_cbranch_scc1 CN_10_b
    s_cmp_lg_u32 s17, 0
    s_cbranch_scc1 CN_10_b
    v_mov_b32 v20, 192
    v_mov_b32 v124, 1
    s_mov_b64 exec, 1
    buffer_store_dword v124, v20, s[12:15], 0 offen sc1
    s_mov_b64 exec, -1
    CN_10_b:
    s_waitcnt lgkmcnt(0)
    v_readfirstlane_b32 s19, v21
    s_nop 0
    s_bitcmp1_b32 s19, s16
    s_cbranch_scc1 F_loser
    CN_10_ok:
    s_cmp_lt_u32 s40, 96
    s_cbranch_scc1 W_noln2
    s_lshl_b32 s20, s17, 6
    v_lshlrev_b32 v73, 2, v120
    v_add_u32 v73, 0x27040, v73
    v_add_u32 v74, s20, v73
    s_waitcnt vmcnt(18)
    v_lshlrev_b32 v40, 16, v24
    v_and_b32 v41, 0xffff0000, v24
    v_lshlrev_b32 v42, 16, v25
    v_and_b32 v43, 0xffff0000, v25
    v_lshlrev_b32 v44, 16, v26
    v_and_b32 v45, 0xffff0000, v26
    v_lshlrev_b32 v46, 16, v27
    v_and_b32 v47, 0xffff0000, v27
    v_lshlrev_b32 v48, 16, v28
    v_and_b32 v49, 0xffff0000, v28
    v_lshlrev_b32 v50, 16, v29
    v_and_b32 v51, 0xffff0000, v29
    v_lshlrev_b32 v52, 16, v30
    v_and_b32 v53, 0xffff0000, v30
    v_lshlrev_b32 v54, 16, v31
    v_and_b32 v55, 0xffff0000, v31
    v_lshlrev_b32 v56, 16, v32
    v_and_b32 v57, 0xffff0000, v32
    v_lshlrev_b32 v58, 16, v33
    v_and_b32 v59, 0xffff0000, v33
    v_lshlrev_b32 v60, 16, v34
    v_and_b32 v61, 0xffff0000, v34
    v_lshlrev_b32 v62, 16, v35
    v_and_b32 v63, 0xffff0000, v35
    v_lshlrev_b32 v64, 16, v36
    v_and_b32 v65, 0xffff0000, v36
    v_lshlrev_b32 v66, 16, v37
    v_and_b32 v67, 0xffff0000, v37
    v_lshlrev_b32 v68, 16, v38
    v_and_b32 v69, 0xffff0000, v38
    v_lshlrev_b32 v70, 16, v39
    v_and_b32 v71, 0xffff0000, v39
    v_pk_add_f32 v[24:25], v[40:41], v[42:43]
    v_pk_add_f32 v[24:25], v[24:25], v[44:45]
    v_pk_add_f32 v[24:25], v[24:25], v[46:47]
    v_pk_add_f32 v[24:25], v[24:25], v[48:49]
    v_pk_add_f32 v[24:25], v[24:25], v[50:51]
    v_pk_add_f32 v[24:25], v[24:25], v[52:53]
    v_pk_add_f32 v[24:25], v[24:25], v[54:55]
    v_pk_add_f32 v[24:25], v[24:25], v[56:57]
    v_pk_add_f32 v[24:25], v[24:25], v[58:59]
    v_pk_add_f32 v[24:25], v[24:25], v[60:61]
    v_pk_add_f32 v[24:25], v[24:25], v[62:63]
    v_pk_add_f32 v[24:25], v[24:25], v[64:65]
    v_pk_add_f32 v[24:25], v[24:25], v[66:67]
    v_pk_add_f32 v[24:25], v[24:25], v[68:69]
    v_pk_add_f32 v[24:25], v[24:25], v[70:71]
    v_add_f32 v24, v24, v25
    v_mov_b32 v25, v24
    s_nop 1
    v_permlane32_swap_b32 v24, v25
    v_add_f32 v24, v24, v25
    v_mov_b32 v25, v24
    s_nop 1
    v_permlane16_swap_b32 v24, v25
    v_add_f32 v24, v24, v25
    ds_write_b32 v74, v24
    s_waitcnt lgkmcnt(0)
    s_barrier
    ds_read_b32 v24, v73
    ds_read_b32 v25, v73 offset:64
    ds_read_b32 v26, v73 offset:128
    ds_read_b32 v27, v73 offset:192
    s_waitcnt lgkmcnt(0)
    v_add_f32 v24, v24, v25
    v_add_f32 v26, v26, v27
    v_add_f32 v24, v24, v26
    v_mul_f32 v24, 0x3b000000, v24
    v_mov_b32 v26, 0
    v_mov_b32 v27, 0
    v_sub_f32 v28, v40, v24
    v_fmac_f32 v26, v28, v28
    v_sub_f32 v28, v41, v24
    v_fmac_f32 v27, v28, v28
    v_sub_f32 v28, v42, v24
    v_fmac_f32 v26, v28, v28
    v_sub_f32 v28, v43, v24
    v_fmac_f32 v27, v28, v28
    v_sub_f32 v28, v44, v24
    v_fmac_f32 v26, v28, v28
    v_sub_f32 v28, v45, v24
    v_fmac_f32 v27, v28, v28
    v_sub_f32 v28, v46, v24
    v_fmac_f32 v26, v28, v28
    v_sub_f32 v28, v47, v24
    v_fmac_f32 v27, v28, v28
    v_sub_f32 v28, v48, v24
    v_fmac_f32 v26, v28, v28
    v_sub_f32 v28, v49, v24
    v_fmac_f32 v27, v28, v28
    v_sub_f32 v28, v50, v24
    v_fmac_f32 v26, v28, v28
    v_sub_f32 v28, v51, v24
    v_fmac_f32 v27, v28, v28
    v_sub_f32 v28, v52, v24
    v_fmac_f32 v26, v28, v28
    v_sub_f32 v28, v53, v24
    v_fmac_f32 v27, v28, v28
    v_sub_f32 v28, v54, v24
    v_fmac_f32 v26, v28, v28
    v_sub_f32 v28, v55, v24
    v_fmac_f32 v27, v28, v28
    v_sub_f32 v28, v56, v24
    v_fmac_f32 v26, v28, v28
    v_sub_f32 v28, v57, v24
    v_fmac_f32 v27, v28, v28
    v_sub_f32 v28, v58, v24
    v_fmac_f32 v26, v28, v28
    v_sub_f32 v28, v59, v24
    v_fmac_f32 v27, v28, v28
    v_sub_f32 v28, v60, v24
    v_fmac_f32 v26, v28, v28
    v_sub_f32 v28, v61, v24
    v_fmac_f32 v27, v28, v28
    v_sub_f32 v28, v62, v24
    v_fmac_f32 v26, v28, v28
    v_sub_f32 v28, v63, v24
    v_fmac_f32 v27, v28, v28
    v_sub_f32 v28, v64, v24
    v_fmac_f32 v26, v28, v28
    v_sub_f32 v28, v65, v24
    v_fmac_f32 v27, v28, v28
    v_sub_f32 v28, v66, v24
    v_fmac_f32 v26, v28, v28
    v_sub_f32 v28, v67, v24
    v_fmac_f32 v27, v28, v28
    v_sub_f32 v28, v68, v24
    v_fmac_f32 v26, v28, v28
    v_sub_f32 v28, v69, v24
    v_fmac_f32 v27, v28, v28
    v_sub_f32 v28, v70, v24
    v_fmac_f32 v26, v28, v28
    v_sub_f32 v28, v71, v24
    v_fmac_f32 v27, v28, v28
    v_add_f32 v26, v26, v27
    v_mov_b32 v27, v26
    s_nop 1
    v_permlane32_swap_b32 v26, v27
    v_add_f32 v26, v26, v27
    v_mov_b32 v27, v26
    s_nop 1
    v_permlane16_swap_b32 v26, v27
    v_add_f32 v26, v26, v27
    ds_write_b32 v74, v26 offset:256
    s_waitcnt lgkmcnt(0)
    s_barrier
    ds_read_b32 v26, v73 offset:256
    ds_read_b32 v27, v73 offset:320
    ds_read_b32 v28, v73 offset:384
    ds_read_b32 v29, v73 offset:448
    s_waitcnt lgkmcnt(0)
    v_add_f32 v26, v26, v27
    v_add_f32 v28, v28, v29
    v_add_f32 v26, v26, v28
    v_mul_f32 v26, 0x3b000000, v26
    v_cvt_pk_bf16_f32 v24, v24, v24
    v_lshlrev_b32 v24, 16, v24
    v_cvt_pk_bf16_f32 v26, v26, v26
    v_lshlrev_b32 v26, 16, v26
    v_add_f32 v26, 0x3727c5ac, v26
    v_cvt_pk_bf16_f32 v26, v26, v26
    v_lshlrev_b32 v26, 16, v26
    v_sqrt_f32 v26, v26
    s_nop 0
    v_cvt_pk_bf16_f32 v26, v26, v26
    v_lshlrev_b32 v26, 16, v26
    v_rcp_f32 v26, v26
    v_sub_f32 v40, v40, v24
    v_sub_f32 v41, v41, v24
    v_cvt_pk_bf16_f32 v41, v40, v41
    v_lshlrev_b32 v40, 16, v41
    v_and_b32 v41, 0xffff0000, v41
    v_mul_f32 v40, v40, v26
    v_mul_f32 v41, v41, v26
    v_cvt_pk_bf16_f32 v40, v40, v41
    v_sub_f32 v42, v42, v24
    v_sub_f32 v43, v43, v24
    v_cvt_pk_bf16_f32 v43, v42, v43
    v_lshlrev_b32 v42, 16, v43
    v_and_b32 v43, 0xffff0000, v43
    v_mul_f32 v42, v42, v26
    v_mul_f32 v43, v43, v26
    v_cvt_pk_bf16_f32 v41, v42, v43
    v_sub_f32 v44, v44, v24
    v_sub_f32 v45, v45, v24
    v_cvt_pk_bf16_f32 v45, v44, v45
    v_lshlrev_b32 v44, 16, v45
    v_and_b32 v45, 0xffff0000, v45
    v_mul_f32 v44, v44, v26
    v_mul_f32 v45, v45, v26
    v_cvt_pk_bf16_f32 v42, v44, v45
    v_sub_f32 v46, v46, v24
    v_sub_f32 v47, v47, v24
    v_cvt_pk_bf16_f32 v47, v46, v47
    v_lshlrev_b32 v46, 16, v47
    v_and_b32 v47, 0xffff0000, v47
    v_mul_f32 v46, v46, v26
    v_mul_f32 v47, v47, v26
    v_cvt_pk_bf16_f32 v43, v46, v47
    v_sub_f32 v48, v48, v24
    v_sub_f32 v49, v49, v24
    v_cvt_pk_bf16_f32 v49, v48, v49
    v_lshlrev_b32 v48, 16, v49
    v_and_b32 v49, 0xffff0000, v49
    v_mul_f32 v48, v48, v26
    v_mul_f32 v49, v49, v26
    v_cvt_pk_bf16_f32 v44, v48, v49
    v_sub_f32 v50, v50, v24
    v_sub_f32 v51, v51, v24
    v_cvt_pk_bf16_f32 v51, v50, v51
    v_lshlrev_b32 v50, 16, v51
    v_and_b32 v51, 0xffff0000, v51
    v_mul_f32 v50, v50, v26
    v_mul_f32 v51, v51, v26
    v_cvt_pk_bf16_f32 v45, v50, v51
    v_sub_f32 v52, v52, v24
    v_sub_f32 v53, v53, v24
    v_cvt_pk_bf16_f32 v53, v52, v53
    v_lshlrev_b32 v52, 16, v53
    v_and_b32 v53, 0xffff0000, v53
    v_mul_f32 v52, v52, v26
    v_mul_f32 v53, v53, v26
    v_cvt_pk_bf16_f32 v46, v52, v53
    v_sub_f32 v54, v54, v24
    v_sub_f32 v55, v55, v24
    v_cvt_pk_bf16_f32 v55, v54, v55
    v_lshlrev_b32 v54, 16, v55
    v_and_b32 v55, 0xffff0000, v55
    v_mul_f32 v54, v54, v26
    v_mul_f32 v55, v55, v26
    v_cvt_pk_bf16_f32 v47, v54, v55
    v_sub_f32 v56, v56, v24
    v_sub_f32 v57, v57, v24
    v_cvt_pk_bf16_f32 v57, v56, v57
    v_lshlrev_b32 v56, 16, v57
    v_and_b32 v57, 0xffff0000, v57
    v_mul_f32 v56, v56, v26
    v_mul_f32 v57, v57, v26
    v_cvt_pk_bf16_f32 v48, v56, v57
    v_sub_f32 v58, v58, v24
    v_sub_f32 v59, v59, v24
    v_cvt_pk_bf16_f32 v59, v58, v59
    v_lshlrev_b32 v58, 16, v59
    v_and_b32 v59, 0xffff0000, v59
    v_mul_f32 v58, v58, v26
    v_mul_f32 v59, v59, v26
    v_cvt_pk_bf16_f32 v49, v58, v59
    v_sub_f32 v60, v60, v24
    v_sub_f32 v61, v61, v24
    v_cvt_pk_bf16_f32 v61, v60, v61
    v_lshlrev_b32 v60, 16, v61
    v_and_b32 v61, 0xffff0000, v61
    v_mul_f32 v60, v60, v26
    v_mul_f32 v61, v61, v26
    v_cvt_pk_bf16_f32 v50, v60, v61
    v_sub_f32 v62, v62, v24
    v_sub_f32 v63, v63, v24
    v_cvt_pk_bf16_f32 v63, v62, v63
    v_lshlrev_b32 v62, 16, v63
    v_and_b32 v63, 0xffff0000, v63
    v_mul_f32 v62, v62, v26
    v_mul_f32 v63, v63, v26
    v_cvt_pk_bf16_f32 v51, v62, v63
    v_sub_f32 v64, v64, v24
    v_sub_f32 v65, v65, v24
    v_cvt_pk_bf16_f32 v65, v64, v65
    v_lshlrev_b32 v64, 16, v65
    v_and_b32 v65, 0xffff0000, v65
    v_mul_f32 v64, v64, v26
    v_mul_f32 v65, v65, v26
    v_cvt_pk_bf16_f32 v52, v64, v65
    v_sub_f32 v66, v66, v24
    v_sub_f32 v67, v67, v24
    v_cvt_pk_bf16_f32 v67, v66, v67
    v_lshlrev_b32 v66, 16, v67
    v_and_b32 v67, 0xffff0000, v67
    v_mul_f32 v66, v66, v26
    v_mul_f32 v67, v67, v26
    v_cvt_pk_bf16_f32 v53, v66, v67
    v_sub_f32 v68, v68, v24
    v_sub_f32 v69, v69, v24
    v_cvt_pk_bf16_f32 v69, v68, v69
    v_lshlrev_b32 v68, 16, v69
    v_and_b32 v69, 0xffff0000, v69
    v_mul_f32 v68, v68, v26
    v_mul_f32 v69, v69, v26
    v_cvt_pk_bf16_f32 v54, v68, v69
    v_sub_f32 v70, v70, v24
    v_sub_f32 v71, v71, v24
    v_cvt_pk_bf16_f32 v71, v70, v71
    v_lshlrev_b32 v70, 16, v71
    v_and_b32 v71, 0xffff0000, v71
    v_mul_f32 v70, v70, v26
    v_mul_f32 v71, v71, v26
    v_cvt_pk_bf16_f32 v55, v70, v71
    s_lshl_b32 s19, s41, 14
    s_lshl_b32 s20, s17, 12
    s_add_u32 s19, s19, s20
    s_add_u32 s19, s19, 0x100000
    buffer_store_dwordx4 v[40:43], v4, s[8:11], s19 offen offset:0 sc1
    buffer_store_dwordx4 v[44:47], v4, s[8:11], s19 offen offset:1024 sc1
    buffer_store_dwordx4 v[48:51], v4, s[8:11], s19 offen offset:2048 sc1
    buffer_store_dwordx4 v[52:55], v4, s[8:11], s19 offen offset:3072 sc1
    v_mov_b32 v252, 192
    s_mov_b32 s21, 0
    PL_11:
    buffer_load_dword v253, v252, s[12:15], 0 offen sc1
    s_add_u32 s21, s21, 1
    s_cmp_gt_u32 s21, 400000
    s_cbranch_scc1 F_fail
    s_waitcnt vmcnt(0)
    v_cmp_gt_u32 vcc, 1, v253
    s_cbranch_vccz PL_11_ok
    s_sleep 2
    s_branch PL_11
    PL_11_ok:
    s_barrier
    s_cmp_lg_u32 s17, 0
    s_cbranch_scc1 LF_12
    s_lshl_b32 s19, s41, 2
    s_add_u32 s19, s19, 0x91000
    v_mov_b32 v21, 1
    s_mov_b64 exec, 1
    buffer_store_dword v21, v4, s[8:11], s19 offen sc1
    s_mov_b64 exec, -1
    LF_12:
    s_branch W_main
    W_noln2:
    v_mov_b32 v252, 192
    s_mov_b32 s21, 0
    PL_13:
    buffer_load_dword v253, v252, s[12:15], 0 offen sc1
    s_add_u32 s21, s21, 1
    s_cmp_gt_u32 s21, 400000
    s_cbranch_scc1 F_fail
    s_waitcnt vmcnt(0)
    v_cmp_gt_u32 vcc, 1, v253
    s_cbranch_vccz PL_13_ok
    s_sleep 2
    s_branch PL_13
    PL_13_ok:
    W_main:
    s_waitcnt vmcnt(0)
    s_barrier
    ds_read_b64_tr_b16 a[0:1], v14 offset:0
    ds_read_b64_tr_b16 a[2:3], v14 offset:512
    ds_read_b64_tr_b16 a[4:5], v15 offset:0
    ds_read_b64_tr_b16 a[6:7], v15 offset:512
    ds_read_b64_tr_b16 a[8:9], v16 offset:0
    ds_read_b64_tr_b16 a[10:11], v16 offset:512
    ds_read_b64_tr_b16 a[12:13], v17 offset:0
    ds_read_b64_tr_b16 a[14:15], v17 offset:512
    s_waitcnt lgkmcnt(0)
    ds_read_b64_tr_b16 a[16:17], v14 offset:4096
    ds_read_b64_tr_b16 a[18:19], v14 offset:4608
    ds_read_b64_tr_b16 a[20:21], v15 offset:4096
    ds_read_b64_tr_b16 a[22:23], v15 offset:4608
    ds_read_b64_tr_b16 a[24:25], v16 offset:4096
    ds_read_b64_tr_b16 a[26:27], v16 offset:4608
    ds_read_b64_tr_b16 a[28:29], v17 offset:4096
    ds_read_b64_tr_b16 a[30:31], v17 offset:4608
    s_waitcnt lgkmcnt(0)
    ds_read_b64_tr_b16 a[32:33], v14 offset:8192
    ds_read_b64_tr_b16 a[34:35], v14 offset:8704
    ds_read_b64_tr_b16 a[36:37], v15 offset:8192
    ds_read_b64_tr_b16 a[38:39], v15 offset:8704
    ds_read_b64_tr_b16 a[40:41], v16 offset:8192
    ds_read_b64_tr_b16 a[42:43], v16 offset:8704
    ds_read_b64_tr_b16 a[44:45], v17 offset:8192
    ds_read_b64_tr_b16 a[46:47], v17 offset:8704
    s_waitcnt lgkmcnt(0)
    ds_read_b64_tr_b16 a[48:49], v14 offset:12288
    ds_read_b64_tr_b16 a[50:51], v14 offset:12800
    ds_read_b64_tr_b16 a[52:53], v15 offset:12288
    ds_read_b64_tr_b16 a[54:55], v15 offset:12800
    ds_read_b64_tr_b16 a[56:57], v16 offset:12288
    ds_read_b64_tr_b16 a[58:59], v16 offset:12800
    ds_read_b64_tr_b16 a[60:61], v17 offset:12288
    ds_read_b64_tr_b16 a[62:63], v17 offset:12800
    s_waitcnt lgkmcnt(0)
    ds_read_b64_tr_b16 a[64:65], v14 offset:16384
    ds_read_b64_tr_b16 a[66:67], v14 offset:16896
    ds_read_b64_tr_b16 a[68:69], v15 offset:16384
    ds_read_b64_tr_b16 a[70:71], v15 offset:16896
    ds_read_b64_tr_b16 a[72:73], v16 offset:16384
    ds_read_b64_tr_b16 a[74:75], v16 offset:16896
    ds_read_b64_tr_b16 a[76:77], v17 offset:16384
    ds_read_b64_tr_b16 a[78:79], v17 offset:16896
    s_waitcnt lgkmcnt(0)
    ds_read_b64_tr_b16 a[80:81], v14 offset:20480
    ds_read_b64_tr_b16 a[82:83], v14 offset:20992
    ds_read_b64_tr_b16 a[84:85], v15 offset:20480
    ds_read_b64_tr_b16 a[86:87], v15 offset:20992
    ds_read_b64_tr_b16 a[88:89], v16 offset:20480
    ds_read_b64_tr_b16 a[90:91], v16 offset:20992
    ds_read_b64_tr_b16 a[92:93], v17 offset:20480
    ds_read_b64_tr_b16 a[94:95], v17 offset:20992
    s_waitcnt lgkmcnt(0)
    ds_read_b64_tr_b16 a[96:97], v14 offset:24576
    ds_read_b64_tr_b16 a[98:99], v14 offset:25088
    ds_read_b64_tr_b16 a[100:101], v15 offset:24576
    ds_read_b64_tr_b16 a[102:103], v15 offset:25088
    ds_read_b64_tr_b16 a[104:105], v16 offset:24576
    ds_read_b64_tr_b16 a[106:107], v16 offset:25088
    ds_read_b64_tr_b16 a[108:109], v17 offset:24576
    ds_read_b64_tr_b16 a[110:111], v17 offset:25088
    s_waitcnt lgkmcnt(0)
    ds_read_b64_tr_b16 a[112:113], v14 offset:28672
    ds_read_b64_tr_b16 a[114:115], v14 offset:29184
    ds_read_b64_tr_b16 a[116:117], v15 offset:28672
    ds_read_b64_tr_b16 a[118:119], v15 offset:29184
    ds_read_b64_tr_b16 a[120:121], v16 offset:28672
    ds_read_b64_tr_b16 a[122:123], v16 offset:29184
    ds_read_b64_tr_b16 a[124:125], v17 offset:28672
    ds_read_b64_tr_b16 a[126:127], v17 offset:29184
    s_waitcnt lgkmcnt(0)
    ds_read_b64_tr_b16 a[128:129], v14 offset:32768
    ds_read_b64_tr_b16 a[130:131], v14 offset:33280
    ds_read_b64_tr_b16 a[132:133], v15 offset:32768
    ds_read_b64_tr_b16 a[134:135], v15 offset:33280
    ds_read_b64_tr_b16 a[136:137], v16 offset:32768
    ds_read_b64_tr_b16 a[138:139], v16 offset:33280
    ds_read_b64_tr_b16 a[140:141], v17 offset:32768
    ds_read_b64_tr_b16 a[142:143], v17 offset:33280
    s_waitcnt lgkmcnt(0)
    ds_read_b64_tr_b16 a[144:145], v14 offset:36864
    ds_read_b64_tr_b16 a[146:147], v14 offset:37376
    ds_read_b64_tr_b16 a[148:149], v15 offset:36864
    ds_read_b64_tr_b16 a[150:151], v15 offset:37376
    ds_read_b64_tr_b16 a[152:153], v16 offset:36864
    ds_read_b64_tr_b16 a[154:155], v16 offset:37376
    ds_read_b64_tr_b16 a[156:157], v17 offset:36864
    ds_read_b64_tr_b16 a[158:159], v17 offset:37376
    s_waitcnt lgkmcnt(0)
    ds_read_b64_tr_b16 a[160:161], v14 offset:40960
    ds_read_b64_tr_b16 a[162:163], v14 offset:41472
    ds_read_b64_tr_b16 a[164:165], v15 offset:40960
    ds_read_b64_tr_b16 a[166:167], v15 offset:41472
    ds_read_b64_tr_b16 a[168:169], v16 offset:40960
    ds_read_b64_tr_b16 a[170:171], v16 offset:41472
    ds_read_b64_tr_b16 a[172:173], v17 offset:40960
    ds_read_b64_tr_b16 a[174:175], v17 offset:41472
    s_waitcnt lgkmcnt(0)
    ds_read_b64_tr_b16 a[176:177], v14 offset:45056
    ds_read_b64_tr_b16 a[178:179], v14 offset:45568
    ds_read_b64_tr_b16 a[180:181], v15 offset:45056
    ds_read_b64_tr_b16 a[182:183], v15 offset:45568
    ds_read_b64_tr_b16 a[184:185], v16 offset:45056
    ds_read_b64_tr_b16 a[186:187], v16 offset:45568
    ds_read_b64_tr_b16 a[188:189], v17 offset:45056
    ds_read_b64_tr_b16 a[190:191], v17 offset:45568
    s_waitcnt lgkmcnt(0)
    ds_read_b64_tr_b16 a[192:193], v14 offset:49152
    ds_read_b64_tr_b16 a[194:195], v14 offset:49664
    ds_read_b64_tr_b16 a[196:197], v15 offset:49152
    ds_read_b64_tr_b16 a[198:199], v15 offset:49664
    ds_read_b64_tr_b16 a[200:201], v16 offset:49152
    ds_read_b64_tr_b16 a[202:203], v16 offset:49664
    ds_read_b64_tr_b16 a[204:205], v17 offset:49152
    ds_read_b64_tr_b16 a[206:207], v17 offset:49664
    s_waitcnt lgkmcnt(0)
    ds_read_b64_tr_b16 a[208:209], v14 offset:53248
    ds_read_b64_tr_b16 a[210:211], v14 offset:53760
    ds_read_b64_tr_b16 a[212:213], v15 offset:53248
    ds_read_b64_tr_b16 a[214:215], v15 offset:53760
    ds_read_b64_tr_b16 a[216:217], v16 offset:53248
    ds_read_b64_tr_b16 a[218:219], v16 offset:53760
    ds_read_b64_tr_b16 a[220:221], v17 offset:53248
    ds_read_b64_tr_b16 a[222:223], v17 offset:53760
    s_waitcnt lgkmcnt(0)
    ds_read_b64_tr_b16 a[224:225], v14 offset:57344
    ds_read_b64_tr_b16 a[226:227], v14 offset:57856
    ds_read_b64_tr_b16 a[228:229], v15 offset:57344
    ds_read_b64_tr_b16 a[230:231], v15 offset:57856
    ds_read_b64_tr_b16 a[232:233], v16 offset:57344
    ds_read_b64_tr_b16 a[234:235], v16 offset:57856
    ds_read_b64_tr_b16 a[236:237], v17 offset:57344
    ds_read_b64_tr_b16 a[238:239], v17 offset:57856
    s_waitcnt lgkmcnt(0)
    ds_read_b64_tr_b16 a[240:241], v14 offset:61440
    ds_read_b64_tr_b16 a[242:243], v14 offset:61952
    ds_read_b64_tr_b16 a[244:245], v15 offset:61440
    ds_read_b64_tr_b16 a[246:247], v15 offset:61952
    ds_read_b64_tr_b16 a[248:249], v16 offset:61440
    ds_read_b64_tr_b16 a[250:251], v16 offset:61952
    ds_read_b64_tr_b16 a[252:253], v17 offset:61440
    ds_read_b64_tr_b16 a[254:255], v17 offset:61952
    s_waitcnt lgkmcnt(0)
    s_and_b32 s19, s40, 63
    s_lshr_b32 s20, s19, 1
    s_and_b32 s21, s40, 1
    s_lshl_b32 s42, s17, 18
    s_lshl_b32 s22, s20, 13
    s_add_u32 s42, s42, s22
    s_lshl_b32 s44, s20, 7
    s_lshl_b32 s22, s21, 2
    s_add_u32 s44, s44, s22
    s_add_u32 s44, s44, 0x90000
    s_mov_b32 s43, 0x100000
    s_cmp_ge_u32 s40, 192
    s_cbranch_scc1 G_bH
    s_cmp_ge_u32 s40, 128
    s_cbranch_scc1 G_bQ
    s_lshl_b32 s22, s17, 4
    s_add_u32 s44, s44, s22
    s_cmp_ge_u32 s40, 64
    s_cbranch_scc1 G_bV
    s_lshl_b32 s22, s21, 11
    s_add_u32 s42, s42, s22
    s_lshr_b32 s48, s42, 1
    s_lshl_b32 s22, s21, 10
    s_add_u32 s48, s48, s22
    s_add_u32 s48, s48, 0x3b80000
    s_add_u32 s42, s42, 0x400000
    s_branch G_bdone
    G_bV:
    s_add_u32 s44, s44, 8
    s_lshl_b32 s22, s21, 12
    s_add_u32 s42, s42, s22
    s_add_u32 s42, s42, 0x1400000
    s_branch G_bdone
    G_bQ:
    s_lshl_b32 s22, s17, 3
    s_add_u32 s44, s44, s22
    s_add_u32 s44, s44, 64
    s_lshl_b32 s22, s21, 11
    s_add_u32 s42, s42, s22
    s_add_u32 s42, s42, 0x2400000
    s_branch G_bdone
    G_bH:
    s_sub_u32 s19, s40, 192
    s_lshl_b32 s44, s19, 4
    s_lshl_b32 s22, s17, 2
    s_add_u32 s44, s44, s22
    s_add_u32 s44, s44, 0x91200
    s_mul_i32 s42, s17, 88064
    s_lshl_b32 s19, s19, 11
    s_add_u32 s42, s42, s19
    s_add_u32 s42, s42, 0x5000000
    s_mov_b32 s43, 352256
    G_bdone:
    s_cmp_eq_u32 s40, 213
    s_cselect_b32 s20, 0x7ffff000, 0
    v_add_u32 v19, s20, v4
    v_lshlrev_b32 v20, 3, v1
    v_and_b32 v23, 63, v20
    s_mov_b32 s22, 0x91000
    s_mov_b32 s21, 0
    PL_14:
    buffer_load_dwordx2 v[210:211], v23, s[8:11], s22 offen sc1
    s_add_u32 s21, s21, 1
    s_cmp_gt_u32 s21, 400000
    s_cbranch_scc1 F_fail
    s_waitcnt vmcnt(0)
    v_min_u32 v210, v210, v211
    v_cmp_gt_u32 vcc, 1, v210
    s_cbranch_vccz PL_14_ok
    s_sleep 2
    s_branch PL_14
    PL_14_ok:
    s_lshl_b32 s45, s17, 15
    s_add_u32 s45, s45, 0x100000
    s_add_u32 s46, s45, 0
    buffer_load_dwordx4 v[24:27], v4, s[8:11], s46 offen offset:0 sc1
    s_add_u32 s47, s45, 16384
    buffer_load_dwordx4 v[28:31], v4, s[8:11], s47 offen offset:0 sc1
    buffer_load_dwordx4 v[32:35], v4, s[8:11], s46 offen offset:1024 sc1
    buffer_load_dwordx4 v[36:39], v4, s[8:11], s47 offen offset:1024 sc1
    buffer_load_dwordx4 v[40:43], v4, s[8:11], s46 offen offset:2048 sc1
    buffer_load_dwordx4 v[44:47], v4, s[8:11], s47 offen offset:2048 sc1
    buffer_load_dwordx4 v[48:51], v4, s[8:11], s46 offen offset:3072 sc1
    buffer_load_dwordx4 v[52:55], v4, s[8:11], s47 offen offset:3072 sc1
    s_add_u32 s46, s45, 4096
    buffer_load_dwordx4 v[56:59], v4, s[8:11], s46 offen offset:0 sc1
    s_add_u32 s47, s45, 20480
    buffer_load_dwordx4 v[60:63], v4, s[8:11], s47 offen offset:0 sc1
    buffer_load_dwordx4 v[64:67], v4, s[8:11], s46 offen offset:1024 sc1
    buffer_load_dwordx4 v[68:71], v4, s[8:11], s47 offen offset:1024 sc1
    buffer_load_dwordx4 v[72:75], v4, s[8:11], s46 offen offset:2048 sc1
    buffer_load_dwordx4 v[76:79], v4, s[8:11], s47 offen offset:2048 sc1
    buffer_load_dwordx4 v[80:83], v4, s[8:11], s46 offen offset:3072 sc1
    buffer_load_dwordx4 v[84:87], v4, s[8:11], s47 offen offset:3072 sc1
    s_add_u32 s46, s45, 8192
    buffer_load_dwordx4 v[88:91], v4, s[8:11], s46 offen offset:0 sc1
    s_add_u32 s47, s45, 24576
    buffer_load_dwordx4 v[92:95], v4, s[8:11], s47 offen offset:0 sc1
    buffer_load_dwordx4 v[96:99], v4, s[8:11], s46 offen offset:1024 sc1
    buffer_load_dwordx4 v[100:103], v4, s[8:11], s47 offen offset:1024 sc1
    buffer_load_dwordx4 v[104:107], v4, s[8:11], s46 offen offset:2048 sc1
    buffer_load_dwordx4 v[108:111], v4, s[8:11], s47 offen offset:2048 sc1
    buffer_load_dwordx4 v[112:115], v4, s[8:11], s46 offen offset:3072 sc1
    buffer_load_dwordx4 v[116:119], v4, s[8:11], s47 offen offset:3072 sc1
    s_add_u32 s46, s45, 12288
    buffer_load_dwordx4 v[120:123], v4, s[8:11], s46 offen offset:0 sc1
    s_add_u32 s47, s45, 28672
    buffer_load_dwordx4 v[124:127], v4, s[8:11], s47 offen offset:0 sc1
    buffer_load_dwordx4 v[128:131], v4, s[8:11], s46 offen offset:1024 sc1
    buffer_load_dwordx4 v[132:135], v4, s[8:11], s47 offen offset:1024 sc1
    buffer_load_dwordx4 v[136:139], v4, s[8:11], s46 offen offset:2048 sc1
    buffer_load_dwordx4 v[140:143], v4, s[8:11], s47 offen offset:2048 sc1
    buffer_load_dwordx4 v[144:147], v4, s[8:11], s46 offen offset:3072 sc1
    buffer_load_dwordx4 v[148:151], v4, s[8:11], s47 offen offset:3072 sc1
    s_sub_u32 s19, s40, 192
    s_lshl_b32 s19, s19, 7
    s_cmp_lt_u32 s40, 192
    s_cselect_b32 s19, 0, s19
    buffer_load_dwordx2 v[200:201], v18, s[60:63], s19 offen
    buffer_load_dwordx2 v[202:203], v18, s[60:63], s19 offen offset:32
    buffer_load_dwordx2 v[204:205], v18, s[60:63], s19 offen offset:64
    buffer_load_dwordx2 v[206:207], v18, s[60:63], s19 offen offset:96
    buffer_load_dwordx2 v[208:209], v18, s[60:63], s19 offen offset:96
    s_mov_b32 s41, 0
    v_mov_b64 v[212:213], -1
    v_mov_b64 v[214:215], -1
    s_cmp_ge_u32 s40, 192
    s_cbranch_scc1 G_H
    s_cmp_ge_u32 s40, 128
    s_cbranch_scc1 G_Q_entry
    s_cmp_ge_u32 s40, 64
    s_cbranch_scc1 G_V
    G_K_entry:
    buffer_load_dwordx2 v[208:209], v18, s[60:63], s19 offen offset:96
    buffer_load_dwordx2 v[208:209], v18, s[60:63], s19 offen offset:96
    G_K:
    s_add_u32 s45, s45, 0x20000
    s_cmp_eq_u32 s41, 15
    s_cselect_b32 s45, 0x7ff00000, s45
    s_cselect_b32 s49, s48, 0x7ff00000
    s_waitcnt vmcnt(38)
    v_mfma_f32_16x16x32_bf16 v[152:155], a[0:3], v[24:27], 0
    v_mfma_f32_16x16x32_bf16 v[156:159], a[4:7], v[24:27], 0
    v_mfma_f32_16x16x32_bf16 v[160:163], a[8:11], v[24:27], 0
    v_mfma_f32_16x16x32_bf16 v[164:167], a[12:15], v[24:27], 0
    s_add_u32 s46, s45, 0
    buffer_load_dwordx4 v[24:27], v4, s[8:11], s46 offen offset:0 sc1
    s_waitcnt vmcnt(38)
    v_mfma_f32_16x16x32_bf16 v[168:171], a[0:3], v[28:31], 0
    v_mfma_f32_16x16x32_bf16 v[172:175], a[4:7], v[28:31], 0
    v_mfma_f32_16x16x32_bf16 v[176:179], a[8:11], v[28:31], 0
    v_mfma_f32_16x16x32_bf16 v[180:183], a[12:15], v[28:31], 0
    s_add_u32 s47, s45, 16384
    buffer_load_dwordx4 v[28:31], v4, s[8:11], s47 offen offset:0 sc1
    s_waitcnt vmcnt(38)
    v_mfma_f32_16x16x32_bf16 v[152:155], a[16:19], v[32:35], v[152:155]
    v_mfma_f32_16x16x32_bf16 v[156:159], a[20:23], v[32:35], v[156:159]
    v_mfma_f32_16x16x32_bf16 v[160:163], a[24:27], v[32:35], v[160:163]
    v_mfma_f32_16x16x32_bf16 v[164:167], a[28:31], v[32:35], v[164:167]
    buffer_load_dwordx4 v[32:35], v4, s[8:11], s46 offen offset:1024 sc1
    s_waitcnt vmcnt(38)
    v_mfma_f32_16x16x32_bf16 v[168:171], a[16:19], v[36:39], v[168:171]
    v_mfma_f32_16x16x32_bf16 v[172:175], a[20:23], v[36:39], v[172:175]
    v_mfma_f32_16x16x32_bf16 v[176:179], a[24:27], v[36:39], v[176:179]
    v_mfma_f32_16x16x32_bf16 v[180:183], a[28:31], v[36:39], v[180:183]
    buffer_load_dwordx4 v[36:39], v4, s[8:11], s47 offen offset:1024 sc1
    s_waitcnt vmcnt(38)
    v_mfma_f32_16x16x32_bf16 v[152:155], a[32:35], v[40:43], v[152:155]
    v_mfma_f32_16x16x32_bf16 v[156:159], a[36:39], v[40:43], v[156:159]
    v_mfma_f32_16x16x32_bf16 v[160:163], a[40:43], v[40:43], v[160:163]
    v_mfma_f32_16x16x32_bf16 v[164:167], a[44:47], v[40:43], v[164:167]
    buffer_load_dwordx4 v[40:43], v4, s[8:11], s46 offen offset:2048 sc1
    s_waitcnt vmcnt(38)
    v_mfma_f32_16x16x32_bf16 v[168:171], a[32:35], v[44:47], v[168:171]
    v_mfma_f32_16x16x32_bf16 v[172:175], a[36:39], v[44:47], v[172:175]
    v_mfma_f32_16x16x32_bf16 v[176:179], a[40:43], v[44:47], v[176:179]
    v_mfma_f32_16x16x32_bf16 v[180:183], a[44:47], v[44:47], v[180:183]
    buffer_load_dwordx4 v[44:47], v4, s[8:11], s47 offen offset:2048 sc1
    s_waitcnt vmcnt(38)
    v_mfma_f32_16x16x32_bf16 v[152:155], a[48:51], v[48:51], v[152:155]
    v_mfma_f32_16x16x32_bf16 v[156:159], a[52:55], v[48:51], v[156:159]
    v_mfma_f32_16x16x32_bf16 v[160:163], a[56:59], v[48:51], v[160:163]
    v_mfma_f32_16x16x32_bf16 v[164:167], a[60:63], v[48:51], v[164:167]
    buffer_load_dwordx4 v[48:51], v4, s[8:11], s46 offen offset:3072 sc1
    s_waitcnt vmcnt(38)
    v_mfma_f32_16x16x32_bf16 v[168:171], a[48:51], v[52:55], v[168:171]
    v_mfma_f32_16x16x32_bf16 v[172:175], a[52:55], v[52:55], v[172:175]
    v_mfma_f32_16x16x32_bf16 v[176:179], a[56:59], v[52:55], v[176:179]
    v_mfma_f32_16x16x32_bf16 v[180:183], a[60:63], v[52:55], v[180:183]
    buffer_load_dwordx4 v[52:55], v4, s[8:11], s47 offen offset:3072 sc1
    s_waitcnt vmcnt(38)
    v_mfma_f32_16x16x32_bf16 v[152:155], a[64:67], v[56:59], v[152:155]
    v_mfma_f32_16x16x32_bf16 v[156:159], a[68:71], v[56:59], v[156:159]
    v_mfma_f32_16x16x32_bf16 v[160:163], a[72:75], v[56:59], v[160:163]
    v_mfma_f32_16x16x32_bf16 v[164:167], a[76:79], v[56:59], v[164:167]
    s_add_u32 s46, s45, 4096
    buffer_load_dwordx4 v[56:59], v4, s[8:11], s46 offen offset:0 sc1
    s_waitcnt vmcnt(38)
    v_mfma_f32_16x16x32_bf16 v[168:171], a[64:67], v[60:63], v[168:171]
    v_mfma_f32_16x16x32_bf16 v[172:175], a[68:71], v[60:63], v[172:175]
    v_mfma_f32_16x16x32_bf16 v[176:179], a[72:75], v[60:63], v[176:179]
    v_mfma_f32_16x16x32_bf16 v[180:183], a[76:79], v[60:63], v[180:183]
    s_add_u32 s47, s45, 20480
    buffer_load_dwordx4 v[60:63], v4, s[8:11], s47 offen offset:0 sc1
    s_waitcnt vmcnt(38)
    v_mfma_f32_16x16x32_bf16 v[152:155], a[80:83], v[64:67], v[152:155]
    v_mfma_f32_16x16x32_bf16 v[156:159], a[84:87], v[64:67], v[156:159]
    v_mfma_f32_16x16x32_bf16 v[160:163], a[88:91], v[64:67], v[160:163]
    v_mfma_f32_16x16x32_bf16 v[164:167], a[92:95], v[64:67], v[164:167]
    buffer_load_dwordx4 v[64:67], v4, s[8:11], s46 offen offset:1024 sc1
    s_waitcnt vmcnt(38)
    v_mfma_f32_16x16x32_bf16 v[168:171], a[80:83], v[68:71], v[168:171]
    v_mfma_f32_16x16x32_bf16 v[172:175], a[84:87], v[68:71], v[172:175]
    v_mfma_f32_16x16x32_bf16 v[176:179], a[88:91], v[68:71], v[176:179]
    v_mfma_f32_16x16x32_bf16 v[180:183], a[92:95], v[68:71], v[180:183]
    buffer_load_dwordx4 v[68:71], v4, s[8:11], s47 offen offset:1024 sc1
    s_waitcnt vmcnt(38)
    v_mfma_f32_16x16x32_bf16 v[152:155], a[96:99], v[72:75], v[152:155]
    v_mfma_f32_16x16x32_bf16 v[156:159], a[100:103], v[72:75], v[156:159]
    v_mfma_f32_16x16x32_bf16 v[160:163], a[104:107], v[72:75], v[160:163]
    v_mfma_f32_16x16x32_bf16 v[164:167], a[108:111], v[72:75], v[164:167]
    buffer_load_dwordx4 v[72:75], v4, s[8:11], s46 offen offset:2048 sc1
    s_waitcnt vmcnt(38)
    v_mfma_f32_16x16x32_bf16 v[168:171], a[96:99], v[76:79], v[168:171]
    v_mfma_f32_16x16x32_bf16 v[172:175], a[100:103], v[76:79], v[172:175]
    v_mfma_f32_16x16x32_bf16 v[176:179], a[104:107], v[76:79], v[176:179]
    v_mfma_f32_16x16x32_bf16 v[180:183], a[108:111], v[76:79], v[180:183]
    buffer_load_dwordx4 v[76:79], v4, s[8:11], s47 offen offset:2048 sc1
    s_waitcnt vmcnt(38)
    v_mfma_f32_16x16x32_bf16 v[152:155], a[112:115], v[80:83], v[152:155]
    v_mfma_f32_16x16x32_bf16 v[156:159], a[116:119], v[80:83], v[156:159]
    v_mfma_f32_16x16x32_bf16 v[160:163], a[120:123], v[80:83], v[160:163]
    v_mfma_f32_16x16x32_bf16 v[164:167], a[124:127], v[80:83], v[164:167]
    buffer_load_dwordx4 v[80:83], v4, s[8:11], s46 offen offset:3072 sc1
    s_waitcnt vmcnt(38)
    v_mfma_f32_16x16x32_bf16 v[168:171], a[112:115], v[84:87], v[168:171]
    v_mfma_f32_16x16x32_bf16 v[172:175], a[116:119], v[84:87], v[172:175]
    v_mfma_f32_16x16x32_bf16 v[176:179], a[120:123], v[84:87], v[176:179]
    v_mfma_f32_16x16x32_bf16 v[180:183], a[124:127], v[84:87], v[180:183]
    buffer_load_dwordx4 v[84:87], v4, s[8:11], s47 offen offset:3072 sc1
    s_waitcnt vmcnt(38)
    v_mfma_f32_16x16x32_bf16 v[152:155], a[128:131], v[88:91], v[152:155]
    v_mfma_f32_16x16x32_bf16 v[156:159], a[132:135], v[88:91], v[156:159]
    v_mfma_f32_16x16x32_bf16 v[160:163], a[136:139], v[88:91], v[160:163]
    v_mfma_f32_16x16x32_bf16 v[164:167], a[140:143], v[88:91], v[164:167]
    s_add_u32 s46, s45, 8192
    buffer_load_dwordx4 v[88:91], v4, s[8:11], s46 offen offset:0 sc1
    s_waitcnt vmcnt(38)
    v_mfma_f32_16x16x32_bf16 v[168:171], a[128:131], v[92:95], v[168:171]
    v_mfma_f32_16x16x32_bf16 v[172:175], a[132:135], v[92:95], v[172:175]
    v_mfma_f32_16x16x32_bf16 v[176:179], a[136:139], v[92:95], v[176:179]
    v_mfma_f32_16x16x32_bf16 v[180:183], a[140:143], v[92:95], v[180:183]
    s_add_u32 s47, s45, 24576
    buffer_load_dwordx4 v[92:95], v4, s[8:11], s47 offen offset:0 sc1
    s_waitcnt vmcnt(38)
    v_mfma_f32_16x16x32_bf16 v[152:155], a[144:147], v[96:99], v[152:155]
    v_mfma_f32_16x16x32_bf16 v[156:159], a[148:151], v[96:99], v[156:159]
    v_mfma_f32_16x16x32_bf16 v[160:163], a[152:155], v[96:99], v[160:163]
    v_mfma_f32_16x16x32_bf16 v[164:167], a[156:159], v[96:99], v[164:167]
    buffer_load_dwordx4 v[96:99], v4, s[8:11], s46 offen offset:1024 sc1
    s_waitcnt vmcnt(38)
    v_mfma_f32_16x16x32_bf16 v[168:171], a[144:147], v[100:103], v[168:171]
    v_mfma_f32_16x16x32_bf16 v[172:175], a[148:151], v[100:103], v[172:175]
    v_mfma_f32_16x16x32_bf16 v[176:179], a[152:155], v[100:103], v[176:179]
    v_mfma_f32_16x16x32_bf16 v[180:183], a[156:159], v[100:103], v[180:183]
    buffer_load_dwordx4 v[100:103], v4, s[8:11], s47 offen offset:1024 sc1
    s_waitcnt vmcnt(38)
    v_mfma_f32_16x16x32_bf16 v[152:155], a[160:163], v[104:107], v[152:155]
    v_mfma_f32_16x16x32_bf16 v[156:159], a[164:167], v[104:107], v[156:159]
    v_mfma_f32_16x16x32_bf16 v[160:163], a[168:171], v[104:107], v[160:163]
    v_mfma_f32_16x16x32_bf16 v[164:167], a[172:175], v[104:107], v[164:167]
    buffer_load_dwordx4 v[104:107], v4, s[8:11], s46 offen offset:2048 sc1
    s_waitcnt vmcnt(38)
    v_mfma_f32_16x16x32_bf16 v[168:171], a[160:163], v[108:111], v[168:171]
    v_mfma_f32_16x16x32_bf16 v[172:175], a[164:167], v[108:111], v[172:175]
    v_mfma_f32_16x16x32_bf16 v[176:179], a[168:171], v[108:111], v[176:179]
    v_mfma_f32_16x16x32_bf16 v[180:183], a[172:175], v[108:111], v[180:183]
    buffer_load_dwordx4 v[108:111], v4, s[8:11], s47 offen offset:2048 sc1
    s_waitcnt vmcnt(38)
    v_mfma_f32_16x16x32_bf16 v[152:155], a[176:179], v[112:115], v[152:155]
    v_mfma_f32_16x16x32_bf16 v[156:159], a[180:183], v[112:115], v[156:159]
    v_mfma_f32_16x16x32_bf16 v[160:163], a[184:187], v[112:115], v[160:163]
    v_mfma_f32_16x16x32_bf16 v[164:167], a[188:191], v[112:115], v[164:167]
    buffer_load_dwordx4 v[112:115], v4, s[8:11], s46 offen offset:3072 sc1
    s_waitcnt vmcnt(38)
    v_mfma_f32_16x16x32_bf16 v[168:171], a[176:179], v[116:119], v[168:171]
    v_mfma_f32_16x16x32_bf16 v[172:175], a[180:183], v[116:119], v[172:175]
    v_mfma_f32_16x16x32_bf16 v[176:179], a[184:187], v[116:119], v[176:179]
    v_mfma_f32_16x16x32_bf16 v[180:183], a[188:191], v[116:119], v[180:183]
    buffer_load_dwordx4 v[116:119], v4, s[8:11], s47 offen offset:3072 sc1
    s_waitcnt vmcnt(38)
    v_mfma_f32_16x16x32_bf16 v[152:155], a[192:195], v[120:123], v[152:155]
    v_mfma_f32_16x16x32_bf16 v[156:159], a[196:199], v[120:123], v[156:159]
    v_mfma_f32_16x16x32_bf16 v[160:163], a[200:203], v[120:123], v[160:163]
    v_mfma_f32_16x16x32_bf16 v[164:167], a[204:207], v[120:123], v[164:167]
    s_add_u32 s46, s45, 12288
    buffer_load_dwordx4 v[120:123], v4, s[8:11], s46 offen offset:0 sc1
    s_waitcnt vmcnt(38)
    v_mfma_f32_16x16x32_bf16 v[168:171], a[192:195], v[124:127], v[168:171]
    v_mfma_f32_16x16x32_bf16 v[172:175], a[196:199], v[124:127], v[172:175]
    v_mfma_f32_16x16x32_bf16 v[176:179], a[200:203], v[124:127], v[176:179]
    v_mfma_f32_16x16x32_bf16 v[180:183], a[204:207], v[124:127], v[180:183]
    s_add_u32 s47, s45, 28672
    buffer_load_dwordx4 v[124:127], v4, s[8:11], s47 offen offset:0 sc1
    s_waitcnt vmcnt(38)
    v_mfma_f32_16x16x32_bf16 v[152:155], a[208:211], v[128:131], v[152:155]
    v_mfma_f32_16x16x32_bf16 v[156:159], a[212:215], v[128:131], v[156:159]
    v_mfma_f32_16x16x32_bf16 v[160:163], a[216:219], v[128:131], v[160:163]
    v_mfma_f32_16x16x32_bf16 v[164:167], a[220:223], v[128:131], v[164:167]
    buffer_load_dwordx4 v[128:131], v4, s[8:11], s46 offen offset:1024 sc1
    s_waitcnt vmcnt(38)
    v_mfma_f32_16x16x32_bf16 v[168:171], a[208:211], v[132:135], v[168:171]
    v_mfma_f32_16x16x32_bf16 v[172:175], a[212:215], v[132:135], v[172:175]
    v_mfma_f32_16x16x32_bf16 v[176:179], a[216:219], v[132:135], v[176:179]
    v_mfma_f32_16x16x32_bf16 v[180:183], a[220:223], v[132:135], v[180:183]
    buffer_load_dwordx4 v[132:135], v4, s[8:11], s47 offen offset:1024 sc1
    s_waitcnt vmcnt(38)
    v_mfma_f32_16x16x32_bf16 v[152:155], a[224:227], v[136:139], v[152:155]
    v_mfma_f32_16x16x32_bf16 v[156:159], a[228:231], v[136:139], v[156:159]
    v_mfma_f32_16x16x32_bf16 v[160:163], a[232:235], v[136:139], v[160:163]
    v_mfma_f32_16x16x32_bf16 v[164:167], a[236:239], v[136:139], v[164:167]
    buffer_load_dwordx4 v[136:139], v4, s[8:11], s46 offen offset:2048 sc1
    s_waitcnt vmcnt(38)
    v_mfma_f32_16x16x32_bf16 v[168:171], a[224:227], v[140:143], v[168:171]
    v_mfma_f32_16x16x32_bf16 v[172:175], a[228:231], v[140:143], v[172:175]
    v_mfma_f32_16x16x32_bf16 v[176:179], a[232:235], v[140:143], v[176:179]
    v_mfma_f32_16x16x32_bf16 v[180:183], a[236:239], v[140:143], v[180:183]
    buffer_load_dwordx4 v[140:143], v4, s[8:11], s47 offen offset:2048 sc1
    s_waitcnt vmcnt(38)
    v_mfma_f32_16x16x32_bf16 v[152:155], a[240:243], v[144:147], v[152:155]
    v_mfma_f32_16x16x32_bf16 v[156:159], a[244:247], v[144:147], v[156:159]
    v_mfma_f32_16x16x32_bf16 v[160:163], a[248:251], v[144:147], v[160:163]
    v_mfma_f32_16x16x32_bf16 v[164:167], a[252:255], v[144:147], v[164:167]
    buffer_load_dwordx4 v[144:147], v4, s[8:11], s46 offen offset:3072 sc1
    s_waitcnt vmcnt(38)
    v_mfma_f32_16x16x32_bf16 v[168:171], a[240:243], v[148:151], v[168:171]
    v_mfma_f32_16x16x32_bf16 v[172:175], a[244:247], v[148:151], v[172:175]
    v_mfma_f32_16x16x32_bf16 v[176:179], a[248:251], v[148:151], v[176:179]
    v_mfma_f32_16x16x32_bf16 v[180:183], a[252:255], v[148:151], v[180:183]
    buffer_load_dwordx4 v[148:151], v4, s[8:11], s47 offen offset:3072 sc1
    s_waitcnt vmcnt(32)
    v_mov_b32 v21, s41
    s_mov_b64 exec, 1
    buffer_store_dword v21, v4, s[8:11], s44 offen sc1
    s_mov_b64 exec, -1
    buffer_store_dwordx4 v[212:215], v4, s[8:11], s49 offen offset:0 sc1
    buffer_store_dwordx4 v[212:215], v4, s[8:11], s49 offen offset:1024 sc1
    s_add_u32 s19, s42, 0x1000
    v_cvt_pk_bf16_f32 v152, v152, v153
    v_cvt_pk_bf16_f32 v153, v154, v155
    v_cvt_pk_bf16_f32 v154, v160, v161
    v_cvt_pk_bf16_f32 v155, v162, v163
    buffer_store_dwordx4 v[152:155], v4, s[8:11], s42 offen offset:0 sc1
    v_cvt_pk_bf16_f32 v156, v156, v157
    v_cvt_pk_bf16_f32 v157, v158, v159
    v_cvt_pk_bf16_f32 v158, v164, v165
    v_cvt_pk_bf16_f32 v159, v166, v167
    buffer_store_dwordx4 v[156:159], v4, s[8:11], s42 offen offset:1024 sc1
    v_cvt_pk_bf16_f32 v168, v168, v169
    v_cvt_pk_bf16_f32 v169, v170, v171
    v_cvt_pk_bf16_f32 v170, v176, v177
    v_cvt_pk_bf16_f32 v171, v178, v179
    buffer_store_dwordx4 v[168:171], v4, s[8:11], s19 offen offset:0 sc1
    v_cvt_pk_bf16_f32 v172, v172, v173
    v_cvt_pk_bf16_f32 v173, v174, v175
    v_cvt_pk_bf16_f32 v174, v180, v181
    v_cvt_pk_bf16_f32 v175, v182, v183
    buffer_store_dwordx4 v[172:175], v4, s[8:11], s19 offen offset:1024 sc1
    s_add_u32 s42, s42, s43
    s_add_u32 s41, s41, 1
    s_cmp_eq_u32 s41, 1
    s_cbranch_scc1 G_K_first
    s_cmp_lt_u32 s41, 16
    s_cbranch_scc1 G_K
    s_branch G_end
    G_K_first:
    s_waitcnt vmcnt(0)
    v_mov_b32 v21, s41
    s_mov_b64 exec, 1
    buffer_store_dword v21, v4, s[8:11], s44 offen sc1
    s_mov_b64 exec, -1
    s_mov_b32 s21, 0
    PL_15:
    buffer_load_dwordx2 v[210:211], v20, s[8:11], s22 offen sc1
    s_add_u32 s21, s21, 1
    s_cmp_gt_u32 s21, 400000
    s_cbranch_scc1 F_fail
    s_waitcnt vmcnt(0)
    v_min_u32 v210, v210, v211
    v_cmp_gt_u32 vcc, 1, v210
    s_cbranch_vccz PL_15_ok
    s_sleep 2
    s_branch PL_15
    PL_15_ok:
    s_branch G_K
    G_Q_entry:
    G_Q:
    s_add_u32 s45, s45, 0x20000
    s_cmp_eq_u32 s41, 15
    s_cselect_b32 s45, 0x7ff00000, s45
    s_cselect_b32 s49, s48, 0x7ff00000
    s_waitcnt vmcnt(36)
    v_mfma_f32_16x16x32_bf16 v[152:155], a[0:3], v[24:27], 0
    v_mfma_f32_16x16x32_bf16 v[156:159], a[4:7], v[24:27], 0
    v_mfma_f32_16x16x32_bf16 v[160:163], a[8:11], v[24:27], 0
    v_mfma_f32_16x16x32_bf16 v[164:167], a[12:15], v[24:27], 0
    s_add_u32 s46, s45, 0
    buffer_load_dwordx4 v[24:27], v4, s[8:11], s46 offen offset:0 sc1
    s_waitcnt vmcnt(36)
    v_mfma_f32_16x16x32_bf16 v[168:171], a[0:3], v[28:31], 0
    v_mfma_f32_16x16x32_bf16 v[172:175], a[4:7], v[28:31], 0
    v_mfma_f32_16x16x32_bf16 v[176:179], a[8:11], v[28:31], 0
    v_mfma_f32_16x16x32_bf16 v[180:183], a[12:15], v[28:31], 0
    s_add_u32 s47, s45, 16384
    buffer_load_dwordx4 v[28:31], v4, s[8:11], s47 offen offset:0 sc1
    s_waitcnt vmcnt(36)
    v_mfma_f32_16x16x32_bf16 v[152:155], a[16:19], v[32:35], v[152:155]
    v_mfma_f32_16x16x32_bf16 v[156:159], a[20:23], v[32:35], v[156:159]
    v_mfma_f32_16x16x32_bf16 v[160:163], a[24:27], v[32:35], v[160:163]
    v_mfma_f32_16x16x32_bf16 v[164:167], a[28:31], v[32:35], v[164:167]
    buffer_load_dwordx4 v[32:35], v4, s[8:11], s46 offen offset:1024 sc1
    s_waitcnt vmcnt(36)
    v_mfma_f32_16x16x32_bf16 v[168:171], a[16:19], v[36:39], v[168:171]
    v_mfma_f32_16x16x32_bf16 v[172:175], a[20:23], v[36:39], v[172:175]
    v_mfma_f32_16x16x32_bf16 v[176:179], a[24:27], v[36:39], v[176:179]
    v_mfma_f32_16x16x32_bf16 v[180:183], a[28:31], v[36:39], v[180:183]
    buffer_load_dwordx4 v[36:39], v4, s[8:11], s47 offen offset:1024 sc1
    s_waitcnt vmcnt(36)
    v_mfma_f32_16x16x32_bf16 v[152:155], a[32:35], v[40:43], v[152:155]
    v_mfma_f32_16x16x32_bf16 v[156:159], a[36:39], v[40:43], v[156:159]
    v_mfma_f32_16x16x32_bf16 v[160:163], a[40:43], v[40:43], v[160:163]
    v_mfma_f32_16x16x32_bf16 v[164:167], a[44:47], v[40:43], v[164:167]
    buffer_load_dwordx4 v[40:43], v4, s[8:11], s46 offen offset:2048 sc1
    s_waitcnt vmcnt(36)
    v_mfma_f32_16x16x32_bf16 v[168:171], a[32:35], v[44:47], v[168:171]
    v_mfma_f32_16x16x32_bf16 v[172:175], a[36:39], v[44:47], v[172:175]
    v_mfma_f32_16x16x32_bf16 v[176:179], a[40:43], v[44:47], v[176:179]
    v_mfma_f32_16x16x32_bf16 v[180:183], a[44:47], v[44:47], v[180:183]
    buffer_load_dwordx4 v[44:47], v4, s[8:11], s47 offen offset:2048 sc1
    s_waitcnt vmcnt(36)
    v_mfma_f32_16x16x32_bf16 v[152:155], a[48:51], v[48:51], v[152:155]
    v_mfma_f32_16x16x32_bf16 v[156:159], a[52:55], v[48:51], v[156:159]
    v_mfma_f32_16x16x32_bf16 v[160:163], a[56:59], v[48:51], v[160:163]
    v_mfma_f32_16x16x32_bf16 v[164:167], a[60:63], v[48:51], v[164:167]
    buffer_load_dwordx4 v[48:51], v4, s[8:11], s46 offen offset:3072 sc1
    s_waitcnt vmcnt(36)
    v_mfma_f32_16x16x32_bf16 v[168:171], a[48:51], v[52:55], v[168:171]
    v_mfma_f32_16x16x32_bf16 v[172:175], a[52:55], v[52:55], v[172:175]
    v_mfma_f32_16x16x32_bf16 v[176:179], a[56:59], v[52:55], v[176:179]
    v_mfma_f32_16x16x32_bf16 v[180:183], a[60:63], v[52:55], v[180:183]
    buffer_load_dwordx4 v[52:55], v4, s[8:11], s47 offen offset:3072 sc1
    s_waitcnt vmcnt(36)
    v_mfma_f32_16x16x32_bf16 v[152:155], a[64:67], v[56:59], v[152:155]
    v_mfma_f32_16x16x32_bf16 v[156:159], a[68:71], v[56:59], v[156:159]
    v_mfma_f32_16x16x32_bf16 v[160:163], a[72:75], v[56:59], v[160:163]
    v_mfma_f32_16x16x32_bf16 v[164:167], a[76:79], v[56:59], v[164:167]
    s_add_u32 s46, s45, 4096
    buffer_load_dwordx4 v[56:59], v4, s[8:11], s46 offen offset:0 sc1
    s_waitcnt vmcnt(36)
    v_mfma_f32_16x16x32_bf16 v[168:171], a[64:67], v[60:63], v[168:171]
    v_mfma_f32_16x16x32_bf16 v[172:175], a[68:71], v[60:63], v[172:175]
    v_mfma_f32_16x16x32_bf16 v[176:179], a[72:75], v[60:63], v[176:179]
    v_mfma_f32_16x16x32_bf16 v[180:183], a[76:79], v[60:63], v[180:183]
    s_add_u32 s47, s45, 20480
    buffer_load_dwordx4 v[60:63], v4, s[8:11], s47 offen offset:0 sc1
    s_waitcnt vmcnt(36)
    v_mfma_f32_16x16x32_bf16 v[152:155], a[80:83], v[64:67], v[152:155]
    v_mfma_f32_16x16x32_bf16 v[156:159], a[84:87], v[64:67], v[156:159]
    v_mfma_f32_16x16x32_bf16 v[160:163], a[88:91], v[64:67], v[160:163]
    v_mfma_f32_16x16x32_bf16 v[164:167], a[92:95], v[64:67], v[164:167]
    buffer_load_dwordx4 v[64:67], v4, s[8:11], s46 offen offset:1024 sc1
    s_waitcnt vmcnt(36)
    v_mfma_f32_16x16x32_bf16 v[168:171], a[80:83], v[68:71], v[168:171]
    v_mfma_f32_16x16x32_bf16 v[172:175], a[84:87], v[68:71], v[172:175]
    v_mfma_f32_16x16x32_bf16 v[176:179], a[88:91], v[68:71], v[176:179]
    v_mfma_f32_16x16x32_bf16 v[180:183], a[92:95], v[68:71], v[180:183]
    buffer_load_dwordx4 v[68:71], v4, s[8:11], s47 offen offset:1024 sc1
    s_waitcnt vmcnt(36)
    v_mfma_f32_16x16x32_bf16 v[152:155], a[96:99], v[72:75], v[152:155]
    v_mfma_f32_16x16x32_bf16 v[156:159], a[100:103], v[72:75], v[156:159]
    v_mfma_f32_16x16x32_bf16 v[160:163], a[104:107], v[72:75], v[160:163]
    v_mfma_f32_16x16x32_bf16 v[164:167], a[108:111], v[72:75], v[164:167]
    buffer_load_dwordx4 v[72:75], v4, s[8:11], s46 offen offset:2048 sc1
    s_waitcnt vmcnt(36)
    v_mfma_f32_16x16x32_bf16 v[168:171], a[96:99], v[76:79], v[168:171]
    v_mfma_f32_16x16x32_bf16 v[172:175], a[100:103], v[76:79], v[172:175]
    v_mfma_f32_16x16x32_bf16 v[176:179], a[104:107], v[76:79], v[176:179]
    v_mfma_f32_16x16x32_bf16 v[180:183], a[108:111], v[76:79], v[180:183]
    buffer_load_dwordx4 v[76:79], v4, s[8:11], s47 offen offset:2048 sc1
    s_waitcnt vmcnt(36)
    v_mfma_f32_16x16x32_bf16 v[152:155], a[112:115], v[80:83], v[152:155]
    v_mfma_f32_16x16x32_bf16 v[156:159], a[116:119], v[80:83], v[156:159]
    v_mfma_f32_16x16x32_bf16 v[160:163], a[120:123], v[80:83], v[160:163]
    v_mfma_f32_16x16x32_bf16 v[164:167], a[124:127], v[80:83], v[164:167]
    buffer_load_dwordx4 v[80:83], v4, s[8:11], s46 offen offset:3072 sc1
    s_waitcnt vmcnt(36)
    v_mfma_f32_16x16x32_bf16 v[168:171], a[112:115], v[84:87], v[168:171]
    v_mfma_f32_16x16x32_bf16 v[172:175], a[116:119], v[84:87], v[172:175]
    v_mfma_f32_16x16x32_bf16 v[176:179], a[120:123], v[84:87], v[176:179]
    v_mfma_f32_16x16x32_bf16 v[180:183], a[124:127], v[84:87], v[180:183]
    buffer_load_dwordx4 v[84:87], v4, s[8:11], s47 offen offset:3072 sc1
    s_waitcnt vmcnt(36)
    v_mfma_f32_16x16x32_bf16 v[152:155], a[128:131], v[88:91], v[152:155]
    v_mfma_f32_16x16x32_bf16 v[156:159], a[132:135], v[88:91], v[156:159]
    v_mfma_f32_16x16x32_bf16 v[160:163], a[136:139], v[88:91], v[160:163]
    v_mfma_f32_16x16x32_bf16 v[164:167], a[140:143], v[88:91], v[164:167]
    s_add_u32 s46, s45, 8192
    buffer_load_dwordx4 v[88:91], v4, s[8:11], s46 offen offset:0 sc1
    s_waitcnt vmcnt(36)
    v_mfma_f32_16x16x32_bf16 v[168:171], a[128:131], v[92:95], v[168:171]
    v_mfma_f32_16x16x32_bf16 v[172:175], a[132:135], v[92:95], v[172:175]
    v_mfma_f32_16x16x32_bf16 v[176:179], a[136:139], v[92:95], v[176:179]
    v_mfma_f32_16x16x32_bf16 v[180:183], a[140:143], v[92:95], v[180:183]
    s_add_u32 s47, s45, 24576
    buffer_load_dwordx4 v[92:95], v4, s[8:11], s47 offen offset:0 sc1
    s_waitcnt vmcnt(36)
    v_mfma_f32_16x16x32_bf16 v[152:155], a[144:147], v[96:99], v[152:155]
    v_mfma_f32_16x16x32_bf16 v[156:159], a[148:151], v[96:99], v[156:159]
    v_mfma_f32_16x16x32_bf16 v[160:163], a[152:155], v[96:99], v[160:163]
    v_mfma_f32_16x16x32_bf16 v[164:167], a[156:159], v[96:99], v[164:167]
    buffer_load_dwordx4 v[96:99], v4, s[8:11], s46 offen offset:1024 sc1
    s_waitcnt vmcnt(36)
    v_mfma_f32_16x16x32_bf16 v[168:171], a[144:147], v[100:103], v[168:171]
    v_mfma_f32_16x16x32_bf16 v[172:175], a[148:151], v[100:103], v[172:175]
    v_mfma_f32_16x16x32_bf16 v[176:179], a[152:155], v[100:103], v[176:179]
    v_mfma_f32_16x16x32_bf16 v[180:183], a[156:159], v[100:103], v[180:183]
    buffer_load_dwordx4 v[100:103], v4, s[8:11], s47 offen offset:1024 sc1
    s_waitcnt vmcnt(36)
    v_mfma_f32_16x16x32_bf16 v[152:155], a[160:163], v[104:107], v[152:155]
    v_mfma_f32_16x16x32_bf16 v[156:159], a[164:167], v[104:107], v[156:159]
    v_mfma_f32_16x16x32_bf16 v[160:163], a[168:171], v[104:107], v[160:163]
    v_mfma_f32_16x16x32_bf16 v[164:167], a[172:175], v[104:107], v[164:167]
    buffer_load_dwordx4 v[104:107], v4, s[8:11], s46 offen offset:2048 sc1
    s_waitcnt vmcnt(36)
    v_mfma_f32_16x16x32_bf16 v[168:171], a[160:163], v[108:111], v[168:171]
    v_mfma_f32_16x16x32_bf16 v[172:175], a[164:167], v[108:111], v[172:175]
    v_mfma_f32_16x16x32_bf16 v[176:179], a[168:171], v[108:111], v[176:179]
    v_mfma_f32_16x16x32_bf16 v[180:183], a[172:175], v[108:111], v[180:183]
    buffer_load_dwordx4 v[108:111], v4, s[8:11], s47 offen offset:2048 sc1
    s_waitcnt vmcnt(36)
    v_mfma_f32_16x16x32_bf16 v[152:155], a[176:179], v[112:115], v[152:155]
    v_mfma_f32_16x16x32_bf16 v[156:159], a[180:183], v[112:115], v[156:159]
    v_mfma_f32_16x16x32_bf16 v[160:163], a[184:187], v[112:115], v[160:163]
    v_mfma_f32_16x16x32_bf16 v[164:167], a[188:191], v[112:115], v[164:167]
    buffer_load_dwordx4 v[112:115], v4, s[8:11], s46 offen offset:3072 sc1
    s_waitcnt vmcnt(36)
    v_mfma_f32_16x16x32_bf16 v[168:171], a[176:179], v[116:119], v[168:171]
    v_mfma_f32_16x16x32_bf16 v[172:175], a[180:183], v[116:119], v[172:175]
    v_mfma_f32_16x16x32_bf16 v[176:179], a[184:187], v[116:119], v[176:179]
    v_mfma_f32_16x16x32_bf16 v[180:183], a[188:191], v[116:119], v[180:183]
    buffer_load_dwordx4 v[116:119], v4, s[8:11], s47 offen offset:3072 sc1
    s_waitcnt vmcnt(36)
    v_mfma_f32_16x16x32_bf16 v[152:155], a[192:195], v[120:123], v[152:155]
    v_mfma_f32_16x16x32_bf16 v[156:159], a[196:199], v[120:123], v[156:159]
    v_mfma_f32_16x16x32_bf16 v[160:163], a[200:203], v[120:123], v[160:163]
    v_mfma_f32_16x16x32_bf16 v[164:167], a[204:207], v[120:123], v[164:167]
    s_add_u32 s46, s45, 12288
    buffer_load_dwordx4 v[120:123], v4, s[8:11], s46 offen offset:0 sc1
    s_waitcnt vmcnt(36)
    v_mfma_f32_16x16x32_bf16 v[168:171], a[192:195], v[124:127], v[168:171]
    v_mfma_f32_16x16x32_bf16 v[172:175], a[196:199], v[124:127], v[172:175]
    v_mfma_f32_16x16x32_bf16 v[176:179], a[200:203], v[124:127], v[176:179]
    v_mfma_f32_16x16x32_bf16 v[180:183], a[204:207], v[124:127], v[180:183]
    s_add_u32 s47, s45, 28672
    buffer_load_dwordx4 v[124:127], v4, s[8:11], s47 offen offset:0 sc1
    s_waitcnt vmcnt(36)
    v_mfma_f32_16x16x32_bf16 v[152:155], a[208:211], v[128:131], v[152:155]
    v_mfma_f32_16x16x32_bf16 v[156:159], a[212:215], v[128:131], v[156:159]
    v_mfma_f32_16x16x32_bf16 v[160:163], a[216:219], v[128:131], v[160:163]
    v_mfma_f32_16x16x32_bf16 v[164:167], a[220:223], v[128:131], v[164:167]
    buffer_load_dwordx4 v[128:131], v4, s[8:11], s46 offen offset:1024 sc1
    s_waitcnt vmcnt(36)
    v_mfma_f32_16x16x32_bf16 v[168:171], a[208:211], v[132:135], v[168:171]
    v_mfma_f32_16x16x32_bf16 v[172:175], a[212:215], v[132:135], v[172:175]
    v_mfma_f32_16x16x32_bf16 v[176:179], a[216:219], v[132:135], v[176:179]
    v_mfma_f32_16x16x32_bf16 v[180:183], a[220:223], v[132:135], v[180:183]
    buffer_load_dwordx4 v[132:135], v4, s[8:11], s47 offen offset:1024 sc1
    s_waitcnt vmcnt(36)
    v_mfma_f32_16x16x32_bf16 v[152:155], a[224:227], v[136:139], v[152:155]
    v_mfma_f32_16x16x32_bf16 v[156:159], a[228:231], v[136:139], v[156:159]
    v_mfma_f32_16x16x32_bf16 v[160:163], a[232:235], v[136:139], v[160:163]
    v_mfma_f32_16x16x32_bf16 v[164:167], a[236:239], v[136:139], v[164:167]
    buffer_load_dwordx4 v[136:139], v4, s[8:11], s46 offen offset:2048 sc1
    s_waitcnt vmcnt(36)
    v_mfma_f32_16x16x32_bf16 v[168:171], a[224:227], v[140:143], v[168:171]
    v_mfma_f32_16x16x32_bf16 v[172:175], a[228:231], v[140:143], v[172:175]
    v_mfma_f32_16x16x32_bf16 v[176:179], a[232:235], v[140:143], v[176:179]
    v_mfma_f32_16x16x32_bf16 v[180:183], a[236:239], v[140:143], v[180:183]
    buffer_load_dwordx4 v[140:143], v4, s[8:11], s47 offen offset:2048 sc1
    s_waitcnt vmcnt(36)
    v_mfma_f32_16x16x32_bf16 v[152:155], a[240:243], v[144:147], v[152:155]
    v_mfma_f32_16x16x32_bf16 v[156:159], a[244:247], v[144:147], v[156:159]
    v_mfma_f32_16x16x32_bf16 v[160:163], a[248:251], v[144:147], v[160:163]
    v_mfma_f32_16x16x32_bf16 v[164:167], a[252:255], v[144:147], v[164:167]
    buffer_load_dwordx4 v[144:147], v4, s[8:11], s46 offen offset:3072 sc1
    s_waitcnt vmcnt(36)
    v_mfma_f32_16x16x32_bf16 v[168:171], a[240:243], v[148:151], v[168:171]
    v_mfma_f32_16x16x32_bf16 v[172:175], a[244:247], v[148:151], v[172:175]
    v_mfma_f32_16x16x32_bf16 v[176:179], a[248:251], v[148:151], v[176:179]
    v_mfma_f32_16x16x32_bf16 v[180:183], a[252:255], v[148:151], v[180:183]
    buffer_load_dwordx4 v[148:151], v4, s[8:11], s47 offen offset:3072 sc1
    s_waitcnt vmcnt(32)
    v_mov_b32 v21, s41
    s_mov_b64 exec, 1
    buffer_store_dword v21, v4, s[8:11], s44 offen sc1
    s_mov_b64 exec, -1
    s_add_u32 s19, s42, 0x1000
    v_cvt_pk_bf16_f32 v152, v152, v153
    v_cvt_pk_bf16_f32 v153, v154, v155
    v_cvt_pk_bf16_f32 v154, v160, v161
    v_cvt_pk_bf16_f32 v155, v162, v163
    buffer_store_dwordx4 v[152:155], v4, s[8:11], s42 offen offset:0 sc1
    v_cvt_pk_bf16_f32 v156, v156, v157
    v_cvt_pk_bf16_f32 v157, v158, v159
    v_cvt_pk_bf16_f32 v158, v164, v165
    v_cvt_pk_bf16_f32 v159, v166, v167
    buffer_store_dwordx4 v[156:159], v4, s[8:11], s42 offen offset:1024 sc1
    v_cvt_pk_bf16_f32 v168, v168, v169
    v_cvt_pk_bf16_f32 v169, v170, v171
    v_cvt_pk_bf16_f32 v170, v176, v177
    v_cvt_pk_bf16_f32 v171, v178, v179
    buffer_store_dwordx4 v[168:171], v4, s[8:11], s19 offen offset:0 sc1
    v_cvt_pk_bf16_f32 v172, v172, v173
    v_cvt_pk_bf16_f32 v173, v174, v175
    v_cvt_pk_bf16_f32 v174, v180, v181
    v_cvt_pk_bf16_f32 v175, v182, v183
    buffer_store_dwordx4 v[172:175], v4, s[8:11], s19 offen offset:1024 sc1
    s_add_u32 s42, s42, s43
    s_add_u32 s41, s41, 1
    s_cmp_eq_u32 s41, 1
    s_cbranch_scc1 G_Q_first
    s_cmp_lt_u32 s41, 16
    s_cbranch_scc1 G_Q
    s_branch G_end
    G_Q_first:
    s_waitcnt vmcnt(0)
    v_mov_b32 v21, s41
    s_mov_b64 exec, 1
    buffer_store_dword v21, v4, s[8:11], s44 offen sc1
    s_mov_b64 exec, -1
    s_mov_b32 s21, 0
    PL_16:
    buffer_load_dwordx2 v[210:211], v20, s[8:11], s22 offen sc1
    s_add_u32 s21, s21, 1
    s_cmp_gt_u32 s21, 400000
    s_cbranch_scc1 F_fail
    s_waitcnt vmcnt(0)
    v_min_u32 v210, v210, v211
    v_cmp_gt_u32 vcc, 1, v210
    s_cbranch_vccz PL_16_ok
    s_sleep 2
    s_branch PL_16
    PL_16_ok:
    s_branch G_Q
    G_V_entry:
    G_V:
    s_add_u32 s45, s45, 0x20000
    s_cmp_eq_u32 s41, 15
    s_cselect_b32 s45, 0x7ff00000, s45
    s_cselect_b32 s49, s48, 0x7ff00000
    s_waitcnt vmcnt(36)
    v_mfma_f32_16x16x32_bf16 v[152:155], v[24:27], a[0:3], 0
    v_mfma_f32_16x16x32_bf16 v[156:159], v[24:27], a[4:7], 0
    v_mfma_f32_16x16x32_bf16 v[160:163], v[24:27], a[8:11], 0
    v_mfma_f32_16x16x32_bf16 v[164:167], v[24:27], a[12:15], 0
    s_add_u32 s46, s45, 0
    buffer_load_dwordx4 v[24:27], v4, s[8:11], s46 offen offset:0 sc1
    s_waitcnt vmcnt(36)
    v_mfma_f32_16x16x32_bf16 v[168:171], v[28:31], a[0:3], 0
    v_mfma_f32_16x16x32_bf16 v[172:175], v[28:31], a[4:7], 0
    v_mfma_f32_16x16x32_bf16 v[176:179], v[28:31], a[8:11], 0
    v_mfma_f32_16x16x32_bf16 v[180:183], v[28:31], a[12:15], 0
    s_add_u32 s47, s45, 16384
    buffer_load_dwordx4 v[28:31], v4, s[8:11], s47 offen offset:0 sc1
    s_waitcnt vmcnt(36)
    v_mfma_f32_16x16x32_bf16 v[152:155], v[32:35], a[16:19], v[152:155]
    v_mfma_f32_16x16x32_bf16 v[156:159], v[32:35], a[20:23], v[156:159]
    v_mfma_f32_16x16x32_bf16 v[160:163], v[32:35], a[24:27], v[160:163]
    v_mfma_f32_16x16x32_bf16 v[164:167], v[32:35], a[28:31], v[164:167]
    buffer_load_dwordx4 v[32:35], v4, s[8:11], s46 offen offset:1024 sc1
    s_waitcnt vmcnt(36)
    v_mfma_f32_16x16x32_bf16 v[168:171], v[36:39], a[16:19], v[168:171]
    v_mfma_f32_16x16x32_bf16 v[172:175], v[36:39], a[20:23], v[172:175]
    v_mfma_f32_16x16x32_bf16 v[176:179], v[36:39], a[24:27], v[176:179]
    v_mfma_f32_16x16x32_bf16 v[180:183], v[36:39], a[28:31], v[180:183]
    buffer_load_dwordx4 v[36:39], v4, s[8:11], s47 offen offset:1024 sc1
    s_waitcnt vmcnt(36)
    v_mfma_f32_16x16x32_bf16 v[152:155], v[40:43], a[32:35], v[152:155]
    v_mfma_f32_16x16x32_bf16 v[156:159], v[40:43], a[36:39], v[156:159]
    v_mfma_f32_16x16x32_bf16 v[160:163], v[40:43], a[40:43], v[160:163]
    v_mfma_f32_16x16x32_bf16 v[164:167], v[40:43], a[44:47], v[164:167]
    buffer_load_dwordx4 v[40:43], v4, s[8:11], s46 offen offset:2048 sc1
    s_waitcnt vmcnt(36)
    v_mfma_f32_16x16x32_bf16 v[168:171], v[44:47], a[32:35], v[168:171]
    v_mfma_f32_16x16x32_bf16 v[172:175], v[44:47], a[36:39], v[172:175]
    v_mfma_f32_16x16x32_bf16 v[176:179], v[44:47], a[40:43], v[176:179]
    v_mfma_f32_16x16x32_bf16 v[180:183], v[44:47], a[44:47], v[180:183]
    buffer_load_dwordx4 v[44:47], v4, s[8:11], s47 offen offset:2048 sc1
    s_waitcnt vmcnt(36)
    v_mfma_f32_16x16x32_bf16 v[152:155], v[48:51], a[48:51], v[152:155]
    v_mfma_f32_16x16x32_bf16 v[156:159], v[48:51], a[52:55], v[156:159]
    v_mfma_f32_16x16x32_bf16 v[160:163], v[48:51], a[56:59], v[160:163]
    v_mfma_f32_16x16x32_bf16 v[164:167], v[48:51], a[60:63], v[164:167]
    buffer_load_dwordx4 v[48:51], v4, s[8:11], s46 offen offset:3072 sc1
    s_waitcnt vmcnt(36)
    v_mfma_f32_16x16x32_bf16 v[168:171], v[52:55], a[48:51], v[168:171]
    v_mfma_f32_16x16x32_bf16 v[172:175], v[52:55], a[52:55], v[172:175]
    v_mfma_f32_16x16x32_bf16 v[176:179], v[52:55], a[56:59], v[176:179]
    v_mfma_f32_16x16x32_bf16 v[180:183], v[52:55], a[60:63], v[180:183]
    buffer_load_dwordx4 v[52:55], v4, s[8:11], s47 offen offset:3072 sc1
    s_waitcnt vmcnt(36)
    v_mfma_f32_16x16x32_bf16 v[152:155], v[56:59], a[64:67], v[152:155]
    v_mfma_f32_16x16x32_bf16 v[156:159], v[56:59], a[68:71], v[156:159]
    v_mfma_f32_16x16x32_bf16 v[160:163], v[56:59], a[72:75], v[160:163]
    v_mfma_f32_16x16x32_bf16 v[164:167], v[56:59], a[76:79], v[164:167]
    s_add_u32 s46, s45, 4096
    buffer_load_dwordx4 v[56:59], v4, s[8:11], s46 offen offset:0 sc1
    s_waitcnt vmcnt(36)
    v_mfma_f32_16x16x32_bf16 v[168:171], v[60:63], a[64:67], v[168:171]
    v_mfma_f32_16x16x32_bf16 v[172:175], v[60:63], a[68:71], v[172:175]
    v_mfma_f32_16x16x32_bf16 v[176:179], v[60:63], a[72:75], v[176:179]
    v_mfma_f32_16x16x32_bf16 v[180:183], v[60:63], a[76:79], v[180:183]
    s_add_u32 s47, s45, 20480
    buffer_load_dwordx4 v[60:63], v4, s[8:11], s47 offen offset:0 sc1
    s_waitcnt vmcnt(36)
    v_mfma_f32_16x16x32_bf16 v[152:155], v[64:67], a[80:83], v[152:155]
    v_mfma_f32_16x16x32_bf16 v[156:159], v[64:67], a[84:87], v[156:159]
    v_mfma_f32_16x16x32_bf16 v[160:163], v[64:67], a[88:91], v[160:163]
    v_mfma_f32_16x16x32_bf16 v[164:167], v[64:67], a[92:95], v[164:167]
    buffer_load_dwordx4 v[64:67], v4, s[8:11], s46 offen offset:1024 sc1
    s_waitcnt vmcnt(36)
    v_mfma_f32_16x16x32_bf16 v[168:171], v[68:71], a[80:83], v[168:171]
    v_mfma_f32_16x16x32_bf16 v[172:175], v[68:71], a[84:87], v[172:175]
    v_mfma_f32_16x16x32_bf16 v[176:179], v[68:71], a[88:91], v[176:179]
    v_mfma_f32_16x16x32_bf16 v[180:183], v[68:71], a[92:95], v[180:183]
    buffer_load_dwordx4 v[68:71], v4, s[8:11], s47 offen offset:1024 sc1
    s_waitcnt vmcnt(36)
    v_mfma_f32_16x16x32_bf16 v[152:155], v[72:75], a[96:99], v[152:155]
    v_mfma_f32_16x16x32_bf16 v[156:159], v[72:75], a[100:103], v[156:159]
    v_mfma_f32_16x16x32_bf16 v[160:163], v[72:75], a[104:107], v[160:163]
    v_mfma_f32_16x16x32_bf16 v[164:167], v[72:75], a[108:111], v[164:167]
    buffer_load_dwordx4 v[72:75], v4, s[8:11], s46 offen offset:2048 sc1
    s_waitcnt vmcnt(36)
    v_mfma_f32_16x16x32_bf16 v[168:171], v[76:79], a[96:99], v[168:171]
    v_mfma_f32_16x16x32_bf16 v[172:175], v[76:79], a[100:103], v[172:175]
    v_mfma_f32_16x16x32_bf16 v[176:179], v[76:79], a[104:107], v[176:179]
    v_mfma_f32_16x16x32_bf16 v[180:183], v[76:79], a[108:111], v[180:183]
    buffer_load_dwordx4 v[76:79], v4, s[8:11], s47 offen offset:2048 sc1
    s_waitcnt vmcnt(36)
    v_mfma_f32_16x16x32_bf16 v[152:155], v[80:83], a[112:115], v[152:155]
    v_mfma_f32_16x16x32_bf16 v[156:159], v[80:83], a[116:119], v[156:159]
    v_mfma_f32_16x16x32_bf16 v[160:163], v[80:83], a[120:123], v[160:163]
    v_mfma_f32_16x16x32_bf16 v[164:167], v[80:83], a[124:127], v[164:167]
    buffer_load_dwordx4 v[80:83], v4, s[8:11], s46 offen offset:3072 sc1
    s_waitcnt vmcnt(36)
    v_mfma_f32_16x16x32_bf16 v[168:171], v[84:87], a[112:115], v[168:171]
    v_mfma_f32_16x16x32_bf16 v[172:175], v[84:87], a[116:119], v[172:175]
    v_mfma_f32_16x16x32_bf16 v[176:179], v[84:87], a[120:123], v[176:179]
    v_mfma_f32_16x16x32_bf16 v[180:183], v[84:87], a[124:127], v[180:183]
    buffer_load_dwordx4 v[84:87], v4, s[8:11], s47 offen offset:3072 sc1
    s_waitcnt vmcnt(36)
    v_mfma_f32_16x16x32_bf16 v[152:155], v[88:91], a[128:131], v[152:155]
    v_mfma_f32_16x16x32_bf16 v[156:159], v[88:91], a[132:135], v[156:159]
    v_mfma_f32_16x16x32_bf16 v[160:163], v[88:91], a[136:139], v[160:163]
    v_mfma_f32_16x16x32_bf16 v[164:167], v[88:91], a[140:143], v[164:167]
    s_add_u32 s46, s45, 8192
    buffer_load_dwordx4 v[88:91], v4, s[8:11], s46 offen offset:0 sc1
    s_waitcnt vmcnt(36)
    v_mfma_f32_16x16x32_bf16 v[168:171], v[92:95], a[128:131], v[168:171]
    v_mfma_f32_16x16x32_bf16 v[172:175], v[92:95], a[132:135], v[172:175]
    v_mfma_f32_16x16x32_bf16 v[176:179], v[92:95], a[136:139], v[176:179]
    v_mfma_f32_16x16x32_bf16 v[180:183], v[92:95], a[140:143], v[180:183]
    s_add_u32 s47, s45, 24576
    buffer_load_dwordx4 v[92:95], v4, s[8:11], s47 offen offset:0 sc1
    s_waitcnt vmcnt(36)
    v_mfma_f32_16x16x32_bf16 v[152:155], v[96:99], a[144:147], v[152:155]
    v_mfma_f32_16x16x32_bf16 v[156:159], v[96:99], a[148:151], v[156:159]
    v_mfma_f32_16x16x32_bf16 v[160:163], v[96:99], a[152:155], v[160:163]
    v_mfma_f32_16x16x32_bf16 v[164:167], v[96:99], a[156:159], v[164:167]
    buffer_load_dwordx4 v[96:99], v4, s[8:11], s46 offen offset:1024 sc1
    s_waitcnt vmcnt(36)
    v_mfma_f32_16x16x32_bf16 v[168:171], v[100:103], a[144:147], v[168:171]
    v_mfma_f32_16x16x32_bf16 v[172:175], v[100:103], a[148:151], v[172:175]
    v_mfma_f32_16x16x32_bf16 v[176:179], v[100:103], a[152:155], v[176:179]
    v_mfma_f32_16x16x32_bf16 v[180:183], v[100:103], a[156:159], v[180:183]
    buffer_load_dwordx4 v[100:103], v4, s[8:11], s47 offen offset:1024 sc1
    s_waitcnt vmcnt(36)
    v_mfma_f32_16x16x32_bf16 v[152:155], v[104:107], a[160:163], v[152:155]
    v_mfma_f32_16x16x32_bf16 v[156:159], v[104:107], a[164:167], v[156:159]
    v_mfma_f32_16x16x32_bf16 v[160:163], v[104:107], a[168:171], v[160:163]
    v_mfma_f32_16x16x32_bf16 v[164:167], v[104:107], a[172:175], v[164:167]
    buffer_load_dwordx4 v[104:107], v4, s[8:11], s46 offen offset:2048 sc1
    s_waitcnt vmcnt(36)
    v_mfma_f32_16x16x32_bf16 v[168:171], v[108:111], a[160:163], v[168:171]
    v_mfma_f32_16x16x32_bf16 v[172:175], v[108:111], a[164:167], v[172:175]
    v_mfma_f32_16x16x32_bf16 v[176:179], v[108:111], a[168:171], v[176:179]
    v_mfma_f32_16x16x32_bf16 v[180:183], v[108:111], a[172:175], v[180:183]
    buffer_load_dwordx4 v[108:111], v4, s[8:11], s47 offen offset:2048 sc1
    s_waitcnt vmcnt(36)
    v_mfma_f32_16x16x32_bf16 v[152:155], v[112:115], a[176:179], v[152:155]
    v_mfma_f32_16x16x32_bf16 v[156:159], v[112:115], a[180:183], v[156:159]
    v_mfma_f32_16x16x32_bf16 v[160:163], v[112:115], a[184:187], v[160:163]
    v_mfma_f32_16x16x32_bf16 v[164:167], v[112:115], a[188:191], v[164:167]
    buffer_load_dwordx4 v[112:115], v4, s[8:11], s46 offen offset:3072 sc1
    s_waitcnt vmcnt(36)
    v_mfma_f32_16x16x32_bf16 v[168:171], v[116:119], a[176:179], v[168:171]
    v_mfma_f32_16x16x32_bf16 v[172:175], v[116:119], a[180:183], v[172:175]
    v_mfma_f32_16x16x32_bf16 v[176:179], v[116:119], a[184:187], v[176:179]
    v_mfma_f32_16x16x32_bf16 v[180:183], v[116:119], a[188:191], v[180:183]
    buffer_load_dwordx4 v[116:119], v4, s[8:11], s47 offen offset:3072 sc1
    s_waitcnt vmcnt(36)
    v_mfma_f32_16x16x32_bf16 v[152:155], v[120:123], a[192:195], v[152:155]
    v_mfma_f32_16x16x32_bf16 v[156:159], v[120:123], a[196:199], v[156:159]
    v_mfma_f32_16x16x32_bf16 v[160:163], v[120:123], a[200:203], v[160:163]
    v_mfma_f32_16x16x32_bf16 v[164:167], v[120:123], a[204:207], v[164:167]
    s_add_u32 s46, s45, 12288
    buffer_load_dwordx4 v[120:123], v4, s[8:11], s46 offen offset:0 sc1
    s_waitcnt vmcnt(36)
    v_mfma_f32_16x16x32_bf16 v[168:171], v[124:127], a[192:195], v[168:171]
    v_mfma_f32_16x16x32_bf16 v[172:175], v[124:127], a[196:199], v[172:175]
    v_mfma_f32_16x16x32_bf16 v[176:179], v[124:127], a[200:203], v[176:179]
    v_mfma_f32_16x16x32_bf16 v[180:183], v[124:127], a[204:207], v[180:183]
    s_add_u32 s47, s45, 28672
    buffer_load_dwordx4 v[124:127], v4, s[8:11], s47 offen offset:0 sc1
    s_waitcnt vmcnt(36)
    v_mfma_f32_16x16x32_bf16 v[152:155], v[128:131], a[208:211], v[152:155]
    v_mfma_f32_16x16x32_bf16 v[156:159], v[128:131], a[212:215], v[156:159]
    v_mfma_f32_16x16x32_bf16 v[160:163], v[128:131], a[216:219], v[160:163]
    v_mfma_f32_16x16x32_bf16 v[164:167], v[128:131], a[220:223], v[164:167]
    buffer_load_dwordx4 v[128:131], v4, s[8:11], s46 offen offset:1024 sc1
    s_waitcnt vmcnt(36)
    v_mfma_f32_16x16x32_bf16 v[168:171], v[132:135], a[208:211], v[168:171]
    v_mfma_f32_16x16x32_bf16 v[172:175], v[132:135], a[212:215], v[172:175]
    v_mfma_f32_16x16x32_bf16 v[176:179], v[132:135], a[216:219], v[176:179]
    v_mfma_f32_16x16x32_bf16 v[180:183], v[132:135], a[220:223], v[180:183]
    buffer_load_dwordx4 v[132:135], v4, s[8:11], s47 offen offset:1024 sc1
    s_waitcnt vmcnt(36)
    v_mfma_f32_16x16x32_bf16 v[152:155], v[136:139], a[224:227], v[152:155]
    v_mfma_f32_16x16x32_bf16 v[156:159], v[136:139], a[228:231], v[156:159]
    v_mfma_f32_16x16x32_bf16 v[160:163], v[136:139], a[232:235], v[160:163]
    v_mfma_f32_16x16x32_bf16 v[164:167], v[136:139], a[236:239], v[164:167]
    buffer_load_dwordx4 v[136:139], v4, s[8:11], s46 offen offset:2048 sc1
    s_waitcnt vmcnt(36)
    v_mfma_f32_16x16x32_bf16 v[168:171], v[140:143], a[224:227], v[168:171]
    v_mfma_f32_16x16x32_bf16 v[172:175], v[140:143], a[228:231], v[172:175]
    v_mfma_f32_16x16x32_bf16 v[176:179], v[140:143], a[232:235], v[176:179]
    v_mfma_f32_16x16x32_bf16 v[180:183], v[140:143], a[236:239], v[180:183]
    buffer_load_dwordx4 v[140:143], v4, s[8:11], s47 offen offset:2048 sc1
    s_waitcnt vmcnt(36)
    v_mfma_f32_16x16x32_bf16 v[152:155], v[144:147], a[240:243], v[152:155]
    v_mfma_f32_16x16x32_bf16 v[156:159], v[144:147], a[244:247], v[156:159]
    v_mfma_f32_16x16x32_bf16 v[160:163], v[144:147], a[248:251], v[160:163]
    v_mfma_f32_16x16x32_bf16 v[164:167], v[144:147], a[252:255], v[164:167]
    buffer_load_dwordx4 v[144:147], v4, s[8:11], s46 offen offset:3072 sc1
    s_waitcnt vmcnt(36)
    v_mfma_f32_16x16x32_bf16 v[168:171], v[148:151], a[240:243], v[168:171]
    v_mfma_f32_16x16x32_bf16 v[172:175], v[148:151], a[244:247], v[172:175]
    v_mfma_f32_16x16x32_bf16 v[176:179], v[148:151], a[248:251], v[176:179]
    v_mfma_f32_16x16x32_bf16 v[180:183], v[148:151], a[252:255], v[180:183]
    buffer_load_dwordx4 v[148:151], v4, s[8:11], s47 offen offset:3072 sc1
    s_waitcnt vmcnt(32)
    v_mov_b32 v21, s41
    s_mov_b64 exec, 1
    buffer_store_dword v21, v4, s[8:11], s44 offen sc1
    s_mov_b64 exec, -1
    v_cvt_pk_bf16_f32 v152, v152, v153
    v_cvt_pk_bf16_f32 v153, v154, v155
    v_cvt_pk_bf16_f32 v154, v168, v169
    v_cvt_pk_bf16_f32 v155, v170, v171
    buffer_store_dwordx4 v[152:155], v4, s[8:11], s42 offen offset:0 sc1
    v_cvt_pk_bf16_f32 v156, v156, v157
    v_cvt_pk_bf16_f32 v157, v158, v159
    v_cvt_pk_bf16_f32 v158, v172, v173
    v_cvt_pk_bf16_f32 v159, v174, v175
    buffer_store_dwordx4 v[156:159], v4, s[8:11], s42 offen offset:1024 sc1
    v_cvt_pk_bf16_f32 v160, v160, v161
    v_cvt_pk_bf16_f32 v161, v162, v163
    v_cvt_pk_bf16_f32 v162, v176, v177
    v_cvt_pk_bf16_f32 v163, v178, v179
    buffer_store_dwordx4 v[160:163], v4, s[8:11], s42 offen offset:2048 sc1
    v_cvt_pk_bf16_f32 v164, v164, v165
    v_cvt_pk_bf16_f32 v165, v166, v167
    v_cvt_pk_bf16_f32 v166, v180, v181
    v_cvt_pk_bf16_f32 v167, v182, v183
    buffer_store_dwordx4 v[164:167], v4, s[8:11], s42 offen offset:3072 sc1
    s_add_u32 s42, s42, s43
    s_add_u32 s41, s41, 1
    s_cmp_eq_u32 s41, 1
    s_cbranch_scc1 G_V_first
    s_cmp_lt_u32 s41, 16
    s_cbranch_scc1 G_V
    s_branch G_end
    G_V_first:
    s_waitcnt vmcnt(0)
    v_mov_b32 v21, s41
    s_mov_b64 exec, 1
    buffer_store_dword v21, v4, s[8:11], s44 offen sc1
    s_mov_b64 exec, -1
    s_mov_b32 s21, 0
    PL_17:
    buffer_load_dwordx2 v[210:211], v20, s[8:11], s22 offen sc1
    s_add_u32 s21, s21, 1
    s_cmp_gt_u32 s21, 400000
    s_cbranch_scc1 F_fail
    s_waitcnt vmcnt(0)
    v_min_u32 v210, v210, v211
    v_cmp_gt_u32 vcc, 1, v210
    s_cbranch_vccz PL_17_ok
    s_sleep 2
    s_branch PL_17
    PL_17_ok:
    s_branch G_V
    G_H_entry:
    G_H:
    s_add_u32 s45, s45, 0x20000
    s_cmp_eq_u32 s41, 15
    s_cselect_b32 s45, 0x7ff00000, s45
    s_cselect_b32 s49, s48, 0x7ff00000
    s_waitcnt vmcnt(36)
    v_mfma_f32_16x16x32_bf16 v[152:155], a[0:3], v[24:27], 0
    v_mfma_f32_16x16x32_bf16 v[156:159], a[4:7], v[24:27], 0
    v_mfma_f32_16x16x32_bf16 v[160:163], a[8:11], v[24:27], 0
    v_mfma_f32_16x16x32_bf16 v[164:167], a[12:15], v[24:27], 0
    s_add_u32 s46, s45, 0
    buffer_load_dwordx4 v[24:27], v4, s[8:11], s46 offen offset:0 sc1
    s_waitcnt vmcnt(36)
    v_mfma_f32_16x16x32_bf16 v[168:171], a[0:3], v[28:31], 0
    v_mfma_f32_16x16x32_bf16 v[172:175], a[4:7], v[28:31], 0
    v_mfma_f32_16x16x32_bf16 v[176:179], a[8:11], v[28:31], 0
    v_mfma_f32_16x16x32_bf16 v[180:183], a[12:15], v[28:31], 0
    s_add_u32 s47, s45, 16384
    buffer_load_dwordx4 v[28:31], v4, s[8:11], s47 offen offset:0 sc1
    s_waitcnt vmcnt(36)
    v_mfma_f32_16x16x32_bf16 v[152:155], a[16:19], v[32:35], v[152:155]
    v_mfma_f32_16x16x32_bf16 v[156:159], a[20:23], v[32:35], v[156:159]
    v_mfma_f32_16x16x32_bf16 v[160:163], a[24:27], v[32:35], v[160:163]
    v_mfma_f32_16x16x32_bf16 v[164:167], a[28:31], v[32:35], v[164:167]
    buffer_load_dwordx4 v[32:35], v4, s[8:11], s46 offen offset:1024 sc1
    s_waitcnt vmcnt(36)
    v_mfma_f32_16x16x32_bf16 v[168:171], a[16:19], v[36:39], v[168:171]
    v_mfma_f32_16x16x32_bf16 v[172:175], a[20:23], v[36:39], v[172:175]
    v_mfma_f32_16x16x32_bf16 v[176:179], a[24:27], v[36:39], v[176:179]
    v_mfma_f32_16x16x32_bf16 v[180:183], a[28:31], v[36:39], v[180:183]
    buffer_load_dwordx4 v[36:39], v4, s[8:11], s47 offen offset:1024 sc1
    s_waitcnt vmcnt(36)
    v_mfma_f32_16x16x32_bf16 v[152:155], a[32:35], v[40:43], v[152:155]
    v_mfma_f32_16x16x32_bf16 v[156:159], a[36:39], v[40:43], v[156:159]
    v_mfma_f32_16x16x32_bf16 v[160:163], a[40:43], v[40:43], v[160:163]
    v_mfma_f32_16x16x32_bf16 v[164:167], a[44:47], v[40:43], v[164:167]
    buffer_load_dwordx4 v[40:43], v4, s[8:11], s46 offen offset:2048 sc1
    s_waitcnt vmcnt(36)
    v_mfma_f32_16x16x32_bf16 v[168:171], a[32:35], v[44:47], v[168:171]
    v_mfma_f32_16x16x32_bf16 v[172:175], a[36:39], v[44:47], v[172:175]
    v_mfma_f32_16x16x32_bf16 v[176:179], a[40:43], v[44:47], v[176:179]
    v_mfma_f32_16x16x32_bf16 v[180:183], a[44:47], v[44:47], v[180:183]
    buffer_load_dwordx4 v[44:47], v4, s[8:11], s47 offen offset:2048 sc1
    s_waitcnt vmcnt(36)
    v_mfma_f32_16x16x32_bf16 v[152:155], a[48:51], v[48:51], v[152:155]
    v_mfma_f32_16x16x32_bf16 v[156:159], a[52:55], v[48:51], v[156:159]
    v_mfma_f32_16x16x32_bf16 v[160:163], a[56:59], v[48:51], v[160:163]
    v_mfma_f32_16x16x32_bf16 v[164:167], a[60:63], v[48:51], v[164:167]
    buffer_load_dwordx4 v[48:51], v4, s[8:11], s46 offen offset:3072 sc1
    s_waitcnt vmcnt(36)
    v_mfma_f32_16x16x32_bf16 v[168:171], a[48:51], v[52:55], v[168:171]
    v_mfma_f32_16x16x32_bf16 v[172:175], a[52:55], v[52:55], v[172:175]
    v_mfma_f32_16x16x32_bf16 v[176:179], a[56:59], v[52:55], v[176:179]
    v_mfma_f32_16x16x32_bf16 v[180:183], a[60:63], v[52:55], v[180:183]
    buffer_load_dwordx4 v[52:55], v4, s[8:11], s47 offen offset:3072 sc1
    s_waitcnt vmcnt(36)
    v_mfma_f32_16x16x32_bf16 v[152:155], a[64:67], v[56:59], v[152:155]
    v_mfma_f32_16x16x32_bf16 v[156:159], a[68:71], v[56:59], v[156:159]
    v_mfma_f32_16x16x32_bf16 v[160:163], a[72:75], v[56:59], v[160:163]
    v_mfma_f32_16x16x32_bf16 v[164:167], a[76:79], v[56:59], v[164:167]
    s_add_u32 s46, s45, 4096
    buffer_load_dwordx4 v[56:59], v4, s[8:11], s46 offen offset:0 sc1
    s_waitcnt vmcnt(36)
    v_mfma_f32_16x16x32_bf16 v[168:171], a[64:67], v[60:63], v[168:171]
    v_mfma_f32_16x16x32_bf16 v[172:175], a[68:71], v[60:63], v[172:175]
    v_mfma_f32_16x16x32_bf16 v[176:179], a[72:75], v[60:63], v[176:179]
    v_mfma_f32_16x16x32_bf16 v[180:183], a[76:79], v[60:63], v[180:183]
    s_add_u32 s47, s45, 20480
    buffer_load_dwordx4 v[60:63], v4, s[8:11], s47 offen offset:0 sc1
    s_waitcnt vmcnt(36)
    v_mfma_f32_16x16x32_bf16 v[152:155], a[80:83], v[64:67], v[152:155]
    v_mfma_f32_16x16x32_bf16 v[156:159], a[84:87], v[64:67], v[156:159]
    v_mfma_f32_16x16x32_bf16 v[160:163], a[88:91], v[64:67], v[160:163]
    v_mfma_f32_16x16x32_bf16 v[164:167], a[92:95], v[64:67], v[164:167]
    buffer_load_dwordx4 v[64:67], v4, s[8:11], s46 offen offset:1024 sc1
    s_waitcnt vmcnt(36)
    v_mfma_f32_16x16x32_bf16 v[168:171], a[80:83], v[68:71], v[168:171]
    v_mfma_f32_16x16x32_bf16 v[172:175], a[84:87], v[68:71], v[172:175]
    v_mfma_f32_16x16x32_bf16 v[176:179], a[88:91], v[68:71], v[176:179]
    v_mfma_f32_16x16x32_bf16 v[180:183], a[92:95], v[68:71], v[180:183]
    buffer_load_dwordx4 v[68:71], v4, s[8:11], s47 offen offset:1024 sc1
    s_waitcnt vmcnt(36)
    v_mfma_f32_16x16x32_bf16 v[152:155], a[96:99], v[72:75], v[152:155]
    v_mfma_f32_16x16x32_bf16 v[156:159], a[100:103], v[72:75], v[156:159]
    v_mfma_f32_16x16x32_bf16 v[160:163], a[104:107], v[72:75], v[160:163]
    v_mfma_f32_16x16x32_bf16 v[164:167], a[108:111], v[72:75], v[164:167]
    buffer_load_dwordx4 v[72:75], v4, s[8:11], s46 offen offset:2048 sc1
    s_waitcnt vmcnt(36)
    v_mfma_f32_16x16x32_bf16 v[168:171], a[96:99], v[76:79], v[168:171]
    v_mfma_f32_16x16x32_bf16 v[172:175], a[100:103], v[76:79], v[172:175]
    v_mfma_f32_16x16x32_bf16 v[176:179], a[104:107], v[76:79], v[176:179]
    v_mfma_f32_16x16x32_bf16 v[180:183], a[108:111], v[76:79], v[180:183]
    buffer_load_dwordx4 v[76:79], v4, s[8:11], s47 offen offset:2048 sc1
    s_waitcnt vmcnt(36)
    v_mfma_f32_16x16x32_bf16 v[152:155], a[112:115], v[80:83], v[152:155]
    v_mfma_f32_16x16x32_bf16 v[156:159], a[116:119], v[80:83], v[156:159]
    v_mfma_f32_16x16x32_bf16 v[160:163], a[120:123], v[80:83], v[160:163]
    v_mfma_f32_16x16x32_bf16 v[164:167], a[124:127], v[80:83], v[164:167]
    buffer_load_dwordx4 v[80:83], v4, s[8:11], s46 offen offset:3072 sc1
    s_waitcnt vmcnt(36)
    v_mfma_f32_16x16x32_bf16 v[168:171], a[112:115], v[84:87], v[168:171]
    v_mfma_f32_16x16x32_bf16 v[172:175], a[116:119], v[84:87], v[172:175]
    v_mfma_f32_16x16x32_bf16 v[176:179], a[120:123], v[84:87], v[176:179]
    v_mfma_f32_16x16x32_bf16 v[180:183], a[124:127], v[84:87], v[180:183]
    buffer_load_dwordx4 v[84:87], v4, s[8:11], s47 offen offset:3072 sc1
    s_waitcnt vmcnt(36)
    v_mfma_f32_16x16x32_bf16 v[152:155], a[128:131], v[88:91], v[152:155]
    v_mfma_f32_16x16x32_bf16 v[156:159], a[132:135], v[88:91], v[156:159]
    v_mfma_f32_16x16x32_bf16 v[160:163], a[136:139], v[88:91], v[160:163]
    v_mfma_f32_16x16x32_bf16 v[164:167], a[140:143], v[88:91], v[164:167]
    s_add_u32 s46, s45, 8192
    buffer_load_dwordx4 v[88:91], v4, s[8:11], s46 offen offset:0 sc1
    s_waitcnt vmcnt(36)
    v_mfma_f32_16x16x32_bf16 v[168:171], a[128:131], v[92:95], v[168:171]
    v_mfma_f32_16x16x32_bf16 v[172:175], a[132:135], v[92:95], v[172:175]
    v_mfma_f32_16x16x32_bf16 v[176:179], a[136:139], v[92:95], v[176:179]
    v_mfma_f32_16x16x32_bf16 v[180:183], a[140:143], v[92:95], v[180:183]
    s_add_u32 s47, s45, 24576
    buffer_load_dwordx4 v[92:95], v4, s[8:11], s47 offen offset:0 sc1
    s_waitcnt vmcnt(36)
    v_mfma_f32_16x16x32_bf16 v[152:155], a[144:147], v[96:99], v[152:155]
    v_mfma_f32_16x16x32_bf16 v[156:159], a[148:151], v[96:99], v[156:159]
    v_mfma_f32_16x16x32_bf16 v[160:163], a[152:155], v[96:99], v[160:163]
    v_mfma_f32_16x16x32_bf16 v[164:167], a[156:159], v[96:99], v[164:167]
    buffer_load_dwordx4 v[96:99], v4, s[8:11], s46 offen offset:1024 sc1
    s_waitcnt vmcnt(36)
    v_mfma_f32_16x16x32_bf16 v[168:171], a[144:147], v[100:103], v[168:171]
    v_mfma_f32_16x16x32_bf16 v[172:175], a[148:151], v[100:103], v[172:175]
    v_mfma_f32_16x16x32_bf16 v[176:179], a[152:155], v[100:103], v[176:179]
    v_mfma_f32_16x16x32_bf16 v[180:183], a[156:159], v[100:103], v[180:183]
    buffer_load_dwordx4 v[100:103], v4, s[8:11], s47 offen offset:1024 sc1
    s_waitcnt vmcnt(36)
    v_mfma_f32_16x16x32_bf16 v[152:155], a[160:163], v[104:107], v[152:155]
    v_mfma_f32_16x16x32_bf16 v[156:159], a[164:167], v[104:107], v[156:159]
    v_mfma_f32_16x16x32_bf16 v[160:163], a[168:171], v[104:107], v[160:163]
    v_mfma_f32_16x16x32_bf16 v[164:167], a[172:175], v[104:107], v[164:167]
    buffer_load_dwordx4 v[104:107], v4, s[8:11], s46 offen offset:2048 sc1
    s_waitcnt vmcnt(36)
    v_mfma_f32_16x16x32_bf16 v[168:171], a[160:163], v[108:111], v[168:171]
    v_mfma_f32_16x16x32_bf16 v[172:175], a[164:167], v[108:111], v[172:175]
    v_mfma_f32_16x16x32_bf16 v[176:179], a[168:171], v[108:111], v[176:179]
    v_mfma_f32_16x16x32_bf16 v[180:183], a[172:175], v[108:111], v[180:183]
    buffer_load_dwordx4 v[108:111], v4, s[8:11], s47 offen offset:2048 sc1
    s_waitcnt vmcnt(36)
    v_mfma_f32_16x16x32_bf16 v[152:155], a[176:179], v[112:115], v[152:155]
    v_mfma_f32_16x16x32_bf16 v[156:159], a[180:183], v[112:115], v[156:159]
    v_mfma_f32_16x16x32_bf16 v[160:163], a[184:187], v[112:115], v[160:163]
    v_mfma_f32_16x16x32_bf16 v[164:167], a[188:191], v[112:115], v[164:167]
    buffer_load_dwordx4 v[112:115], v4, s[8:11], s46 offen offset:3072 sc1
    s_waitcnt vmcnt(36)
    v_mfma_f32_16x16x32_bf16 v[168:171], a[176:179], v[116:119], v[168:171]
    v_mfma_f32_16x16x32_bf16 v[172:175], a[180:183], v[116:119], v[172:175]
    v_mfma_f32_16x16x32_bf16 v[176:179], a[184:187], v[116:119], v[176:179]
    v_mfma_f32_16x16x32_bf16 v[180:183], a[188:191], v[116:119], v[180:183]
    buffer_load_dwordx4 v[116:119], v4, s[8:11], s47 offen offset:3072 sc1
    s_waitcnt vmcnt(36)
    v_mfma_f32_16x16x32_bf16 v[152:155], a[192:195], v[120:123], v[152:155]
    v_mfma_f32_16x16x32_bf16 v[156:159], a[196:199], v[120:123], v[156:159]
    v_mfma_f32_16x16x32_bf16 v[160:163], a[200:203], v[120:123], v[160:163]
    v_mfma_f32_16x16x32_bf16 v[164:167], a[204:207], v[120:123], v[164:167]
    s_add_u32 s46, s45, 12288
    buffer_load_dwordx4 v[120:123], v4, s[8:11], s46 offen offset:0 sc1
    s_waitcnt vmcnt(36)
    v_mfma_f32_16x16x32_bf16 v[168:171], a[192:195], v[124:127], v[168:171]
    v_mfma_f32_16x16x32_bf16 v[172:175], a[196:199], v[124:127], v[172:175]
    v_mfma_f32_16x16x32_bf16 v[176:179], a[200:203], v[124:127], v[176:179]
    v_mfma_f32_16x16x32_bf16 v[180:183], a[204:207], v[124:127], v[180:183]
    s_add_u32 s47, s45, 28672
    buffer_load_dwordx4 v[124:127], v4, s[8:11], s47 offen offset:0 sc1
    s_waitcnt vmcnt(36)
    v_mfma_f32_16x16x32_bf16 v[152:155], a[208:211], v[128:131], v[152:155]
    v_mfma_f32_16x16x32_bf16 v[156:159], a[212:215], v[128:131], v[156:159]
    v_mfma_f32_16x16x32_bf16 v[160:163], a[216:219], v[128:131], v[160:163]
    v_mfma_f32_16x16x32_bf16 v[164:167], a[220:223], v[128:131], v[164:167]
    buffer_load_dwordx4 v[128:131], v4, s[8:11], s46 offen offset:1024 sc1
    s_waitcnt vmcnt(36)
    v_mfma_f32_16x16x32_bf16 v[168:171], a[208:211], v[132:135], v[168:171]
    v_mfma_f32_16x16x32_bf16 v[172:175], a[212:215], v[132:135], v[172:175]
    v_mfma_f32_16x16x32_bf16 v[176:179], a[216:219], v[132:135], v[176:179]
    v_mfma_f32_16x16x32_bf16 v[180:183], a[220:223], v[132:135], v[180:183]
    buffer_load_dwordx4 v[132:135], v4, s[8:11], s47 offen offset:1024 sc1
    s_waitcnt vmcnt(36)
    v_mfma_f32_16x16x32_bf16 v[152:155], a[224:227], v[136:139], v[152:155]
    v_mfma_f32_16x16x32_bf16 v[156:159], a[228:231], v[136:139], v[156:159]
    v_mfma_f32_16x16x32_bf16 v[160:163], a[232:235], v[136:139], v[160:163]
    v_mfma_f32_16x16x32_bf16 v[164:167], a[236:239], v[136:139], v[164:167]
    buffer_load_dwordx4 v[136:139], v4, s[8:11], s46 offen offset:2048 sc1
    s_waitcnt vmcnt(36)
    v_mfma_f32_16x16x32_bf16 v[168:171], a[224:227], v[140:143], v[168:171]
    v_mfma_f32_16x16x32_bf16 v[172:175], a[228:231], v[140:143], v[172:175]
    v_mfma_f32_16x16x32_bf16 v[176:179], a[232:235], v[140:143], v[176:179]
    v_mfma_f32_16x16x32_bf16 v[180:183], a[236:239], v[140:143], v[180:183]
    buffer_load_dwordx4 v[140:143], v4, s[8:11], s47 offen offset:2048 sc1
    s_waitcnt vmcnt(36)
    v_mfma_f32_16x16x32_bf16 v[152:155], a[240:243], v[144:147], v[152:155]
    v_mfma_f32_16x16x32_bf16 v[156:159], a[244:247], v[144:147], v[156:159]
    v_mfma_f32_16x16x32_bf16 v[160:163], a[248:251], v[144:147], v[160:163]
    v_mfma_f32_16x16x32_bf16 v[164:167], a[252:255], v[144:147], v[164:167]
    buffer_load_dwordx4 v[144:147], v4, s[8:11], s46 offen offset:3072 sc1
    s_waitcnt vmcnt(36)
    v_mfma_f32_16x16x32_bf16 v[168:171], a[240:243], v[148:151], v[168:171]
    v_mfma_f32_16x16x32_bf16 v[172:175], a[244:247], v[148:151], v[172:175]
    v_mfma_f32_16x16x32_bf16 v[176:179], a[248:251], v[148:151], v[176:179]
    v_mfma_f32_16x16x32_bf16 v[180:183], a[252:255], v[148:151], v[180:183]
    buffer_load_dwordx4 v[148:151], v4, s[8:11], s47 offen offset:3072 sc1
    s_waitcnt vmcnt(32)
    v_mov_b32 v21, s41
    s_mov_b64 exec, 1
    buffer_store_dword v21, v4, s[8:11], s44 offen sc1
    s_mov_b64 exec, -1
    s_add_u32 s19, s42, 44032
    v_lshlrev_b32 v184, 16, v200
    v_and_b32 v185, 0xffff0000, v200
    v_lshlrev_b32 v186, 16, v201
    v_and_b32 v187, 0xffff0000, v201
    v_lshlrev_b32 v188, 16, v202
    v_and_b32 v189, 0xffff0000, v202
    v_lshlrev_b32 v190, 16, v203
    v_and_b32 v191, 0xffff0000, v203
    v_lshlrev_b32 v192, 16, v204
    v_and_b32 v193, 0xffff0000, v204
    v_lshlrev_b32 v194, 16, v205
    v_and_b32 v195, 0xffff0000, v205
    v_lshlrev_b32 v196, 16, v206
    v_and_b32 v197, 0xffff0000, v206
    v_lshlrev_b32 v198, 16, v207
    v_and_b32 v199, 0xffff0000, v207
    v_cvt_pk_bf16_f32 v153, v152, v153
    v_lshlrev_b32 v152, 16, v153
    v_and_b32 v153, 0xffff0000, v153
    v_add_f32 v152, v152, v184
    v_add_f32 v153, v153, v185
    v_cvt_pk_bf16_f32 v153, v152, v153
    v_lshlrev_b32 v152, 16, v153
    v_and_b32 v153, 0xffff0000, v153
    v_max_f32 v152, 0, v152
    v_max_f32 v153, 0, v153
    v_mul_f32 v152, v152, v152
    v_mul_f32 v153, v153, v153
    v_cvt_pk_bf16_f32 v152, v152, v153
    v_cvt_pk_bf16_f32 v155, v154, v155
    v_lshlrev_b32 v154, 16, v155
    v_and_b32 v155, 0xffff0000, v155
    v_add_f32 v154, v154, v186
    v_add_f32 v155, v155, v187
    v_cvt_pk_bf16_f32 v155, v154, v155
    v_lshlrev_b32 v154, 16, v155
    v_and_b32 v155, 0xffff0000, v155
    v_max_f32 v154, 0, v154
    v_max_f32 v155, 0, v155
    v_mul_f32 v154, v154, v154
    v_mul_f32 v155, v155, v155
    v_cvt_pk_bf16_f32 v153, v154, v155
    v_cvt_pk_bf16_f32 v157, v156, v157
    v_lshlrev_b32 v156, 16, v157
    v_and_b32 v157, 0xffff0000, v157
    v_add_f32 v156, v156, v188
    v_add_f32 v157, v157, v189
    v_cvt_pk_bf16_f32 v157, v156, v157
    v_lshlrev_b32 v156, 16, v157
    v_and_b32 v157, 0xffff0000, v157
    v_max_f32 v156, 0, v156
    v_max_f32 v157, 0, v157
    v_mul_f32 v156, v156, v156
    v_mul_f32 v157, v157, v157
    v_cvt_pk_bf16_f32 v154, v156, v157
    v_cvt_pk_bf16_f32 v159, v158, v159
    v_lshlrev_b32 v158, 16, v159
    v_and_b32 v159, 0xffff0000, v159
    v_add_f32 v158, v158, v190
    v_add_f32 v159, v159, v191
    v_cvt_pk_bf16_f32 v159, v158, v159
    v_lshlrev_b32 v158, 16, v159
    v_and_b32 v159, 0xffff0000, v159
    v_max_f32 v158, 0, v158
    v_max_f32 v159, 0, v159
    v_mul_f32 v158, v158, v158
    v_mul_f32 v159, v159, v159
    v_cvt_pk_bf16_f32 v155, v158, v159
    buffer_store_dwordx4 v[152:155], v4, s[8:11], s42 offen offset:0 sc1
    v_cvt_pk_bf16_f32 v161, v160, v161
    v_lshlrev_b32 v160, 16, v161
    v_and_b32 v161, 0xffff0000, v161
    v_add_f32 v160, v160, v192
    v_add_f32 v161, v161, v193
    v_cvt_pk_bf16_f32 v161, v160, v161
    v_lshlrev_b32 v160, 16, v161
    v_and_b32 v161, 0xffff0000, v161
    v_max_f32 v160, 0, v160
    v_max_f32 v161, 0, v161
    v_mul_f32 v160, v160, v160
    v_mul_f32 v161, v161, v161
    v_cvt_pk_bf16_f32 v160, v160, v161
    v_cvt_pk_bf16_f32 v163, v162, v163
    v_lshlrev_b32 v162, 16, v163
    v_and_b32 v163, 0xffff0000, v163
    v_add_f32 v162, v162, v194
    v_add_f32 v163, v163, v195
    v_cvt_pk_bf16_f32 v163, v162, v163
    v_lshlrev_b32 v162, 16, v163
    v_and_b32 v163, 0xffff0000, v163
    v_max_f32 v162, 0, v162
    v_max_f32 v163, 0, v163
    v_mul_f32 v162, v162, v162
    v_mul_f32 v163, v163, v163
    v_cvt_pk_bf16_f32 v161, v162, v163
    v_cvt_pk_bf16_f32 v165, v164, v165
    v_lshlrev_b32 v164, 16, v165
    v_and_b32 v165, 0xffff0000, v165
    v_add_f32 v164, v164, v196
    v_add_f32 v165, v165, v197
    v_cvt_pk_bf16_f32 v165, v164, v165
    v_lshlrev_b32 v164, 16, v165
    v_and_b32 v165, 0xffff0000, v165
    v_max_f32 v164, 0, v164
    v_max_f32 v165, 0, v165
    v_mul_f32 v164, v164, v164
    v_mul_f32 v165, v165, v165
    v_cvt_pk_bf16_f32 v162, v164, v165
    v_cvt_pk_bf16_f32 v167, v166, v167
    v_lshlrev_b32 v166, 16, v167
    v_and_b32 v167, 0xffff0000, v167
    v_add_f32 v166, v166, v198
    v_add_f32 v167, v167, v199
    v_cvt_pk_bf16_f32 v167, v166, v167
    v_lshlrev_b32 v166, 16, v167
    v_and_b32 v167, 0xffff0000, v167
    v_max_f32 v166, 0, v166
    v_max_f32 v167, 0, v167
    v_mul_f32 v166, v166, v166
    v_mul_f32 v167, v167, v167
    v_cvt_pk_bf16_f32 v163, v166, v167
    buffer_store_dwordx4 v[160:163], v19, s[8:11], s42 offen offset:1024 sc1
    v_cvt_pk_bf16_f32 v169, v168, v169
    v_lshlrev_b32 v168, 16, v169
    v_and_b32 v169, 0xffff0000, v169
    v_add_f32 v168, v168, v184
    v_add_f32 v169, v169, v185
    v_cvt_pk_bf16_f32 v169, v168, v169
    v_lshlrev_b32 v168, 16, v169
    v_and_b32 v169, 0xffff0000, v169
    v_max_f32 v168, 0, v168
    v_max_f32 v169, 0, v169
    v_mul_f32 v168, v168, v168
    v_mul_f32 v169, v169, v169
    v_cvt_pk_bf16_f32 v168, v168, v169
    v_cvt_pk_bf16_f32 v171, v170, v171
    v_lshlrev_b32 v170, 16, v171
    v_and_b32 v171, 0xffff0000, v171
    v_add_f32 v170, v170, v186
    v_add_f32 v171, v171, v187
    v_cvt_pk_bf16_f32 v171, v170, v171
    v_lshlrev_b32 v170, 16, v171
    v_and_b32 v171, 0xffff0000, v171
    v_max_f32 v170, 0, v170
    v_max_f32 v171, 0, v171
    v_mul_f32 v170, v170, v170
    v_mul_f32 v171, v171, v171
    v_cvt_pk_bf16_f32 v169, v170, v171
    v_cvt_pk_bf16_f32 v173, v172, v173
    v_lshlrev_b32 v172, 16, v173
    v_and_b32 v173, 0xffff0000, v173
    v_add_f32 v172, v172, v188
    v_add_f32 v173, v173, v189
    v_cvt_pk_bf16_f32 v173, v172, v173
    v_lshlrev_b32 v172, 16, v173
    v_and_b32 v173, 0xffff0000, v173
    v_max_f32 v172, 0, v172
    v_max_f32 v173, 0, v173
    v_mul_f32 v172, v172, v172
    v_mul_f32 v173, v173, v173
    v_cvt_pk_bf16_f32 v170, v172, v173
    v_cvt_pk_bf16_f32 v175, v174, v175
    v_lshlrev_b32 v174, 16, v175
    v_and_b32 v175, 0xffff0000, v175
    v_add_f32 v174, v174, v190
    v_add_f32 v175, v175, v191
    v_cvt_pk_bf16_f32 v175, v174, v175
    v_lshlrev_b32 v174, 16, v175
    v_and_b32 v175, 0xffff0000, v175
    v_max_f32 v174, 0, v174
    v_max_f32 v175, 0, v175
    v_mul_f32 v174, v174, v174
    v_mul_f32 v175, v175, v175
    v_cvt_pk_bf16_f32 v171, v174, v175
    buffer_store_dwordx4 v[168:171], v4, s[8:11], s19 offen offset:0 sc1
    v_cvt_pk_bf16_f32 v177, v176, v177
    v_lshlrev_b32 v176, 16, v177
    v_and_b32 v177, 0xffff0000, v177
    v_add_f32 v176, v176, v192
    v_add_f32 v177, v177, v193
    v_cvt_pk_bf16_f32 v177, v176, v177
    v_lshlrev_b32 v176, 16, v177
    v_and_b32 v177, 0xffff0000, v177
    v_max_f32 v176, 0, v176
    v_max_f32 v177, 0, v177
    v_mul_f32 v176, v176, v176
    v_mul_f32 v177, v177, v177
    v_cvt_pk_bf16_f32 v176, v176, v177
    v_cvt_pk_bf16_f32 v179, v178, v179
    v_lshlrev_b32 v178, 16, v179
    v_and_b32 v179, 0xffff0000, v179
    v_add_f32 v178, v178, v194
    v_add_f32 v179, v179, v195
    v_cvt_pk_bf16_f32 v179, v178, v179
    v_lshlrev_b32 v178, 16, v179
    v_and_b32 v179, 0xffff0000, v179
    v_max_f32 v178, 0, v178
    v_max_f32 v179, 0, v179
    v_mul_f32 v178, v178, v178
    v_mul_f32 v179, v179, v179
    v_cvt_pk_bf16_f32 v177, v178, v179
    v_cvt_pk_bf16_f32 v181, v180, v181
    v_lshlrev_b32 v180, 16, v181
    v_and_b32 v181, 0xffff0000, v181
    v_add_f32 v180, v180, v196
    v_add_f32 v181, v181, v197
    v_cvt_pk_bf16_f32 v181, v180, v181
    v_lshlrev_b32 v180, 16, v181
    v_and_b32 v181, 0xffff0000, v181
    v_max_f32 v180, 0, v180
    v_max_f32 v181, 0, v181
    v_mul_f32 v180, v180, v180
    v_mul_f32 v181, v181, v181
    v_cvt_pk_bf16_f32 v178, v180, v181
    v_cvt_pk_bf16_f32 v183, v182, v183
    v_lshlrev_b32 v182, 16, v183
    v_and_b32 v183, 0xffff0000, v183
    v_add_f32 v182, v182, v198
    v_add_f32 v183, v183, v199
    v_cvt_pk_bf16_f32 v183, v182, v183
    v_lshlrev_b32 v182, 16, v183
    v_and_b32 v183, 0xffff0000, v183
    v_max_f32 v182, 0, v182
    v_max_f32 v183, 0, v183
    v_mul_f32 v182, v182, v182
    v_mul_f32 v183, v183, v183
    v_cvt_pk_bf16_f32 v179, v182, v183
    buffer_store_dwordx4 v[176:179], v19, s[8:11], s19 offen offset:1024 sc1
    s_add_u32 s42, s42, s43
    s_add_u32 s41, s41, 1
    s_cmp_eq_u32 s41, 1
    s_cbranch_scc1 G_H_first
    s_cmp_lt_u32 s41, 16
    s_cbranch_scc1 G_H
    s_branch G_end
    G_H_first:
    s_waitcnt vmcnt(0)
    v_mov_b32 v21, s41
    s_mov_b64 exec, 1
    buffer_store_dword v21, v4, s[8:11], s44 offen sc1
    s_mov_b64 exec, -1
    s_mov_b32 s21, 0
    PL_18:
    buffer_load_dwordx2 v[210:211], v20, s[8:11], s22 offen sc1
    s_add_u32 s21, s21, 1
    s_cmp_gt_u32 s21, 400000
    s_cbranch_scc1 F_fail
    s_waitcnt vmcnt(0)
    v_min_u32 v210, v210, v211
    v_cmp_gt_u32 vcc, 1, v210
    s_cbranch_vccz PL_18_ok
    s_sleep 2
    s_branch PL_18
    PL_18_ok:
    s_branch G_H
    G_end:
    s_lshr_b32 s19, s40, 4
    s_mul_i32 s19, s19, 0x60000
    s_and_b32 s20, s40, 15
    s_lshl_b32 s20, s20, 13
    s_add_u32 s19, s19, s20
    s_lshl_b32 s20, s17, 11
    s_add_u32 s19, s19, s20
    s_add_u32 s19, s19, 0x4000000
    buffer_store_dwordx4 v[212:215], v4, s[8:11], s19 offen offset:0 sc1
    buffer_store_dwordx4 v[212:215], v4, s[8:11], s19 offen offset:1024 sc1
    s_add_u32 s19, s19, 0x20000
    buffer_store_dwordx4 v[212:215], v4, s[8:11], s19 offen offset:0 sc1
    buffer_store_dwordx4 v[212:215], v4, s[8:11], s19 offen offset:1024 sc1
    s_add_u32 s19, s19, 0x20000
    buffer_store_dwordx4 v[212:215], v4, s[8:11], s19 offen offset:0 sc1
    buffer_store_dwordx4 v[212:215], v4, s[8:11], s19 offen offset:1024 sc1
    s_add_u32 s19, s19, 0x20000
    s_waitcnt vmcnt(0)
    v_mov_b32 v21, 16
    s_mov_b64 exec, 1
    buffer_store_dword v21, v4, s[8:11], s44 offen sc1
    s_mov_b64 exec, -1
    s_barrier
    G_add:
    s_cmp_lg_u32 s17, 0
    s_cbranch_scc1 G_noadd
    v_lshlrev_b32 v20, 7, v1
    v_mov_b32 v21, 1
    s_mov_b32 s19, 0x96000
    s_mov_b64 exec, 0xffffffff
    buffer_atomic_add v21, v20, s[8:11], s19 offen sc1
    s_mov_b64 exec, -1
    G_noadd:
    W_c:
    s_lshr_b32 s41, s40, 4
    s_and_b32 s43, s40, 15
    v_and_b32 v120, 15, v1
    v_lshrrev_b32 v121, 4, v1
    v_lshrrev_b32 v122, 2, v120
    v_and_b32 v123, 3, v120
    s_lshl_b32 s36, s17, 15
    v_lshrrev_b32 v5, 2, v1
    v_lshlrev_b32 v5, 10, v5
    v_bfe_u32 v6, v1, 1, 1
    v_bfe_u32 v7, v1, 4, 1
    v_xor_b32 v6, v6, v7
    v_lshl_add_u32 v5, v6, 5, v5
    v_and_b32 v6, 1, v1
    v_lshl_add_u32 v5, v6, 4, v5
    s_lshl_b32 s19, s43, 6
    v_add_u32 v5, s19, v5
    v_lshl_add_u32 v6, v121, 2, v122
    v_lshlrev_b32 v6, 6, v6
    v_and_b32 v7, 1, v121
    v_lshl_add_u32 v6, v7, 5, v6
    v_lshl_add_u32 v6, v123, 3, v6
    v_add_u32 v6, s36, v6
    v_xor_b32 v7, 32, v6
    s_lshl_b32 s19, s17, 12
    v_add_u32 v8, s19, v4
    v_add_u32 v8, 0x20000, v8
    s_lshl_b32 s19, s17, 10
    v_add_u32 v9, s19, v4
    v_add_u32 v9, 0x20000, v9
    s_lshr_b32 s19, s17, 1
    s_lshl_b32 s19, s19, 14
    s_and_b32 s20, s17, 1
    s_lshl_b32 s20, s20, 5
    s_lshl_b32 s21, s43, 6
    s_add_u32 s20, s20, s21
    v_lshlrev_b32 v11, 3, v121
    v_add_u32 v11, s20, v11
    v_lshl_add_u32 v10, v120, 10, v11
    v_add_u32 v10, s19, v10
    s_lshr_b32 s19, s17, 1
    s_lshl_b32 s24, s43, 1
    s_add_u32 s24, s24, s19
    s_lshl_b32 s25, s24, 7
    s_add_u32 s25, s25, 0x92000
    s_lshl_b32 s19, s17, 11
    s_add_u32 s19, s19, 0x24000
    v_lshrrev_b32 v20, 3, v120
    v_xor_b32 v21, v121, v20
    v_lshlrev_b32 v2, 8, v20
    v_lshl_add_u32 v2, v21, 6, v2
    v_and_b32 v21, 7, v120
    v_lshl_add_u32 v2, v21, 3, v2
    v_add_u32 v2, s19, v2
    v_lshrrev_b32 v20, 1, v121
    v_xor_b32 v21, v123, v20
    v_lshlrev_b32 v3, 8, v20
    v_lshl_add_u32 v3, v21, 6, v3
    v_and_b32 v21, 1, v121
    v_lshl_add_u32 v3, v21, 5, v3
    v_lshl_add_u32 v3, v122, 3, v3
    v_add_u32 v3, s19, v3
    s_mov_b32 s73, 0x3db504f3
    s_mov_b32 s72, 0x3fb8aa3b
    s_and_b32 s19, s41, 1
    s_lshl_b32 s19, s19, 4
    v_add_u32 v20, s19, v120
    v_lshlrev_b32 v21, 2, v121
    v_lshl_add_u32 v10, v120, 10, v11
    s_and_b32 s19, s17, 1
    s_lshl_b32 s19, s19, 10
    s_add_u32 s19, s19, 0x20000
    v_add_u32 v19, s19, v4
    v_add_u32 v22, 0, v21
    v_cmp_le_u32 s[56:57], v22, v20
    v_add_u32 v22, 1, v21
    v_cmp_le_u32 s[58:59], v22, v20
    v_add_u32 v22, 2, v21
    v_cmp_le_u32 s[60:61], v22, v20
    v_add_u32 v22, 3, v21
    v_cmp_le_u32 s[62:63], v22, v20
    v_add_u32 v22, 16, v21
    v_cmp_le_u32 s[64:65], v22, v20
    v_add_u32 v22, 17, v21
    v_cmp_le_u32 s[66:67], v22, v20
    v_add_u32 v22, 18, v21
    v_cmp_le_u32 s[68:69], v22, v20
    v_add_u32 v22, 19, v21
    v_cmp_le_u32 s[70:71], v22, v20
    s_barrier
    s_load_dwordx2 s[20:21], s[0:1], 80
    s_waitcnt lgkmcnt(0)
    s_mov_b32 s44, s20
    s_and_b32 s45, s21, 0xffff
    s_mov_b32 s46, 0x158000
    s_mov_b32 s47, 0x00020000
    s_load_dwordx2 s[20:21], s[0:1], 88
    s_waitcnt lgkmcnt(0)
    s_mov_b32 s48, s20
    s_and_b32 s49, s21, 0xffff
    s_mov_b32 s50, 0x400
    s_mov_b32 s51, 0x00020000
    s_mul_i32 s22, s17, 360448
    buffer_load_dwordx2 v[14:15], v11, s[48:51], 0 offen
    s_add_u32 m0, s36, 0
    s_nop 0
    buffer_load_dwordx4 v5, s[44:47], s22 offen lds
    s_add_u32 s22, s22, 16384
    s_add_u32 m0, s36, 1024
    s_nop 0
    buffer_load_dwordx4 v5, s[44:47], s22 offen lds
    s_add_u32 s22, s22, 16384
    s_add_u32 m0, s36, 2048
    s_nop 0
    buffer_load_dwordx4 v5, s[44:47], s22 offen lds
    s_add_u32 s22, s22, 16384
    s_add_u32 m0, s36, 3072
    s_nop 0
    buffer_load_dwordx4 v5, s[44:47], s22 offen lds
    s_add_u32 s22, s22, 16384
    s_add_u32 m0, s36, 4096
    s_nop 0
    buffer_load_dwordx4 v5, s[44:47], s22 offen lds
    s_add_u32 s22, s22, 16384
    s_add_u32 m0, s36, 5120
    s_nop 0
    buffer_load_dwordx4 v5, s[44:47], s22 offen lds
    s_add_u32 s22, s22, 16384
    s_add_u32 m0, s36, 6144
    s_nop 0
    buffer_load_dwordx4 v5, s[44:47], s22 offen lds
    s_add_u32 s22, s22, 16384
    s_add_u32 m0, s36, 7168
    s_nop 0
    buffer_load_dwordx4 v5, s[44:47], s22 offen lds
    s_add_u32 s22, s22, 16384
    s_add_u32 m0, s36, 8192
    s_nop 0
    buffer_load_dwordx4 v5, s[44:47], s22 offen lds
    s_add_u32 s22, s22, 16384
    s_add_u32 m0, s36, 9216
    s_nop 0
    buffer_load_dwordx4 v5, s[44:47], s22 offen lds
    s_add_u32 s22, s22, 16384
    s_add_u32 m0, s36, 10240
    s_nop 0
    buffer_load_dwordx4 v5, s[44:47], s22 offen lds
    s_add_u32 s22, s22, 16384
    s_add_u32 m0, s36, 11264
    s_nop 0
    buffer_load_dwordx4 v5, s[44:47], s22 offen lds
    s_add_u32 s22, s22, 16384
    s_add_u32 m0, s36, 12288
    s_nop 0
    buffer_load_dwordx4 v5, s[44:47], s22 offen lds
    s_add_u32 s22, s22, 16384
    s_add_u32 m0, s36, 13312
    s_nop 0
    buffer_load_dwordx4 v5, s[44:47], s22 offen lds
    s_add_u32 s22, s22, 16384
    s_add_u32 m0, s36, 14336
    s_nop 0
    buffer_load_dwordx4 v5, s[44:47], s22 offen lds
    s_add_u32 s22, s22, 16384
    s_add_u32 m0, s36, 15360
    s_nop 0
    buffer_load_dwordx4 v5, s[44:47], s22 offen lds
    s_add_u32 s22, s22, 16384
    s_add_u32 m0, s36, 16384
    s_nop 0
    buffer_load_dwordx4 v5, s[44:47], s22 offen lds
    s_add_u32 s22, s22, 16384
    s_add_u32 m0, s36, 17408
    s_nop 0
    buffer_load_dwordx4 v5, s[44:47], s22 offen lds
    s_add_u32 s22, s22, 16384
    s_add_u32 m0, s36, 18432
    s_nop 0
    buffer_load_dwordx4 v5, s[44:47], s22 offen lds
    s_add_u32 s22, s22, 16384
    s_add_u32 m0, s36, 19456
    s_nop 0
    buffer_load_dwordx4 v5, s[44:47], s22 offen lds
    s_add_u32 s22, s22, 16384
    s_add_u32 m0, s36, 20480
    s_nop 0
    buffer_load_dwordx4 v5, s[44:47], s22 offen lds
    s_add_u32 s22, s22, 16384
    s_add_u32 m0, s36, 21504
    s_nop 0
    buffer_load_dwordx4 v5, s[44:47], s22 offen lds
    s_add_u32 s22, s22, 16384
    s_waitcnt vmcnt(6)
    ds_read_b64_tr_b16 v[128:129], v6 offset:0
    ds_read_b64_tr_b16 v[130:131], v6 offset:1024
    ds_read_b64_tr_b16 v[132:133], v7 offset:0
    ds_read_b64_tr_b16 v[134:135], v7 offset:1024
    ds_read_b64_tr_b16 v[136:137], v6 offset:2048
    ds_read_b64_tr_b16 v[138:139], v6 offset:3072
    ds_read_b64_tr_b16 v[140:141], v7 offset:2048
    ds_read_b64_tr_b16 v[142:143], v7 offset:3072
    s_waitcnt lgkmcnt(0)
    ds_read_b64_tr_b16 v[144:145], v6 offset:4096
    ds_read_b64_tr_b16 v[146:147], v6 offset:5120
    ds_read_b64_tr_b16 v[148:149], v7 offset:4096
    ds_read_b64_tr_b16 v[150:151], v7 offset:5120
    ds_read_b64_tr_b16 v[152:153], v6 offset:6144
    ds_read_b64_tr_b16 v[154:155], v6 offset:7168
    ds_read_b64_tr_b16 v[156:157], v7 offset:6144
    ds_read_b64_tr_b16 v[158:159], v7 offset:7168
    s_waitcnt lgkmcnt(0)
    ds_read_b64_tr_b16 v[160:161], v6 offset:8192
    ds_read_b64_tr_b16 v[162:163], v6 offset:9216
    ds_read_b64_tr_b16 v[164:165], v7 offset:8192
    ds_read_b64_tr_b16 v[166:167], v7 offset:9216
    ds_read_b64_tr_b16 v[168:169], v6 offset:10240
    ds_read_b64_tr_b16 v[170:171], v6 offset:11264
    ds_read_b64_tr_b16 v[172:173], v7 offset:10240
    ds_read_b64_tr_b16 v[174:175], v7 offset:11264
    s_waitcnt lgkmcnt(0)
    ds_read_b64_tr_b16 v[176:177], v6 offset:12288
    ds_read_b64_tr_b16 v[178:179], v6 offset:13312
    ds_read_b64_tr_b16 v[180:181], v7 offset:12288
    ds_read_b64_tr_b16 v[182:183], v7 offset:13312
    ds_read_b64_tr_b16 v[184:185], v6 offset:14336
    ds_read_b64_tr_b16 v[186:187], v6 offset:15360
    ds_read_b64_tr_b16 v[188:189], v7 offset:14336
    ds_read_b64_tr_b16 v[190:191], v7 offset:15360
    s_waitcnt lgkmcnt(0)
    s_waitcnt lgkmcnt(0)
    s_waitcnt vmcnt(0)
    ds_read_b64_tr_b16 v[192:193], v6 offset:16384
    ds_read_b64_tr_b16 v[194:195], v6 offset:17408
    ds_read_b64_tr_b16 v[196:197], v7 offset:16384
    ds_read_b64_tr_b16 v[198:199], v7 offset:17408
    ds_read_b64_tr_b16 v[200:201], v6 offset:18432
    ds_read_b64_tr_b16 v[202:203], v6 offset:19456
    ds_read_b64_tr_b16 v[204:205], v7 offset:18432
    ds_read_b64_tr_b16 v[206:207], v7 offset:19456
    s_waitcnt lgkmcnt(0)
    ds_read_b64_tr_b16 v[208:209], v6 offset:20480
    ds_read_b64_tr_b16 v[210:211], v6 offset:21504
    ds_read_b64_tr_b16 v[212:213], v7 offset:20480
    ds_read_b64_tr_b16 v[214:215], v7 offset:21504
    s_waitcnt lgkmcnt(0)
    v_lshlrev_b32 v12, 16, v14
    v_and_b32 v13, 0xffff0000, v14
    v_lshlrev_b32 v14, 16, v15
    v_and_b32 v15, 0xffff0000, v15
    s_load_dwordx2 s[20:21], s[0:1], 40
    s_waitcnt lgkmcnt(0)
    s_mov_b32 s44, s20
    s_and_b32 s45, s21, 0xffff
    s_mov_b32 s46, 0x400000
    s_mov_b32 s47, 0x00020000
    s_load_dwordx2 s[20:21], s[0:1], 0
    s_waitcnt lgkmcnt(0)
    s_mov_b32 s48, s20
    s_and_b32 s49, s21, 0xffff
    s_mov_b32 s50, 0x200000
    s_mov_b32 s51, 0x00020000
    s_load_dwordx2 s[20:21], s[0:1], 96
    s_waitcnt lgkmcnt(0)
    s_mov_b32 s52, s20
    s_and_b32 s53, s21, 0xffff
    s_mov_b32 s54, 0x200000
    s_mov_b32 s55, 0x00020000
    s_lshl_b32 s22, s17, 20
    s_add_u32 m0, s36, 0
    s_nop 0
    buffer_load_dwordx4 v5, s[44:47], s22 offen lds
    s_add_u32 s22, s22, 16384
    s_add_u32 m0, s36, 1024
    s_nop 0
    buffer_load_dwordx4 v5, s[44:47], s22 offen lds
    s_add_u32 s22, s22, 16384
    s_add_u32 m0, s36, 2048
    s_nop 0
    buffer_load_dwordx4 v5, s[44:47], s22 offen lds
    s_add_u32 s22, s22, 16384
    s_add_u32 m0, s36, 3072
    s_nop 0
    buffer_load_dwordx4 v5, s[44:47], s22 offen lds
    s_add_u32 s22, s22, 16384
    s_add_u32 m0, s36, 4096
    s_nop 0
    buffer_load_dwordx4 v5, s[44:47], s22 offen lds
    s_add_u32 s22, s22, 16384
    s_add_u32 m0, s36, 5120
    s_nop 0
    buffer_load_dwordx4 v5, s[44:47], s22 offen lds
    s_add_u32 s22, s22, 16384
    s_add_u32 m0, s36, 6144
    s_nop 0
    buffer_load_dwordx4 v5, s[44:47], s22 offen lds
    s_add_u32 s22, s22, 16384
    s_add_u32 m0, s36, 7168
    s_nop 0
    buffer_load_dwordx4 v5, s[44:47], s22 offen lds
    s_add_u32 s22, s22, 16384
    s_add_u32 m0, s36, 8192
    s_nop 0
    buffer_load_dwordx4 v5, s[44:47], s22 offen lds
    s_add_u32 s22, s22, 16384
    s_add_u32 m0, s36, 9216
    s_nop 0
    buffer_load_dwordx4 v5, s[44:47], s22 offen lds
    s_add_u32 s22, s22, 16384
    s_add_u32 m0, s36, 10240
    s_nop 0
    buffer_load_dwordx4 v5, s[44:47], s22 offen lds
    s_add_u32 s22, s22, 16384
    s_add_u32 m0, s36, 11264
    s_nop 0
    buffer_load_dwordx4 v5, s[44:47], s22 offen lds
    s_add_u32 s22, s22, 16384
    s_add_u32 m0, s36, 12288
    s_nop 0
    buffer_load_dwordx4 v5, s[44:47], s22 offen lds
    s_add_u32 s22, s22, 16384
    s_add_u32 m0, s36, 13312
    s_nop 0
    buffer_load_dwordx4 v5, s[44:47], s22 offen lds
    s_add_u32 s22, s22, 16384
    s_add_u32 m0, s36, 14336
    s_nop 0
    buffer_load_dwordx4 v5, s[44:47], s22 offen lds
    s_add_u32 s22, s22, 16384
    s_add_u32 m0, s36, 15360
    s_nop 0
    buffer_load_dwordx4 v5, s[44:47], s22 offen lds
    s_add_u32 s22, s22, 16384
    s_add_u32 m0, s36, 16384
    s_nop 0
    buffer_load_dwordx4 v5, s[44:47], s22 offen lds
    s_add_u32 s22, s22, 16384
    s_add_u32 m0, s36, 17408
    s_nop 0
    buffer_load_dwordx4 v5, s[44:47], s22 offen lds
    s_add_u32 s22, s22, 16384
    s_add_u32 m0, s36, 18432
    s_nop 0
    buffer_load_dwordx4 v5, s[44:47], s22 offen lds
    s_add_u32 s22, s22, 16384
    s_add_u32 m0, s36, 19456
    s_nop 0
    buffer_load_dwordx4 v5, s[44:47], s22 offen lds
    s_add_u32 s22, s22, 16384
    s_add_u32 m0, s36, 20480
    s_nop 0
    buffer_load_dwordx4 v5, s[44:47], s22 offen lds
    s_add_u32 s22, s22, 16384
    s_add_u32 m0, s36, 21504
    s_nop 0
    buffer_load_dwordx4 v5, s[44:47], s22 offen lds
    s_add_u32 s22, s22, 16384
    s_add_u32 m0, s36, 22528
    s_nop 0
    buffer_load_dwordx4 v5, s[44:47], s22 offen lds
    s_add_u32 s22, s22, 16384
    s_add_u32 m0, s36, 23552
    s_nop 0
    buffer_load_dwordx4 v5, s[44:47], s22 offen lds
    s_add_u32 s22, s22, 16384
    s_add_u32 m0, s36, 24576
    s_nop 0
    buffer_load_dwordx4 v5, s[44:47], s22 offen lds
    s_add_u32 s22, s22, 16384
    s_add_u32 m0, s36, 25600
    s_nop 0
    buffer_load_dwordx4 v5, s[44:47], s22 offen lds
    s_add_u32 s22, s22, 16384
    s_add_u32 m0, s36, 26624
    s_nop 0
    buffer_load_dwordx4 v5, s[44:47], s22 offen lds
    s_add_u32 s22, s22, 16384
    s_add_u32 m0, s36, 27648
    s_nop 0
    buffer_load_dwordx4 v5, s[44:47], s22 offen lds
    s_add_u32 s22, s22, 16384
    s_add_u32 m0, s36, 28672
    s_nop 0
    buffer_load_dwordx4 v5, s[44:47], s22 offen lds
    s_add_u32 s22, s22, 16384
    s_add_u32 m0, s36, 29696
    s_nop 0
    buffer_load_dwordx4 v5, s[44:47], s22 offen lds
    s_add_u32 s22, s22, 16384
    s_add_u32 m0, s36, 30720
    s_nop 0
    buffer_load_dwordx4 v5, s[44:47], s22 offen lds
    s_add_u32 s22, s22, 16384
    s_add_u32 m0, s36, 31744
    s_nop 0
    buffer_load_dwordx4 v5, s[44:47], s22 offen lds
    s_add_u32 s22, s22, 16384
    s_waitcnt vmcnt(16)
    ds_read_b64_tr_b16 a[0:1], v6 offset:0
    ds_read_b64_tr_b16 a[2:3], v6 offset:1024
    ds_read_b64_tr_b16 a[4:5], v7 offset:0
    ds_read_b64_tr_b16 a[6:7], v7 offset:1024
    ds_read_b64_tr_b16 a[8:9], v6 offset:2048
    ds_read_b64_tr_b16 a[10:11], v6 offset:3072
    ds_read_b64_tr_b16 a[12:13], v7 offset:2048
    ds_read_b64_tr_b16 a[14:15], v7 offset:3072
    s_waitcnt lgkmcnt(0)
    ds_read_b64_tr_b16 a[16:17], v6 offset:4096
    ds_read_b64_tr_b16 a[18:19], v6 offset:5120
    ds_read_b64_tr_b16 a[20:21], v7 offset:4096
    ds_read_b64_tr_b16 a[22:23], v7 offset:5120
    ds_read_b64_tr_b16 a[24:25], v6 offset:6144
    ds_read_b64_tr_b16 a[26:27], v6 offset:7168
    ds_read_b64_tr_b16 a[28:29], v7 offset:6144
    ds_read_b64_tr_b16 a[30:31], v7 offset:7168
    s_waitcnt lgkmcnt(0)
    ds_read_b64_tr_b16 a[32:33], v6 offset:8192
    ds_read_b64_tr_b16 a[34:35], v6 offset:9216
    ds_read_b64_tr_b16 a[36:37], v7 offset:8192
    ds_read_b64_tr_b16 a[38:39], v7 offset:9216
    ds_read_b64_tr_b16 a[40:41], v6 offset:10240
    ds_read_b64_tr_b16 a[42:43], v6 offset:11264
    ds_read_b64_tr_b16 a[44:45], v7 offset:10240
    ds_read_b64_tr_b16 a[46:47], v7 offset:11264
    s_waitcnt lgkmcnt(0)
    ds_read_b64_tr_b16 a[48:49], v6 offset:12288
    ds_read_b64_tr_b16 a[50:51], v6 offset:13312
    ds_read_b64_tr_b16 a[52:53], v7 offset:12288
    ds_read_b64_tr_b16 a[54:55], v7 offset:13312
    ds_read_b64_tr_b16 a[56:57], v6 offset:14336
    ds_read_b64_tr_b16 a[58:59], v6 offset:15360
    ds_read_b64_tr_b16 a[60:61], v7 offset:14336
    ds_read_b64_tr_b16 a[62:63], v7 offset:15360
    s_waitcnt lgkmcnt(0)
    s_waitcnt lgkmcnt(0)
    s_add_u32 m0, s36, 0
    s_nop 0
    buffer_load_dwordx4 v5, s[44:47], s22 offen lds
    s_add_u32 s22, s22, 16384
    s_add_u32 m0, s36, 1024
    s_nop 0
    buffer_load_dwordx4 v5, s[44:47], s22 offen lds
    s_add_u32 s22, s22, 16384
    s_add_u32 m0, s36, 2048
    s_nop 0
    buffer_load_dwordx4 v5, s[44:47], s22 offen lds
    s_add_u32 s22, s22, 16384
    s_add_u32 m0, s36, 3072
    s_nop 0
    buffer_load_dwordx4 v5, s[44:47], s22 offen lds
    s_add_u32 s22, s22, 16384
    s_add_u32 m0, s36, 4096
    s_nop 0
    buffer_load_dwordx4 v5, s[44:47], s22 offen lds
    s_add_u32 s22, s22, 16384
    s_add_u32 m0, s36, 5120
    s_nop 0
    buffer_load_dwordx4 v5, s[44:47], s22 offen lds
    s_add_u32 s22, s22, 16384
    s_add_u32 m0, s36, 6144
    s_nop 0
    buffer_load_dwordx4 v5, s[44:47], s22 offen lds
    s_add_u32 s22, s22, 16384
    s_add_u32 m0, s36, 7168
    s_nop 0
    buffer_load_dwordx4 v5, s[44:47], s22 offen lds
    s_add_u32 s22, s22, 16384
    s_add_u32 m0, s36, 8192
    s_nop 0
    buffer_load_dwordx4 v5, s[44:47], s22 offen lds
    s_add_u32 s22, s22, 16384
    s_add_u32 m0, s36, 9216
    s_nop 0
    buffer_load_dwordx4 v5, s[44:47], s22 offen lds
    s_add_u32 s22, s22, 16384
    s_add_u32 m0, s36, 10240
    s_nop 0
    buffer_load_dwordx4 v5, s[44:47], s22 offen lds
    s_add_u32 s22, s22, 16384
    s_add_u32 m0, s36, 11264
    s_nop 0
    buffer_load_dwordx4 v5, s[44:47], s22 offen lds
    s_add_u32 s22, s22, 16384
    s_add_u32 m0, s36, 12288
    s_nop 0
    buffer_load_dwordx4 v5, s[44:47], s22 offen lds
    s_add_u32 s22, s22, 16384
    s_add_u32 m0, s36, 13312
    s_nop 0
    buffer_load_dwordx4 v5, s[44:47], s22 offen lds
    s_add_u32 s22, s22, 16384
    s_add_u32 m0, s36, 14336
    s_nop 0
    buffer_load_dwordx4 v5, s[44:47], s22 offen lds
    s_add_u32 s22, s22, 16384
    s_add_u32 m0, s36, 15360
    s_nop 0
    buffer_load_dwordx4 v5, s[44:47], s22 offen lds
    s_add_u32 s22, s22, 16384
    s_waitcnt vmcnt(16)
    ds_read_b64_tr_b16 a[64:65], v6 offset:16384
    ds_read_b64_tr_b16 a[66:67], v6 offset:17408
    ds_read_b64_tr_b16 a[68:69], v7 offset:16384
    ds_read_b64_tr_b16 a[70:71], v7 offset:17408
    ds_read_b64_tr_b16 a[72:73], v6 offset:18432
    ds_read_b64_tr_b16 a[74:75], v6 offset:19456
    ds_read_b64_tr_b16 a[76:77], v7 offset:18432
    ds_read_b64_tr_b16 a[78:79], v7 offset:19456
    s_waitcnt lgkmcnt(0)
    ds_read_b64_tr_b16 a[80:81], v6 offset:20480
    ds_read_b64_tr_b16 a[82:83], v6 offset:21504
    ds_read_b64_tr_b16 a[84:85], v7 offset:20480
    ds_read_b64_tr_b16 a[86:87], v7 offset:21504
    ds_read_b64_tr_b16 a[88:89], v6 offset:22528
    ds_read_b64_tr_b16 a[90:91], v6 offset:23552
    ds_read_b64_tr_b16 a[92:93], v7 offset:22528
    ds_read_b64_tr_b16 a[94:95], v7 offset:23552
    s_waitcnt lgkmcnt(0)
    ds_read_b64_tr_b16 a[96:97], v6 offset:24576
    ds_read_b64_tr_b16 a[98:99], v6 offset:25600
    ds_read_b64_tr_b16 a[100:101], v7 offset:24576
    ds_read_b64_tr_b16 a[102:103], v7 offset:25600
    ds_read_b64_tr_b16 a[104:105], v6 offset:26624
    ds_read_b64_tr_b16 a[106:107], v6 offset:27648
    ds_read_b64_tr_b16 a[108:109], v7 offset:26624
    ds_read_b64_tr_b16 a[110:111], v7 offset:27648
    s_waitcnt lgkmcnt(0)
    ds_read_b64_tr_b16 a[112:113], v6 offset:28672
    ds_read_b64_tr_b16 a[114:115], v6 offset:29696
    ds_read_b64_tr_b16 a[116:117], v7 offset:28672
    ds_read_b64_tr_b16 a[118:119], v7 offset:29696
    ds_read_b64_tr_b16 a[120:121], v6 offset:30720
    ds_read_b64_tr_b16 a[122:123], v6 offset:31744
    ds_read_b64_tr_b16 a[124:125], v7 offset:30720
    ds_read_b64_tr_b16 a[126:127], v7 offset:31744
    s_waitcnt lgkmcnt(0)
    s_waitcnt lgkmcnt(0)
    s_add_u32 m0, s36, 16384
    s_nop 0
    buffer_load_dwordx4 v5, s[44:47], s22 offen lds
    s_add_u32 s22, s22, 16384
    s_add_u32 m0, s36, 17408
    s_nop 0
    buffer_load_dwordx4 v5, s[44:47], s22 offen lds
    s_add_u32 s22, s22, 16384
    s_add_u32 m0, s36, 18432
    s_nop 0
    buffer_load_dwordx4 v5, s[44:47], s22 offen lds
    s_add_u32 s22, s22, 16384
    s_add_u32 m0, s36, 19456
    s_nop 0
    buffer_load_dwordx4 v5, s[44:47], s22 offen lds
    s_add_u32 s22, s22, 16384
    s_add_u32 m0, s36, 20480
    s_nop 0
    buffer_load_dwordx4 v5, s[44:47], s22 offen lds
    s_add_u32 s22, s22, 16384
    s_add_u32 m0, s36, 21504
    s_nop 0
    buffer_load_dwordx4 v5, s[44:47], s22 offen lds
    s_add_u32 s22, s22, 16384
    s_add_u32 m0, s36, 22528
    s_nop 0
    buffer_load_dwordx4 v5, s[44:47], s22 offen lds
    s_add_u32 s22, s22, 16384
    s_add_u32 m0, s36, 23552
    s_nop 0
    buffer_load_dwordx4 v5, s[44:47], s22 offen lds
    s_add_u32 s22, s22, 16384
    s_add_u32 m0, s36, 24576
    s_nop 0
    buffer_load_dwordx4 v5, s[44:47], s22 offen lds
    s_add_u32 s22, s22, 16384
    s_add_u32 m0, s36, 25600
    s_nop 0
    buffer_load_dwordx4 v5, s[44:47], s22 offen lds
    s_add_u32 s22, s22, 16384
    s_add_u32 m0, s36, 26624
    s_nop 0
    buffer_load_dwordx4 v5, s[44:47], s22 offen lds
    s_add_u32 s22, s22, 16384
    s_add_u32 m0, s36, 27648
    s_nop 0
    buffer_load_dwordx4 v5, s[44:47], s22 offen lds
    s_add_u32 s22, s22, 16384
    s_add_u32 m0, s36, 28672
    s_nop 0
    buffer_load_dwordx4 v5, s[44:47], s22 offen lds
    s_add_u32 s22, s22, 16384
    s_add_u32 m0, s36, 29696
    s_nop 0
    buffer_load_dwordx4 v5, s[44:47], s22 offen lds
    s_add_u32 s22, s22, 16384
    s_add_u32 m0, s36, 30720
    s_nop 0
    buffer_load_dwordx4 v5, s[44:47], s22 offen lds
    s_add_u32 s22, s22, 16384
    s_add_u32 m0, s36, 31744
    s_nop 0
    buffer_load_dwordx4 v5, s[44:47], s22 offen lds
    s_add_u32 s22, s22, 16384
    s_waitcnt vmcnt(16)
    ds_read_b64_tr_b16 a[128:129], v6 offset:0
    ds_read_b64_tr_b16 a[130:131], v6 offset:1024
    ds_read_b64_tr_b16 a[132:133], v7 offset:0
    ds_read_b64_tr_b16 a[134:135], v7 offset:1024
    ds_read_b64_tr_b16 a[136:137], v6 offset:2048
    ds_read_b64_tr_b16 a[138:139], v6 offset:3072
    ds_read_b64_tr_b16 a[140:141], v7 offset:2048
    ds_read_b64_tr_b16 a[142:143], v7 offset:3072
    s_waitcnt lgkmcnt(0)
    ds_read_b64_tr_b16 a[144:145], v6 offset:4096
    ds_read_b64_tr_b16 a[146:147], v6 offset:5120
    ds_read_b64_tr_b16 a[148:149], v7 offset:4096
    ds_read_b64_tr_b16 a[150:151], v7 offset:5120
    ds_read_b64_tr_b16 a[152:153], v6 offset:6144
    ds_read_b64_tr_b16 a[154:155], v6 offset:7168
    ds_read_b64_tr_b16 a[156:157], v7 offset:6144
    ds_read_b64_tr_b16 a[158:159], v7 offset:7168
    s_waitcnt lgkmcnt(0)
    ds_read_b64_tr_b16 a[160:161], v6 offset:8192
    ds_read_b64_tr_b16 a[162:163], v6 offset:9216
    ds_read_b64_tr_b16 a[164:165], v7 offset:8192
    ds_read_b64_tr_b16 a[166:167], v7 offset:9216
    ds_read_b64_tr_b16 a[168:169], v6 offset:10240
    ds_read_b64_tr_b16 a[170:171], v6 offset:11264
    ds_read_b64_tr_b16 a[172:173], v7 offset:10240
    ds_read_b64_tr_b16 a[174:175], v7 offset:11264
    s_waitcnt lgkmcnt(0)
    ds_read_b64_tr_b16 a[176:177], v6 offset:12288
    ds_read_b64_tr_b16 a[178:179], v6 offset:13312
    ds_read_b64_tr_b16 a[180:181], v7 offset:12288
    ds_read_b64_tr_b16 a[182:183], v7 offset:13312
    ds_read_b64_tr_b16 a[184:185], v6 offset:14336
    ds_read_b64_tr_b16 a[186:187], v6 offset:15360
    ds_read_b64_tr_b16 a[188:189], v7 offset:14336
    ds_read_b64_tr_b16 a[190:191], v7 offset:15360
    s_waitcnt lgkmcnt(0)
    s_waitcnt lgkmcnt(0)
    s_waitcnt vmcnt(0)
    ds_read_b64_tr_b16 a[192:193], v6 offset:16384
    ds_read_b64_tr_b16 a[194:195], v6 offset:17408
    ds_read_b64_tr_b16 a[196:197], v7 offset:16384
    ds_read_b64_tr_b16 a[198:199], v7 offset:17408
    ds_read_b64_tr_b16 a[200:201], v6 offset:18432
    ds_read_b64_tr_b16 a[202:203], v6 offset:19456
    ds_read_b64_tr_b16 a[204:205], v7 offset:18432
    ds_read_b64_tr_b16 a[206:207], v7 offset:19456
    s_waitcnt lgkmcnt(0)
    ds_read_b64_tr_b16 a[208:209], v6 offset:20480
    ds_read_b64_tr_b16 a[210:211], v6 offset:21504
    ds_read_b64_tr_b16 a[212:213], v7 offset:20480
    ds_read_b64_tr_b16 a[214:215], v7 offset:21504
    ds_read_b64_tr_b16 a[216:217], v6 offset:22528
    ds_read_b64_tr_b16 a[218:219], v6 offset:23552
    ds_read_b64_tr_b16 a[220:221], v7 offset:22528
    ds_read_b64_tr_b16 a[222:223], v7 offset:23552
    s_waitcnt lgkmcnt(0)
    ds_read_b64_tr_b16 a[224:225], v6 offset:24576
    ds_read_b64_tr_b16 a[226:227], v6 offset:25600
    ds_read_b64_tr_b16 a[228:229], v7 offset:24576
    ds_read_b64_tr_b16 a[230:231], v7 offset:25600
    ds_read_b64_tr_b16 a[232:233], v6 offset:26624
    ds_read_b64_tr_b16 a[234:235], v6 offset:27648
    ds_read_b64_tr_b16 a[236:237], v7 offset:26624
    ds_read_b64_tr_b16 a[238:239], v7 offset:27648
    s_waitcnt lgkmcnt(0)
    ds_read_b64_tr_b16 a[240:241], v6 offset:28672
    ds_read_b64_tr_b16 a[242:243], v6 offset:29696
    ds_read_b64_tr_b16 a[244:245], v7 offset:28672
    ds_read_b64_tr_b16 a[246:247], v7 offset:29696
    ds_read_b64_tr_b16 a[248:249], v6 offset:30720
    ds_read_b64_tr_b16 a[250:251], v6 offset:31744
    ds_read_b64_tr_b16 a[252:253], v7 offset:30720
    ds_read_b64_tr_b16 a[254:255], v7 offset:31744
    s_waitcnt lgkmcnt(0)
    s_waitcnt lgkmcnt(0)
    s_cmp_lg_u32 s17, 0
    s_cbranch_scc1 W_nopoll
    s_and_b32 s22, s40, 31
    s_lshl_b32 s22, s22, 7
    s_add_u32 s22, s22, 0x96000
    s_movk_i32 s23, 224
    v_mov_b32 v20, 0
    s_mov_b32 s21, 0
    PL_19:
    buffer_load_dword v22, v20, s[8:11], s22 offen sc1
    s_add_u32 s21, s21, 1
    s_cmp_gt_u32 s21, 400000
    s_cbranch_scc1 F_fail
    s_waitcnt vmcnt(0)
    v_cmp_gt_u32 vcc, s23, v22
    s_cbranch_vccz PL_19_ok
    s_sleep 16
    s_branch PL_19
    PL_19_ok:
    W_nopoll:
    s_barrier
    v_mov_b32 v18, 0
    buffer_load_dword v23, v18, s[12:15], 0 offen offset:132 sc1
    s_mov_b32 s42, s41
    W_gate:
    v_mov_b64 v[232:233], v[236:237]
    v_mov_b64 v[234:235], v[238:239]
    v_mov_b64 v[236:237], v[240:241]
    v_mov_b64 v[238:239], v[242:243]
    v_mov_b64 v[240:241], v[244:245]
    v_mov_b64 v[242:243], v[246:247]
    v_mov_b64 v[244:245], v[248:249]
    v_mov_b64 v[246:247], v[250:251]
    s_mul_i32 s19, s42, 44032
    s_mul_i32 s20, s17, 11264
    s_add_u32 s19, s19, s20
    s_add_u32 s19, s19, 0x5000000
    s_add_u32 s20, s19, 0
    buffer_load_dwordx4 v[24:27], v4, s[8:11], s20 offen offset:0 sc1
    buffer_load_dwordx4 v[28:31], v4, s[8:11], s20 offen offset:1024 sc1
    buffer_load_dwordx4 v[32:35], v4, s[8:11], s20 offen offset:2048 sc1
    buffer_load_dwordx4 v[36:39], v4, s[8:11], s20 offen offset:3072 sc1
    s_add_u32 s20, s19, 4096
    buffer_load_dwordx4 v[40:43], v4, s[8:11], s20 offen offset:0 sc1
    buffer_load_dwordx4 v[44:47], v4, s[8:11], s20 offen offset:1024 sc1
    buffer_load_dwordx4 v[48:51], v4, s[8:11], s20 offen offset:2048 sc1
    buffer_load_dwordx4 v[52:55], v4, s[8:11], s20 offen offset:3072 sc1
    s_add_u32 s20, s19, 8192
    buffer_load_dwordx4 v[56:59], v4, s[8:11], s20 offen offset:0 sc1
    buffer_load_dwordx4 v[60:63], v4, s[8:11], s20 offen offset:1024 sc1
    s_cmp_eq_u32 s17, 3
    s_cselect_b32 s21, 0x7ff00000, s20
    buffer_load_dwordx4 v[64:67], v4, s[8:11], s21 offen offset:2048 sc1
    s_add_u32 s20, s19, 616448
    buffer_load_dwordx4 v[68:71], v4, s[8:11], s20 offen offset:0 sc1
    buffer_load_dwordx4 v[72:75], v4, s[8:11], s20 offen offset:1024 sc1
    buffer_load_dwordx4 v[76:79], v4, s[8:11], s20 offen offset:2048 sc1
    buffer_load_dwordx4 v[80:83], v4, s[8:11], s20 offen offset:3072 sc1
    s_add_u32 s20, s19, 620544
    buffer_load_dwordx4 v[84:87], v4, s[8:11], s20 offen offset:0 sc1
    buffer_load_dwordx4 v[88:91], v4, s[8:11], s20 offen offset:1024 sc1
    buffer_load_dwordx4 v[92:95], v4, s[8:11], s20 offen offset:2048 sc1
    buffer_load_dwordx4 v[96:99], v4, s[8:11], s20 offen offset:3072 sc1
    s_add_u32 s20, s19, 624640
    buffer_load_dwordx4 v[100:103], v4, s[8:11], s20 offen offset:0 sc1
    buffer_load_dwordx4 v[104:107], v4, s[8:11], s20 offen offset:1024 sc1
    s_cmp_eq_u32 s17, 3
    s_cselect_b32 s21, 0x7ff00000, s20
    buffer_load_dwordx4 v[108:111], v4, s[8:11], s21 offen offset:2048 sc1
    s_waitcnt vmcnt(21)
    v_mfma_f32_16x16x32_bf16 v[216:219], v[128:131], v[24:27], 0
    v_mfma_f32_16x16x32_bf16 v[220:223], v[132:135], v[24:27], 0
    s_waitcnt vmcnt(20)
    v_mfma_f32_16x16x32_bf16 v[216:219], v[136:139], v[28:31], v[216:219]
    v_mfma_f32_16x16x32_bf16 v[220:223], v[140:143], v[28:31], v[220:223]
    s_waitcnt vmcnt(19)
    v_mfma_f32_16x16x32_bf16 v[216:219], v[144:147], v[32:35], v[216:219]
    v_mfma_f32_16x16x32_bf16 v[220:223], v[148:151], v[32:35], v[220:223]
    s_waitcnt vmcnt(18)
    v_mfma_f32_16x16x32_bf16 v[216:219], v[152:155], v[36:39], v[216:219]
    v_mfma_f32_16x16x32_bf16 v[220:223], v[156:159], v[36:39], v[220:223]
    s_waitcnt vmcnt(17)
    v_mfma_f32_16x16x32_bf16 v[216:219], v[160:163], v[40:43], v[216:219]
    v_mfma_f32_16x16x32_bf16 v[220:223], v[164:167], v[40:43], v[220:223]
    s_waitcnt vmcnt(16)
    v_mfma_f32_16x16x32_bf16 v[216:219], v[168:171], v[44:47], v[216:219]
    v_mfma_f32_16x16x32_bf16 v[220:223], v[172:175], v[44:47], v[220:223]
    s_waitcnt vmcnt(15)
    v_mfma_f32_16x16x32_bf16 v[216:219], v[176:179], v[48:51], v[216:219]
    v_mfma_f32_16x16x32_bf16 v[220:223], v[180:183], v[48:51], v[220:223]
    s_waitcnt vmcnt(14)
    v_mfma_f32_16x16x32_bf16 v[216:219], v[184:187], v[52:55], v[216:219]
    v_mfma_f32_16x16x32_bf16 v[220:223], v[188:191], v[52:55], v[220:223]
    s_waitcnt vmcnt(13)
    v_mfma_f32_16x16x32_bf16 v[216:219], v[192:195], v[56:59], v[216:219]
    v_mfma_f32_16x16x32_bf16 v[220:223], v[196:199], v[56:59], v[220:223]
    s_waitcnt vmcnt(12)
    v_mfma_f32_16x16x32_bf16 v[216:219], v[200:203], v[60:63], v[216:219]
    v_mfma_f32_16x16x32_bf16 v[220:223], v[204:207], v[60:63], v[220:223]
    s_waitcnt vmcnt(11)
    v_mfma_f32_16x16x32_bf16 v[216:219], v[208:211], v[64:67], v[216:219]
    v_mfma_f32_16x16x32_bf16 v[220:223], v[212:215], v[64:67], v[220:223]
    s_waitcnt vmcnt(10)
    v_mfma_f32_16x16x32_bf16 v[224:227], v[128:131], v[68:71], 0
    v_mfma_f32_16x16x32_bf16 v[228:231], v[132:135], v[68:71], 0
    s_waitcnt vmcnt(9)
    v_mfma_f32_16x16x32_bf16 v[224:227], v[136:139], v[72:75], v[224:227]
    v_mfma_f32_16x16x32_bf16 v[228:231], v[140:143], v[72:75], v[228:231]
    s_waitcnt vmcnt(8)
    v_mfma_f32_16x16x32_bf16 v[224:227], v[144:147], v[76:79], v[224:227]
    v_mfma_f32_16x16x32_bf16 v[228:231], v[148:151], v[76:79], v[228:231]
    s_waitcnt vmcnt(7)
    v_mfma_f32_16x16x32_bf16 v[224:227], v[152:155], v[80:83], v[224:227]
    v_mfma_f32_16x16x32_bf16 v[228:231], v[156:159], v[80:83], v[228:231]
    s_waitcnt vmcnt(6)
    v_mfma_f32_16x16x32_bf16 v[224:227], v[160:163], v[84:87], v[224:227]
    v_mfma_f32_16x16x32_bf16 v[228:231], v[164:167], v[84:87], v[228:231]
    s_waitcnt vmcnt(5)
    v_mfma_f32_16x16x32_bf16 v[224:227], v[168:171], v[88:91], v[224:227]
    v_mfma_f32_16x16x32_bf16 v[228:231], v[172:175], v[88:91], v[228:231]
    s_waitcnt vmcnt(4)
    v_mfma_f32_16x16x32_bf16 v[224:227], v[176:179], v[92:95], v[224:227]
    v_mfma_f32_16x16x32_bf16 v[228:231], v[180:183], v[92:95], v[228:231]
    s_waitcnt vmcnt(3)
    v_mfma_f32_16x16x32_bf16 v[224:227], v[184:187], v[96:99], v[224:227]
    v_mfma_f32_16x16x32_bf16 v[228:231], v[188:191], v[96:99], v[228:231]
    s_waitcnt vmcnt(2)
    v_mfma_f32_16x16x32_bf16 v[224:227], v[192:195], v[100:103], v[224:227]
    v_mfma_f32_16x16x32_bf16 v[228:231], v[196:199], v[100:103], v[228:231]
    s_waitcnt vmcnt(1)
    v_mfma_f32_16x16x32_bf16 v[224:227], v[200:203], v[104:107], v[224:227]
    v_mfma_f32_16x16x32_bf16 v[228:231], v[204:207], v[104:107], v[228:231]
    s_waitcnt vmcnt(0)
    v_mfma_f32_16x16x32_bf16 v[224:227], v[208:211], v[108:111], v[224:227]
    v_mfma_f32_16x16x32_bf16 v[228:231], v[212:215], v[108:111], v[228:231]
    s_barrier
    ds_write_b128 v8, v[216:219] offset:0
    ds_write_b128 v8, v[220:223] offset:1024
    s_nop 0
    ds_write_b128 v8, v[224:227] offset:2048
    s_nop 2
    ds_write_b128 v8, v[228:231] offset:3072
    s_waitcnt lgkmcnt(0)
    s_barrier
    ds_read_b128 v[216:219], v9 offset:0
    ds_read_b128 v[220:223], v9 offset:4096
    ds_read_b128 v[224:227], v9 offset:8192
    ds_read_b128 v[228:231], v9 offset:12288
    s_waitcnt lgkmcnt(0)
    v_pk_add_f32 v[216:217], v[216:217], v[220:221]
    v_pk_add_f32 v[218:219], v[218:219], v[222:223]
    v_pk_add_f32 v[224:225], v[224:225], v[228:229]
    v_pk_add_f32 v[226:227], v[226:227], v[230:231]
    v_pk_add_f32 v[248:249], v[216:217], v[224:225]
    v_pk_add_f32 v[250:251], v[218:219], v[226:227]
    v_cvt_pk_bf16_f32 v249, v248, v249
    v_lshlrev_b32 v248, 16, v249
    v_and_b32 v249, 0xffff0000, v249
    v_cvt_pk_bf16_f32 v251, v250, v251
    v_lshlrev_b32 v250, 16, v251
    v_and_b32 v251, 0xffff0000, v251
    v_add_f32 v248, v248, v12
    v_add_f32 v249, v249, v13
    v_add_f32 v250, v250, v14
    v_add_f32 v251, v251, v15
    v_cvt_pk_bf16_f32 v249, v248, v249
    v_lshlrev_b32 v248, 16, v249
    v_and_b32 v249, 0xffff0000, v249
    v_cvt_pk_bf16_f32 v251, v250, v251
    v_lshlrev_b32 v250, 16, v251
    v_and_b32 v251, 0xffff0000, v251
    v_mul_f32 v24, 0xbfb8aa3b, v248
    v_mul_f32 v25, 0xbfb8aa3b, v249
    v_mul_f32 v26, 0xbfb8aa3b, v250
    v_mul_f32 v27, 0xbfb8aa3b, v251
    v_exp_f32 v24, v24
    v_exp_f32 v25, v25
    v_exp_f32 v26, v26
    v_exp_f32 v27, v27
    v_add_f32 v24, 1.0, v24
    v_add_f32 v25, 1.0, v25
    v_add_f32 v26, 1.0, v26
    v_add_f32 v27, 1.0, v27
    v_rcp_f32 v24, v24
    v_rcp_f32 v25, v25
    v_rcp_f32 v26, v26
    v_rcp_f32 v27, v27
    v_mul_f32 v248, v248, v24
    v_mul_f32 v249, v249, v25
    v_mul_f32 v250, v250, v26
    v_mul_f32 v251, v251, v27
    v_cvt_pk_bf16_f32 v249, v248, v249
    v_lshlrev_b32 v248, 16, v249
    v_and_b32 v249, 0xffff0000, v249
    v_cvt_pk_bf16_f32 v251, v250, v251
    v_lshlrev_b32 v250, 16, v251
    v_and_b32 v251, 0xffff0000, v251
    s_add_u32 s42, s42, 28
    s_cmp_lt_u32 s42, 128
    s_cbranch_scc1 W_gate
    v_readfirstlane_b32 s27, v23
    s_and_b32 s19, s17, 1
    s_lshl_b32 s19, s19, 10
    v_add_u32 v2, s19, v2
    v_xor_b32 v5, 0x400, v2
    v_and_b32 v6, 31, v1
    v_lshlrev_b32 v6, 10, v6
    v_lshrrev_b32 v7, 5, v1
    v_mul_u32_u24 v7, 0x3fc, v7
    v_add_u32 v6, v6, v7
    s_mov_b32 s42, s41
    s_lshr_b32 s28, s17, 1
    s_lshl_b32 s28, s28, 30
    s_barrier
    s_lshr_b32 s29, s42, 1
    s_lshl_b32 s29, s29, 18
    s_lshl_b32 s30, s24, 13
    s_add_u32 s29, s29, s30
    s_and_b32 s30, s42, 1
    s_lshl_b32 s30, s30, 12
    s_add_u32 s30, s30, s29
    s_add_u32 s30, s30, 0x2400000
    buffer_load_dwordx4 v[152:155], v4, s[8:11], s30 offen offset:0 sc1
    buffer_load_dwordx4 v[156:159], v4, s[8:11], s30 offen offset:1024 sc1
    buffer_load_dwordx4 v[160:163], v4, s[8:11], s30 offen offset:2048 sc1
    buffer_load_dwordx4 v[164:167], v4, s[8:11], s30 offen offset:3072 sc1
    s_add_u32 s30, s29, 0x400000
    buffer_load_dwordx4 v[168:171], v4, s[8:11], s30 offen offset:0 sc1
    buffer_load_dwordx4 v[172:175], v4, s[8:11], s30 offen offset:1024 sc1
    buffer_load_dwordx4 v[176:179], v4, s[8:11], s30 offen offset:2048 sc1
    buffer_load_dwordx4 v[180:183], v4, s[8:11], s30 offen offset:3072 sc1
    s_add_u32 s30, s29, 0x401000
    buffer_load_dwordx4 v[184:187], v4, s[8:11], s30 offen offset:0 sc1
    buffer_load_dwordx4 v[188:191], v4, s[8:11], s30 offen offset:1024 sc1
    buffer_load_dwordx4 v[192:195], v4, s[8:11], s30 offen offset:2048 sc1
    buffer_load_dwordx4 v[196:199], v4, s[8:11], s30 offen offset:3072 sc1
    s_and_b32 s30, s17, 1
    s_lshl_b32 s30, s30, 12
    s_add_u32 s30, s30, s29
    s_add_u32 s30, s30, 0x1400000
    buffer_load_dwordx4 v[200:203], v4, s[8:11], s30 offen offset:0 sc1
    buffer_load_dwordx4 v[204:207], v4, s[8:11], s30 offen offset:1024 sc1
    buffer_load_dwordx4 v[208:211], v4, s[8:11], s30 offen offset:2048 sc1
    buffer_load_dwordx4 v[212:215], v4, s[8:11], s30 offen offset:3072 sc1
    s_lshl_b32 s30, s42, 14
    buffer_load_dwordx2 v[12:13], v10, s[48:51], s30 offen
    s_mul_i32 s34, s41, 0x60000
    s_add_u32 s34, s34, 0x4000000
    s_add_u32 s38, s34, 0x20000
    s_add_u32 s35, s34, 0x40000
    s_lshl_b32 s37, s43, 13
    s_lshl_b32 s22, s17, 11
    s_add_u32 s37, s37, s22
    s_mov_b32 s32, 0
    s_mov_b32 s33, 0
    s_waitcnt vmcnt(5)
    W_seg:
    s_lshr_b32 s26, s42, 1
    s_lshl_b32 s23, s42, 14
    s_waitcnt vmcnt(8)
    v_mfma_f32_16x16x32_bf16 v[128:131], v[168:171], v[152:155], 0
    v_mfma_f32_16x16x32_bf16 v[128:131], v[172:175], v[156:159], v[128:131]
    v_mfma_f32_16x16x32_bf16 v[128:131], v[176:179], v[160:163], v[128:131]
    v_mfma_f32_16x16x32_bf16 v[128:131], v[180:183], v[164:167], v[128:131]
    v_mfma_f32_16x16x32_bf16 v[132:135], v[184:187], v[152:155], 0
    v_mfma_f32_16x16x32_bf16 v[132:135], v[188:191], v[156:159], v[132:135]
    v_mfma_f32_16x16x32_bf16 v[132:135], v[192:195], v[160:163], v[132:135]
    v_mfma_f32_16x16x32_bf16 v[132:135], v[196:199], v[164:167], v[132:135]
    v_mov_b32 v146, 0xf149f2ca
    v_mov_b32 v100, 0
    v_mov_b32 v103, 0
    v_cvt_pk_bf16_f32 v129, v128, v129
    v_lshlrev_b32 v128, 16, v129
    v_and_b32 v129, 0xffff0000, v129
    v_mul_f32 v128, s73, v128
    v_mul_f32 v129, s73, v129
    v_cvt_pk_bf16_f32 v129, v128, v129
    v_lshlrev_b32 v128, 16, v129
    v_and_b32 v129, 0xffff0000, v129
    v_cvt_pk_bf16_f32 v131, v130, v131
    v_lshlrev_b32 v130, 16, v131
    v_and_b32 v131, 0xffff0000, v131
    v_mul_f32 v130, s73, v130
    v_mul_f32 v131, s73, v131
    v_cvt_pk_bf16_f32 v131, v130, v131
    v_lshlrev_b32 v130, 16, v131
    v_and_b32 v131, 0xffff0000, v131
    v_cvt_pk_bf16_f32 v133, v132, v133
    v_lshlrev_b32 v132, 16, v133
    v_and_b32 v133, 0xffff0000, v133
    v_mul_f32 v132, s73, v132
    v_mul_f32 v133, s73, v133
    v_cvt_pk_bf16_f32 v133, v132, v133
    v_lshlrev_b32 v132, 16, v133
    v_and_b32 v133, 0xffff0000, v133
    v_cvt_pk_bf16_f32 v135, v134, v135
    v_lshlrev_b32 v134, 16, v135
    v_and_b32 v135, 0xffff0000, v135
    v_mul_f32 v134, s73, v134
    v_mul_f32 v135, s73, v135
    v_cvt_pk_bf16_f32 v135, v134, v135
    v_lshlrev_b32 v134, 16, v135
    v_and_b32 v135, 0xffff0000, v135
    v_cndmask_b32 v128, v146, v128, s[56:57]
    v_cndmask_b32 v129, v146, v129, s[58:59]
    v_cndmask_b32 v130, v146, v130, s[60:61]
    v_cndmask_b32 v131, v146, v131, s[62:63]
    v_cndmask_b32 v132, v146, v132, s[64:65]
    v_cndmask_b32 v133, v146, v133, s[66:67]
    v_cndmask_b32 v134, v146, v134, s[68:69]
    v_cndmask_b32 v135, v146, v135, s[70:71]
    v_max3_f32 v144, v128, v129, v130
    v_max3_f32 v144, v144, v131, v132
    v_max3_f32 v144, v144, v133, v134
    v_max_f32 v144, v144, v135
    s_lshl_b32 s19, s26, 17
    s_lshl_b32 s20, s24, 12
    s_add_u32 s19, s19, s20
    s_add_u32 s19, s19, 0x3400000
    s_and_b32 s20, s17, 1
    s_lshl_b32 s20, s20, 11
    s_add_u32 s22, s19, s20
    s_xor_b32 s19, s22, 0x800
    s_mov_b32 s21, 0
    s_cmp_lt_u32 s26, 60
    s_addc_u32 s26, s26, 1
    s_min_u32 s26, s26, 63
    s_cmp_lg_u32 s33, 0
    s_cbranch_scc1 CF_20_chk
    CF_20:
    buffer_load_dwordx4 v[20:23], v18, s[8:11], s25 offen offset:96 sc1
    s_add_u32 s21, s21, 1
    s_cmp_gt_u32 s21, 400000
    s_cbranch_scc1 F_fail
    s_waitcnt vmcnt(0)
    v_readfirstlane_b32 s20, v20
    s_nop 0
    s_mov_b32 s32, s20
    s_cmp_ge_u32 s20, s26
    s_cbranch_scc1 CF_20_ok
    s_add_u32 s20, s20, 1
    s_cmp_ge_u32 s20, s26
    s_cbranch_scc1 CF_20_s
    s_sleep 16
    s_add_u32 s20, s20, 2
    s_cmp_ge_u32 s20, s26
    s_cbranch_scc1 CF_20
    s_sleep 80
    CF_20_s:
    s_sleep 2
    s_branch CF_20
    CF_20_ok:
    buffer_load_dwordx4 v[104:107], v4, s[8:11], s22 offen offset:0 sc1
    buffer_load_dwordx4 v[108:111], v4, s[8:11], s22 offen offset:1024 sc1
    buffer_load_dwordx4 v[112:115], v4, s[8:11], s19 offen offset:0 sc1
    buffer_load_dwordx4 v[116:119], v4, s[8:11], s19 offen offset:1024 sc1
    s_add_u32 s21, s21, 1
    s_cmp_gt_u32 s21, 400000
    s_cbranch_scc1 F_fail
    CF_20_chk:
    s_waitcnt vmcnt(3)
    ds_write_b64 v2, v[104:105] offset:0
    v_max3_u32 v20, v104, v105, v106
    v_max_u32 v20, v20, v107
    s_waitcnt vmcnt(2)
    ds_write_b64 v2, v[108:109] offset:512
    v_max3_u32 v20, v20, v108, v109
    v_max3_u32 v20, v20, v110, v111
    s_waitcnt vmcnt(1)
    ds_write_b64 v5, v[112:113] offset:0
    v_max3_u32 v20, v20, v112, v113
    v_max3_u32 v20, v20, v114, v115
    s_waitcnt vmcnt(0)
    ds_write_b64 v5, v[116:117] offset:512
    v_max3_u32 v20, v20, v116, v117
    v_max3_u32 v20, v20, v118, v119
    ds_read_b64_tr_b16 v[120:121], v3 offset:0
    ds_read_b64_tr_b16 v[122:123], v3 offset:512
    ds_read_b64_tr_b16 v[124:125], v3 offset:1024
    ds_read_b64_tr_b16 v[126:127], v3 offset:1536
    v_cmp_eq_u32 vcc, -1, v20
    s_cbranch_vccnz CF_20_ok
    s_add_u32 s20, s34, s37
    s_lshl_b32 s22, s17, 15
    s_add_u32 s19, s34, s22
    s_waitcnt lgkmcnt(2)
    v_mfma_f32_16x16x32_bf16 v[136:139], v[120:123], v[152:155], 0
    v_mfma_f32_16x16x32_bf16 v[140:143], v[120:123], v[156:159], 0
    s_waitcnt lgkmcnt(0)
    v_mfma_f32_16x16x32_bf16 v[136:139], v[124:127], v[160:163], v[136:139]
    v_mfma_f32_16x16x32_bf16 v[140:143], v[124:127], v[164:167], v[140:143]
    s_nop 7
    v_add_f32 v136, v136, v142
    v_add_f32 v137, v137, v143
    v_cvt_pk_bf16_f32 v137, v136, v137
    v_lshlrev_b32 v136, 16, v137
    v_and_b32 v137, 0xffff0000, v137
    v_mul_f32 v136, s73, v136
    v_mul_f32 v137, s73, v137
    v_cvt_pk_bf16_f32 v137, v136, v137
    v_lshlrev_b32 v136, 16, v137
    v_and_b32 v137, 0xffff0000, v137
    v_max3_f32 v144, v144, v136, v137
    v_mov_b32 v145, v144
    s_nop 1
    v_permlane32_swap_b32 v144, v145
    v_max_f32 v144, v144, v145
    v_mov_b32 v145, v144
    s_nop 1
    v_permlane16_swap_b32 v144, v145
    v_max_f32 v144, v144, v145
    v_sub_f32 v128, v128, v144
    v_sub_f32 v129, v129, v144
    v_sub_f32 v130, v130, v144
    v_sub_f32 v131, v131, v144
    v_sub_f32 v132, v132, v144
    v_sub_f32 v133, v133, v144
    v_sub_f32 v134, v134, v144
    v_sub_f32 v135, v135, v144
    v_sub_f32 v136, v136, v144
    v_sub_f32 v137, v137, v144
    v_mul_f32 v128, s72, v128
    v_mul_f32 v129, s72, v129
    v_mul_f32 v130, s72, v130
    v_mul_f32 v131, s72, v131
    v_mul_f32 v132, s72, v132
    v_mul_f32 v133, s72, v133
    v_mul_f32 v134, s72, v134
    v_mul_f32 v135, s72, v135
    v_mul_f32 v136, s72, v136
    v_mul_f32 v137, s72, v137
    v_exp_f32 v128, v128
    v_exp_f32 v129, v129
    v_exp_f32 v130, v130
    v_exp_f32 v131, v131
    v_exp_f32 v132, v132
    v_exp_f32 v133, v133
    v_exp_f32 v134, v134
    v_exp_f32 v135, v135
    v_exp_f32 v136, v136
    v_exp_f32 v137, v137
    v_add_f32 v144, v128, v129
    v_add_f32 v144, v144, v130
    v_add_f32 v144, v144, v131
    v_add_f32 v144, v144, v132
    v_add_f32 v144, v144, v133
    v_add_f32 v144, v144, v134
    v_add_f32 v144, v144, v135
    v_add_f32 v144, v144, v136
    v_add_f32 v144, v144, v137
    v_mov_b32 v145, v144
    s_nop 1
    v_permlane32_swap_b32 v144, v145
    v_add_f32 v144, v144, v145
    v_mov_b32 v145, v144
    s_nop 1
    v_permlane16_swap_b32 v144, v145
    v_add_f32 v144, v144, v145
    v_rcp_f32 v144, v144
    s_nop 0
    v_mul_f32 v128, v128, v144
    v_mul_f32 v129, v129, v144
    v_mul_f32 v130, v130, v144
    v_mul_f32 v131, v131, v144
    v_mul_f32 v132, v132, v144
    v_mul_f32 v133, v133, v144
    v_mul_f32 v134, v134, v144
    v_mul_f32 v135, v135, v144
    v_mul_f32 v136, v136, v144
    v_mul_f32 v137, v137, v144
    v_cvt_pk_bf16_f32 v96, v128, v129
    v_cvt_pk_bf16_f32 v97, v130, v131
    v_cvt_pk_bf16_f32 v98, v132, v133
    v_cvt_pk_bf16_f32 v99, v134, v135
    v_cvt_pk_bf16_f32 v101, v136, v137
    v_cvt_pk_bf16_f32 v102, v136, v137
    v_mfma_f32_16x16x32_bf16 v[24:27], v[200:203], v[96:99], 0
    v_mfma_f32_16x16x32_bf16 v[28:31], v[204:207], v[96:99], 0
    v_mfma_f32_16x16x32_bf16 v[32:35], v[208:211], v[96:99], 0
    v_mfma_f32_16x16x32_bf16 v[36:39], v[212:215], v[96:99], 0
    v_mfma_f32_16x16x16_bf16 v[24:27], v[106:107], v[102:103], v[24:27]
    v_mfma_f32_16x16x16_bf16 v[28:31], v[106:107], v[100:101], v[28:31]
    v_mfma_f32_16x16x16_bf16 v[32:35], v[110:111], v[102:103], v[32:35]
    v_mfma_f32_16x16x16_bf16 v[36:39], v[110:111], v[100:101], v[36:39]
    s_cmp_lg_u32 s27, 0
    v_cvt_pk_bf16_f32 v24, v24, v25
    v_cvt_pk_bf16_f32 v25, v26, v27
    v_cvt_pk_bf16_f32 v26, v28, v29
    v_cvt_pk_bf16_f32 v27, v30, v31
    v_cvt_pk_bf16_f32 v32, v32, v33
    v_cvt_pk_bf16_f32 v33, v34, v35
    s_nop 0
    v_cvt_pk_bf16_f32 v34, v36, v37
    v_cvt_pk_bf16_f32 v35, v38, v39
    s_cbranch_scc1 W_oslow
    buffer_store_dwordx4 v[24:27], v4, s[8:11], s20 offen offset:0
    buffer_store_dwordx4 v[32:35], v4, s[8:11], s20 offen offset:1024
    s_branch W_odone
    W_oslow:
    buffer_store_dwordx4 v[24:27], v4, s[8:11], s20 offen offset:0 sc1
    buffer_store_dwordx4 v[32:35], v4, s[8:11], s20 offen offset:1024 sc1
    W_odone:
    v_mov_b64 v[16:17], v[12:13]
    s_mov_b32 s21, 0
    W_pre:
    buffer_load_dword v20, v6, s[8:11], s19 offen sc1
    s_add_u32 s21, s21, 1
    s_cmp_gt_u32 s21, 400000
    s_cbranch_scc1 F_fail
    s_waitcnt vmcnt(0)
    v_cmp_eq_u32 vcc, -1, v20
    s_cbranch_vccnz W_pre
    s_add_u32 s20, s19, 0
    buffer_load_dwordx4 v[24:27], v4, s[8:11], s20 offen offset:0 sc1
    buffer_load_dwordx4 v[28:31], v4, s[8:11], s20 offen offset:1024 sc1
    buffer_load_dwordx4 v[32:35], v4, s[8:11], s20 offen offset:2048 sc1
    buffer_load_dwordx4 v[36:39], v4, s[8:11], s20 offen offset:3072 sc1
    s_add_u32 s20, s19, 4096
    buffer_load_dwordx4 v[40:43], v4, s[8:11], s20 offen offset:0 sc1
    buffer_load_dwordx4 v[44:47], v4, s[8:11], s20 offen offset:1024 sc1
    buffer_load_dwordx4 v[48:51], v4, s[8:11], s20 offen offset:2048 sc1
    buffer_load_dwordx4 v[52:55], v4, s[8:11], s20 offen offset:3072 sc1
    s_add_u32 s20, s19, 8192
    buffer_load_dwordx4 v[56:59], v4, s[8:11], s20 offen offset:0 sc1
    buffer_load_dwordx4 v[60:63], v4, s[8:11], s20 offen offset:1024 sc1
    buffer_load_dwordx4 v[64:67], v4, s[8:11], s20 offen offset:2048 sc1
    buffer_load_dwordx4 v[68:71], v4, s[8:11], s20 offen offset:3072 sc1
    s_add_u32 s20, s19, 12288
    buffer_load_dwordx4 v[72:75], v4, s[8:11], s20 offen offset:0 sc1
    buffer_load_dwordx4 v[76:79], v4, s[8:11], s20 offen offset:1024 sc1
    buffer_load_dwordx4 v[80:83], v4, s[8:11], s20 offen offset:2048 sc1
    buffer_load_dwordx4 v[84:87], v4, s[8:11], s20 offen offset:3072 sc1
    s_add_u32 s20, s19, 16384
    buffer_load_dwordx4 v[88:91], v4, s[8:11], s20 offen offset:0 sc1
    buffer_load_dwordx4 v[92:95], v4, s[8:11], s20 offen offset:1024 sc1
    buffer_load_dwordx4 v[96:99], v4, s[8:11], s20 offen offset:2048 sc1
    buffer_load_dwordx4 v[100:103], v4, s[8:11], s20 offen offset:3072 sc1
    s_add_u32 s20, s19, 20480
    buffer_load_dwordx4 v[104:107], v4, s[8:11], s20 offen offset:0 sc1
    buffer_load_dwordx4 v[108:111], v4, s[8:11], s20 offen offset:1024 sc1
    buffer_load_dwordx4 v[112:115], v4, s[8:11], s20 offen offset:2048 sc1
    buffer_load_dwordx4 v[116:119], v4, s[8:11], s20 offen offset:3072 sc1
    s_add_u32 s20, s19, 24576
    buffer_load_dwordx4 v[120:123], v4, s[8:11], s20 offen offset:0 sc1
    buffer_load_dwordx4 v[124:127], v4, s[8:11], s20 offen offset:1024 sc1
    buffer_load_dwordx4 v[128:131], v4, s[8:11], s20 offen offset:2048 sc1
    buffer_load_dwordx4 v[132:135], v4, s[8:11], s20 offen offset:3072 sc1
    s_add_u32 s20, s19, 28672
    buffer_load_dwordx4 v[136:139], v4, s[8:11], s20 offen offset:0 sc1
    buffer_load_dwordx4 v[140:143], v4, s[8:11], s20 offen offset:1024 sc1
    buffer_load_dwordx4 v[144:147], v4, s[8:11], s20 offen offset:2048 sc1
    buffer_load_dwordx4 v[148:151], v4, s[8:11], s20 offen offset:3072 sc1
    s_waitcnt vmcnt(31)
    v_mfma_f32_16x16x32_bf16 v[216:219], a[0:3], v[24:27], 0
    v_max3_u32 v20, v20, v24, v25
    v_mfma_f32_16x16x32_bf16 v[220:223], a[4:7], v[24:27], 0
    v_max3_u32 v20, v20, v26, v27
    s_waitcnt vmcnt(30)
    v_mfma_f32_16x16x32_bf16 v[216:219], a[8:11], v[28:31], v[216:219]
    v_max3_u32 v20, v20, v28, v29
    v_mfma_f32_16x16x32_bf16 v[220:223], a[12:15], v[28:31], v[220:223]
    v_max3_u32 v20, v20, v30, v31
    s_waitcnt vmcnt(29)
    v_mfma_f32_16x16x32_bf16 v[216:219], a[16:19], v[32:35], v[216:219]
    v_max3_u32 v20, v20, v32, v33
    v_mfma_f32_16x16x32_bf16 v[220:223], a[20:23], v[32:35], v[220:223]
    v_max3_u32 v20, v20, v34, v35
    s_waitcnt vmcnt(28)
    v_mfma_f32_16x16x32_bf16 v[216:219], a[24:27], v[36:39], v[216:219]
    v_max3_u32 v20, v20, v36, v37
    v_mfma_f32_16x16x32_bf16 v[220:223], a[28:31], v[36:39], v[220:223]
    v_max3_u32 v20, v20, v38, v39
    s_waitcnt vmcnt(27)
    v_mfma_f32_16x16x32_bf16 v[216:219], a[32:35], v[40:43], v[216:219]
    v_max3_u32 v20, v20, v40, v41
    v_mfma_f32_16x16x32_bf16 v[220:223], a[36:39], v[40:43], v[220:223]
    v_max3_u32 v20, v20, v42, v43
    s_waitcnt vmcnt(26)
    v_mfma_f32_16x16x32_bf16 v[216:219], a[40:43], v[44:47], v[216:219]
    v_max3_u32 v20, v20, v44, v45
    v_mfma_f32_16x16x32_bf16 v[220:223], a[44:47], v[44:47], v[220:223]
    v_max3_u32 v20, v20, v46, v47
    s_waitcnt vmcnt(25)
    v_mfma_f32_16x16x32_bf16 v[216:219], a[48:51], v[48:51], v[216:219]
    v_max3_u32 v20, v20, v48, v49
    v_mfma_f32_16x16x32_bf16 v[220:223], a[52:55], v[48:51], v[220:223]
    v_max3_u32 v20, v20, v50, v51
    s_waitcnt vmcnt(24)
    v_mfma_f32_16x16x32_bf16 v[216:219], a[56:59], v[52:55], v[216:219]
    v_max3_u32 v20, v20, v52, v53
    v_mfma_f32_16x16x32_bf16 v[220:223], a[60:63], v[52:55], v[220:223]
    v_max3_u32 v20, v20, v54, v55
    s_waitcnt vmcnt(23)
    v_mfma_f32_16x16x32_bf16 v[216:219], a[64:67], v[56:59], v[216:219]
    v_max3_u32 v20, v20, v56, v57
    v_mfma_f32_16x16x32_bf16 v[220:223], a[68:71], v[56:59], v[220:223]
    v_max3_u32 v20, v20, v58, v59
    s_waitcnt vmcnt(22)
    v_mfma_f32_16x16x32_bf16 v[216:219], a[72:75], v[60:63], v[216:219]
    v_max3_u32 v20, v20, v60, v61
    v_mfma_f32_16x16x32_bf16 v[220:223], a[76:79], v[60:63], v[220:223]
    v_max3_u32 v20, v20, v62, v63
    s_waitcnt vmcnt(21)
    v_mfma_f32_16x16x32_bf16 v[216:219], a[80:83], v[64:67], v[216:219]
    v_max3_u32 v20, v20, v64, v65
    v_mfma_f32_16x16x32_bf16 v[220:223], a[84:87], v[64:67], v[220:223]
    v_max3_u32 v20, v20, v66, v67
    s_waitcnt vmcnt(20)
    v_mfma_f32_16x16x32_bf16 v[216:219], a[88:91], v[68:71], v[216:219]
    v_max3_u32 v20, v20, v68, v69
    v_mfma_f32_16x16x32_bf16 v[220:223], a[92:95], v[68:71], v[220:223]
    v_max3_u32 v20, v20, v70, v71
    s_waitcnt vmcnt(19)
    v_mfma_f32_16x16x32_bf16 v[216:219], a[96:99], v[72:75], v[216:219]
    v_max3_u32 v20, v20, v72, v73
    v_mfma_f32_16x16x32_bf16 v[220:223], a[100:103], v[72:75], v[220:223]
    v_max3_u32 v20, v20, v74, v75
    s_waitcnt vmcnt(18)
    v_mfma_f32_16x16x32_bf16 v[216:219], a[104:107], v[76:79], v[216:219]
    v_max3_u32 v20, v20, v76, v77
    v_mfma_f32_16x16x32_bf16 v[220:223], a[108:111], v[76:79], v[220:223]
    v_max3_u32 v20, v20, v78, v79
    s_waitcnt vmcnt(17)
    v_mfma_f32_16x16x32_bf16 v[216:219], a[112:115], v[80:83], v[216:219]
    v_max3_u32 v20, v20, v80, v81
    v_mfma_f32_16x16x32_bf16 v[220:223], a[116:119], v[80:83], v[220:223]
    v_max3_u32 v20, v20, v82, v83
    s_waitcnt vmcnt(16)
    v_mfma_f32_16x16x32_bf16 v[216:219], a[120:123], v[84:87], v[216:219]
    v_max3_u32 v20, v20, v84, v85
    v_mfma_f32_16x16x32_bf16 v[220:223], a[124:127], v[84:87], v[220:223]
    v_max3_u32 v20, v20, v86, v87
    s_waitcnt vmcnt(15)
    v_mfma_f32_16x16x32_bf16 v[216:219], a[128:131], v[88:91], v[216:219]
    v_max3_u32 v20, v20, v88, v89
    v_mfma_f32_16x16x32_bf16 v[220:223], a[132:135], v[88:91], v[220:223]
    v_max3_u32 v20, v20, v90, v91
    s_waitcnt vmcnt(14)
    v_mfma_f32_16x16x32_bf16 v[216:219], a[136:139], v[92:95], v[216:219]
    v_max3_u32 v20, v20, v92, v93
    v_mfma_f32_16x16x32_bf16 v[220:223], a[140:143], v[92:95], v[220:223]
    v_max3_u32 v20, v20, v94, v95
    s_waitcnt vmcnt(13)
    v_mfma_f32_16x16x32_bf16 v[216:219], a[144:147], v[96:99], v[216:219]
    v_max3_u32 v20, v20, v96, v97
    v_mfma_f32_16x16x32_bf16 v[220:223], a[148:151], v[96:99], v[220:223]
    v_max3_u32 v20, v20, v98, v99
    s_waitcnt vmcnt(12)
    v_mfma_f32_16x16x32_bf16 v[216:219], a[152:155], v[100:103], v[216:219]
    v_max3_u32 v20, v20, v100, v101
    v_mfma_f32_16x16x32_bf16 v[220:223], a[156:159], v[100:103], v[220:223]
    v_max3_u32 v20, v20, v102, v103
    s_waitcnt vmcnt(11)
    v_mfma_f32_16x16x32_bf16 v[216:219], a[160:163], v[104:107], v[216:219]
    v_max3_u32 v20, v20, v104, v105
    v_mfma_f32_16x16x32_bf16 v[220:223], a[164:167], v[104:107], v[220:223]
    v_max3_u32 v20, v20, v106, v107
    s_waitcnt vmcnt(10)
    v_mfma_f32_16x16x32_bf16 v[216:219], a[168:171], v[108:111], v[216:219]
    v_max3_u32 v20, v20, v108, v109
    v_mfma_f32_16x16x32_bf16 v[220:223], a[172:175], v[108:111], v[220:223]
    v_max3_u32 v20, v20, v110, v111
    s_waitcnt vmcnt(9)
    v_mfma_f32_16x16x32_bf16 v[216:219], a[176:179], v[112:115], v[216:219]
    v_max3_u32 v20, v20, v112, v113
    v_mfma_f32_16x16x32_bf16 v[220:223], a[180:183], v[112:115], v[220:223]
    v_max3_u32 v20, v20, v114, v115
    s_waitcnt vmcnt(8)
    v_mfma_f32_16x16x32_bf16 v[216:219], a[184:187], v[116:119], v[216:219]
    v_max3_u32 v20, v20, v116, v117
    v_mfma_f32_16x16x32_bf16 v[220:223], a[188:191], v[116:119], v[220:223]
    v_max3_u32 v20, v20, v118, v119
    s_waitcnt vmcnt(7)
    v_mfma_f32_16x16x32_bf16 v[216:219], a[192:195], v[120:123], v[216:219]
    v_max3_u32 v20, v20, v120, v121
    v_mfma_f32_16x16x32_bf16 v[220:223], a[196:199], v[120:123], v[220:223]
    v_max3_u32 v20, v20, v122, v123
    s_waitcnt vmcnt(6)
    v_mfma_f32_16x16x32_bf16 v[216:219], a[200:203], v[124:127], v[216:219]
    v_max3_u32 v20, v20, v124, v125
    v_mfma_f32_16x16x32_bf16 v[220:223], a[204:207], v[124:127], v[220:223]
    v_max3_u32 v20, v20, v126, v127
    s_waitcnt vmcnt(5)
    v_mfma_f32_16x16x32_bf16 v[216:219], a[208:211], v[128:131], v[216:219]
    v_max3_u32 v20, v20, v128, v129
    v_mfma_f32_16x16x32_bf16 v[220:223], a[212:215], v[128:131], v[220:223]
    v_max3_u32 v20, v20, v130, v131
    s_waitcnt vmcnt(4)
    v_mfma_f32_16x16x32_bf16 v[216:219], a[216:219], v[132:135], v[216:219]
    v_max3_u32 v20, v20, v132, v133
    v_mfma_f32_16x16x32_bf16 v[220:223], a[220:223], v[132:135], v[220:223]
    v_max3_u32 v20, v20, v134, v135
    s_waitcnt vmcnt(3)
    v_mfma_f32_16x16x32_bf16 v[216:219], a[224:227], v[136:139], v[216:219]
    v_max3_u32 v20, v20, v136, v137
    v_mfma_f32_16x16x32_bf16 v[220:223], a[228:231], v[136:139], v[220:223]
    v_max3_u32 v20, v20, v138, v139
    s_waitcnt vmcnt(2)
    v_mfma_f32_16x16x32_bf16 v[216:219], a[232:235], v[140:143], v[216:219]
    v_max3_u32 v20, v20, v140, v141
    v_mfma_f32_16x16x32_bf16 v[220:223], a[236:239], v[140:143], v[220:223]
    v_max3_u32 v20, v20, v142, v143
    s_waitcnt vmcnt(1)
    v_mfma_f32_16x16x32_bf16 v[216:219], a[240:243], v[144:147], v[216:219]
    v_max3_u32 v20, v20, v144, v145
    v_mfma_f32_16x16x32_bf16 v[220:223], a[244:247], v[144:147], v[220:223]
    v_max3_u32 v20, v20, v146, v147
    s_waitcnt vmcnt(0)
    v_mfma_f32_16x16x32_bf16 v[216:219], a[248:251], v[148:151], v[216:219]
    v_max3_u32 v20, v20, v148, v149
    v_mfma_f32_16x16x32_bf16 v[220:223], a[252:255], v[148:151], v[220:223]
    v_max3_u32 v20, v20, v150, v151
    v_cmp_eq_u32 vcc, -1, v20
    s_cbranch_vccnz W_pre
    s_nop 0
    ds_write_b128 v8, v[216:219]
    s_nop 2
    ds_write_b128 v8, v[220:223] offset:1024
    s_add_u32 s31, s42, 14
    s_cmp_ge_u32 s31, 128
    s_cbranch_scc1 W_nopf
    s_lshr_b32 s29, s31, 1
    s_lshl_b32 s29, s29, 18
    s_lshl_b32 s30, s24, 13
    s_add_u32 s29, s29, s30
    s_and_b32 s30, s42, 1
    s_lshl_b32 s30, s30, 12
    s_add_u32 s30, s30, s29
    s_add_u32 s30, s30, 0x2400000
    buffer_load_dwordx4 v[152:155], v4, s[8:11], s30 offen offset:0 sc1
    buffer_load_dwordx4 v[156:159], v4, s[8:11], s30 offen offset:1024 sc1
    buffer_load_dwordx4 v[160:163], v4, s[8:11], s30 offen offset:2048 sc1
    buffer_load_dwordx4 v[164:167], v4, s[8:11], s30 offen offset:3072 sc1
    s_add_u32 s30, s29, 0x400000
    buffer_load_dwordx4 v[168:171], v4, s[8:11], s30 offen offset:0 sc1
    buffer_load_dwordx4 v[172:175], v4, s[8:11], s30 offen offset:1024 sc1
    buffer_load_dwordx4 v[176:179], v4, s[8:11], s30 offen offset:2048 sc1
    buffer_load_dwordx4 v[180:183], v4, s[8:11], s30 offen offset:3072 sc1
    s_add_u32 s30, s29, 0x401000
    buffer_load_dwordx4 v[184:187], v4, s[8:11], s30 offen offset:0 sc1
    buffer_load_dwordx4 v[188:191], v4, s[8:11], s30 offen offset:1024 sc1
    buffer_load_dwordx4 v[192:195], v4, s[8:11], s30 offen offset:2048 sc1
    buffer_load_dwordx4 v[196:199], v4, s[8:11], s30 offen offset:3072 sc1
    s_and_b32 s30, s17, 1
    s_lshl_b32 s30, s30, 12
    s_add_u32 s30, s30, s29
    s_add_u32 s30, s30, 0x1400000
    buffer_load_dwordx4 v[200:203], v4, s[8:11], s30 offen offset:0 sc1
    buffer_load_dwordx4 v[204:207], v4, s[8:11], s30 offen offset:1024 sc1
    buffer_load_dwordx4 v[208:211], v4, s[8:11], s30 offen offset:2048 sc1
    buffer_load_dwordx4 v[212:215], v4, s[8:11], s30 offen offset:3072 sc1
    s_lshl_b32 s30, s31, 14
    buffer_load_dwordx2 v[12:13], v10, s[48:51], s30 offen
    s_lshr_b32 s30, s31, 1
    s_add_u32 s30, s30, 1
    s_cmp_gt_u32 s32, s30
    s_cselect_b32 s33, 1, 0
    s_cbranch_scc0 PK_21
    s_lshr_b32 s29, s29, 1
    s_and_b32 s30, s17, 1
    s_lshl_b32 s30, s30, 11
    s_add_u32 s29, s29, s30
    s_add_u32 s29, s29, 0x3400000
    s_xor_b32 s30, s29, 0x800
    buffer_load_dwordx4 v[104:107], v4, s[8:11], s29 offen offset:0 sc1
    buffer_load_dwordx4 v[108:111], v4, s[8:11], s29 offen offset:1024 sc1
    buffer_load_dwordx4 v[112:115], v4, s[8:11], s30 offen offset:0 sc1
    buffer_load_dwordx4 v[116:119], v4, s[8:11], s30 offen offset:1024 sc1
    PK_21:
    W_nopf:
    v_lshlrev_b32 v28, 16, v16
    v_and_b32 v29, 0xffff0000, v16
    v_lshlrev_b32 v30, 16, v17
    v_and_b32 v31, 0xffff0000, v17
    s_add_u32 s23, s23, s28
    s_waitcnt lgkmcnt(0)
    s_barrier
    ds_read_b128 v[216:219], v19 offset:0
    ds_read_b128 v[220:223], v19 offset:4096
    ds_read_b128 v[224:227], v19 offset:8192
    ds_read_b128 v[228:231], v19 offset:12288
    v_mov_b64 v[32:33], -1
    v_mov_b64 v[34:35], -1
    s_add_u32 s20, s35, s37
    s_mov_b32 s22, s35
    s_mov_b32 s35, s34
    s_mov_b32 s34, s38
    s_mov_b32 s38, s22
    s_cmp_lg_u32 s27, 0
    s_cbranch_scc1 W_cslow
    buffer_store_dwordx4 v[32:35], v4, s[8:11], s20 offen
    buffer_store_dwordx4 v[32:35], v4, s[8:11], s20 offen offset:1024
    s_branch W_cdone
    W_cslow:
    buffer_store_dwordx4 v[32:35], v4, s[8:11], s20 offen sc1
    buffer_store_dwordx4 v[32:35], v4, s[8:11], s20 offen offset:1024 sc1
    W_cdone:
    v_xor_b32 v8, 0x800, v8
    v_xor_b32 v19, 0x800, v19
    s_waitcnt lgkmcnt(2)
    v_add_f32 v216, v216, v220
    v_add_f32 v217, v217, v221
    v_add_f32 v218, v218, v222
    v_add_f32 v219, v219, v223
    s_waitcnt lgkmcnt(0)
    v_add_f32 v224, v224, v228
    v_add_f32 v225, v225, v229
    v_add_f32 v226, v226, v230
    v_add_f32 v227, v227, v231
    v_add_f32 v24, v216, v224
    v_add_f32 v25, v217, v225
    v_add_f32 v26, v218, v226
    v_add_f32 v27, v219, v227
    v_cvt_pk_bf16_f32 v25, v24, v25
    v_lshlrev_b32 v24, 16, v25
    v_and_b32 v25, 0xffff0000, v25
    v_cvt_pk_bf16_f32 v27, v26, v27
    v_lshlrev_b32 v26, 16, v27
    v_and_b32 v27, 0xffff0000, v27
    v_mul_f32 v24, v24, v232
    v_mul_f32 v25, v25, v233
    v_mul_f32 v26, v26, v234
    v_mul_f32 v27, v27, v235
    v_cvt_pk_bf16_f32 v25, v24, v25
    v_lshlrev_b32 v24, 16, v25
    v_and_b32 v25, 0xffff0000, v25
    v_cvt_pk_bf16_f32 v27, v26, v27
    v_lshlrev_b32 v26, 16, v27
    v_and_b32 v27, 0xffff0000, v27
    v_add_f32 v24, v24, v28
    v_add_f32 v25, v25, v29
    v_add_f32 v26, v26, v30
    v_add_f32 v27, v27, v31
    v_cvt_pk_bf16_f32 v24, v24, v25
    v_cvt_pk_bf16_f32 v25, v26, v27
    buffer_store_dwordx2 v[24:25], v10, s[52:55], s23 offen
    s_xor_b32 s28, s28, 0x40000000
    s_add_u32 s42, s42, 14
    s_sub_u32 s19, s42, s41
    s_bitcmp1_b32 s19, 1
    s_cbranch_scc1 W_norot
    v_mov_b64 v[232:233], v[236:237]
    v_mov_b64 v[234:235], v[238:239]
    v_mov_b64 v[236:237], v[240:241]
    v_mov_b64 v[238:239], v[242:243]
    v_mov_b64 v[240:241], v[244:245]
    v_mov_b64 v[242:243], v[246:247]
    v_mov_b64 v[244:245], v[248:249]
    v_mov_b64 v[246:247], v[250:251]
    W_norot:
    s_cmp_lt_u32 s42, 128
    s_cbranch_scc1 W_seg
    s_endpgm
    F_fail:
    v_mov_b32 v32, 0xdead
    v_mov_b32 v33, 0
    s_mov_b64 exec, 1
    buffer_store_dword v32, v33, s[12:15], 0 offen
    F_exit:
    s_endpgm
    F_loser:
    v_mbcnt_lo_u32_b32 v1, -1, 0
    v_mbcnt_hi_u32_b32 v1, -1, v1
    s_lshl_b32 s19, s17, 6
    v_add_u32 v0, s19, v1
    v_lshlrev_b32 v4, 4, v1
    v_mov_b32 v3, 0x27000
    s_waitcnt vmcnt(0) lgkmcnt(0)
    s_barrier
    s_cmp_lg_u32 s17, 0
    s_cbranch_scc1 F_lwait
    s_lshl_b32 s19, s3, 2
    s_add_u32 s19, s19, 96
    v_mov_b32 v5, s19
    v_mov_b32 v6, 1
    s_mov_b64 exec, 1
    buffer_atomic_add v6, v5, s[12:15], 0 offen sc0 sc1
    s_waitcnt vmcnt(0)
    s_mov_b64 exec, -1
    v_readfirstlane_b32 s16, v6
    v_and_b32 v5, 15, v1
    v_lshlrev_b32 v5, 2, v5
    s_mov_b32 s21, 0
    F_ovf:
    buffer_load_dword v6, v5, s[12:15], 0 offen offset:64 sc1
    s_add_u32 s21, s21, 1
    s_cmp_gt_u32 s21, 400000
    s_cbranch_scc1 F_fail
    s_waitcnt vmcnt(0)
    s_mov_b32 s19, 0
    v_readlane_b32 s40, v6, 0
    v_readlane_b32 s41, v6, 1
    v_readlane_b32 s42, v6, 2
    v_readlane_b32 s43, v6, 3
    v_readlane_b32 s44, v6, 4
    v_readlane_b32 s45, v6, 5
    v_readlane_b32 s46, v6, 6
    v_readlane_b32 s47, v6, 7
    v_readlane_b32 s48, v6, 8
    v_readlane_b32 s49, v6, 9
    v_readlane_b32 s50, v6, 10
    v_readlane_b32 s51, v6, 11
    v_readlane_b32 s52, v6, 12
    v_readlane_b32 s53, v6, 13
    v_readlane_b32 s54, v6, 14
    v_readlane_b32 s55, v6, 15
    s_bcnt0_i32_b32 s56, s40
    s_add_u32 s19, s19, s48
    s_sub_u32 s19, s19, s56
    s_bcnt0_i32_b32 s57, s41
    s_add_u32 s19, s19, s49
    s_sub_u32 s19, s19, s57
    s_bcnt0_i32_b32 s58, s42
    s_add_u32 s19, s19, s50
    s_sub_u32 s19, s19, s58
    s_bcnt0_i32_b32 s59, s43
    s_add_u32 s19, s19, s51
    s_sub_u32 s19, s19, s59
    s_bcnt0_i32_b32 s60, s44
    s_add_u32 s19, s19, s52
    s_sub_u32 s19, s19, s60
    s_bcnt0_i32_b32 s61, s45
    s_add_u32 s19, s19, s53
    s_sub_u32 s19, s19, s61
    s_bcnt0_i32_b32 s62, s46
    s_add_u32 s19, s19, s54
    s_sub_u32 s19, s19, s62
    s_bcnt0_i32_b32 s63, s47
    s_add_u32 s19, s19, s55
    s_sub_u32 s19, s19, s63
    s_cmp_lg_u32 s19, 0
    s_cbranch_scc1 F_ovf
    s_cmp_eq_u32 s3, 0
    s_cselect_b32 s22, s40, s22
    s_cmp_eq_u32 s3, 1
    s_cselect_b32 s22, s41, s22
    s_cmp_eq_u32 s3, 2
    s_cselect_b32 s22, s42, s22
    s_cmp_eq_u32 s3, 3
    s_cselect_b32 s22, s43, s22
    s_cmp_eq_u32 s3, 4
    s_cselect_b32 s22, s44, s22
    s_cmp_eq_u32 s3, 5
    s_cselect_b32 s22, s45, s22
    s_cmp_eq_u32 s3, 6
    s_cselect_b32 s22, s46, s22
    s_cmp_eq_u32 s3, 7
    s_cselect_b32 s22, s47, s22
    s_bcnt0_i32_b32 s19, s22
    s_mov_b32 s23, s3
    s_cmp_lt_u32 s16, s19
    s_cbranch_scc1 F_pick
    s_sub_u32 s16, s16, s19
    s_max_u32 s19, s48, s56
    s_sub_u32 s19, s19, s56
    s_cmp_gt_u32 s3, 0
    s_cselect_b32 s19, s19, 0
    s_add_u32 s16, s16, s19
    s_max_u32 s19, s49, s57
    s_sub_u32 s19, s19, s57
    s_cmp_gt_u32 s3, 1
    s_cselect_b32 s19, s19, 0
    s_add_u32 s16, s16, s19
    s_max_u32 s19, s50, s58
    s_sub_u32 s19, s19, s58
    s_cmp_gt_u32 s3, 2
    s_cselect_b32 s19, s19, 0
    s_add_u32 s16, s16, s19
    s_max_u32 s19, s51, s59
    s_sub_u32 s19, s19, s59
    s_cmp_gt_u32 s3, 3
    s_cselect_b32 s19, s19, 0
    s_add_u32 s16, s16, s19
    s_max_u32 s19, s52, s60
    s_sub_u32 s19, s19, s60
    s_cmp_gt_u32 s3, 4
    s_cselect_b32 s19, s19, 0
    s_add_u32 s16, s16, s19
    s_max_u32 s19, s53, s61
    s_sub_u32 s19, s19, s61
    s_cmp_gt_u32 s3, 5
    s_cselect_b32 s19, s19, 0
    s_add_u32 s16, s16, s19
    s_max_u32 s19, s54, s62
    s_sub_u32 s19, s19, s62
    s_cmp_gt_u32 s3, 6
    s_cselect_b32 s19, s19, 0
    s_add_u32 s16, s16, s19
    s_max_u32 s19, s55, s63
    s_sub_u32 s19, s19, s63
    s_cmp_gt_u32 s3, 7
    s_cselect_b32 s19, s19, 0
    s_add_u32 s16, s16, s19
    s_max_u32 s20, s48, s56
    s_sub_u32 s20, s20, s48
    s_mov_b32 s19, s48
    s_mov_b32 s22, s40
    s_mov_b32 s23, 0
    s_cmp_lt_u32 s16, s20
    s_cbranch_scc1 F_ovf_done
    s_sub_u32 s16, s16, s20
    s_max_u32 s20, s49, s57
    s_sub_u32 s20, s20, s49
    s_mov_b32 s19, s49
    s_mov_b32 s22, s41
    s_mov_b32 s23, 1
    s_cmp_lt_u32 s16, s20
    s_cbranch_scc1 F_ovf_done
    s_sub_u32 s16, s16, s20
    s_max_u32 s20, s50, s58
    s_sub_u32 s20, s20, s50
    s_mov_b32 s19, s50
    s_mov_b32 s22, s42
    s_mov_b32 s23, 2
    s_cmp_lt_u32 s16, s20
    s_cbranch_scc1 F_ovf_done
    s_sub_u32 s16, s16, s20
    s_max_u32 s20, s51, s59
    s_sub_u32 s20, s20, s51
    s_mov_b32 s19, s51
    s_mov_b32 s22, s43
    s_mov_b32 s23, 3
    s_cmp_lt_u32 s16, s20
    s_cbranch_scc1 F_ovf_done
    s_sub_u32 s16, s16, s20
    s_max_u32 s20, s52, s60
    s_sub_u32 s20, s20, s52
    s_mov_b32 s19, s52
    s_mov_b32 s22, s44
    s_mov_b32 s23, 4
    s_cmp_lt_u32 s16, s20
    s_cbranch_scc1 F_ovf_done
    s_sub_u32 s16, s16, s20
    s_max_u32 s20, s53, s61
    s_sub_u32 s20, s20, s53
    s_mov_b32 s19, s53
    s_mov_b32 s22, s45
    s_mov_b32 s23, 5
    s_cmp_lt_u32 s16, s20
    s_cbranch_scc1 F_ovf_done
    s_sub_u32 s16, s16, s20
    s_max_u32 s20, s54, s62
    s_sub_u32 s20, s20, s54
    s_mov_b32 s19, s54
    s_mov_b32 s22, s46
    s_mov_b32 s23, 6
    s_cmp_lt_u32 s16, s20
    s_cbranch_scc1 F_ovf_done
    s_sub_u32 s16, s16, s20
    s_max_u32 s20, s55, s63
    s_sub_u32 s20, s20, s55
    s_mov_b32 s19, s55
    s_mov_b32 s22, s47
    s_mov_b32 s23, 7
    s_cmp_lt_u32 s16, s20
    s_cbranch_scc1 F_ovf_done
    s_sub_u32 s16, s16, s20
    s_branch F_fail
    F_ovf_done:
    s_add_u32 s16, s16, s19
    v_mov_b32 v5, 132
    v_mov_b32 v6, 1
    s_mov_b64 exec, 1
    buffer_store_dword v6, v5, s[12:15], 0 offen sc1
    s_waitcnt vmcnt(0)
    s_mov_b64 exec, -1
    F_pick:
    s_ff0_i32_b32 s19, s22
    s_bitset1_b32 s22, s19
    s_sub_u32 s16, s16, 1
    s_cbranch_scc0 F_pick
    s_lshl_b32 s23, s23, 5
    s_add_u32 s19, s19, s23
    v_mov_b32 v6, s19
    ds_write_b32 v3, v6
    s_waitcnt lgkmcnt(0)
    F_lwait:
    s_barrier
    ds_read_b32 v6, v3
    s_waitcnt lgkmcnt(0)
    v_readfirstlane_b32 s16, v6
    s_mov_b32 s18, 1
    s_barrier
    s_branch F_dispatch
.section .rodata,"a"
.p2align 6
.amdhsa_kernel fused_kernel
  .amdhsa_next_free_vgpr 512
  .amdhsa_next_free_sgpr 102
  .amdhsa_accum_offset 256
  .amdhsa_group_segment_fixed_size 0
  .amdhsa_kernarg_size 120
  .amdhsa_user_sgpr_count 2
  .amdhsa_user_sgpr_kernarg_segment_ptr 1
  .amdhsa_system_sgpr_workgroup_id_x 1
.end_amdhsa_kernel
```
